```python
import torch

def _softmax(x, axis=-1):
    return torch.softmax(x, dim=axis)
def _gelu(x):
    return torch.nn.functional.gelu(x, approximate="tanh")
def _silu(x):
    return torch.nn.functional.silu(x)
def _sigmoid(x):
    return torch.sigmoid(x)
def _layernorm(x, axis=-1, eps=1e-5):
    m = x.mean(dim=axis, keepdim=True)
    v = x.var(dim=axis, keepdim=True, unbiased=False)
    return (x - m) / torch.sqrt(v + eps)
def _scatter_add(tgt, idx, src, axis=0):
    return tgt.clone().index_add_(axis, idx, src)
def _segment_sum(src, seg, n):
    out = torch.zeros((n,) + src.shape[1:], dtype=src.dtype)
    return out.index_add_(0, seg, src)
def _pad(x, pw):
    flat = tuple(v for pair in reversed(pw) for v in pair)
    return torch.nn.functional.pad(x, flat)

kernel_name = 'parallel_sum__compressed_kv_cla__mixer_channel_mlp__prompt'

def setup_inputs():

    _w = (lambda a: (lambda t: t.to(torch.bfloat16) if t.is_floating_point() else t)(torch.as_tensor(a)))
    def _A_setup():
        B, H, Sq, Sk, D, M = 1, 32, 2048, 2048, 128, 512
        Dc = 4 * D
        return {
            "x": _w((lambda *s: torch.randn(*s, dtype=torch.bfloat16) * 0.05)(B, Sq, M)),
            "c_kv": _w((lambda *s: torch.randn(*s, dtype=torch.bfloat16) * 0.4)(B, Sk, Dc)),
            "w_q": _w((lambda *s: torch.randn(*s, dtype=torch.bfloat16) * 3.2)(M, H, D) * (M ** -0.5)),
            "w_uk": _w((lambda *s: torch.randn(*s, dtype=torch.bfloat16) * 3.2)(Dc, H, D) * (Dc ** -0.5)),
            "w_uv": _w((lambda *s: torch.randn(*s, dtype=torch.bfloat16) * 0.4)(Dc, H, D) * (Dc ** -0.5)),
            "w_o": _w((lambda *s: torch.randn(*s, dtype=torch.bfloat16) * 0.4)(H, D, M) * ((H * D) ** -0.5)),
        }
    _A_in = _A_setup()

    def _B_setup():
        B, S, D, F = 1, 2048, 512, 1376
        return {
            "x": _w((lambda *s: torch.randn(*s, dtype=torch.bfloat16) * 0.05)(B, S, D)),
            "w1": _w((lambda *s: torch.randn(*s, dtype=torch.bfloat16) * 0.8)(D, F) * (D ** -0.5)),
            "b1": _w((lambda *s: torch.randn(*s, dtype=torch.bfloat16) * 0.4)(F)),
            "w2": _w((lambda *s: torch.randn(*s, dtype=torch.bfloat16) * 0.05)(F, D) * (F ** -0.5)),
            "b2": _w((lambda *s: torch.randn(*s, dtype=torch.bfloat16) * 0.05)(D)),
        }
    _B_in = _B_setup()

    return {
        "A_x": _A_in["x"],
        "A_c_kv": _A_in["c_kv"],
        "A_w_q": _A_in["w_q"],
        "A_w_uk": _A_in["w_uk"],
        "A_w_uv": _A_in["w_uv"],
        "A_w_o": _A_in["w_o"],
        "B_x": _B_in["x"],
        "B_w1": _B_in["w1"],
        "B_b1": _B_in["b1"],
        "B_w2": _B_in["w2"],
        "B_b2": _B_in["b2"],
    }

def reference(A_x, A_c_kv, A_w_q, A_w_uk, A_w_uv, A_w_o, B_x, B_w1, B_b1, B_w2, B_b2):
    def _A_ref(x, c_kv, w_q, w_uk, w_uv, w_o):
        B, Sq, M = x.shape[0], x.shape[1], x.shape[2]
        Sk = c_kv.shape[1]
        H, D = w_q.shape[1], w_q.shape[2]
        q = torch.einsum("bqm,mhd->bhqd", x, w_q)
        k = torch.einsum("bkc,chd->bhkd", c_kv, w_uk)
        v = torch.einsum("bkc,chd->bhkd", c_kv, w_uv)
        scores = torch.einsum("bhqd,bhkd->bhqk", q, k) * (D ** -0.5)
        off = Sk - Sq
        qi = torch.arange(Sq)[:, None]
        kj = torch.arange(Sk)[None, :]
        cmask = kj <= (qi + off)
        scores = torch.where(cmask[None, None], scores, -1e9)
        p = _softmax(scores, axis=-1)
        ctx = torch.einsum("bhqk,bhkd->bhqd", p, v)
        return torch.einsum("bhqd,hdm->bqm", ctx, w_o)

    def _B_ref(x, w1, b1, w2, b2):
        y = _layernorm(x, axis=-1)
        h = _gelu(torch.einsum("bsd,df->bsf", y, w1) + b1)
        return torch.einsum("bsf,fd->bsd", h, w2) + b2

    x = A_x
    xn = _layernorm(x, axis=-1)
    return x + _A_ref(xn, A_c_kv, A_w_q, A_w_uk, A_w_uv, A_w_o) + _B_ref(xn, B_w1, B_b1, B_w2, B_b2)
```

```asm
; @launch grid=(256,1,1) block=(256,1,1) lds=163840
.amdgcn_target "amdgcn-amd-amdhsa--gfx950"
.text
.globl parallel_sum__compressed_kv_cla__mixer_channel_mlp__prompt_kernel
.p2align 8
.type parallel_sum__compressed_kv_cla__mixer_channel_mlp__prompt_kernel,@function
parallel_sum__compressed_kv_cla__mixer_channel_mlp__prompt_kernel:
  s_cmp_ge_u32 s2, 256
  s_cbranch_scc1 k1_end
  s_getpc_b64 s[4:5]
k1_kernel_pc1:
  v_lshlrev_b32 v14, 7, v0
  s_and_b32 s5, s5, 0xffff
  s_mov_b32 s6, k1_end-k1_kernel_pc1
  s_mov_b32 s7, 0x20000
  s_lshr_b32 s3, s2, 3
  s_lshl_b32 s3, s3, 15
  buffer_load_dword v15, v14, s[4:7], s3 offen
  s_load_dwordx4 s[84:87], s[0:1], 0
  s_load_dwordx4 s[88:91], s[0:1], 24
  s_load_dwordx4 s[92:95], s[0:1], 96
  s_load_dwordx2 s[96:97], s[0:1], 16
  s_load_dwordx2 s[98:99], s[0:1], 56
  v_and_b32 v1, 63, v0
  v_lshrrev_b32 v9, 6, v0
  s_and_b32 s28, s2, 7
  v_readfirstlane_b32 s32, v9
  s_lshr_b32 s29, s2, 3
  s_and_b32 s30, s29, 3
  s_lshl_b32 s33, s28, 2
  s_add_u32 s33, s33, s30
  s_lshr_b32 s35, s29, 2
  s_lshr_b32 s31, s32, 1
  v_lshlrev_b32 v2, 4, v1
  v_lshrrev_b32 v4, 4, v1
  v_and_b32 v5, 15, v1
  v_bfe_u32 v6, v1, 2, 2
  v_and_b32 v7, 3, v1
  v_and_b32 v8, 1, v4
  v_and_b32 v11, 7, v1
  s_lshl_b32 s48, s32, 12
  s_lshl_b32 s44, s32, 13
  v_lshlrev_b32 v9, 1, v4
  v_xor_b32 v9, v9, v5
  v_lshlrev_b32 v9, 4, v9
  v_lshl_add_u32 v9, v4, 13, v9
  s_lshl_b32 s28, s32, 17
  s_lshl_b32 s29, s33, 8
  s_add_u32 s28, s28, s29
  v_add_u32 v36, s28, v9
  v_add_u32 v37, 31744, v36
  v_xor_b32 v38, 128, v36
  v_add_u32 v38, 63488, v38
  v_add_u32 v39, 31744, v38
  s_and_b32 s28, s32, 1
  s_lshl_b32 s28, s28, 7
  v_xor_b32 v9, s28, v9
  s_lshl_b32 s28, s32, 16
  s_add_u32 s28, s28, s29
  v_add_u32 v46, s28, v9
  v_add_u32 v47, 31744, v46
  v_lshrrev_b32 v10, 3, v1
  v_xor_b32 v9, v11, v4
  v_lshlrev_b32 v9, 4, v9
  v_lshl_add_u32 v9, v10, 10, v9
  s_lshl_b32 s42, s35, 18
  s_lshl_b32 s28, s32, 16
  s_add_u32 s42, s42, s28
  v_add_u32 v32, s42, v9
  v_xor_b32 v33, 64, v32
  v_add_u32 v33, 7168, v33
  v_add_u32 v34, 14336, v32
  v_add_u32 v35, 14336, v33
  s_add_u32 s49, s35, s30
  s_and_b32 s49, s49, 1
  s_lshl_b32 s50, s32, 11
  s_lshl_b32 s45, s2, 3
  s_lshl_b32 s29, s32, 1
  s_add_u32 s45, s45, s29
  s_lshl_b32 s45, s45, 10
  s_waitcnt lgkmcnt(0)
  s_mov_b32 s24, s84
  s_and_b32 s25, s85, 0xffff
  s_mov_b32 s26, 0x200000
  s_mov_b32 s27, 0x20000
  buffer_load_dwordx4 v[224:227], v2, s[24:27], s45 offen
  buffer_load_dwordx4 v[228:231], v2, s[24:27], s45 offen offset:1024
  s_mov_b32 s12, s86
  s_and_b32 s13, s87, 0xffff
  s_mov_b32 s14, 0x200000
  s_mov_b32 s15, 0x20000
  s_mov_b32 s16, s88
  s_and_b32 s17, s89, 0xffff
  s_mov_b32 s18, 0x400000
  s_mov_b32 s19, 0x20000
  s_mov_b32 s20, s90
  s_and_b32 s21, s91, 0xffff
  s_mov_b32 s22, 0x400000
  s_mov_b32 s23, 0x20000
  s_add_u32 m0, s50, 0
  s_xor_b32 s36, s49, 0
  s_lshl_b32 s36, s36, 19
  buffer_load_dwordx4 v46, s[16:19], s36 offen offset:0 lds
  buffer_load_dwordx4 v47, s[16:19], s36 offen offset:1024 lds
  s_add_u32 m0, s50, 8192
  s_nop 0
  buffer_load_dwordx4 v46, s[20:23], s36 offen offset:0 lds
  buffer_load_dwordx4 v47, s[20:23], s36 offen offset:1024 lds
  s_add_u32 m0, s44, 65536
  s_xor_b32 s36, s49, 0
  s_lshl_b32 s36, s36, 7
  buffer_load_dwordx4 v32, s[12:15], s36 offen offset:0 lds
  buffer_load_dwordx4 v33, s[12:15], s36 offen offset:1024 lds
  buffer_load_dwordx4 v34, s[12:15], s36 offen offset:2048 lds
  buffer_load_dwordx4 v35, s[12:15], s36 offen offset:3072 lds
  s_add_u32 m0, s44, 69632
  s_xor_b32 s36, s49, 0
  s_lshl_b32 s36, s36, 7
  s_add_u32 s36, s36, 32768
  buffer_load_dwordx4 v32, s[12:15], s36 offen offset:0 lds
  buffer_load_dwordx4 v33, s[12:15], s36 offen offset:1024 lds
  buffer_load_dwordx4 v34, s[12:15], s36 offen offset:2048 lds
  buffer_load_dwordx4 v35, s[12:15], s36 offen offset:3072 lds
  s_mov_b32 s8, s94
  s_and_b32 s9, s95, 0xffff
  s_mov_b32 s10, 0x4000000
  s_mov_b32 s11, 0x20000
  v_lshl_or_b32 v10, v8, 2, v6
  v_lshl_add_u32 v9, v4, 3, v6
  v_lshlrev_b32 v9, 8, v9
  v_lshl_add_u32 v9, v7, 3, v9
  s_lshl_b32 s28, s31, 13
  v_add_u32 v9, s28, v9
  v_xor_b32 v12, 0, v10
  v_lshl_add_u32 v16, v12, 5, v9
  v_xor_b32 v12, 1, v10
  v_lshl_add_u32 v17, v12, 5, v9
  v_xor_b32 v12, 2, v10
  v_lshl_add_u32 v18, v12, 5, v9
  v_xor_b32 v12, 3, v10
  v_lshl_add_u32 v19, v12, 5, v9
  v_xor_b32 v12, 4, v10
  v_lshl_add_u32 v20, v12, 5, v9
  v_xor_b32 v12, 5, v10
  v_lshl_add_u32 v21, v12, 5, v9
  v_xor_b32 v12, 6, v10
  v_lshl_add_u32 v22, v12, 5, v9
  v_xor_b32 v12, 7, v10
  v_lshl_add_u32 v23, v12, 5, v9
  v_lshrrev_b32 v10, 1, v5
  v_xor_b32 v10, v10, v4
  v_lshlrev_b32 v10, 4, v10
  v_lshl_add_u32 v10, v5, 7, v10
  s_and_b32 s28, s32, 1
  s_lshl_b32 s28, s28, 14
  s_add_u32 s28, s28, 65536
  v_add_u32 v40, s28, v10
  v_xor_b32 v41, 64, v40
  v_add_u32 v42, 65536, v40
  v_add_u32 v43, 65536, v41
  s_lshl_b32 s43, s33, 19
  s_lshl_b32 s29, s35, 16
  s_add_u32 s43, s43, s29
  s_and_b32 s29, s32, 1
  s_lshl_b32 s29, s29, 15
  s_add_u32 s43, s43, s29
  s_mov_b32 s29, 20971520
  s_cmp_eq_u32 s31, 0
  s_cselect_b32 s29, 4194304, s29
  s_add_u32 s43, s43, s29
  v_mov_b32 v233, 0
  s_lshl_b32 s53, s2, 2
  s_add_u32 s53, s53, 61935616
  s_lshl_b32 s54, s33, 7
  s_lshl_b32 s29, s35, 2
  s_add_u32 s54, s54, s29
  s_add_u32 s54, s54, 61939712
  s_lshl_b32 s55, s35, 8
  s_lshl_b32 s29, s33, 2
  s_add_u32 s55, s55, s29
  s_add_u32 s55, s55, 61931520
  s_and_b32 s29, s2, 1
  s_lshl_b32 s56, s29, 13
  s_bfe_u32 s29, s2, 0x30003
  s_lshl_b32 s29, s29, 10
  s_add_u32 s56, s56, s29
  s_lshr_b32 s29, s2, 6
  s_lshl_b32 s29, s29, 8
  s_add_u32 s56, s56, s29
  s_and_b32 s29, s2, 6
  s_lshl_b32 s29, s29, 1
  s_add_u32 s56, s56, s29
  s_add_u32 s56, s56, 61865984
  s_add_u32 s57, s55, 128
  v_mov_b32 v236, 0
  v_mov_b32 v237, 0
  s_cmp_lg_u32 s32, 0
  s_cbranch_scc1 k1_kernel_skip12
  s_mov_b64 exec, 1
  buffer_store_dword v237, v236, s[8:11], s53 offen sc1
  buffer_store_dword v237, v236, s[8:11], s54 offen sc1
  buffer_store_dword v237, v236, s[8:11], s55 offen sc1
  buffer_store_dword v237, v236, s[8:11], s56 offen sc1
  buffer_store_dword v237, v236, s[8:11], s57 offen sc1
  s_mov_b64 exec, -1
k1_kernel_skip12:
  s_mov_b32 s4, s92
  s_and_b32 s5, s93, 0xffff
  s_mov_b32 s6, 256
  s_mov_b32 s7, 0x20000
  s_waitcnt vmcnt(12)
  s_lshl_b32 s29, s32, 5
  s_add_u32 s29, s29, 131072
  v_lshlrev_b32 v232, 7, v1
  v_add_u32 v232, s29, v232
  s_lshl_b32 s29, s32, 4
  s_add_u32 s29, s29, 139264
  v_mov_b32 v234, s29
  v_lshlrev_b32 v92, 16, v224
  v_and_b32 v93, 0xffff0000, v224
  v_lshlrev_b32 v94, 16, v225
  v_and_b32 v95, 0xffff0000, v225
  v_lshlrev_b32 v96, 16, v226
  v_and_b32 v97, 0xffff0000, v226
  s_add_u32 m0, s50, 16384
  s_xor_b32 s36, s49, 0
  s_lshl_b32 s36, s36, 19
  s_add_u32 s36, s36, 262144
  v_lshlrev_b32 v98, 16, v227
  v_and_b32 v99, 0xffff0000, v227
  v_add_f32 v100, v92, v93
  v_add_f32 v100, v100, v94
  v_add_f32 v100, v100, v95
  v_add_f32 v100, v100, v96
  v_add_f32 v100, v100, v97
  v_add_f32 v100, v100, v98
  v_add_f32 v100, v100, v99
  s_nop 1
  v_add_f32_dpp v100, v100, v100 quad_perm:[1,0,3,2] row_mask:0xf bank_mask:0xf
  s_nop 1
  buffer_load_dwordx4 v46, s[16:19], s36 offen offset:0 lds
  v_add_f32_dpp v100, v100, v100 quad_perm:[2,3,0,1] row_mask:0xf bank_mask:0xf
  s_nop 1
  v_add_f32_dpp v100, v100, v100 row_half_mirror row_mask:0xf bank_mask:0xf
  s_nop 1
  v_add_f32_dpp v100, v100, v100 row_mirror row_mask:0xf bank_mask:0xf
  v_mov_b32 v101, v100
  s_nop 1
  v_permlane16_swap_b32 v100, v101
  v_add_f32 v100, v100, v101
  v_mov_b32 v101, v100
  s_nop 1
  v_permlane32_swap_b32 v100, v101
  buffer_load_dwordx4 v47, s[16:19], s36 offen offset:1024 lds
  v_add_f32 v100, v100, v101
  v_mul_f32 v102, 0x3b000000, v100
  v_sub_f32 v104, v92, v102
  v_mul_f32 v103, v104, v104
  v_sub_f32 v104, v93, v102
  v_fmac_f32 v103, v104, v104
  v_sub_f32 v104, v94, v102
  v_fmac_f32 v103, v104, v104
  v_sub_f32 v104, v95, v102
  v_fmac_f32 v103, v104, v104
  v_sub_f32 v104, v96, v102
  v_fmac_f32 v103, v104, v104
  s_add_u32 m0, s50, 24576
  s_nop 0
  v_sub_f32 v104, v97, v102
  v_fmac_f32 v103, v104, v104
  v_sub_f32 v104, v98, v102
  v_fmac_f32 v103, v104, v104
  v_sub_f32 v104, v99, v102
  v_fmac_f32 v103, v104, v104
  s_nop 1
  v_add_f32_dpp v103, v103, v103 quad_perm:[1,0,3,2] row_mask:0xf bank_mask:0xf
  s_nop 1
  v_add_f32_dpp v103, v103, v103 quad_perm:[2,3,0,1] row_mask:0xf bank_mask:0xf
  s_nop 1
  v_add_f32_dpp v103, v103, v103 row_half_mirror row_mask:0xf bank_mask:0xf
  buffer_load_dwordx4 v46, s[20:23], s36 offen offset:0 lds
  s_nop 1
  v_add_f32_dpp v103, v103, v103 row_mirror row_mask:0xf bank_mask:0xf
  v_mov_b32 v101, v103
  s_nop 1
  v_permlane16_swap_b32 v103, v101
  v_add_f32 v103, v103, v101
  v_mov_b32 v101, v103
  s_nop 1
  v_permlane32_swap_b32 v103, v101
  v_add_f32 v103, v103, v101
  v_mul_f32 v103, 0x3b000000, v103
  v_cvt_pk_bf16_f32 v102, v102, v102
  buffer_load_dwordx4 v47, s[20:23], s36 offen offset:1024 lds
  v_lshlrev_b32 v102, 16, v102
  v_cvt_pk_bf16_f32 v103, v103, v103
  v_lshlrev_b32 v103, 16, v103
  v_add_f32 v103, 0x3727c5ac, v103
  v_cvt_pk_bf16_f32 v103, v103, v103
  v_lshlrev_b32 v103, 16, v103
  v_sqrt_f32 v103, v103
  s_nop 0
  v_cvt_pk_bf16_f32 v103, v103, v103
  v_lshlrev_b32 v103, 16, v103
  v_rcp_f32 v105, v103
  v_sub_f32 v92, v92, v102
  s_add_u32 m0, s50, 32768
  s_xor_b32 s36, s49, 1
  s_lshl_b32 s36, s36, 19
  v_sub_f32 v93, v93, v102
  v_sub_f32 v94, v94, v102
  v_sub_f32 v95, v95, v102
  v_sub_f32 v96, v96, v102
  v_sub_f32 v97, v97, v102
  v_sub_f32 v98, v98, v102
  v_sub_f32 v99, v99, v102
  v_cvt_pk_bf16_f32 v101, v92, v93
  v_lshlrev_b32 v92, 16, v101
  v_and_b32 v93, 0xffff0000, v101
  v_cvt_pk_bf16_f32 v101, v94, v95
  v_lshlrev_b32 v94, 16, v101
  buffer_load_dwordx4 v46, s[16:19], s36 offen offset:0 lds
  v_and_b32 v95, 0xffff0000, v101
  v_cvt_pk_bf16_f32 v101, v96, v97
  v_lshlrev_b32 v96, 16, v101
  v_and_b32 v97, 0xffff0000, v101
  v_cvt_pk_bf16_f32 v101, v98, v99
  v_lshlrev_b32 v98, 16, v101
  v_and_b32 v99, 0xffff0000, v101
  v_mul_f32 v104, v92, v105
  v_fma_f32 v101, -v104, v103, v92
  v_fma_f32 v92, v101, v105, v104
  v_mul_f32 v104, v93, v105
  v_fma_f32 v101, -v104, v103, v93
  buffer_load_dwordx4 v47, s[16:19], s36 offen offset:1024 lds
  v_fma_f32 v93, v101, v105, v104
  v_mul_f32 v104, v94, v105
  v_fma_f32 v101, -v104, v103, v94
  v_fma_f32 v94, v101, v105, v104
  v_mul_f32 v104, v95, v105
  v_fma_f32 v101, -v104, v103, v95
  v_fma_f32 v95, v101, v105, v104
  v_mul_f32 v104, v96, v105
  v_fma_f32 v101, -v104, v103, v96
  v_fma_f32 v96, v101, v105, v104
  v_mul_f32 v104, v97, v105
  v_fma_f32 v101, -v104, v103, v97
  s_add_u32 m0, s50, 40960
  s_nop 0
  v_fma_f32 v97, v101, v105, v104
  v_mul_f32 v104, v98, v105
  v_fma_f32 v101, -v104, v103, v98
  v_fma_f32 v98, v101, v105, v104
  v_mul_f32 v104, v99, v105
  v_fma_f32 v101, -v104, v103, v99
  v_fma_f32 v99, v101, v105, v104
  v_cvt_pk_bf16_f32 v88, v92, v93
  v_cvt_pk_bf16_f32 v89, v94, v95
  v_cvt_pk_bf16_f32 v90, v96, v97
  v_cvt_pk_bf16_f32 v91, v98, v99
  v_lshlrev_b32 v92, 16, v88
  buffer_load_dwordx4 v46, s[20:23], s36 offen offset:0 lds
  v_and_b32 v93, 0xffff0000, v88
  v_lshlrev_b32 v94, 16, v89
  v_and_b32 v95, 0xffff0000, v89
  v_lshlrev_b32 v96, 16, v90
  v_and_b32 v97, 0xffff0000, v90
  v_lshlrev_b32 v98, 16, v91
  v_and_b32 v99, 0xffff0000, v91
  v_add_f32 v100, v92, v93
  v_add_f32 v100, v100, v94
  v_add_f32 v100, v100, v95
  v_add_f32 v100, v100, v96
  v_add_f32 v100, v100, v97
  buffer_load_dwordx4 v47, s[20:23], s36 offen offset:1024 lds
  v_add_f32 v100, v100, v98
  v_add_f32 v100, v100, v99
  s_nop 1
  v_add_f32_dpp v100, v100, v100 quad_perm:[1,0,3,2] row_mask:0xf bank_mask:0xf
  s_nop 1
  v_add_f32_dpp v100, v100, v100 quad_perm:[2,3,0,1] row_mask:0xf bank_mask:0xf
  s_nop 1
  v_add_f32_dpp v100, v100, v100 row_half_mirror row_mask:0xf bank_mask:0xf
  s_nop 1
  v_add_f32_dpp v100, v100, v100 row_mirror row_mask:0xf bank_mask:0xf
  v_mov_b32 v101, v100
  s_nop 1
  s_add_u32 m0, s44, 98304
  s_xor_b32 s36, s49, 1
  s_lshl_b32 s36, s36, 7
  v_permlane16_swap_b32 v100, v101
  v_add_f32 v100, v100, v101
  v_mov_b32 v101, v100
  s_nop 1
  v_permlane32_swap_b32 v100, v101
  v_add_f32 v100, v100, v101
  v_mul_f32 v102, 0x3b000000, v100
  v_sub_f32 v104, v92, v102
  v_mul_f32 v103, v104, v104
  v_sub_f32 v104, v93, v102
  v_fmac_f32 v103, v104, v104
  v_sub_f32 v104, v94, v102
  buffer_load_dwordx4 v32, s[12:15], s36 offen offset:0 lds
  v_fmac_f32 v103, v104, v104
  v_sub_f32 v104, v95, v102
  v_fmac_f32 v103, v104, v104
  v_sub_f32 v104, v96, v102
  v_fmac_f32 v103, v104, v104
  v_sub_f32 v104, v97, v102
  v_fmac_f32 v103, v104, v104
  v_sub_f32 v104, v98, v102
  v_fmac_f32 v103, v104, v104
  v_sub_f32 v104, v99, v102
  v_fmac_f32 v103, v104, v104
  s_nop 1
  buffer_load_dwordx4 v33, s[12:15], s36 offen offset:1024 lds
  v_add_f32_dpp v103, v103, v103 quad_perm:[1,0,3,2] row_mask:0xf bank_mask:0xf
  s_nop 1
  v_add_f32_dpp v103, v103, v103 quad_perm:[2,3,0,1] row_mask:0xf bank_mask:0xf
  s_nop 1
  v_add_f32_dpp v103, v103, v103 row_half_mirror row_mask:0xf bank_mask:0xf
  s_nop 1
  v_add_f32_dpp v103, v103, v103 row_mirror row_mask:0xf bank_mask:0xf
  v_mov_b32 v101, v103
  s_nop 1
  v_permlane16_swap_b32 v103, v101
  v_add_f32 v103, v103, v101
  v_mov_b32 v101, v103
  buffer_load_dwordx4 v34, s[12:15], s36 offen offset:2048 lds
  s_nop 1
  v_permlane32_swap_b32 v103, v101
  v_add_f32 v103, v103, v101
  v_mul_f32 v103, 0x3b000000, v103
  v_cvt_pk_bf16_f32 v102, v102, v102
  v_lshlrev_b32 v102, 16, v102
  v_cvt_pk_bf16_f32 v103, v103, v103
  v_lshlrev_b32 v103, 16, v103
  v_add_f32 v103, 0x3727c5ac, v103
  v_cvt_pk_bf16_f32 v103, v103, v103
  v_lshlrev_b32 v103, 16, v103
  v_sqrt_f32 v103, v103
  buffer_load_dwordx4 v35, s[12:15], s36 offen offset:3072 lds
  s_nop 0
  v_cvt_pk_bf16_f32 v103, v103, v103
  v_lshlrev_b32 v103, 16, v103
  v_rcp_f32 v105, v103
  v_mov_b32 v108, v102
  v_fma_f32 v101, -v103, v105, 1.0
  v_fma_f32 v109, v101, v105, v105
  ds_write_b128 v232, v[88:91] offset:0
  ds_write_b64 v234, v[108:109] offset:0
  s_waitcnt lgkmcnt(0)
  v_lshlrev_b32 v92, 16, v228
  v_and_b32 v93, 0xffff0000, v228
  s_add_u32 m0, s44, 102400
  s_xor_b32 s36, s49, 1
  s_lshl_b32 s36, s36, 7
  s_add_u32 s36, s36, 32768
  v_lshlrev_b32 v94, 16, v229
  v_and_b32 v95, 0xffff0000, v229
  v_lshlrev_b32 v96, 16, v230
  v_and_b32 v97, 0xffff0000, v230
  v_lshlrev_b32 v98, 16, v231
  v_and_b32 v99, 0xffff0000, v231
  v_add_f32 v100, v92, v93
  v_add_f32 v100, v100, v94
  v_add_f32 v100, v100, v95
  v_add_f32 v100, v100, v96
  v_add_f32 v100, v100, v97
  v_add_f32 v100, v100, v98
  buffer_load_dwordx4 v32, s[12:15], s36 offen offset:0 lds
  v_add_f32 v100, v100, v99
  s_nop 1
  v_add_f32_dpp v100, v100, v100 quad_perm:[1,0,3,2] row_mask:0xf bank_mask:0xf
  s_nop 1
  v_add_f32_dpp v100, v100, v100 quad_perm:[2,3,0,1] row_mask:0xf bank_mask:0xf
  s_nop 1
  v_add_f32_dpp v100, v100, v100 row_half_mirror row_mask:0xf bank_mask:0xf
  s_nop 1
  v_add_f32_dpp v100, v100, v100 row_mirror row_mask:0xf bank_mask:0xf
  v_mov_b32 v101, v100
  s_nop 1
  v_permlane16_swap_b32 v100, v101
  buffer_load_dwordx4 v33, s[12:15], s36 offen offset:1024 lds
  v_add_f32 v100, v100, v101
  v_mov_b32 v101, v100
  s_nop 1
  v_permlane32_swap_b32 v100, v101
  v_add_f32 v100, v100, v101
  v_mul_f32 v102, 0x3b000000, v100
  v_sub_f32 v104, v92, v102
  v_mul_f32 v103, v104, v104
  v_sub_f32 v104, v93, v102
  v_fmac_f32 v103, v104, v104
  v_sub_f32 v104, v94, v102
  v_fmac_f32 v103, v104, v104
  buffer_load_dwordx4 v34, s[12:15], s36 offen offset:2048 lds
  v_sub_f32 v104, v95, v102
  v_fmac_f32 v103, v104, v104
  v_sub_f32 v104, v96, v102
  v_fmac_f32 v103, v104, v104
  v_sub_f32 v104, v97, v102
  v_fmac_f32 v103, v104, v104
  v_sub_f32 v104, v98, v102
  v_fmac_f32 v103, v104, v104
  v_sub_f32 v104, v99, v102
  v_fmac_f32 v103, v104, v104
  s_nop 1
  v_add_f32_dpp v103, v103, v103 quad_perm:[1,0,3,2] row_mask:0xf bank_mask:0xf
  buffer_load_dwordx4 v35, s[12:15], s36 offen offset:3072 lds
  s_nop 1
  v_add_f32_dpp v103, v103, v103 quad_perm:[2,3,0,1] row_mask:0xf bank_mask:0xf
  s_nop 1
  v_add_f32_dpp v103, v103, v103 row_half_mirror row_mask:0xf bank_mask:0xf
  s_nop 1
  v_add_f32_dpp v103, v103, v103 row_mirror row_mask:0xf bank_mask:0xf
  v_mov_b32 v101, v103
  s_nop 1
  v_permlane16_swap_b32 v103, v101
  v_add_f32 v103, v103, v101
  v_mov_b32 v101, v103
  s_nop 1
  v_permlane32_swap_b32 v103, v101
  v_add_f32 v103, v103, v101
  v_mul_f32 v103, 0x3b000000, v103
  v_cvt_pk_bf16_f32 v102, v102, v102
  v_lshlrev_b32 v102, 16, v102
  v_cvt_pk_bf16_f32 v103, v103, v103
  v_lshlrev_b32 v103, 16, v103
  v_add_f32 v103, 0x3727c5ac, v103
  v_cvt_pk_bf16_f32 v103, v103, v103
  v_lshlrev_b32 v103, 16, v103
  v_sqrt_f32 v103, v103
  s_nop 0
  v_cvt_pk_bf16_f32 v103, v103, v103
  v_lshlrev_b32 v103, 16, v103
  v_rcp_f32 v105, v103
  v_sub_f32 v92, v92, v102
  v_sub_f32 v93, v93, v102
  v_sub_f32 v94, v94, v102
  v_sub_f32 v95, v95, v102
  v_sub_f32 v96, v96, v102
  v_sub_f32 v97, v97, v102
  v_sub_f32 v98, v98, v102
  v_sub_f32 v99, v99, v102
  v_cvt_pk_bf16_f32 v101, v92, v93
  v_lshlrev_b32 v92, 16, v101
  v_and_b32 v93, 0xffff0000, v101
  v_cvt_pk_bf16_f32 v101, v94, v95
  v_lshlrev_b32 v94, 16, v101
  v_and_b32 v95, 0xffff0000, v101
  v_cvt_pk_bf16_f32 v101, v96, v97
  v_lshlrev_b32 v96, 16, v101
  v_and_b32 v97, 0xffff0000, v101
  v_cvt_pk_bf16_f32 v101, v98, v99
  v_lshlrev_b32 v98, 16, v101
  v_and_b32 v99, 0xffff0000, v101
  v_mul_f32 v104, v92, v105
  v_fma_f32 v101, -v104, v103, v92
  v_fma_f32 v92, v101, v105, v104
  v_mul_f32 v104, v93, v105
  v_fma_f32 v101, -v104, v103, v93
  v_fma_f32 v93, v101, v105, v104
  v_mul_f32 v104, v94, v105
  v_fma_f32 v101, -v104, v103, v94
  v_fma_f32 v94, v101, v105, v104
  v_mul_f32 v104, v95, v105
  v_fma_f32 v101, -v104, v103, v95
  v_fma_f32 v95, v101, v105, v104
  v_mul_f32 v104, v96, v105
  v_fma_f32 v101, -v104, v103, v96
  v_fma_f32 v96, v101, v105, v104
  v_mul_f32 v104, v97, v105
  v_fma_f32 v101, -v104, v103, v97
  v_fma_f32 v97, v101, v105, v104
  v_mul_f32 v104, v98, v105
  v_fma_f32 v101, -v104, v103, v98
  v_fma_f32 v98, v101, v105, v104
  v_mul_f32 v104, v99, v105
  v_fma_f32 v101, -v104, v103, v99
  v_fma_f32 v99, v101, v105, v104
  v_cvt_pk_bf16_f32 v88, v92, v93
  v_cvt_pk_bf16_f32 v89, v94, v95
  v_cvt_pk_bf16_f32 v90, v96, v97
  v_cvt_pk_bf16_f32 v91, v98, v99
  v_lshlrev_b32 v92, 16, v88
  v_and_b32 v93, 0xffff0000, v88
  v_lshlrev_b32 v94, 16, v89
  v_and_b32 v95, 0xffff0000, v89
  v_lshlrev_b32 v96, 16, v90
  v_and_b32 v97, 0xffff0000, v90
  v_lshlrev_b32 v98, 16, v91
  v_and_b32 v99, 0xffff0000, v91
  v_add_f32 v100, v92, v93
  v_add_f32 v100, v100, v94
  v_add_f32 v100, v100, v95
  v_add_f32 v100, v100, v96
  v_add_f32 v100, v100, v97
  v_add_f32 v100, v100, v98
  v_add_f32 v100, v100, v99
  s_nop 1
  v_add_f32_dpp v100, v100, v100 quad_perm:[1,0,3,2] row_mask:0xf bank_mask:0xf
  s_nop 1
  v_add_f32_dpp v100, v100, v100 quad_perm:[2,3,0,1] row_mask:0xf bank_mask:0xf
  s_nop 1
  v_add_f32_dpp v100, v100, v100 row_half_mirror row_mask:0xf bank_mask:0xf
  s_nop 1
  v_add_f32_dpp v100, v100, v100 row_mirror row_mask:0xf bank_mask:0xf
  v_mov_b32 v101, v100
  s_nop 1
  v_permlane16_swap_b32 v100, v101
  v_add_f32 v100, v100, v101
  v_mov_b32 v101, v100
  s_nop 1
  v_permlane32_swap_b32 v100, v101
  v_add_f32 v100, v100, v101
  v_mul_f32 v102, 0x3b000000, v100
  v_sub_f32 v104, v92, v102
  v_mul_f32 v103, v104, v104
  v_sub_f32 v104, v93, v102
  v_fmac_f32 v103, v104, v104
  v_sub_f32 v104, v94, v102
  v_fmac_f32 v103, v104, v104
  v_sub_f32 v104, v95, v102
  v_fmac_f32 v103, v104, v104
  v_sub_f32 v104, v96, v102
  v_fmac_f32 v103, v104, v104
  v_sub_f32 v104, v97, v102
  v_fmac_f32 v103, v104, v104
  v_sub_f32 v104, v98, v102
  v_fmac_f32 v103, v104, v104
  v_sub_f32 v104, v99, v102
  v_fmac_f32 v103, v104, v104
  s_nop 1
  v_add_f32_dpp v103, v103, v103 quad_perm:[1,0,3,2] row_mask:0xf bank_mask:0xf
  s_nop 1
  v_add_f32_dpp v103, v103, v103 quad_perm:[2,3,0,1] row_mask:0xf bank_mask:0xf
  s_nop 1
  v_add_f32_dpp v103, v103, v103 row_half_mirror row_mask:0xf bank_mask:0xf
  s_nop 1
  v_add_f32_dpp v103, v103, v103 row_mirror row_mask:0xf bank_mask:0xf
  v_mov_b32 v101, v103
  s_nop 1
  v_permlane16_swap_b32 v103, v101
  v_add_f32 v103, v103, v101
  v_mov_b32 v101, v103
  s_nop 1
  v_permlane32_swap_b32 v103, v101
  v_add_f32 v103, v103, v101
  v_mul_f32 v103, 0x3b000000, v103
  v_cvt_pk_bf16_f32 v102, v102, v102
  v_lshlrev_b32 v102, 16, v102
  v_cvt_pk_bf16_f32 v103, v103, v103
  v_lshlrev_b32 v103, 16, v103
  v_add_f32 v103, 0x3727c5ac, v103
  v_cvt_pk_bf16_f32 v103, v103, v103
  v_lshlrev_b32 v103, 16, v103
  v_sqrt_f32 v103, v103
  s_nop 0
  v_cvt_pk_bf16_f32 v103, v103, v103
  v_lshlrev_b32 v103, 16, v103
  v_rcp_f32 v105, v103
  v_mov_b32 v108, v102
  v_fma_f32 v101, -v103, v105, 1.0
  v_fma_f32 v109, v101, v105, v105
  ds_write_b128 v232, v[88:91] offset:16
  ds_write_b64 v234, v[108:109] offset:8
  s_waitcnt lgkmcnt(0)
  s_lshl_b32 s29, s32, 11
  s_add_u32 s29, s29, 131072
  v_add_u32 v232, s29, v2
  v_lshrrev_b32 v235, 3, v1
  v_lshlrev_b32 v235, 8, v235
  v_lshl_add_u32 v235, v11, 4, v235
  s_lshr_b32 s46, s2, 1
  s_lshl_b32 s46, s46, 14
  s_and_b32 s29, s2, 1
  s_lshl_b32 s29, s29, 7
  s_add_u32 s46, s46, s29
  s_add_u32 s46, s46, s48
  s_lshl_b32 s47, s2, 6
  s_add_u32 s47, s47, 2097152
  v_and_b32 v234, 48, v2
  v_add_u32 v114, 139264, v234
  s_barrier
  ds_read_b128 v[84:87], v232
  ds_read_b128 v[88:91], v232 offset:1024
  ds_read_b128 v[92:95], v114
  s_waitcnt lgkmcnt(0)
  buffer_store_dwordx4 v[84:87], v235, s[8:11], s46 offen sc1
  buffer_store_dwordx4 v[88:91], v235, s[8:11], s46 offen offset:2048 sc1
  buffer_store_dwordx4 v[92:95], v234, s[8:11], s47 offen sc1
  s_cmp_lg_u32 s31, 0
  s_cbranch_scc1 k1_V
  s_waitcnt vmcnt(19)
  s_barrier
  ds_read_b64_tr_b16 v[52:53], v16 offset:0
  ds_read_b64_tr_b16 v[54:55], v16 offset:1024
  ds_read_b128 v[128:131], v40 offset:0
  ds_read_b128 v[132:135], v40 offset:2048
  ds_read_b128 v[136:139], v40 offset:4096
  ds_read_b128 v[140:143], v40 offset:6144
  ds_read_b128 v[144:147], v40 offset:8192
  ds_read_b128 v[148:151], v40 offset:10240
  ds_read_b128 v[152:155], v40 offset:12288
  ds_read_b128 v[156:159], v40 offset:14336
  ds_read_b64_tr_b16 v[56:57], v17 offset:0
  ds_read_b64_tr_b16 v[58:59], v17 offset:1024
  ds_read_b64_tr_b16 v[60:61], v18 offset:0
  ds_read_b64_tr_b16 v[62:63], v18 offset:1024
  ds_read_b64_tr_b16 v[64:65], v19 offset:0
  ds_read_b64_tr_b16 v[66:67], v19 offset:1024
  ds_read_b64_tr_b16 v[68:69], v20 offset:0
  ds_read_b64_tr_b16 v[70:71], v20 offset:1024
  s_waitcnt lgkmcnt(8)
  v_mfma_f32_16x16x32_bf16 a[0:3], v[52:55], v[128:131], 0
  ds_read_b64_tr_b16 v[72:73], v21 offset:0
  v_mfma_f32_16x16x32_bf16 a[32:35], v[52:55], v[132:135], 0
  ds_read_b64_tr_b16 v[74:75], v21 offset:1024
  v_mfma_f32_16x16x32_bf16 a[64:67], v[52:55], v[136:139], 0
  v_mfma_f32_16x16x32_bf16 a[96:99], v[52:55], v[140:143], 0
  v_mfma_f32_16x16x32_bf16 a[128:131], v[52:55], v[144:147], 0
  v_mfma_f32_16x16x32_bf16 a[160:163], v[52:55], v[148:151], 0
  v_mfma_f32_16x16x32_bf16 a[192:195], v[52:55], v[152:155], 0
  v_mfma_f32_16x16x32_bf16 a[224:227], v[52:55], v[156:159], 0
  s_waitcnt lgkmcnt(8)
  v_mfma_f32_16x16x32_bf16 a[4:7], v[56:59], v[128:131], 0
  ds_read_b64_tr_b16 v[76:77], v22 offset:0
  v_mfma_f32_16x16x32_bf16 a[36:39], v[56:59], v[132:135], 0
  ds_read_b64_tr_b16 v[78:79], v22 offset:1024
  v_mfma_f32_16x16x32_bf16 a[68:71], v[56:59], v[136:139], 0
  v_mfma_f32_16x16x32_bf16 a[100:103], v[56:59], v[140:143], 0
  v_mfma_f32_16x16x32_bf16 a[132:135], v[56:59], v[144:147], 0
  v_mfma_f32_16x16x32_bf16 a[164:167], v[56:59], v[148:151], 0
  v_mfma_f32_16x16x32_bf16 a[196:199], v[56:59], v[152:155], 0
  v_mfma_f32_16x16x32_bf16 a[228:231], v[56:59], v[156:159], 0
  s_waitcnt lgkmcnt(8)
  v_mfma_f32_16x16x32_bf16 a[8:11], v[60:63], v[128:131], 0
  ds_read_b64_tr_b16 v[80:81], v23 offset:0
  v_mfma_f32_16x16x32_bf16 a[40:43], v[60:63], v[132:135], 0
  ds_read_b64_tr_b16 v[82:83], v23 offset:1024
  v_mfma_f32_16x16x32_bf16 a[72:75], v[60:63], v[136:139], 0
  v_mfma_f32_16x16x32_bf16 a[104:107], v[60:63], v[140:143], 0
  v_mfma_f32_16x16x32_bf16 a[136:139], v[60:63], v[144:147], 0
  v_mfma_f32_16x16x32_bf16 a[168:171], v[60:63], v[148:151], 0
  v_mfma_f32_16x16x32_bf16 a[200:203], v[60:63], v[152:155], 0
  v_mfma_f32_16x16x32_bf16 a[232:235], v[60:63], v[156:159], 0
  s_waitcnt lgkmcnt(8)
  v_mfma_f32_16x16x32_bf16 a[12:15], v[64:67], v[128:131], 0
  s_waitcnt vmcnt(15)
  s_barrier
  ds_read_b64_tr_b16 v[52:53], v16 offset:16384
  v_mfma_f32_16x16x32_bf16 a[44:47], v[64:67], v[132:135], 0
  ds_read_b64_tr_b16 v[54:55], v16 offset:17408
  v_mfma_f32_16x16x32_bf16 a[76:79], v[64:67], v[136:139], 0
  ds_read_b128 v[160:163], v41 offset:0
  v_mfma_f32_16x16x32_bf16 a[108:111], v[64:67], v[140:143], 0
  s_add_u32 m0, s50, 49152
  s_xor_b32 s36, s49, 1
  s_lshl_b32 s36, s36, 19
  s_add_u32 s36, s36, 262144
  v_mfma_f32_16x16x32_bf16 a[140:143], v[64:67], v[144:147], 0
  ds_read_b128 v[164:167], v41 offset:2048
  v_mfma_f32_16x16x32_bf16 a[172:175], v[64:67], v[148:151], 0
  v_mfma_f32_16x16x32_bf16 a[204:207], v[64:67], v[152:155], 0
  ds_read_b128 v[168:171], v41 offset:4096
  v_mfma_f32_16x16x32_bf16 a[236:239], v[64:67], v[156:159], 0
  buffer_load_dwordx4 v46, s[16:19], s36 offen offset:0 lds
  s_waitcnt lgkmcnt(11)
  v_mfma_f32_16x16x32_bf16 a[16:19], v[68:71], v[128:131], 0
  ds_read_b64_tr_b16 v[56:57], v17 offset:16384
  v_mfma_f32_16x16x32_bf16 a[48:51], v[68:71], v[132:135], 0
  ds_read_b64_tr_b16 v[58:59], v17 offset:17408
  v_mfma_f32_16x16x32_bf16 a[80:83], v[68:71], v[136:139], 0
  ds_read_b128 v[172:175], v41 offset:6144
  v_mfma_f32_16x16x32_bf16 a[112:115], v[68:71], v[140:143], 0
  buffer_load_dwordx4 v47, s[16:19], s36 offen offset:1024 lds
  v_mfma_f32_16x16x32_bf16 a[144:147], v[68:71], v[144:147], 0
  ds_read_b128 v[176:179], v41 offset:8192
  v_mfma_f32_16x16x32_bf16 a[176:179], v[68:71], v[148:151], 0
  v_mfma_f32_16x16x32_bf16 a[208:211], v[68:71], v[152:155], 0
  ds_read_b128 v[180:183], v41 offset:10240
  v_mfma_f32_16x16x32_bf16 a[240:243], v[68:71], v[156:159], 0
  s_add_u32 m0, s50, 57344
  s_nop 0
  s_waitcnt lgkmcnt(14)
  v_mfma_f32_16x16x32_bf16 a[20:23], v[72:75], v[128:131], 0
  ds_read_b64_tr_b16 v[60:61], v18 offset:16384
  v_mfma_f32_16x16x32_bf16 a[52:55], v[72:75], v[132:135], 0
  ds_read_b64_tr_b16 v[62:63], v18 offset:17408
  v_mfma_f32_16x16x32_bf16 a[84:87], v[72:75], v[136:139], 0
  ds_read_b128 v[184:187], v41 offset:12288
  v_mfma_f32_16x16x32_bf16 a[116:119], v[72:75], v[140:143], 0
  buffer_load_dwordx4 v46, s[20:23], s36 offen offset:0 lds
  v_mfma_f32_16x16x32_bf16 a[148:151], v[72:75], v[144:147], 0
  ds_read_b128 v[188:191], v41 offset:14336
  v_mfma_f32_16x16x32_bf16 a[180:183], v[72:75], v[148:151], 0
  v_mfma_f32_16x16x32_bf16 a[212:215], v[72:75], v[152:155], 0
  v_mfma_f32_16x16x32_bf16 a[244:247], v[72:75], v[156:159], 0
  buffer_load_dwordx4 v47, s[20:23], s36 offen offset:1024 lds
  s_waitcnt lgkmcnt(15)
  v_mfma_f32_16x16x32_bf16 a[24:27], v[76:79], v[128:131], 0
  ds_read_b64_tr_b16 v[64:65], v19 offset:16384
  v_mfma_f32_16x16x32_bf16 a[56:59], v[76:79], v[132:135], 0
  ds_read_b64_tr_b16 v[66:67], v19 offset:17408
  v_mfma_f32_16x16x32_bf16 a[88:91], v[76:79], v[136:139], 0
  v_mfma_f32_16x16x32_bf16 a[120:123], v[76:79], v[140:143], 0
  s_add_u32 m0, s44, 131072
  s_xor_b32 s36, s49, 2
  s_lshl_b32 s36, s36, 7
  v_mfma_f32_16x16x32_bf16 a[152:155], v[76:79], v[144:147], 0
  v_mfma_f32_16x16x32_bf16 a[184:187], v[76:79], v[148:151], 0
  v_mfma_f32_16x16x32_bf16 a[216:219], v[76:79], v[152:155], 0
  v_mfma_f32_16x16x32_bf16 a[248:251], v[76:79], v[156:159], 0
  buffer_load_dwordx4 v32, s[12:15], s36 offen offset:0 lds
  s_waitcnt lgkmcnt(15)
  v_mfma_f32_16x16x32_bf16 a[28:31], v[80:83], v[128:131], 0
  ds_read_b64_tr_b16 v[68:69], v20 offset:16384
  v_mfma_f32_16x16x32_bf16 a[60:63], v[80:83], v[132:135], 0
  ds_read_b64_tr_b16 v[70:71], v20 offset:17408
  v_mfma_f32_16x16x32_bf16 a[92:95], v[80:83], v[136:139], 0
  v_mfma_f32_16x16x32_bf16 a[124:127], v[80:83], v[140:143], 0
  buffer_load_dwordx4 v33, s[12:15], s36 offen offset:1024 lds
  v_mfma_f32_16x16x32_bf16 a[156:159], v[80:83], v[144:147], 0
  v_mfma_f32_16x16x32_bf16 a[188:191], v[80:83], v[148:151], 0
  v_mfma_f32_16x16x32_bf16 a[220:223], v[80:83], v[152:155], 0
  v_mfma_f32_16x16x32_bf16 a[252:255], v[80:83], v[156:159], 0
  buffer_load_dwordx4 v34, s[12:15], s36 offen offset:2048 lds
  s_waitcnt lgkmcnt(4)
  v_mfma_f32_16x16x32_bf16 a[0:3], v[52:55], v[160:163], a[0:3]
  ds_read_b64_tr_b16 v[72:73], v21 offset:16384
  v_mfma_f32_16x16x32_bf16 a[32:35], v[52:55], v[164:167], a[32:35]
  ds_read_b64_tr_b16 v[74:75], v21 offset:17408
  v_mfma_f32_16x16x32_bf16 a[64:67], v[52:55], v[168:171], a[64:67]
  v_mfma_f32_16x16x32_bf16 a[96:99], v[52:55], v[172:175], a[96:99]
  buffer_load_dwordx4 v35, s[12:15], s36 offen offset:3072 lds
  v_mfma_f32_16x16x32_bf16 a[128:131], v[52:55], v[176:179], a[128:131]
  v_mfma_f32_16x16x32_bf16 a[160:163], v[52:55], v[180:183], a[160:163]
  v_mfma_f32_16x16x32_bf16 a[192:195], v[52:55], v[184:187], a[192:195]
  v_mfma_f32_16x16x32_bf16 a[224:227], v[52:55], v[188:191], a[224:227]
  v_mfma_f32_16x16x32_bf16 a[4:7], v[56:59], v[160:163], a[4:7]
  ds_read_b64_tr_b16 v[76:77], v22 offset:16384
  v_mfma_f32_16x16x32_bf16 a[36:39], v[56:59], v[164:167], a[36:39]
  ds_read_b64_tr_b16 v[78:79], v22 offset:17408
  v_mfma_f32_16x16x32_bf16 a[68:71], v[56:59], v[168:171], a[68:71]
  v_mfma_f32_16x16x32_bf16 a[100:103], v[56:59], v[172:175], a[100:103]
  v_mfma_f32_16x16x32_bf16 a[132:135], v[56:59], v[176:179], a[132:135]
  v_mfma_f32_16x16x32_bf16 a[164:167], v[56:59], v[180:183], a[164:167]
  v_mfma_f32_16x16x32_bf16 a[196:199], v[56:59], v[184:187], a[196:199]
  v_mfma_f32_16x16x32_bf16 a[228:231], v[56:59], v[188:191], a[228:231]
  v_mfma_f32_16x16x32_bf16 a[8:11], v[60:63], v[160:163], a[8:11]
  ds_read_b64_tr_b16 v[80:81], v23 offset:16384
  v_mfma_f32_16x16x32_bf16 a[40:43], v[60:63], v[164:167], a[40:43]
  ds_read_b64_tr_b16 v[82:83], v23 offset:17408
  v_mfma_f32_16x16x32_bf16 a[72:75], v[60:63], v[168:171], a[72:75]
  v_mfma_f32_16x16x32_bf16 a[104:107], v[60:63], v[172:175], a[104:107]
  v_mfma_f32_16x16x32_bf16 a[136:139], v[60:63], v[176:179], a[136:139]
  v_mfma_f32_16x16x32_bf16 a[168:171], v[60:63], v[180:183], a[168:171]
  v_mfma_f32_16x16x32_bf16 a[200:203], v[60:63], v[184:187], a[200:203]
  v_mfma_f32_16x16x32_bf16 a[232:235], v[60:63], v[188:191], a[232:235]
  s_waitcnt lgkmcnt(8)
  v_mfma_f32_16x16x32_bf16 a[12:15], v[64:67], v[160:163], a[12:15]
  s_waitcnt vmcnt(11)
  s_barrier
  ds_read_b64_tr_b16 v[52:53], v16 offset:32768
  v_mfma_f32_16x16x32_bf16 a[44:47], v[64:67], v[164:167], a[44:47]
  ds_read_b64_tr_b16 v[54:55], v16 offset:33792
  v_mfma_f32_16x16x32_bf16 a[76:79], v[64:67], v[168:171], a[76:79]
  ds_read_b128 v[128:131], v40 offset:32768
  v_mfma_f32_16x16x32_bf16 a[108:111], v[64:67], v[172:175], a[108:111]
  s_add_u32 m0, s50, 0
  s_xor_b32 s36, s49, 2
  s_lshl_b32 s36, s36, 19
  v_mfma_f32_16x16x32_bf16 a[140:143], v[64:67], v[176:179], a[140:143]
  ds_read_b128 v[132:135], v40 offset:34816
  v_mfma_f32_16x16x32_bf16 a[172:175], v[64:67], v[180:183], a[172:175]
  v_mfma_f32_16x16x32_bf16 a[204:207], v[64:67], v[184:187], a[204:207]
  ds_read_b128 v[136:139], v40 offset:36864
  v_mfma_f32_16x16x32_bf16 a[236:239], v[64:67], v[188:191], a[236:239]
  buffer_load_dwordx4 v46, s[16:19], s36 offen offset:0 lds
  s_waitcnt lgkmcnt(11)
  v_mfma_f32_16x16x32_bf16 a[16:19], v[68:71], v[160:163], a[16:19]
  ds_read_b64_tr_b16 v[56:57], v17 offset:32768
  v_mfma_f32_16x16x32_bf16 a[48:51], v[68:71], v[164:167], a[48:51]
  ds_read_b64_tr_b16 v[58:59], v17 offset:33792
  v_mfma_f32_16x16x32_bf16 a[80:83], v[68:71], v[168:171], a[80:83]
  ds_read_b128 v[140:143], v40 offset:38912
  v_mfma_f32_16x16x32_bf16 a[112:115], v[68:71], v[172:175], a[112:115]
  buffer_load_dwordx4 v47, s[16:19], s36 offen offset:1024 lds
  v_mfma_f32_16x16x32_bf16 a[144:147], v[68:71], v[176:179], a[144:147]
  ds_read_b128 v[144:147], v40 offset:40960
  v_mfma_f32_16x16x32_bf16 a[176:179], v[68:71], v[180:183], a[176:179]
  v_mfma_f32_16x16x32_bf16 a[208:211], v[68:71], v[184:187], a[208:211]
  ds_read_b128 v[148:151], v40 offset:43008
  v_mfma_f32_16x16x32_bf16 a[240:243], v[68:71], v[188:191], a[240:243]
  s_add_u32 m0, s50, 8192
  s_nop 0
  s_waitcnt lgkmcnt(14)
  v_mfma_f32_16x16x32_bf16 a[20:23], v[72:75], v[160:163], a[20:23]
  ds_read_b64_tr_b16 v[60:61], v18 offset:32768
  v_mfma_f32_16x16x32_bf16 a[52:55], v[72:75], v[164:167], a[52:55]
  ds_read_b64_tr_b16 v[62:63], v18 offset:33792
  v_mfma_f32_16x16x32_bf16 a[84:87], v[72:75], v[168:171], a[84:87]
  ds_read_b128 v[152:155], v40 offset:45056
  v_mfma_f32_16x16x32_bf16 a[116:119], v[72:75], v[172:175], a[116:119]
  buffer_load_dwordx4 v46, s[20:23], s36 offen offset:0 lds
  v_mfma_f32_16x16x32_bf16 a[148:151], v[72:75], v[176:179], a[148:151]
  ds_read_b128 v[156:159], v40 offset:47104
  v_mfma_f32_16x16x32_bf16 a[180:183], v[72:75], v[180:183], a[180:183]
  v_mfma_f32_16x16x32_bf16 a[212:215], v[72:75], v[184:187], a[212:215]
  v_mfma_f32_16x16x32_bf16 a[244:247], v[72:75], v[188:191], a[244:247]
  buffer_load_dwordx4 v47, s[20:23], s36 offen offset:1024 lds
  s_waitcnt lgkmcnt(15)
  v_mfma_f32_16x16x32_bf16 a[24:27], v[76:79], v[160:163], a[24:27]
  ds_read_b64_tr_b16 v[64:65], v19 offset:32768
  v_mfma_f32_16x16x32_bf16 a[56:59], v[76:79], v[164:167], a[56:59]
  ds_read_b64_tr_b16 v[66:67], v19 offset:33792
  v_mfma_f32_16x16x32_bf16 a[88:91], v[76:79], v[168:171], a[88:91]
  v_mfma_f32_16x16x32_bf16 a[120:123], v[76:79], v[172:175], a[120:123]
  s_add_u32 m0, s44, 135168
  s_xor_b32 s36, s49, 2
  s_lshl_b32 s36, s36, 7
  s_add_u32 s36, s36, 32768
  v_mfma_f32_16x16x32_bf16 a[152:155], v[76:79], v[176:179], a[152:155]
  v_mfma_f32_16x16x32_bf16 a[184:187], v[76:79], v[180:183], a[184:187]
  v_mfma_f32_16x16x32_bf16 a[216:219], v[76:79], v[184:187], a[216:219]
  v_mfma_f32_16x16x32_bf16 a[248:251], v[76:79], v[188:191], a[248:251]
  buffer_load_dwordx4 v32, s[12:15], s36 offen offset:0 lds
  s_waitcnt lgkmcnt(15)
  v_mfma_f32_16x16x32_bf16 a[28:31], v[80:83], v[160:163], a[28:31]
  ds_read_b64_tr_b16 v[68:69], v20 offset:32768
  v_mfma_f32_16x16x32_bf16 a[60:63], v[80:83], v[164:167], a[60:63]
  ds_read_b64_tr_b16 v[70:71], v20 offset:33792
  v_mfma_f32_16x16x32_bf16 a[92:95], v[80:83], v[168:171], a[92:95]
  v_mfma_f32_16x16x32_bf16 a[124:127], v[80:83], v[172:175], a[124:127]
  buffer_load_dwordx4 v33, s[12:15], s36 offen offset:1024 lds
  v_mfma_f32_16x16x32_bf16 a[156:159], v[80:83], v[176:179], a[156:159]
  v_mfma_f32_16x16x32_bf16 a[188:191], v[80:83], v[180:183], a[188:191]
  v_mfma_f32_16x16x32_bf16 a[220:223], v[80:83], v[184:187], a[220:223]
  v_mfma_f32_16x16x32_bf16 a[252:255], v[80:83], v[188:191], a[252:255]
  buffer_load_dwordx4 v34, s[12:15], s36 offen offset:2048 lds
  s_waitcnt lgkmcnt(4)
  v_mfma_f32_16x16x32_bf16 a[0:3], v[52:55], v[128:131], a[0:3]
  ds_read_b64_tr_b16 v[72:73], v21 offset:32768
  v_mfma_f32_16x16x32_bf16 a[32:35], v[52:55], v[132:135], a[32:35]
  ds_read_b64_tr_b16 v[74:75], v21 offset:33792
  v_mfma_f32_16x16x32_bf16 a[64:67], v[52:55], v[136:139], a[64:67]
  v_mfma_f32_16x16x32_bf16 a[96:99], v[52:55], v[140:143], a[96:99]
  buffer_load_dwordx4 v35, s[12:15], s36 offen offset:3072 lds
  v_mfma_f32_16x16x32_bf16 a[128:131], v[52:55], v[144:147], a[128:131]
  v_mfma_f32_16x16x32_bf16 a[160:163], v[52:55], v[148:151], a[160:163]
  v_mfma_f32_16x16x32_bf16 a[192:195], v[52:55], v[152:155], a[192:195]
  v_mfma_f32_16x16x32_bf16 a[224:227], v[52:55], v[156:159], a[224:227]
  v_mov_b32 v237, 1
  s_cmp_lg_u32 s32, 0
  s_cbranch_scc1 k1_kernel_noz3
  s_mov_b64 exec, 1
  buffer_store_byte v237, v233, s[4:7], s2 offen sc1
  s_mov_b64 exec, -1
k1_kernel_noz3:
  v_mfma_f32_16x16x32_bf16 a[4:7], v[56:59], v[128:131], a[4:7]
  ds_read_b64_tr_b16 v[76:77], v22 offset:32768
  v_mfma_f32_16x16x32_bf16 a[36:39], v[56:59], v[132:135], a[36:39]
  ds_read_b64_tr_b16 v[78:79], v22 offset:33792
  v_mfma_f32_16x16x32_bf16 a[68:71], v[56:59], v[136:139], a[68:71]
  v_mfma_f32_16x16x32_bf16 a[100:103], v[56:59], v[140:143], a[100:103]
  v_mfma_f32_16x16x32_bf16 a[132:135], v[56:59], v[144:147], a[132:135]
  v_mfma_f32_16x16x32_bf16 a[164:167], v[56:59], v[148:151], a[164:167]
  v_mfma_f32_16x16x32_bf16 a[196:199], v[56:59], v[152:155], a[196:199]
  v_mfma_f32_16x16x32_bf16 a[228:231], v[56:59], v[156:159], a[228:231]
  v_mfma_f32_16x16x32_bf16 a[8:11], v[60:63], v[128:131], a[8:11]
  ds_read_b64_tr_b16 v[80:81], v23 offset:32768
  v_mfma_f32_16x16x32_bf16 a[40:43], v[60:63], v[132:135], a[40:43]
  ds_read_b64_tr_b16 v[82:83], v23 offset:33792
  v_mfma_f32_16x16x32_bf16 a[72:75], v[60:63], v[136:139], a[72:75]
  v_mfma_f32_16x16x32_bf16 a[104:107], v[60:63], v[140:143], a[104:107]
  v_mfma_f32_16x16x32_bf16 a[136:139], v[60:63], v[144:147], a[136:139]
  v_mfma_f32_16x16x32_bf16 a[168:171], v[60:63], v[148:151], a[168:171]
  v_mfma_f32_16x16x32_bf16 a[200:203], v[60:63], v[152:155], a[200:203]
  v_mfma_f32_16x16x32_bf16 a[232:235], v[60:63], v[156:159], a[232:235]
  s_waitcnt lgkmcnt(8)
  v_mfma_f32_16x16x32_bf16 a[12:15], v[64:67], v[128:131], a[12:15]
  s_waitcnt vmcnt(12)
  s_barrier
  ds_read_b64_tr_b16 v[52:53], v16 offset:49152
  v_mfma_f32_16x16x32_bf16 a[44:47], v[64:67], v[132:135], a[44:47]
  ds_read_b64_tr_b16 v[54:55], v16 offset:50176
  v_mfma_f32_16x16x32_bf16 a[76:79], v[64:67], v[136:139], a[76:79]
  ds_read_b128 v[160:163], v41 offset:32768
  v_mfma_f32_16x16x32_bf16 a[108:111], v[64:67], v[140:143], a[108:111]
  s_add_u32 m0, s50, 16384
  s_xor_b32 s36, s49, 2
  s_lshl_b32 s36, s36, 19
  s_add_u32 s36, s36, 262144
  v_mfma_f32_16x16x32_bf16 a[140:143], v[64:67], v[144:147], a[140:143]
  ds_read_b128 v[164:167], v41 offset:34816
  v_mfma_f32_16x16x32_bf16 a[172:175], v[64:67], v[148:151], a[172:175]
  v_mfma_f32_16x16x32_bf16 a[204:207], v[64:67], v[152:155], a[204:207]
  ds_read_b128 v[168:171], v41 offset:36864
  v_mfma_f32_16x16x32_bf16 a[236:239], v[64:67], v[156:159], a[236:239]
  buffer_load_dwordx4 v46, s[16:19], s36 offen offset:0 lds
  s_waitcnt lgkmcnt(11)
  v_mfma_f32_16x16x32_bf16 a[16:19], v[68:71], v[128:131], a[16:19]
  ds_read_b64_tr_b16 v[56:57], v17 offset:49152
  v_mfma_f32_16x16x32_bf16 a[48:51], v[68:71], v[132:135], a[48:51]
  ds_read_b64_tr_b16 v[58:59], v17 offset:50176
  v_mfma_f32_16x16x32_bf16 a[80:83], v[68:71], v[136:139], a[80:83]
  ds_read_b128 v[172:175], v41 offset:38912
  v_mfma_f32_16x16x32_bf16 a[112:115], v[68:71], v[140:143], a[112:115]
  buffer_load_dwordx4 v47, s[16:19], s36 offen offset:1024 lds
  v_mfma_f32_16x16x32_bf16 a[144:147], v[68:71], v[144:147], a[144:147]
  ds_read_b128 v[176:179], v41 offset:40960
  v_mfma_f32_16x16x32_bf16 a[176:179], v[68:71], v[148:151], a[176:179]
  v_mfma_f32_16x16x32_bf16 a[208:211], v[68:71], v[152:155], a[208:211]
  ds_read_b128 v[180:183], v41 offset:43008
  v_mfma_f32_16x16x32_bf16 a[240:243], v[68:71], v[156:159], a[240:243]
  s_add_u32 m0, s50, 24576
  s_nop 0
  s_waitcnt lgkmcnt(14)
  v_mfma_f32_16x16x32_bf16 a[20:23], v[72:75], v[128:131], a[20:23]
  ds_read_b64_tr_b16 v[60:61], v18 offset:49152
  v_mfma_f32_16x16x32_bf16 a[52:55], v[72:75], v[132:135], a[52:55]
  ds_read_b64_tr_b16 v[62:63], v18 offset:50176
  v_mfma_f32_16x16x32_bf16 a[84:87], v[72:75], v[136:139], a[84:87]
  ds_read_b128 v[184:187], v41 offset:45056
  v_mfma_f32_16x16x32_bf16 a[116:119], v[72:75], v[140:143], a[116:119]
  buffer_load_dwordx4 v46, s[20:23], s36 offen offset:0 lds
  v_mfma_f32_16x16x32_bf16 a[148:151], v[72:75], v[144:147], a[148:151]
  ds_read_b128 v[188:191], v41 offset:47104
  v_mfma_f32_16x16x32_bf16 a[180:183], v[72:75], v[148:151], a[180:183]
  v_mfma_f32_16x16x32_bf16 a[212:215], v[72:75], v[152:155], a[212:215]
  v_mfma_f32_16x16x32_bf16 a[244:247], v[72:75], v[156:159], a[244:247]
  buffer_load_dwordx4 v47, s[20:23], s36 offen offset:1024 lds
  s_waitcnt lgkmcnt(15)
  v_mfma_f32_16x16x32_bf16 a[24:27], v[76:79], v[128:131], a[24:27]
  ds_read_b64_tr_b16 v[64:65], v19 offset:49152
  v_mfma_f32_16x16x32_bf16 a[56:59], v[76:79], v[132:135], a[56:59]
  ds_read_b64_tr_b16 v[66:67], v19 offset:50176
  v_mfma_f32_16x16x32_bf16 a[88:91], v[76:79], v[136:139], a[88:91]
  v_mfma_f32_16x16x32_bf16 a[120:123], v[76:79], v[140:143], a[120:123]
  s_add_u32 m0, s44, 65536
  s_xor_b32 s36, s49, 3
  s_lshl_b32 s36, s36, 7
  v_mfma_f32_16x16x32_bf16 a[152:155], v[76:79], v[144:147], a[152:155]
  v_mfma_f32_16x16x32_bf16 a[184:187], v[76:79], v[148:151], a[184:187]
  v_mfma_f32_16x16x32_bf16 a[216:219], v[76:79], v[152:155], a[216:219]
  v_mfma_f32_16x16x32_bf16 a[248:251], v[76:79], v[156:159], a[248:251]
  buffer_load_dwordx4 v32, s[12:15], s36 offen offset:0 lds
  s_waitcnt lgkmcnt(15)
  v_mfma_f32_16x16x32_bf16 a[28:31], v[80:83], v[128:131], a[28:31]
  ds_read_b64_tr_b16 v[68:69], v20 offset:49152
  v_mfma_f32_16x16x32_bf16 a[60:63], v[80:83], v[132:135], a[60:63]
  ds_read_b64_tr_b16 v[70:71], v20 offset:50176
  v_mfma_f32_16x16x32_bf16 a[92:95], v[80:83], v[136:139], a[92:95]
  v_mfma_f32_16x16x32_bf16 a[124:127], v[80:83], v[140:143], a[124:127]
  buffer_load_dwordx4 v33, s[12:15], s36 offen offset:1024 lds
  v_mfma_f32_16x16x32_bf16 a[156:159], v[80:83], v[144:147], a[156:159]
  v_mfma_f32_16x16x32_bf16 a[188:191], v[80:83], v[148:151], a[188:191]
  v_mfma_f32_16x16x32_bf16 a[220:223], v[80:83], v[152:155], a[220:223]
  v_mfma_f32_16x16x32_bf16 a[252:255], v[80:83], v[156:159], a[252:255]
  buffer_load_dwordx4 v34, s[12:15], s36 offen offset:2048 lds
  s_waitcnt lgkmcnt(4)
  v_mfma_f32_16x16x32_bf16 a[0:3], v[52:55], v[160:163], a[0:3]
  ds_read_b64_tr_b16 v[72:73], v21 offset:49152
  v_mfma_f32_16x16x32_bf16 a[32:35], v[52:55], v[164:167], a[32:35]
  ds_read_b64_tr_b16 v[74:75], v21 offset:50176
  v_mfma_f32_16x16x32_bf16 a[64:67], v[52:55], v[168:171], a[64:67]
  v_mfma_f32_16x16x32_bf16 a[96:99], v[52:55], v[172:175], a[96:99]
  buffer_load_dwordx4 v35, s[12:15], s36 offen offset:3072 lds
  v_mfma_f32_16x16x32_bf16 a[128:131], v[52:55], v[176:179], a[128:131]
  v_mfma_f32_16x16x32_bf16 a[160:163], v[52:55], v[180:183], a[160:163]
  v_mfma_f32_16x16x32_bf16 a[192:195], v[52:55], v[184:187], a[192:195]
  v_mfma_f32_16x16x32_bf16 a[224:227], v[52:55], v[188:191], a[224:227]
  v_mov_b32 v236, 0
  v_mov_b32 v237, 1
  s_cmp_lg_u32 s32, 0
  s_cbranch_scc1 k1_kernel_skip14
  s_mov_b64 exec, 1
  buffer_store_dword v237, v236, s[8:11], s53 offen sc1
  s_mov_b64 exec, -1
k1_kernel_skip14:
  v_mfma_f32_16x16x32_bf16 a[4:7], v[56:59], v[160:163], a[4:7]
  ds_read_b64_tr_b16 v[76:77], v22 offset:49152
  v_mfma_f32_16x16x32_bf16 a[36:39], v[56:59], v[164:167], a[36:39]
  ds_read_b64_tr_b16 v[78:79], v22 offset:50176
  v_mfma_f32_16x16x32_bf16 a[68:71], v[56:59], v[168:171], a[68:71]
  v_mfma_f32_16x16x32_bf16 a[100:103], v[56:59], v[172:175], a[100:103]
  v_mfma_f32_16x16x32_bf16 a[132:135], v[56:59], v[176:179], a[132:135]
  v_mfma_f32_16x16x32_bf16 a[164:167], v[56:59], v[180:183], a[164:167]
  v_mfma_f32_16x16x32_bf16 a[196:199], v[56:59], v[184:187], a[196:199]
  v_mfma_f32_16x16x32_bf16 a[228:231], v[56:59], v[188:191], a[228:231]
  v_mfma_f32_16x16x32_bf16 a[8:11], v[60:63], v[160:163], a[8:11]
  ds_read_b64_tr_b16 v[80:81], v23 offset:49152
  v_mfma_f32_16x16x32_bf16 a[40:43], v[60:63], v[164:167], a[40:43]
  ds_read_b64_tr_b16 v[82:83], v23 offset:50176
  v_mfma_f32_16x16x32_bf16 a[72:75], v[60:63], v[168:171], a[72:75]
  v_mfma_f32_16x16x32_bf16 a[104:107], v[60:63], v[172:175], a[104:107]
  v_mfma_f32_16x16x32_bf16 a[136:139], v[60:63], v[176:179], a[136:139]
  v_mfma_f32_16x16x32_bf16 a[168:171], v[60:63], v[180:183], a[168:171]
  v_mfma_f32_16x16x32_bf16 a[200:203], v[60:63], v[184:187], a[200:203]
  v_mfma_f32_16x16x32_bf16 a[232:235], v[60:63], v[188:191], a[232:235]
  s_waitcnt lgkmcnt(8)
  v_mfma_f32_16x16x32_bf16 a[12:15], v[64:67], v[160:163], a[12:15]
  s_waitcnt vmcnt(8)
  s_barrier
  ds_read_b64_tr_b16 v[52:53], v16 offset:0
  v_mfma_f32_16x16x32_bf16 a[44:47], v[64:67], v[164:167], a[44:47]
  ds_read_b64_tr_b16 v[54:55], v16 offset:1024
  v_mfma_f32_16x16x32_bf16 a[76:79], v[64:67], v[168:171], a[76:79]
  ds_read_b128 v[128:131], v42 offset:0
  v_mfma_f32_16x16x32_bf16 a[108:111], v[64:67], v[172:175], a[108:111]
  s_add_u32 m0, s50, 32768
  s_xor_b32 s36, s49, 3
  s_lshl_b32 s36, s36, 19
  v_mfma_f32_16x16x32_bf16 a[140:143], v[64:67], v[176:179], a[140:143]
  ds_read_b128 v[132:135], v42 offset:2048
  v_mfma_f32_16x16x32_bf16 a[172:175], v[64:67], v[180:183], a[172:175]
  v_mfma_f32_16x16x32_bf16 a[204:207], v[64:67], v[184:187], a[204:207]
  ds_read_b128 v[136:139], v42 offset:4096
  v_mfma_f32_16x16x32_bf16 a[236:239], v[64:67], v[188:191], a[236:239]
  buffer_load_dwordx4 v46, s[16:19], s36 offen offset:0 lds
  s_waitcnt lgkmcnt(11)
  v_mfma_f32_16x16x32_bf16 a[16:19], v[68:71], v[160:163], a[16:19]
  ds_read_b64_tr_b16 v[56:57], v17 offset:0
  v_mfma_f32_16x16x32_bf16 a[48:51], v[68:71], v[164:167], a[48:51]
  ds_read_b64_tr_b16 v[58:59], v17 offset:1024
  v_mfma_f32_16x16x32_bf16 a[80:83], v[68:71], v[168:171], a[80:83]
  ds_read_b128 v[140:143], v42 offset:6144
  v_mfma_f32_16x16x32_bf16 a[112:115], v[68:71], v[172:175], a[112:115]
  buffer_load_dwordx4 v47, s[16:19], s36 offen offset:1024 lds
  v_mfma_f32_16x16x32_bf16 a[144:147], v[68:71], v[176:179], a[144:147]
  ds_read_b128 v[144:147], v42 offset:8192
  v_mfma_f32_16x16x32_bf16 a[176:179], v[68:71], v[180:183], a[176:179]
  v_mfma_f32_16x16x32_bf16 a[208:211], v[68:71], v[184:187], a[208:211]
  ds_read_b128 v[148:151], v42 offset:10240
  v_mfma_f32_16x16x32_bf16 a[240:243], v[68:71], v[188:191], a[240:243]
  s_add_u32 m0, s50, 40960
  s_nop 0
  s_waitcnt lgkmcnt(14)
  v_mfma_f32_16x16x32_bf16 a[20:23], v[72:75], v[160:163], a[20:23]
  ds_read_b64_tr_b16 v[60:61], v18 offset:0
  v_mfma_f32_16x16x32_bf16 a[52:55], v[72:75], v[164:167], a[52:55]
  ds_read_b64_tr_b16 v[62:63], v18 offset:1024
  v_mfma_f32_16x16x32_bf16 a[84:87], v[72:75], v[168:171], a[84:87]
  ds_read_b128 v[152:155], v42 offset:12288
  v_mfma_f32_16x16x32_bf16 a[116:119], v[72:75], v[172:175], a[116:119]
  buffer_load_dwordx4 v46, s[20:23], s36 offen offset:0 lds
  v_mfma_f32_16x16x32_bf16 a[148:151], v[72:75], v[176:179], a[148:151]
  ds_read_b128 v[156:159], v42 offset:14336
  v_mfma_f32_16x16x32_bf16 a[180:183], v[72:75], v[180:183], a[180:183]
  v_mfma_f32_16x16x32_bf16 a[212:215], v[72:75], v[184:187], a[212:215]
  v_mfma_f32_16x16x32_bf16 a[244:247], v[72:75], v[188:191], a[244:247]
  buffer_load_dwordx4 v47, s[20:23], s36 offen offset:1024 lds
  s_waitcnt lgkmcnt(15)
  v_mfma_f32_16x16x32_bf16 a[24:27], v[76:79], v[160:163], a[24:27]
  ds_read_b64_tr_b16 v[64:65], v19 offset:0
  v_mfma_f32_16x16x32_bf16 a[56:59], v[76:79], v[164:167], a[56:59]
  ds_read_b64_tr_b16 v[66:67], v19 offset:1024
  v_mfma_f32_16x16x32_bf16 a[88:91], v[76:79], v[168:171], a[88:91]
  v_mfma_f32_16x16x32_bf16 a[120:123], v[76:79], v[172:175], a[120:123]
  s_add_u32 m0, s44, 69632
  s_xor_b32 s36, s49, 3
  s_lshl_b32 s36, s36, 7
  s_add_u32 s36, s36, 32768
  v_mfma_f32_16x16x32_bf16 a[152:155], v[76:79], v[176:179], a[152:155]
  v_mfma_f32_16x16x32_bf16 a[184:187], v[76:79], v[180:183], a[184:187]
  v_mfma_f32_16x16x32_bf16 a[216:219], v[76:79], v[184:187], a[216:219]
  v_mfma_f32_16x16x32_bf16 a[248:251], v[76:79], v[188:191], a[248:251]
  buffer_load_dwordx4 v32, s[12:15], s36 offen offset:0 lds
  s_waitcnt lgkmcnt(15)
  v_mfma_f32_16x16x32_bf16 a[28:31], v[80:83], v[160:163], a[28:31]
  ds_read_b64_tr_b16 v[68:69], v20 offset:0
  v_mfma_f32_16x16x32_bf16 a[60:63], v[80:83], v[164:167], a[60:63]
  ds_read_b64_tr_b16 v[70:71], v20 offset:1024
  v_mfma_f32_16x16x32_bf16 a[92:95], v[80:83], v[168:171], a[92:95]
  v_mfma_f32_16x16x32_bf16 a[124:127], v[80:83], v[172:175], a[124:127]
  buffer_load_dwordx4 v33, s[12:15], s36 offen offset:1024 lds
  v_mfma_f32_16x16x32_bf16 a[156:159], v[80:83], v[176:179], a[156:159]
  v_mfma_f32_16x16x32_bf16 a[188:191], v[80:83], v[180:183], a[188:191]
  v_mfma_f32_16x16x32_bf16 a[220:223], v[80:83], v[184:187], a[220:223]
  v_mfma_f32_16x16x32_bf16 a[252:255], v[80:83], v[188:191], a[252:255]
  buffer_load_dwordx4 v34, s[12:15], s36 offen offset:2048 lds
  s_waitcnt lgkmcnt(4)
  v_mfma_f32_16x16x32_bf16 a[0:3], v[52:55], v[128:131], a[0:3]
  ds_read_b64_tr_b16 v[72:73], v21 offset:0
  v_mfma_f32_16x16x32_bf16 a[32:35], v[52:55], v[132:135], a[32:35]
  ds_read_b64_tr_b16 v[74:75], v21 offset:1024
  v_mfma_f32_16x16x32_bf16 a[64:67], v[52:55], v[136:139], a[64:67]
  v_mfma_f32_16x16x32_bf16 a[96:99], v[52:55], v[140:143], a[96:99]
  buffer_load_dwordx4 v35, s[12:15], s36 offen offset:3072 lds
  v_mfma_f32_16x16x32_bf16 a[128:131], v[52:55], v[144:147], a[128:131]
  v_mfma_f32_16x16x32_bf16 a[160:163], v[52:55], v[148:151], a[160:163]
  v_mfma_f32_16x16x32_bf16 a[192:195], v[52:55], v[152:155], a[192:195]
  v_mfma_f32_16x16x32_bf16 a[224:227], v[52:55], v[156:159], a[224:227]
  v_mfma_f32_16x16x32_bf16 a[4:7], v[56:59], v[128:131], a[4:7]
  ds_read_b64_tr_b16 v[76:77], v22 offset:0
  v_mfma_f32_16x16x32_bf16 a[36:39], v[56:59], v[132:135], a[36:39]
  ds_read_b64_tr_b16 v[78:79], v22 offset:1024
  v_mfma_f32_16x16x32_bf16 a[68:71], v[56:59], v[136:139], a[68:71]
  v_mfma_f32_16x16x32_bf16 a[100:103], v[56:59], v[140:143], a[100:103]
  v_mfma_f32_16x16x32_bf16 a[132:135], v[56:59], v[144:147], a[132:135]
  v_mfma_f32_16x16x32_bf16 a[164:167], v[56:59], v[148:151], a[164:167]
  v_mfma_f32_16x16x32_bf16 a[196:199], v[56:59], v[152:155], a[196:199]
  v_mfma_f32_16x16x32_bf16 a[228:231], v[56:59], v[156:159], a[228:231]
  v_mfma_f32_16x16x32_bf16 a[8:11], v[60:63], v[128:131], a[8:11]
  ds_read_b64_tr_b16 v[80:81], v23 offset:0
  v_mfma_f32_16x16x32_bf16 a[40:43], v[60:63], v[132:135], a[40:43]
  ds_read_b64_tr_b16 v[82:83], v23 offset:1024
  v_mfma_f32_16x16x32_bf16 a[72:75], v[60:63], v[136:139], a[72:75]
  v_mfma_f32_16x16x32_bf16 a[104:107], v[60:63], v[140:143], a[104:107]
  v_mfma_f32_16x16x32_bf16 a[136:139], v[60:63], v[144:147], a[136:139]
  v_mfma_f32_16x16x32_bf16 a[168:171], v[60:63], v[148:151], a[168:171]
  v_mfma_f32_16x16x32_bf16 a[200:203], v[60:63], v[152:155], a[200:203]
  v_mfma_f32_16x16x32_bf16 a[232:235], v[60:63], v[156:159], a[232:235]
  s_waitcnt lgkmcnt(8)
  v_mfma_f32_16x16x32_bf16 a[12:15], v[64:67], v[128:131], a[12:15]
  s_waitcnt vmcnt(12)
  s_barrier
  ds_read_b64_tr_b16 v[52:53], v16 offset:16384
  v_mfma_f32_16x16x32_bf16 a[44:47], v[64:67], v[132:135], a[44:47]
  ds_read_b64_tr_b16 v[54:55], v16 offset:17408
  v_mfma_f32_16x16x32_bf16 a[76:79], v[64:67], v[136:139], a[76:79]
  ds_read_b128 v[160:163], v43 offset:0
  v_mfma_f32_16x16x32_bf16 a[108:111], v[64:67], v[140:143], a[108:111]
  s_add_u32 m0, s50, 49152
  s_xor_b32 s36, s49, 3
  s_lshl_b32 s36, s36, 19
  s_add_u32 s36, s36, 262144
  v_mfma_f32_16x16x32_bf16 a[140:143], v[64:67], v[144:147], a[140:143]
  ds_read_b128 v[164:167], v43 offset:2048
  v_mfma_f32_16x16x32_bf16 a[172:175], v[64:67], v[148:151], a[172:175]
  v_mfma_f32_16x16x32_bf16 a[204:207], v[64:67], v[152:155], a[204:207]
  ds_read_b128 v[168:171], v43 offset:4096
  v_mfma_f32_16x16x32_bf16 a[236:239], v[64:67], v[156:159], a[236:239]
  buffer_load_dwordx4 v46, s[16:19], s36 offen offset:0 lds
  s_waitcnt lgkmcnt(11)
  v_mfma_f32_16x16x32_bf16 a[16:19], v[68:71], v[128:131], a[16:19]
  ds_read_b64_tr_b16 v[56:57], v17 offset:16384
  v_mfma_f32_16x16x32_bf16 a[48:51], v[68:71], v[132:135], a[48:51]
  ds_read_b64_tr_b16 v[58:59], v17 offset:17408
  v_mfma_f32_16x16x32_bf16 a[80:83], v[68:71], v[136:139], a[80:83]
  ds_read_b128 v[172:175], v43 offset:6144
  v_mfma_f32_16x16x32_bf16 a[112:115], v[68:71], v[140:143], a[112:115]
  buffer_load_dwordx4 v47, s[16:19], s36 offen offset:1024 lds
  v_mfma_f32_16x16x32_bf16 a[144:147], v[68:71], v[144:147], a[144:147]
  ds_read_b128 v[176:179], v43 offset:8192
  v_mfma_f32_16x16x32_bf16 a[176:179], v[68:71], v[148:151], a[176:179]
  v_mfma_f32_16x16x32_bf16 a[208:211], v[68:71], v[152:155], a[208:211]
  ds_read_b128 v[180:183], v43 offset:10240
  v_mfma_f32_16x16x32_bf16 a[240:243], v[68:71], v[156:159], a[240:243]
  s_add_u32 m0, s50, 57344
  s_nop 0
  s_waitcnt lgkmcnt(14)
  v_mfma_f32_16x16x32_bf16 a[20:23], v[72:75], v[128:131], a[20:23]
  ds_read_b64_tr_b16 v[60:61], v18 offset:16384
  v_mfma_f32_16x16x32_bf16 a[52:55], v[72:75], v[132:135], a[52:55]
  ds_read_b64_tr_b16 v[62:63], v18 offset:17408
  v_mfma_f32_16x16x32_bf16 a[84:87], v[72:75], v[136:139], a[84:87]
  ds_read_b128 v[184:187], v43 offset:12288
  v_mfma_f32_16x16x32_bf16 a[116:119], v[72:75], v[140:143], a[116:119]
  buffer_load_dwordx4 v46, s[20:23], s36 offen offset:0 lds
  v_mfma_f32_16x16x32_bf16 a[148:151], v[72:75], v[144:147], a[148:151]
  ds_read_b128 v[188:191], v43 offset:14336
  v_mfma_f32_16x16x32_bf16 a[180:183], v[72:75], v[148:151], a[180:183]
  v_mfma_f32_16x16x32_bf16 a[212:215], v[72:75], v[152:155], a[212:215]
  v_mfma_f32_16x16x32_bf16 a[244:247], v[72:75], v[156:159], a[244:247]
  buffer_load_dwordx4 v47, s[20:23], s36 offen offset:1024 lds
  s_waitcnt lgkmcnt(15)
  v_mfma_f32_16x16x32_bf16 a[24:27], v[76:79], v[128:131], a[24:27]
  ds_read_b64_tr_b16 v[64:65], v19 offset:16384
  v_mfma_f32_16x16x32_bf16 a[56:59], v[76:79], v[132:135], a[56:59]
  ds_read_b64_tr_b16 v[66:67], v19 offset:17408
  v_mfma_f32_16x16x32_bf16 a[88:91], v[76:79], v[136:139], a[88:91]
  v_mfma_f32_16x16x32_bf16 a[120:123], v[76:79], v[140:143], a[120:123]
  s_add_u32 m0, s44, 98304
  s_xor_b32 s36, s49, 4
  s_lshl_b32 s36, s36, 7
  v_mfma_f32_16x16x32_bf16 a[152:155], v[76:79], v[144:147], a[152:155]
  v_mfma_f32_16x16x32_bf16 a[184:187], v[76:79], v[148:151], a[184:187]
  v_mfma_f32_16x16x32_bf16 a[216:219], v[76:79], v[152:155], a[216:219]
  v_mfma_f32_16x16x32_bf16 a[248:251], v[76:79], v[156:159], a[248:251]
  buffer_load_dwordx4 v32, s[12:15], s36 offen offset:0 lds
  s_waitcnt lgkmcnt(15)
  v_mfma_f32_16x16x32_bf16 a[28:31], v[80:83], v[128:131], a[28:31]
  ds_read_b64_tr_b16 v[68:69], v20 offset:16384
  v_mfma_f32_16x16x32_bf16 a[60:63], v[80:83], v[132:135], a[60:63]
  ds_read_b64_tr_b16 v[70:71], v20 offset:17408
  v_mfma_f32_16x16x32_bf16 a[92:95], v[80:83], v[136:139], a[92:95]
  v_mfma_f32_16x16x32_bf16 a[124:127], v[80:83], v[140:143], a[124:127]
  buffer_load_dwordx4 v33, s[12:15], s36 offen offset:1024 lds
  v_mfma_f32_16x16x32_bf16 a[156:159], v[80:83], v[144:147], a[156:159]
  v_mfma_f32_16x16x32_bf16 a[188:191], v[80:83], v[148:151], a[188:191]
  v_mfma_f32_16x16x32_bf16 a[220:223], v[80:83], v[152:155], a[220:223]
  v_mfma_f32_16x16x32_bf16 a[252:255], v[80:83], v[156:159], a[252:255]
  buffer_load_dwordx4 v34, s[12:15], s36 offen offset:2048 lds
  s_waitcnt lgkmcnt(4)
  v_mfma_f32_16x16x32_bf16 a[0:3], v[52:55], v[160:163], a[0:3]
  ds_read_b64_tr_b16 v[72:73], v21 offset:16384
  v_mfma_f32_16x16x32_bf16 a[32:35], v[52:55], v[164:167], a[32:35]
  ds_read_b64_tr_b16 v[74:75], v21 offset:17408
  v_mfma_f32_16x16x32_bf16 a[64:67], v[52:55], v[168:171], a[64:67]
  v_mfma_f32_16x16x32_bf16 a[96:99], v[52:55], v[172:175], a[96:99]
  buffer_load_dwordx4 v35, s[12:15], s36 offen offset:3072 lds
  v_mfma_f32_16x16x32_bf16 a[128:131], v[52:55], v[176:179], a[128:131]
  v_mfma_f32_16x16x32_bf16 a[160:163], v[52:55], v[180:183], a[160:163]
  v_mfma_f32_16x16x32_bf16 a[192:195], v[52:55], v[184:187], a[192:195]
  v_mfma_f32_16x16x32_bf16 a[224:227], v[52:55], v[188:191], a[224:227]
  v_mfma_f32_16x16x32_bf16 a[4:7], v[56:59], v[160:163], a[4:7]
  ds_read_b64_tr_b16 v[76:77], v22 offset:16384
  v_mfma_f32_16x16x32_bf16 a[36:39], v[56:59], v[164:167], a[36:39]
  ds_read_b64_tr_b16 v[78:79], v22 offset:17408
  v_mfma_f32_16x16x32_bf16 a[68:71], v[56:59], v[168:171], a[68:71]
  v_mfma_f32_16x16x32_bf16 a[100:103], v[56:59], v[172:175], a[100:103]
  v_mfma_f32_16x16x32_bf16 a[132:135], v[56:59], v[176:179], a[132:135]
  v_mfma_f32_16x16x32_bf16 a[164:167], v[56:59], v[180:183], a[164:167]
  v_mfma_f32_16x16x32_bf16 a[196:199], v[56:59], v[184:187], a[196:199]
  v_mfma_f32_16x16x32_bf16 a[228:231], v[56:59], v[188:191], a[228:231]
  v_mfma_f32_16x16x32_bf16 a[8:11], v[60:63], v[160:163], a[8:11]
  ds_read_b64_tr_b16 v[80:81], v23 offset:16384
  v_mfma_f32_16x16x32_bf16 a[40:43], v[60:63], v[164:167], a[40:43]
  ds_read_b64_tr_b16 v[82:83], v23 offset:17408
  v_mfma_f32_16x16x32_bf16 a[72:75], v[60:63], v[168:171], a[72:75]
  v_mfma_f32_16x16x32_bf16 a[104:107], v[60:63], v[172:175], a[104:107]
  v_mfma_f32_16x16x32_bf16 a[136:139], v[60:63], v[176:179], a[136:139]
  v_mfma_f32_16x16x32_bf16 a[168:171], v[60:63], v[180:183], a[168:171]
  v_mfma_f32_16x16x32_bf16 a[200:203], v[60:63], v[184:187], a[200:203]
  v_mfma_f32_16x16x32_bf16 a[232:235], v[60:63], v[188:191], a[232:235]
  s_waitcnt lgkmcnt(8)
  v_mfma_f32_16x16x32_bf16 a[12:15], v[64:67], v[160:163], a[12:15]
  s_waitcnt vmcnt(8)
  s_barrier
  ds_read_b64_tr_b16 v[52:53], v16 offset:32768
  v_mfma_f32_16x16x32_bf16 a[44:47], v[64:67], v[164:167], a[44:47]
  ds_read_b64_tr_b16 v[54:55], v16 offset:33792
  v_mfma_f32_16x16x32_bf16 a[76:79], v[64:67], v[168:171], a[76:79]
  ds_read_b128 v[128:131], v40 offset:0
  v_mfma_f32_16x16x32_bf16 a[108:111], v[64:67], v[172:175], a[108:111]
  s_add_u32 m0, s50, 0
  s_xor_b32 s36, s49, 4
  s_lshl_b32 s36, s36, 19
  v_mfma_f32_16x16x32_bf16 a[140:143], v[64:67], v[176:179], a[140:143]
  ds_read_b128 v[132:135], v40 offset:2048
  v_mfma_f32_16x16x32_bf16 a[172:175], v[64:67], v[180:183], a[172:175]
  v_mfma_f32_16x16x32_bf16 a[204:207], v[64:67], v[184:187], a[204:207]
  ds_read_b128 v[136:139], v40 offset:4096
  v_mfma_f32_16x16x32_bf16 a[236:239], v[64:67], v[188:191], a[236:239]
  buffer_load_dwordx4 v46, s[16:19], s36 offen offset:0 lds
  s_waitcnt lgkmcnt(11)
  v_mfma_f32_16x16x32_bf16 a[16:19], v[68:71], v[160:163], a[16:19]
  ds_read_b64_tr_b16 v[56:57], v17 offset:32768
  v_mfma_f32_16x16x32_bf16 a[48:51], v[68:71], v[164:167], a[48:51]
  ds_read_b64_tr_b16 v[58:59], v17 offset:33792
  v_mfma_f32_16x16x32_bf16 a[80:83], v[68:71], v[168:171], a[80:83]
  ds_read_b128 v[140:143], v40 offset:6144
  v_mfma_f32_16x16x32_bf16 a[112:115], v[68:71], v[172:175], a[112:115]
  buffer_load_dwordx4 v47, s[16:19], s36 offen offset:1024 lds
  v_mfma_f32_16x16x32_bf16 a[144:147], v[68:71], v[176:179], a[144:147]
  ds_read_b128 v[144:147], v40 offset:8192
  v_mfma_f32_16x16x32_bf16 a[176:179], v[68:71], v[180:183], a[176:179]
  v_mfma_f32_16x16x32_bf16 a[208:211], v[68:71], v[184:187], a[208:211]
  ds_read_b128 v[148:151], v40 offset:10240
  v_mfma_f32_16x16x32_bf16 a[240:243], v[68:71], v[188:191], a[240:243]
  s_add_u32 m0, s50, 8192
  s_nop 0
  s_waitcnt lgkmcnt(14)
  v_mfma_f32_16x16x32_bf16 a[20:23], v[72:75], v[160:163], a[20:23]
  ds_read_b64_tr_b16 v[60:61], v18 offset:32768
  v_mfma_f32_16x16x32_bf16 a[52:55], v[72:75], v[164:167], a[52:55]
  ds_read_b64_tr_b16 v[62:63], v18 offset:33792
  v_mfma_f32_16x16x32_bf16 a[84:87], v[72:75], v[168:171], a[84:87]
  ds_read_b128 v[152:155], v40 offset:12288
  v_mfma_f32_16x16x32_bf16 a[116:119], v[72:75], v[172:175], a[116:119]
  buffer_load_dwordx4 v46, s[20:23], s36 offen offset:0 lds
  v_mfma_f32_16x16x32_bf16 a[148:151], v[72:75], v[176:179], a[148:151]
  ds_read_b128 v[156:159], v40 offset:14336
  v_mfma_f32_16x16x32_bf16 a[180:183], v[72:75], v[180:183], a[180:183]
  v_mfma_f32_16x16x32_bf16 a[212:215], v[72:75], v[184:187], a[212:215]
  v_mfma_f32_16x16x32_bf16 a[244:247], v[72:75], v[188:191], a[244:247]
  buffer_load_dwordx4 v47, s[20:23], s36 offen offset:1024 lds
  s_waitcnt lgkmcnt(15)
  v_mfma_f32_16x16x32_bf16 a[24:27], v[76:79], v[160:163], a[24:27]
  ds_read_b64_tr_b16 v[64:65], v19 offset:32768
  v_mfma_f32_16x16x32_bf16 a[56:59], v[76:79], v[164:167], a[56:59]
  ds_read_b64_tr_b16 v[66:67], v19 offset:33792
  v_mfma_f32_16x16x32_bf16 a[88:91], v[76:79], v[168:171], a[88:91]
  v_mfma_f32_16x16x32_bf16 a[120:123], v[76:79], v[172:175], a[120:123]
  s_add_u32 m0, s44, 102400
  s_xor_b32 s36, s49, 4
  s_lshl_b32 s36, s36, 7
  s_add_u32 s36, s36, 32768
  v_mfma_f32_16x16x32_bf16 a[152:155], v[76:79], v[176:179], a[152:155]
  v_mfma_f32_16x16x32_bf16 a[184:187], v[76:79], v[180:183], a[184:187]
  v_mfma_f32_16x16x32_bf16 a[216:219], v[76:79], v[184:187], a[216:219]
  v_mfma_f32_16x16x32_bf16 a[248:251], v[76:79], v[188:191], a[248:251]
  buffer_load_dwordx4 v32, s[12:15], s36 offen offset:0 lds
  s_waitcnt lgkmcnt(15)
  v_mfma_f32_16x16x32_bf16 a[28:31], v[80:83], v[160:163], a[28:31]
  ds_read_b64_tr_b16 v[68:69], v20 offset:32768
  v_mfma_f32_16x16x32_bf16 a[60:63], v[80:83], v[164:167], a[60:63]
  ds_read_b64_tr_b16 v[70:71], v20 offset:33792
  v_mfma_f32_16x16x32_bf16 a[92:95], v[80:83], v[168:171], a[92:95]
  v_mfma_f32_16x16x32_bf16 a[124:127], v[80:83], v[172:175], a[124:127]
  buffer_load_dwordx4 v33, s[12:15], s36 offen offset:1024 lds
  v_mfma_f32_16x16x32_bf16 a[156:159], v[80:83], v[176:179], a[156:159]
  v_mfma_f32_16x16x32_bf16 a[188:191], v[80:83], v[180:183], a[188:191]
  v_mfma_f32_16x16x32_bf16 a[220:223], v[80:83], v[184:187], a[220:223]
  v_mfma_f32_16x16x32_bf16 a[252:255], v[80:83], v[188:191], a[252:255]
  buffer_load_dwordx4 v34, s[12:15], s36 offen offset:2048 lds
  s_waitcnt lgkmcnt(4)
  v_mfma_f32_16x16x32_bf16 a[0:3], v[52:55], v[128:131], a[0:3]
  ds_read_b64_tr_b16 v[72:73], v21 offset:32768
  v_mfma_f32_16x16x32_bf16 a[32:35], v[52:55], v[132:135], a[32:35]
  ds_read_b64_tr_b16 v[74:75], v21 offset:33792
  v_mfma_f32_16x16x32_bf16 a[64:67], v[52:55], v[136:139], a[64:67]
  v_mfma_f32_16x16x32_bf16 a[96:99], v[52:55], v[140:143], a[96:99]
  buffer_load_dwordx4 v35, s[12:15], s36 offen offset:3072 lds
  v_mfma_f32_16x16x32_bf16 a[128:131], v[52:55], v[144:147], a[128:131]
  v_mfma_f32_16x16x32_bf16 a[160:163], v[52:55], v[148:151], a[160:163]
  v_mfma_f32_16x16x32_bf16 a[192:195], v[52:55], v[152:155], a[192:195]
  v_mfma_f32_16x16x32_bf16 a[224:227], v[52:55], v[156:159], a[224:227]
  v_mfma_f32_16x16x32_bf16 a[4:7], v[56:59], v[128:131], a[4:7]
  ds_read_b64_tr_b16 v[76:77], v22 offset:32768
  v_mfma_f32_16x16x32_bf16 a[36:39], v[56:59], v[132:135], a[36:39]
  ds_read_b64_tr_b16 v[78:79], v22 offset:33792
  v_mfma_f32_16x16x32_bf16 a[68:71], v[56:59], v[136:139], a[68:71]
  v_mfma_f32_16x16x32_bf16 a[100:103], v[56:59], v[140:143], a[100:103]
  v_mfma_f32_16x16x32_bf16 a[132:135], v[56:59], v[144:147], a[132:135]
  v_mfma_f32_16x16x32_bf16 a[164:167], v[56:59], v[148:151], a[164:167]
  v_mfma_f32_16x16x32_bf16 a[196:199], v[56:59], v[152:155], a[196:199]
  v_mfma_f32_16x16x32_bf16 a[228:231], v[56:59], v[156:159], a[228:231]
  v_mfma_f32_16x16x32_bf16 a[8:11], v[60:63], v[128:131], a[8:11]
  ds_read_b64_tr_b16 v[80:81], v23 offset:32768
  v_mfma_f32_16x16x32_bf16 a[40:43], v[60:63], v[132:135], a[40:43]
  ds_read_b64_tr_b16 v[82:83], v23 offset:33792
  v_mfma_f32_16x16x32_bf16 a[72:75], v[60:63], v[136:139], a[72:75]
  v_mfma_f32_16x16x32_bf16 a[104:107], v[60:63], v[140:143], a[104:107]
  v_mfma_f32_16x16x32_bf16 a[136:139], v[60:63], v[144:147], a[136:139]
  v_mfma_f32_16x16x32_bf16 a[168:171], v[60:63], v[148:151], a[168:171]
  v_mfma_f32_16x16x32_bf16 a[200:203], v[60:63], v[152:155], a[200:203]
  v_mfma_f32_16x16x32_bf16 a[232:235], v[60:63], v[156:159], a[232:235]
  s_waitcnt lgkmcnt(8)
  v_mfma_f32_16x16x32_bf16 a[12:15], v[64:67], v[128:131], a[12:15]
  s_waitcnt vmcnt(12)
  s_barrier
  ds_read_b64_tr_b16 v[52:53], v16 offset:49152
  v_mfma_f32_16x16x32_bf16 a[44:47], v[64:67], v[132:135], a[44:47]
  ds_read_b64_tr_b16 v[54:55], v16 offset:50176
  v_mfma_f32_16x16x32_bf16 a[76:79], v[64:67], v[136:139], a[76:79]
  ds_read_b128 v[160:163], v41 offset:0
  v_mfma_f32_16x16x32_bf16 a[108:111], v[64:67], v[140:143], a[108:111]
  s_add_u32 m0, s50, 16384
  s_xor_b32 s36, s49, 4
  s_lshl_b32 s36, s36, 19
  s_add_u32 s36, s36, 262144
  v_mfma_f32_16x16x32_bf16 a[140:143], v[64:67], v[144:147], a[140:143]
  ds_read_b128 v[164:167], v41 offset:2048
  v_mfma_f32_16x16x32_bf16 a[172:175], v[64:67], v[148:151], a[172:175]
  v_mfma_f32_16x16x32_bf16 a[204:207], v[64:67], v[152:155], a[204:207]
  ds_read_b128 v[168:171], v41 offset:4096
  v_mfma_f32_16x16x32_bf16 a[236:239], v[64:67], v[156:159], a[236:239]
  buffer_load_dwordx4 v46, s[16:19], s36 offen offset:0 lds
  s_waitcnt lgkmcnt(11)
  v_mfma_f32_16x16x32_bf16 a[16:19], v[68:71], v[128:131], a[16:19]
  ds_read_b64_tr_b16 v[56:57], v17 offset:49152
  v_mfma_f32_16x16x32_bf16 a[48:51], v[68:71], v[132:135], a[48:51]
  ds_read_b64_tr_b16 v[58:59], v17 offset:50176
  v_mfma_f32_16x16x32_bf16 a[80:83], v[68:71], v[136:139], a[80:83]
  ds_read_b128 v[172:175], v41 offset:6144
  v_mfma_f32_16x16x32_bf16 a[112:115], v[68:71], v[140:143], a[112:115]
  buffer_load_dwordx4 v47, s[16:19], s36 offen offset:1024 lds
  v_mfma_f32_16x16x32_bf16 a[144:147], v[68:71], v[144:147], a[144:147]
  ds_read_b128 v[176:179], v41 offset:8192
  v_mfma_f32_16x16x32_bf16 a[176:179], v[68:71], v[148:151], a[176:179]
  v_mfma_f32_16x16x32_bf16 a[208:211], v[68:71], v[152:155], a[208:211]
  ds_read_b128 v[180:183], v41 offset:10240
  v_mfma_f32_16x16x32_bf16 a[240:243], v[68:71], v[156:159], a[240:243]
  s_add_u32 m0, s50, 24576
  s_nop 0
  s_waitcnt lgkmcnt(14)
  v_mfma_f32_16x16x32_bf16 a[20:23], v[72:75], v[128:131], a[20:23]
  ds_read_b64_tr_b16 v[60:61], v18 offset:49152
  v_mfma_f32_16x16x32_bf16 a[52:55], v[72:75], v[132:135], a[52:55]
  ds_read_b64_tr_b16 v[62:63], v18 offset:50176
  v_mfma_f32_16x16x32_bf16 a[84:87], v[72:75], v[136:139], a[84:87]
  ds_read_b128 v[184:187], v41 offset:12288
  v_mfma_f32_16x16x32_bf16 a[116:119], v[72:75], v[140:143], a[116:119]
  buffer_load_dwordx4 v46, s[20:23], s36 offen offset:0 lds
  v_mfma_f32_16x16x32_bf16 a[148:151], v[72:75], v[144:147], a[148:151]
  ds_read_b128 v[188:191], v41 offset:14336
  v_mfma_f32_16x16x32_bf16 a[180:183], v[72:75], v[148:151], a[180:183]
  v_mfma_f32_16x16x32_bf16 a[212:215], v[72:75], v[152:155], a[212:215]
  v_mfma_f32_16x16x32_bf16 a[244:247], v[72:75], v[156:159], a[244:247]
  buffer_load_dwordx4 v47, s[20:23], s36 offen offset:1024 lds
  s_waitcnt lgkmcnt(15)
  v_mfma_f32_16x16x32_bf16 a[24:27], v[76:79], v[128:131], a[24:27]
  ds_read_b64_tr_b16 v[64:65], v19 offset:49152
  v_mfma_f32_16x16x32_bf16 a[56:59], v[76:79], v[132:135], a[56:59]
  ds_read_b64_tr_b16 v[66:67], v19 offset:50176
  v_mfma_f32_16x16x32_bf16 a[88:91], v[76:79], v[136:139], a[88:91]
  v_mfma_f32_16x16x32_bf16 a[120:123], v[76:79], v[140:143], a[120:123]
  s_add_u32 m0, s44, 131072
  s_xor_b32 s36, s49, 5
  s_lshl_b32 s36, s36, 7
  v_mfma_f32_16x16x32_bf16 a[152:155], v[76:79], v[144:147], a[152:155]
  v_mfma_f32_16x16x32_bf16 a[184:187], v[76:79], v[148:151], a[184:187]
  v_mfma_f32_16x16x32_bf16 a[216:219], v[76:79], v[152:155], a[216:219]
  v_mfma_f32_16x16x32_bf16 a[248:251], v[76:79], v[156:159], a[248:251]
  buffer_load_dwordx4 v32, s[12:15], s36 offen offset:0 lds
  s_waitcnt lgkmcnt(15)
  v_mfma_f32_16x16x32_bf16 a[28:31], v[80:83], v[128:131], a[28:31]
  ds_read_b64_tr_b16 v[68:69], v20 offset:49152
  v_mfma_f32_16x16x32_bf16 a[60:63], v[80:83], v[132:135], a[60:63]
  ds_read_b64_tr_b16 v[70:71], v20 offset:50176
  v_mfma_f32_16x16x32_bf16 a[92:95], v[80:83], v[136:139], a[92:95]
  v_mfma_f32_16x16x32_bf16 a[124:127], v[80:83], v[140:143], a[124:127]
  buffer_load_dwordx4 v33, s[12:15], s36 offen offset:1024 lds
  v_mfma_f32_16x16x32_bf16 a[156:159], v[80:83], v[144:147], a[156:159]
  v_mfma_f32_16x16x32_bf16 a[188:191], v[80:83], v[148:151], a[188:191]
  v_mfma_f32_16x16x32_bf16 a[220:223], v[80:83], v[152:155], a[220:223]
  v_mfma_f32_16x16x32_bf16 a[252:255], v[80:83], v[156:159], a[252:255]
  buffer_load_dwordx4 v34, s[12:15], s36 offen offset:2048 lds
  s_waitcnt lgkmcnt(4)
  v_mfma_f32_16x16x32_bf16 a[0:3], v[52:55], v[160:163], a[0:3]
  ds_read_b64_tr_b16 v[72:73], v21 offset:49152
  v_mfma_f32_16x16x32_bf16 a[32:35], v[52:55], v[164:167], a[32:35]
  ds_read_b64_tr_b16 v[74:75], v21 offset:50176
  v_mfma_f32_16x16x32_bf16 a[64:67], v[52:55], v[168:171], a[64:67]
  v_mfma_f32_16x16x32_bf16 a[96:99], v[52:55], v[172:175], a[96:99]
  buffer_load_dwordx4 v35, s[12:15], s36 offen offset:3072 lds
  v_mfma_f32_16x16x32_bf16 a[128:131], v[52:55], v[176:179], a[128:131]
  v_mfma_f32_16x16x32_bf16 a[160:163], v[52:55], v[180:183], a[160:163]
  v_mfma_f32_16x16x32_bf16 a[192:195], v[52:55], v[184:187], a[192:195]
  v_mfma_f32_16x16x32_bf16 a[224:227], v[52:55], v[188:191], a[224:227]
  v_mfma_f32_16x16x32_bf16 a[4:7], v[56:59], v[160:163], a[4:7]
  ds_read_b64_tr_b16 v[76:77], v22 offset:49152
  v_mfma_f32_16x16x32_bf16 a[36:39], v[56:59], v[164:167], a[36:39]
  ds_read_b64_tr_b16 v[78:79], v22 offset:50176
  v_mfma_f32_16x16x32_bf16 a[68:71], v[56:59], v[168:171], a[68:71]
  v_mfma_f32_16x16x32_bf16 a[100:103], v[56:59], v[172:175], a[100:103]
  v_mfma_f32_16x16x32_bf16 a[132:135], v[56:59], v[176:179], a[132:135]
  v_mfma_f32_16x16x32_bf16 a[164:167], v[56:59], v[180:183], a[164:167]
  v_mfma_f32_16x16x32_bf16 a[196:199], v[56:59], v[184:187], a[196:199]
  v_mfma_f32_16x16x32_bf16 a[228:231], v[56:59], v[188:191], a[228:231]
  v_mfma_f32_16x16x32_bf16 a[8:11], v[60:63], v[160:163], a[8:11]
  ds_read_b64_tr_b16 v[80:81], v23 offset:49152
  v_mfma_f32_16x16x32_bf16 a[40:43], v[60:63], v[164:167], a[40:43]
  ds_read_b64_tr_b16 v[82:83], v23 offset:50176
  v_mfma_f32_16x16x32_bf16 a[72:75], v[60:63], v[168:171], a[72:75]
  v_mfma_f32_16x16x32_bf16 a[104:107], v[60:63], v[172:175], a[104:107]
  v_mfma_f32_16x16x32_bf16 a[136:139], v[60:63], v[176:179], a[136:139]
  v_mfma_f32_16x16x32_bf16 a[168:171], v[60:63], v[180:183], a[168:171]
  v_mfma_f32_16x16x32_bf16 a[200:203], v[60:63], v[184:187], a[200:203]
  v_mfma_f32_16x16x32_bf16 a[232:235], v[60:63], v[188:191], a[232:235]
  s_waitcnt lgkmcnt(8)
  v_mfma_f32_16x16x32_bf16 a[12:15], v[64:67], v[160:163], a[12:15]
  s_waitcnt vmcnt(8)
  s_barrier
  ds_read_b64_tr_b16 v[52:53], v16 offset:0
  v_mfma_f32_16x16x32_bf16 a[44:47], v[64:67], v[164:167], a[44:47]
  ds_read_b64_tr_b16 v[54:55], v16 offset:1024
  v_mfma_f32_16x16x32_bf16 a[76:79], v[64:67], v[168:171], a[76:79]
  ds_read_b128 v[128:131], v40 offset:32768
  v_mfma_f32_16x16x32_bf16 a[108:111], v[64:67], v[172:175], a[108:111]
  s_add_u32 m0, s50, 32768
  s_xor_b32 s36, s49, 5
  s_lshl_b32 s36, s36, 19
  v_mfma_f32_16x16x32_bf16 a[140:143], v[64:67], v[176:179], a[140:143]
  ds_read_b128 v[132:135], v40 offset:34816
  v_mfma_f32_16x16x32_bf16 a[172:175], v[64:67], v[180:183], a[172:175]
  v_mfma_f32_16x16x32_bf16 a[204:207], v[64:67], v[184:187], a[204:207]
  ds_read_b128 v[136:139], v40 offset:36864
  v_mfma_f32_16x16x32_bf16 a[236:239], v[64:67], v[188:191], a[236:239]
  buffer_load_dwordx4 v46, s[16:19], s36 offen offset:0 lds
  s_waitcnt lgkmcnt(11)
  v_mfma_f32_16x16x32_bf16 a[16:19], v[68:71], v[160:163], a[16:19]
  ds_read_b64_tr_b16 v[56:57], v17 offset:0
  v_mfma_f32_16x16x32_bf16 a[48:51], v[68:71], v[164:167], a[48:51]
  ds_read_b64_tr_b16 v[58:59], v17 offset:1024
  v_mfma_f32_16x16x32_bf16 a[80:83], v[68:71], v[168:171], a[80:83]
  ds_read_b128 v[140:143], v40 offset:38912
  v_mfma_f32_16x16x32_bf16 a[112:115], v[68:71], v[172:175], a[112:115]
  buffer_load_dwordx4 v47, s[16:19], s36 offen offset:1024 lds
  v_mfma_f32_16x16x32_bf16 a[144:147], v[68:71], v[176:179], a[144:147]
  ds_read_b128 v[144:147], v40 offset:40960
  v_mfma_f32_16x16x32_bf16 a[176:179], v[68:71], v[180:183], a[176:179]
  v_mfma_f32_16x16x32_bf16 a[208:211], v[68:71], v[184:187], a[208:211]
  ds_read_b128 v[148:151], v40 offset:43008
  v_mfma_f32_16x16x32_bf16 a[240:243], v[68:71], v[188:191], a[240:243]
  s_add_u32 m0, s50, 40960
  s_nop 0
  s_waitcnt lgkmcnt(14)
  v_mfma_f32_16x16x32_bf16 a[20:23], v[72:75], v[160:163], a[20:23]
  ds_read_b64_tr_b16 v[60:61], v18 offset:0
  v_mfma_f32_16x16x32_bf16 a[52:55], v[72:75], v[164:167], a[52:55]
  ds_read_b64_tr_b16 v[62:63], v18 offset:1024
  v_mfma_f32_16x16x32_bf16 a[84:87], v[72:75], v[168:171], a[84:87]
  ds_read_b128 v[152:155], v40 offset:45056
  v_mfma_f32_16x16x32_bf16 a[116:119], v[72:75], v[172:175], a[116:119]
  buffer_load_dwordx4 v46, s[20:23], s36 offen offset:0 lds
  v_mfma_f32_16x16x32_bf16 a[148:151], v[72:75], v[176:179], a[148:151]
  ds_read_b128 v[156:159], v40 offset:47104
  v_mfma_f32_16x16x32_bf16 a[180:183], v[72:75], v[180:183], a[180:183]
  v_mfma_f32_16x16x32_bf16 a[212:215], v[72:75], v[184:187], a[212:215]
  v_mfma_f32_16x16x32_bf16 a[244:247], v[72:75], v[188:191], a[244:247]
  buffer_load_dwordx4 v47, s[20:23], s36 offen offset:1024 lds
  s_waitcnt lgkmcnt(15)
  v_mfma_f32_16x16x32_bf16 a[24:27], v[76:79], v[160:163], a[24:27]
  ds_read_b64_tr_b16 v[64:65], v19 offset:0
  v_mfma_f32_16x16x32_bf16 a[56:59], v[76:79], v[164:167], a[56:59]
  ds_read_b64_tr_b16 v[66:67], v19 offset:1024
  v_mfma_f32_16x16x32_bf16 a[88:91], v[76:79], v[168:171], a[88:91]
  v_mfma_f32_16x16x32_bf16 a[120:123], v[76:79], v[172:175], a[120:123]
  s_add_u32 m0, s44, 135168
  s_xor_b32 s36, s49, 5
  s_lshl_b32 s36, s36, 7
  s_add_u32 s36, s36, 32768
  v_mfma_f32_16x16x32_bf16 a[152:155], v[76:79], v[176:179], a[152:155]
  v_mfma_f32_16x16x32_bf16 a[184:187], v[76:79], v[180:183], a[184:187]
  v_mfma_f32_16x16x32_bf16 a[216:219], v[76:79], v[184:187], a[216:219]
  v_mfma_f32_16x16x32_bf16 a[248:251], v[76:79], v[188:191], a[248:251]
  buffer_load_dwordx4 v32, s[12:15], s36 offen offset:0 lds
  s_waitcnt lgkmcnt(15)
  v_mfma_f32_16x16x32_bf16 a[28:31], v[80:83], v[160:163], a[28:31]
  ds_read_b64_tr_b16 v[68:69], v20 offset:0
  v_mfma_f32_16x16x32_bf16 a[60:63], v[80:83], v[164:167], a[60:63]
  ds_read_b64_tr_b16 v[70:71], v20 offset:1024
  v_mfma_f32_16x16x32_bf16 a[92:95], v[80:83], v[168:171], a[92:95]
  v_mfma_f32_16x16x32_bf16 a[124:127], v[80:83], v[172:175], a[124:127]
  buffer_load_dwordx4 v33, s[12:15], s36 offen offset:1024 lds
  v_mfma_f32_16x16x32_bf16 a[156:159], v[80:83], v[176:179], a[156:159]
  v_mfma_f32_16x16x32_bf16 a[188:191], v[80:83], v[180:183], a[188:191]
  v_mfma_f32_16x16x32_bf16 a[220:223], v[80:83], v[184:187], a[220:223]
  v_mfma_f32_16x16x32_bf16 a[252:255], v[80:83], v[188:191], a[252:255]
  buffer_load_dwordx4 v34, s[12:15], s36 offen offset:2048 lds
  s_waitcnt lgkmcnt(4)
  v_mfma_f32_16x16x32_bf16 a[0:3], v[52:55], v[128:131], a[0:3]
  ds_read_b64_tr_b16 v[72:73], v21 offset:0
  v_mfma_f32_16x16x32_bf16 a[32:35], v[52:55], v[132:135], a[32:35]
  ds_read_b64_tr_b16 v[74:75], v21 offset:1024
  v_mfma_f32_16x16x32_bf16 a[64:67], v[52:55], v[136:139], a[64:67]
  v_mfma_f32_16x16x32_bf16 a[96:99], v[52:55], v[140:143], a[96:99]
  buffer_load_dwordx4 v35, s[12:15], s36 offen offset:3072 lds
  v_mfma_f32_16x16x32_bf16 a[128:131], v[52:55], v[144:147], a[128:131]
  v_mfma_f32_16x16x32_bf16 a[160:163], v[52:55], v[148:151], a[160:163]
  v_mfma_f32_16x16x32_bf16 a[192:195], v[52:55], v[152:155], a[192:195]
  v_mfma_f32_16x16x32_bf16 a[224:227], v[52:55], v[156:159], a[224:227]
  v_lshlrev_b32 v243, 2, v1
  buffer_load_dword v242, v243, s[4:7], 0 offen sc1
  v_mfma_f32_16x16x32_bf16 a[4:7], v[56:59], v[128:131], a[4:7]
  ds_read_b64_tr_b16 v[76:77], v22 offset:0
  v_mfma_f32_16x16x32_bf16 a[36:39], v[56:59], v[132:135], a[36:39]
  ds_read_b64_tr_b16 v[78:79], v22 offset:1024
  v_mfma_f32_16x16x32_bf16 a[68:71], v[56:59], v[136:139], a[68:71]
  v_mfma_f32_16x16x32_bf16 a[100:103], v[56:59], v[140:143], a[100:103]
  v_mfma_f32_16x16x32_bf16 a[132:135], v[56:59], v[144:147], a[132:135]
  v_mfma_f32_16x16x32_bf16 a[164:167], v[56:59], v[148:151], a[164:167]
  v_mfma_f32_16x16x32_bf16 a[196:199], v[56:59], v[152:155], a[196:199]
  v_mfma_f32_16x16x32_bf16 a[228:231], v[56:59], v[156:159], a[228:231]
  v_mfma_f32_16x16x32_bf16 a[8:11], v[60:63], v[128:131], a[8:11]
  ds_read_b64_tr_b16 v[80:81], v23 offset:0
  v_mfma_f32_16x16x32_bf16 a[40:43], v[60:63], v[132:135], a[40:43]
  ds_read_b64_tr_b16 v[82:83], v23 offset:1024
  v_mfma_f32_16x16x32_bf16 a[72:75], v[60:63], v[136:139], a[72:75]
  v_mfma_f32_16x16x32_bf16 a[104:107], v[60:63], v[140:143], a[104:107]
  v_mfma_f32_16x16x32_bf16 a[136:139], v[60:63], v[144:147], a[136:139]
  v_mfma_f32_16x16x32_bf16 a[168:171], v[60:63], v[148:151], a[168:171]
  v_mfma_f32_16x16x32_bf16 a[200:203], v[60:63], v[152:155], a[200:203]
  v_mfma_f32_16x16x32_bf16 a[232:235], v[60:63], v[156:159], a[232:235]
  s_waitcnt lgkmcnt(8)
  v_mfma_f32_16x16x32_bf16 a[12:15], v[64:67], v[128:131], a[12:15]
  s_waitcnt vmcnt(13)
  s_barrier
  ds_read_b64_tr_b16 v[52:53], v16 offset:16384
  v_mfma_f32_16x16x32_bf16 a[44:47], v[64:67], v[132:135], a[44:47]
  ds_read_b64_tr_b16 v[54:55], v16 offset:17408
  v_mfma_f32_16x16x32_bf16 a[76:79], v[64:67], v[136:139], a[76:79]
  ds_read_b128 v[160:163], v41 offset:32768
  v_mfma_f32_16x16x32_bf16 a[108:111], v[64:67], v[140:143], a[108:111]
  s_add_u32 m0, s50, 49152
  s_xor_b32 s36, s49, 5
  s_lshl_b32 s36, s36, 19
  s_add_u32 s36, s36, 262144
  v_mfma_f32_16x16x32_bf16 a[140:143], v[64:67], v[144:147], a[140:143]
  ds_read_b128 v[164:167], v41 offset:34816
  v_mfma_f32_16x16x32_bf16 a[172:175], v[64:67], v[148:151], a[172:175]
  v_mfma_f32_16x16x32_bf16 a[204:207], v[64:67], v[152:155], a[204:207]
  ds_read_b128 v[168:171], v41 offset:36864
  v_mfma_f32_16x16x32_bf16 a[236:239], v[64:67], v[156:159], a[236:239]
  buffer_load_dwordx4 v46, s[16:19], s36 offen offset:0 lds
  s_waitcnt lgkmcnt(11)
  v_mfma_f32_16x16x32_bf16 a[16:19], v[68:71], v[128:131], a[16:19]
  ds_read_b64_tr_b16 v[56:57], v17 offset:16384
  v_mfma_f32_16x16x32_bf16 a[48:51], v[68:71], v[132:135], a[48:51]
  ds_read_b64_tr_b16 v[58:59], v17 offset:17408
  v_mfma_f32_16x16x32_bf16 a[80:83], v[68:71], v[136:139], a[80:83]
  ds_read_b128 v[172:175], v41 offset:38912
  v_mfma_f32_16x16x32_bf16 a[112:115], v[68:71], v[140:143], a[112:115]
  buffer_load_dwordx4 v47, s[16:19], s36 offen offset:1024 lds
  v_mfma_f32_16x16x32_bf16 a[144:147], v[68:71], v[144:147], a[144:147]
  ds_read_b128 v[176:179], v41 offset:40960
  v_mfma_f32_16x16x32_bf16 a[176:179], v[68:71], v[148:151], a[176:179]
  v_mfma_f32_16x16x32_bf16 a[208:211], v[68:71], v[152:155], a[208:211]
  ds_read_b128 v[180:183], v41 offset:43008
  v_mfma_f32_16x16x32_bf16 a[240:243], v[68:71], v[156:159], a[240:243]
  s_add_u32 m0, s50, 57344
  s_nop 0
  s_waitcnt lgkmcnt(14)
  v_mfma_f32_16x16x32_bf16 a[20:23], v[72:75], v[128:131], a[20:23]
  ds_read_b64_tr_b16 v[60:61], v18 offset:16384
  v_mfma_f32_16x16x32_bf16 a[52:55], v[72:75], v[132:135], a[52:55]
  ds_read_b64_tr_b16 v[62:63], v18 offset:17408
  v_mfma_f32_16x16x32_bf16 a[84:87], v[72:75], v[136:139], a[84:87]
  ds_read_b128 v[184:187], v41 offset:45056
  v_mfma_f32_16x16x32_bf16 a[116:119], v[72:75], v[140:143], a[116:119]
  buffer_load_dwordx4 v46, s[20:23], s36 offen offset:0 lds
  v_mfma_f32_16x16x32_bf16 a[148:151], v[72:75], v[144:147], a[148:151]
  ds_read_b128 v[188:191], v41 offset:47104
  v_mfma_f32_16x16x32_bf16 a[180:183], v[72:75], v[148:151], a[180:183]
  v_mfma_f32_16x16x32_bf16 a[212:215], v[72:75], v[152:155], a[212:215]
  v_mfma_f32_16x16x32_bf16 a[244:247], v[72:75], v[156:159], a[244:247]
  buffer_load_dwordx4 v47, s[20:23], s36 offen offset:1024 lds
  s_waitcnt lgkmcnt(15)
  v_mfma_f32_16x16x32_bf16 a[24:27], v[76:79], v[128:131], a[24:27]
  ds_read_b64_tr_b16 v[64:65], v19 offset:16384
  v_mfma_f32_16x16x32_bf16 a[56:59], v[76:79], v[132:135], a[56:59]
  ds_read_b64_tr_b16 v[66:67], v19 offset:17408
  v_mfma_f32_16x16x32_bf16 a[88:91], v[76:79], v[136:139], a[88:91]
  v_mfma_f32_16x16x32_bf16 a[120:123], v[76:79], v[140:143], a[120:123]
  s_add_u32 m0, s44, 65536
  s_xor_b32 s36, s49, 6
  s_lshl_b32 s36, s36, 7
  v_mfma_f32_16x16x32_bf16 a[152:155], v[76:79], v[144:147], a[152:155]
  v_mfma_f32_16x16x32_bf16 a[184:187], v[76:79], v[148:151], a[184:187]
  v_mfma_f32_16x16x32_bf16 a[216:219], v[76:79], v[152:155], a[216:219]
  v_mfma_f32_16x16x32_bf16 a[248:251], v[76:79], v[156:159], a[248:251]
  buffer_load_dwordx4 v32, s[12:15], s36 offen offset:0 lds
  s_waitcnt lgkmcnt(15)
  v_mfma_f32_16x16x32_bf16 a[28:31], v[80:83], v[128:131], a[28:31]
  ds_read_b64_tr_b16 v[68:69], v20 offset:16384
  v_mfma_f32_16x16x32_bf16 a[60:63], v[80:83], v[132:135], a[60:63]
  ds_read_b64_tr_b16 v[70:71], v20 offset:17408
  v_mfma_f32_16x16x32_bf16 a[92:95], v[80:83], v[136:139], a[92:95]
  v_mfma_f32_16x16x32_bf16 a[124:127], v[80:83], v[140:143], a[124:127]
  buffer_load_dwordx4 v33, s[12:15], s36 offen offset:1024 lds
  v_mfma_f32_16x16x32_bf16 a[156:159], v[80:83], v[144:147], a[156:159]
  v_mfma_f32_16x16x32_bf16 a[188:191], v[80:83], v[148:151], a[188:191]
  v_mfma_f32_16x16x32_bf16 a[220:223], v[80:83], v[152:155], a[220:223]
  v_mfma_f32_16x16x32_bf16 a[252:255], v[80:83], v[156:159], a[252:255]
  buffer_load_dwordx4 v34, s[12:15], s36 offen offset:2048 lds
  s_waitcnt lgkmcnt(4)
  v_mfma_f32_16x16x32_bf16 a[0:3], v[52:55], v[160:163], a[0:3]
  ds_read_b64_tr_b16 v[72:73], v21 offset:16384
  v_mfma_f32_16x16x32_bf16 a[32:35], v[52:55], v[164:167], a[32:35]
  ds_read_b64_tr_b16 v[74:75], v21 offset:17408
  v_mfma_f32_16x16x32_bf16 a[64:67], v[52:55], v[168:171], a[64:67]
  v_mfma_f32_16x16x32_bf16 a[96:99], v[52:55], v[172:175], a[96:99]
  buffer_load_dwordx4 v35, s[12:15], s36 offen offset:3072 lds
  v_mfma_f32_16x16x32_bf16 a[128:131], v[52:55], v[176:179], a[128:131]
  v_mfma_f32_16x16x32_bf16 a[160:163], v[52:55], v[180:183], a[160:163]
  v_mfma_f32_16x16x32_bf16 a[192:195], v[52:55], v[184:187], a[192:195]
  v_mfma_f32_16x16x32_bf16 a[224:227], v[52:55], v[188:191], a[224:227]
  v_mfma_f32_16x16x32_bf16 a[4:7], v[56:59], v[160:163], a[4:7]
  ds_read_b64_tr_b16 v[76:77], v22 offset:16384
  v_mfma_f32_16x16x32_bf16 a[36:39], v[56:59], v[164:167], a[36:39]
  ds_read_b64_tr_b16 v[78:79], v22 offset:17408
  v_mfma_f32_16x16x32_bf16 a[68:71], v[56:59], v[168:171], a[68:71]
  v_mfma_f32_16x16x32_bf16 a[100:103], v[56:59], v[172:175], a[100:103]
  v_mfma_f32_16x16x32_bf16 a[132:135], v[56:59], v[176:179], a[132:135]
  v_mfma_f32_16x16x32_bf16 a[164:167], v[56:59], v[180:183], a[164:167]
  v_mfma_f32_16x16x32_bf16 a[196:199], v[56:59], v[184:187], a[196:199]
  v_mfma_f32_16x16x32_bf16 a[228:231], v[56:59], v[188:191], a[228:231]
  v_mfma_f32_16x16x32_bf16 a[8:11], v[60:63], v[160:163], a[8:11]
  ds_read_b64_tr_b16 v[80:81], v23 offset:16384
  v_mfma_f32_16x16x32_bf16 a[40:43], v[60:63], v[164:167], a[40:43]
  ds_read_b64_tr_b16 v[82:83], v23 offset:17408
  v_mfma_f32_16x16x32_bf16 a[72:75], v[60:63], v[168:171], a[72:75]
  v_mfma_f32_16x16x32_bf16 a[104:107], v[60:63], v[172:175], a[104:107]
  v_mfma_f32_16x16x32_bf16 a[136:139], v[60:63], v[176:179], a[136:139]
  v_mfma_f32_16x16x32_bf16 a[168:171], v[60:63], v[180:183], a[168:171]
  v_mfma_f32_16x16x32_bf16 a[200:203], v[60:63], v[184:187], a[200:203]
  v_mfma_f32_16x16x32_bf16 a[232:235], v[60:63], v[188:191], a[232:235]
  s_waitcnt lgkmcnt(8)
  v_mfma_f32_16x16x32_bf16 a[12:15], v[64:67], v[160:163], a[12:15]
  s_waitcnt vmcnt(9)
  s_barrier
  s_waitcnt vmcnt(8)
  s_mov_b32 s29, 0
k1_sz0_again:
  v_cmp_ne_u32 vcc, 0x01010101, v242
  s_cmp_gt_u32 s29, 400000
  s_cbranch_scc1 k1_sz0_done
  s_cbranch_vccz k1_sz0_done
  s_sleep 4
  buffer_load_dword v242, v243, s[4:7], 0 offen sc1
  s_add_u32 s29, s29, 1
  s_waitcnt vmcnt(0)
  s_branch k1_sz0_again
k1_sz0_done:
  ds_read_b64_tr_b16 v[52:53], v16 offset:32768
  v_mfma_f32_16x16x32_bf16 a[44:47], v[64:67], v[164:167], a[44:47]
  ds_read_b64_tr_b16 v[54:55], v16 offset:33792
  v_mfma_f32_16x16x32_bf16 a[76:79], v[64:67], v[168:171], a[76:79]
  ds_read_b128 v[128:131], v42 offset:0
  v_mfma_f32_16x16x32_bf16 a[108:111], v[64:67], v[172:175], a[108:111]
  s_add_u32 m0, s50, 0
  s_xor_b32 s36, s49, 6
  s_lshl_b32 s36, s36, 19
  v_mfma_f32_16x16x32_bf16 a[140:143], v[64:67], v[176:179], a[140:143]
  ds_read_b128 v[132:135], v42 offset:2048
  v_mfma_f32_16x16x32_bf16 a[172:175], v[64:67], v[180:183], a[172:175]
  v_mfma_f32_16x16x32_bf16 a[204:207], v[64:67], v[184:187], a[204:207]
  ds_read_b128 v[136:139], v42 offset:4096
  v_mfma_f32_16x16x32_bf16 a[236:239], v[64:67], v[188:191], a[236:239]
  buffer_load_dwordx4 v46, s[16:19], s36 offen offset:0 lds
  s_waitcnt lgkmcnt(11)
  v_mfma_f32_16x16x32_bf16 a[16:19], v[68:71], v[160:163], a[16:19]
  ds_read_b64_tr_b16 v[56:57], v17 offset:32768
  v_mfma_f32_16x16x32_bf16 a[48:51], v[68:71], v[164:167], a[48:51]
  ds_read_b64_tr_b16 v[58:59], v17 offset:33792
  v_mfma_f32_16x16x32_bf16 a[80:83], v[68:71], v[168:171], a[80:83]
  ds_read_b128 v[140:143], v42 offset:6144
  v_mfma_f32_16x16x32_bf16 a[112:115], v[68:71], v[172:175], a[112:115]
  buffer_load_dwordx4 v47, s[16:19], s36 offen offset:1024 lds
  v_mfma_f32_16x16x32_bf16 a[144:147], v[68:71], v[176:179], a[144:147]
  ds_read_b128 v[144:147], v42 offset:8192
  v_mfma_f32_16x16x32_bf16 a[176:179], v[68:71], v[180:183], a[176:179]
  v_mfma_f32_16x16x32_bf16 a[208:211], v[68:71], v[184:187], a[208:211]
  ds_read_b128 v[148:151], v42 offset:10240
  v_mfma_f32_16x16x32_bf16 a[240:243], v[68:71], v[188:191], a[240:243]
  s_add_u32 m0, s50, 8192
  s_nop 0
  s_waitcnt lgkmcnt(14)
  v_mfma_f32_16x16x32_bf16 a[20:23], v[72:75], v[160:163], a[20:23]
  ds_read_b64_tr_b16 v[60:61], v18 offset:32768
  v_mfma_f32_16x16x32_bf16 a[52:55], v[72:75], v[164:167], a[52:55]
  ds_read_b64_tr_b16 v[62:63], v18 offset:33792
  v_mfma_f32_16x16x32_bf16 a[84:87], v[72:75], v[168:171], a[84:87]
  ds_read_b128 v[152:155], v42 offset:12288
  v_mfma_f32_16x16x32_bf16 a[116:119], v[72:75], v[172:175], a[116:119]
  buffer_load_dwordx4 v46, s[20:23], s36 offen offset:0 lds
  v_mfma_f32_16x16x32_bf16 a[148:151], v[72:75], v[176:179], a[148:151]
  ds_read_b128 v[156:159], v42 offset:14336
  v_mfma_f32_16x16x32_bf16 a[180:183], v[72:75], v[180:183], a[180:183]
  v_mfma_f32_16x16x32_bf16 a[212:215], v[72:75], v[184:187], a[212:215]
  v_mfma_f32_16x16x32_bf16 a[244:247], v[72:75], v[188:191], a[244:247]
  buffer_load_dwordx4 v47, s[20:23], s36 offen offset:1024 lds
  s_waitcnt lgkmcnt(15)
  v_mfma_f32_16x16x32_bf16 a[24:27], v[76:79], v[160:163], a[24:27]
  ds_read_b64_tr_b16 v[64:65], v19 offset:32768
  v_mfma_f32_16x16x32_bf16 a[56:59], v[76:79], v[164:167], a[56:59]
  ds_read_b64_tr_b16 v[66:67], v19 offset:33792
  v_mfma_f32_16x16x32_bf16 a[88:91], v[76:79], v[168:171], a[88:91]
  v_mfma_f32_16x16x32_bf16 a[120:123], v[76:79], v[172:175], a[120:123]
  s_add_u32 m0, s44, 69632
  s_xor_b32 s36, s49, 6
  s_lshl_b32 s36, s36, 7
  s_add_u32 s36, s36, 32768
  v_mfma_f32_16x16x32_bf16 a[152:155], v[76:79], v[176:179], a[152:155]
  v_mfma_f32_16x16x32_bf16 a[184:187], v[76:79], v[180:183], a[184:187]
  v_mfma_f32_16x16x32_bf16 a[216:219], v[76:79], v[184:187], a[216:219]
  v_mfma_f32_16x16x32_bf16 a[248:251], v[76:79], v[188:191], a[248:251]
  buffer_load_dwordx4 v32, s[12:15], s36 offen offset:0 lds
  s_waitcnt lgkmcnt(15)
  v_mfma_f32_16x16x32_bf16 a[28:31], v[80:83], v[160:163], a[28:31]
  ds_read_b64_tr_b16 v[68:69], v20 offset:32768
  v_mfma_f32_16x16x32_bf16 a[60:63], v[80:83], v[164:167], a[60:63]
  ds_read_b64_tr_b16 v[70:71], v20 offset:33792
  v_mfma_f32_16x16x32_bf16 a[92:95], v[80:83], v[168:171], a[92:95]
  v_mfma_f32_16x16x32_bf16 a[124:127], v[80:83], v[172:175], a[124:127]
  buffer_load_dwordx4 v33, s[12:15], s36 offen offset:1024 lds
  v_mfma_f32_16x16x32_bf16 a[156:159], v[80:83], v[176:179], a[156:159]
  v_mfma_f32_16x16x32_bf16 a[188:191], v[80:83], v[180:183], a[188:191]
  v_mfma_f32_16x16x32_bf16 a[220:223], v[80:83], v[184:187], a[220:223]
  v_mfma_f32_16x16x32_bf16 a[252:255], v[80:83], v[188:191], a[252:255]
  buffer_load_dwordx4 v34, s[12:15], s36 offen offset:2048 lds
  s_waitcnt lgkmcnt(4)
  v_mfma_f32_16x16x32_bf16 a[0:3], v[52:55], v[128:131], a[0:3]
  ds_read_b64_tr_b16 v[72:73], v21 offset:32768
  v_mfma_f32_16x16x32_bf16 a[32:35], v[52:55], v[132:135], a[32:35]
  ds_read_b64_tr_b16 v[74:75], v21 offset:33792
  v_mfma_f32_16x16x32_bf16 a[64:67], v[52:55], v[136:139], a[64:67]
  v_mfma_f32_16x16x32_bf16 a[96:99], v[52:55], v[140:143], a[96:99]
  buffer_load_dwordx4 v35, s[12:15], s36 offen offset:3072 lds
  v_mfma_f32_16x16x32_bf16 a[128:131], v[52:55], v[144:147], a[128:131]
  v_mfma_f32_16x16x32_bf16 a[160:163], v[52:55], v[148:151], a[160:163]
  v_mfma_f32_16x16x32_bf16 a[192:195], v[52:55], v[152:155], a[192:195]
  v_mfma_f32_16x16x32_bf16 a[224:227], v[52:55], v[156:159], a[224:227]
  v_mfma_f32_16x16x32_bf16 a[4:7], v[56:59], v[128:131], a[4:7]
  ds_read_b64_tr_b16 v[76:77], v22 offset:32768
  v_mfma_f32_16x16x32_bf16 a[36:39], v[56:59], v[132:135], a[36:39]
  ds_read_b64_tr_b16 v[78:79], v22 offset:33792
  v_mfma_f32_16x16x32_bf16 a[68:71], v[56:59], v[136:139], a[68:71]
  v_mfma_f32_16x16x32_bf16 a[100:103], v[56:59], v[140:143], a[100:103]
  v_mfma_f32_16x16x32_bf16 a[132:135], v[56:59], v[144:147], a[132:135]
  v_mfma_f32_16x16x32_bf16 a[164:167], v[56:59], v[148:151], a[164:167]
  v_mfma_f32_16x16x32_bf16 a[196:199], v[56:59], v[152:155], a[196:199]
  v_mfma_f32_16x16x32_bf16 a[228:231], v[56:59], v[156:159], a[228:231]
  v_mfma_f32_16x16x32_bf16 a[8:11], v[60:63], v[128:131], a[8:11]
  ds_read_b64_tr_b16 v[80:81], v23 offset:32768
  v_mfma_f32_16x16x32_bf16 a[40:43], v[60:63], v[132:135], a[40:43]
  ds_read_b64_tr_b16 v[82:83], v23 offset:33792
  v_mfma_f32_16x16x32_bf16 a[72:75], v[60:63], v[136:139], a[72:75]
  v_mfma_f32_16x16x32_bf16 a[104:107], v[60:63], v[140:143], a[104:107]
  v_mfma_f32_16x16x32_bf16 a[136:139], v[60:63], v[144:147], a[136:139]
  v_mfma_f32_16x16x32_bf16 a[168:171], v[60:63], v[148:151], a[168:171]
  v_mfma_f32_16x16x32_bf16 a[200:203], v[60:63], v[152:155], a[200:203]
  v_mfma_f32_16x16x32_bf16 a[232:235], v[60:63], v[156:159], a[232:235]
  s_waitcnt lgkmcnt(8)
  v_mfma_f32_16x16x32_bf16 a[12:15], v[64:67], v[128:131], a[12:15]
  s_waitcnt vmcnt(12)
  s_barrier
  ds_read_b64_tr_b16 v[52:53], v16 offset:49152
  v_mfma_f32_16x16x32_bf16 a[44:47], v[64:67], v[132:135], a[44:47]
  ds_read_b64_tr_b16 v[54:55], v16 offset:50176
  v_mfma_f32_16x16x32_bf16 a[76:79], v[64:67], v[136:139], a[76:79]
  ds_read_b128 v[160:163], v43 offset:0
  v_mfma_f32_16x16x32_bf16 a[108:111], v[64:67], v[140:143], a[108:111]
  s_add_u32 m0, s50, 16384
  s_xor_b32 s36, s49, 6
  s_lshl_b32 s36, s36, 19
  s_add_u32 s36, s36, 262144
  v_mfma_f32_16x16x32_bf16 a[140:143], v[64:67], v[144:147], a[140:143]
  ds_read_b128 v[164:167], v43 offset:2048
  v_mfma_f32_16x16x32_bf16 a[172:175], v[64:67], v[148:151], a[172:175]
  v_mfma_f32_16x16x32_bf16 a[204:207], v[64:67], v[152:155], a[204:207]
  ds_read_b128 v[168:171], v43 offset:4096
  v_mfma_f32_16x16x32_bf16 a[236:239], v[64:67], v[156:159], a[236:239]
  buffer_load_dwordx4 v46, s[16:19], s36 offen offset:0 lds
  s_waitcnt lgkmcnt(11)
  v_mfma_f32_16x16x32_bf16 a[16:19], v[68:71], v[128:131], a[16:19]
  ds_read_b64_tr_b16 v[56:57], v17 offset:49152
  v_mfma_f32_16x16x32_bf16 a[48:51], v[68:71], v[132:135], a[48:51]
  ds_read_b64_tr_b16 v[58:59], v17 offset:50176
  v_mfma_f32_16x16x32_bf16 a[80:83], v[68:71], v[136:139], a[80:83]
  ds_read_b128 v[172:175], v43 offset:6144
  v_mfma_f32_16x16x32_bf16 a[112:115], v[68:71], v[140:143], a[112:115]
  buffer_load_dwordx4 v47, s[16:19], s36 offen offset:1024 lds
  v_mfma_f32_16x16x32_bf16 a[144:147], v[68:71], v[144:147], a[144:147]
  ds_read_b128 v[176:179], v43 offset:8192
  v_mfma_f32_16x16x32_bf16 a[176:179], v[68:71], v[148:151], a[176:179]
  v_mfma_f32_16x16x32_bf16 a[208:211], v[68:71], v[152:155], a[208:211]
  ds_read_b128 v[180:183], v43 offset:10240
  v_mfma_f32_16x16x32_bf16 a[240:243], v[68:71], v[156:159], a[240:243]
  s_add_u32 m0, s50, 24576
  s_nop 0
  s_waitcnt lgkmcnt(14)
  v_mfma_f32_16x16x32_bf16 a[20:23], v[72:75], v[128:131], a[20:23]
  ds_read_b64_tr_b16 v[60:61], v18 offset:49152
  v_mfma_f32_16x16x32_bf16 a[52:55], v[72:75], v[132:135], a[52:55]
  ds_read_b64_tr_b16 v[62:63], v18 offset:50176
  v_mfma_f32_16x16x32_bf16 a[84:87], v[72:75], v[136:139], a[84:87]
  ds_read_b128 v[184:187], v43 offset:12288
  v_mfma_f32_16x16x32_bf16 a[116:119], v[72:75], v[140:143], a[116:119]
  buffer_load_dwordx4 v46, s[20:23], s36 offen offset:0 lds
  v_mfma_f32_16x16x32_bf16 a[148:151], v[72:75], v[144:147], a[148:151]
  ds_read_b128 v[188:191], v43 offset:14336
  v_mfma_f32_16x16x32_bf16 a[180:183], v[72:75], v[148:151], a[180:183]
  v_mfma_f32_16x16x32_bf16 a[212:215], v[72:75], v[152:155], a[212:215]
  v_mfma_f32_16x16x32_bf16 a[244:247], v[72:75], v[156:159], a[244:247]
  buffer_load_dwordx4 v47, s[20:23], s36 offen offset:1024 lds
  s_waitcnt lgkmcnt(15)
  v_mfma_f32_16x16x32_bf16 a[24:27], v[76:79], v[128:131], a[24:27]
  ds_read_b64_tr_b16 v[64:65], v19 offset:49152
  v_mfma_f32_16x16x32_bf16 a[56:59], v[76:79], v[132:135], a[56:59]
  ds_read_b64_tr_b16 v[66:67], v19 offset:50176
  v_mfma_f32_16x16x32_bf16 a[88:91], v[76:79], v[136:139], a[88:91]
  v_mfma_f32_16x16x32_bf16 a[120:123], v[76:79], v[140:143], a[120:123]
  s_add_u32 m0, s44, 98304
  s_xor_b32 s36, s49, 7
  s_lshl_b32 s36, s36, 7
  v_mfma_f32_16x16x32_bf16 a[152:155], v[76:79], v[144:147], a[152:155]
  v_mfma_f32_16x16x32_bf16 a[184:187], v[76:79], v[148:151], a[184:187]
  v_mfma_f32_16x16x32_bf16 a[216:219], v[76:79], v[152:155], a[216:219]
  v_mfma_f32_16x16x32_bf16 a[248:251], v[76:79], v[156:159], a[248:251]
  buffer_load_dwordx4 v32, s[12:15], s36 offen offset:0 lds
  s_waitcnt lgkmcnt(15)
  v_mfma_f32_16x16x32_bf16 a[28:31], v[80:83], v[128:131], a[28:31]
  ds_read_b64_tr_b16 v[68:69], v20 offset:49152
  v_mfma_f32_16x16x32_bf16 a[60:63], v[80:83], v[132:135], a[60:63]
  ds_read_b64_tr_b16 v[70:71], v20 offset:50176
  v_mfma_f32_16x16x32_bf16 a[92:95], v[80:83], v[136:139], a[92:95]
  v_mfma_f32_16x16x32_bf16 a[124:127], v[80:83], v[140:143], a[124:127]
  buffer_load_dwordx4 v33, s[12:15], s36 offen offset:1024 lds
  v_mfma_f32_16x16x32_bf16 a[156:159], v[80:83], v[144:147], a[156:159]
  v_mfma_f32_16x16x32_bf16 a[188:191], v[80:83], v[148:151], a[188:191]
  v_mfma_f32_16x16x32_bf16 a[220:223], v[80:83], v[152:155], a[220:223]
  v_mfma_f32_16x16x32_bf16 a[252:255], v[80:83], v[156:159], a[252:255]
  buffer_load_dwordx4 v34, s[12:15], s36 offen offset:2048 lds
  s_waitcnt lgkmcnt(4)
  v_mfma_f32_16x16x32_bf16 a[0:3], v[52:55], v[160:163], a[0:3]
  ds_read_b64_tr_b16 v[72:73], v21 offset:49152
  v_mfma_f32_16x16x32_bf16 a[32:35], v[52:55], v[164:167], a[32:35]
  ds_read_b64_tr_b16 v[74:75], v21 offset:50176
  v_mfma_f32_16x16x32_bf16 a[64:67], v[52:55], v[168:171], a[64:67]
  v_mfma_f32_16x16x32_bf16 a[96:99], v[52:55], v[172:175], a[96:99]
  buffer_load_dwordx4 v35, s[12:15], s36 offen offset:3072 lds
  v_mfma_f32_16x16x32_bf16 a[128:131], v[52:55], v[176:179], a[128:131]
  v_mfma_f32_16x16x32_bf16 a[160:163], v[52:55], v[180:183], a[160:163]
  v_mfma_f32_16x16x32_bf16 a[192:195], v[52:55], v[184:187], a[192:195]
  v_mfma_f32_16x16x32_bf16 a[224:227], v[52:55], v[188:191], a[224:227]
  s_lshl_b32 s29, s35, 6
  s_sub_u32 s30, 960, s29
  v_mov_b32 v240, s29
  v_mov_b32 v241, s30
  v_cmp_eq_u32 vcc, 0, v8
  s_mov_b32 s53, 61935616
  s_nop 0
  v_cndmask_b32 v240, v241, v240, vcc
  v_lshl_add_u32 v240, v5, 2, v240
  buffer_load_dword v241, v240, s[8:11], s53 offen sc1
  v_mfma_f32_16x16x32_bf16 a[4:7], v[56:59], v[160:163], a[4:7]
  ds_read_b64_tr_b16 v[76:77], v22 offset:49152
  v_mfma_f32_16x16x32_bf16 a[36:39], v[56:59], v[164:167], a[36:39]
  ds_read_b64_tr_b16 v[78:79], v22 offset:50176
  v_mfma_f32_16x16x32_bf16 a[68:71], v[56:59], v[168:171], a[68:71]
  v_mfma_f32_16x16x32_bf16 a[100:103], v[56:59], v[172:175], a[100:103]
  v_mfma_f32_16x16x32_bf16 a[132:135], v[56:59], v[176:179], a[132:135]
  v_mfma_f32_16x16x32_bf16 a[164:167], v[56:59], v[180:183], a[164:167]
  v_mfma_f32_16x16x32_bf16 a[196:199], v[56:59], v[184:187], a[196:199]
  v_mfma_f32_16x16x32_bf16 a[228:231], v[56:59], v[188:191], a[228:231]
  v_mfma_f32_16x16x32_bf16 a[8:11], v[60:63], v[160:163], a[8:11]
  ds_read_b64_tr_b16 v[80:81], v23 offset:49152
  v_mfma_f32_16x16x32_bf16 a[40:43], v[60:63], v[164:167], a[40:43]
  ds_read_b64_tr_b16 v[82:83], v23 offset:50176
  v_mfma_f32_16x16x32_bf16 a[72:75], v[60:63], v[168:171], a[72:75]
  v_mfma_f32_16x16x32_bf16 a[104:107], v[60:63], v[172:175], a[104:107]
  v_mfma_f32_16x16x32_bf16 a[136:139], v[60:63], v[176:179], a[136:139]
  v_mfma_f32_16x16x32_bf16 a[168:171], v[60:63], v[180:183], a[168:171]
  v_mfma_f32_16x16x32_bf16 a[200:203], v[60:63], v[184:187], a[200:203]
  v_mfma_f32_16x16x32_bf16 a[232:235], v[60:63], v[188:191], a[232:235]
  s_waitcnt lgkmcnt(8)
  v_mfma_f32_16x16x32_bf16 a[12:15], v[64:67], v[160:163], a[12:15]
  s_waitcnt vmcnt(9)
  s_barrier
  ds_read_b64_tr_b16 v[52:53], v16 offset:0
  v_mfma_f32_16x16x32_bf16 a[44:47], v[64:67], v[164:167], a[44:47]
  ds_read_b64_tr_b16 v[54:55], v16 offset:1024
  v_mfma_f32_16x16x32_bf16 a[76:79], v[64:67], v[168:171], a[76:79]
  ds_read_b128 v[128:131], v40 offset:0
  v_mfma_f32_16x16x32_bf16 a[108:111], v[64:67], v[172:175], a[108:111]
  s_add_u32 m0, s50, 32768
  s_xor_b32 s36, s49, 7
  s_lshl_b32 s36, s36, 19
  v_mfma_f32_16x16x32_bf16 a[140:143], v[64:67], v[176:179], a[140:143]
  ds_read_b128 v[132:135], v40 offset:2048
  v_mfma_f32_16x16x32_bf16 a[172:175], v[64:67], v[180:183], a[172:175]
  v_mfma_f32_16x16x32_bf16 a[204:207], v[64:67], v[184:187], a[204:207]
  ds_read_b128 v[136:139], v40 offset:4096
  v_mfma_f32_16x16x32_bf16 a[236:239], v[64:67], v[188:191], a[236:239]
  buffer_load_dwordx4 v46, s[16:19], s36 offen offset:0 lds
  s_waitcnt lgkmcnt(11)
  v_mfma_f32_16x16x32_bf16 a[16:19], v[68:71], v[160:163], a[16:19]
  ds_read_b64_tr_b16 v[56:57], v17 offset:0
  v_mfma_f32_16x16x32_bf16 a[48:51], v[68:71], v[164:167], a[48:51]
  ds_read_b64_tr_b16 v[58:59], v17 offset:1024
  v_mfma_f32_16x16x32_bf16 a[80:83], v[68:71], v[168:171], a[80:83]
  ds_read_b128 v[140:143], v40 offset:6144
  v_mfma_f32_16x16x32_bf16 a[112:115], v[68:71], v[172:175], a[112:115]
  buffer_load_dwordx4 v47, s[16:19], s36 offen offset:1024 lds
  v_mfma_f32_16x16x32_bf16 a[144:147], v[68:71], v[176:179], a[144:147]
  ds_read_b128 v[144:147], v40 offset:8192
  v_mfma_f32_16x16x32_bf16 a[176:179], v[68:71], v[180:183], a[176:179]
  v_mfma_f32_16x16x32_bf16 a[208:211], v[68:71], v[184:187], a[208:211]
  ds_read_b128 v[148:151], v40 offset:10240
  v_mfma_f32_16x16x32_bf16 a[240:243], v[68:71], v[188:191], a[240:243]
  s_add_u32 m0, s50, 40960
  s_nop 0
  s_waitcnt lgkmcnt(14)
  v_mfma_f32_16x16x32_bf16 a[20:23], v[72:75], v[160:163], a[20:23]
  ds_read_b64_tr_b16 v[60:61], v18 offset:0
  v_mfma_f32_16x16x32_bf16 a[52:55], v[72:75], v[164:167], a[52:55]
  ds_read_b64_tr_b16 v[62:63], v18 offset:1024
  v_mfma_f32_16x16x32_bf16 a[84:87], v[72:75], v[168:171], a[84:87]
  ds_read_b128 v[152:155], v40 offset:12288
  v_mfma_f32_16x16x32_bf16 a[116:119], v[72:75], v[172:175], a[116:119]
  buffer_load_dwordx4 v46, s[20:23], s36 offen offset:0 lds
  v_mfma_f32_16x16x32_bf16 a[148:151], v[72:75], v[176:179], a[148:151]
  ds_read_b128 v[156:159], v40 offset:14336
  v_mfma_f32_16x16x32_bf16 a[180:183], v[72:75], v[180:183], a[180:183]
  v_mfma_f32_16x16x32_bf16 a[212:215], v[72:75], v[184:187], a[212:215]
  v_mfma_f32_16x16x32_bf16 a[244:247], v[72:75], v[188:191], a[244:247]
  buffer_load_dwordx4 v47, s[20:23], s36 offen offset:1024 lds
  s_waitcnt lgkmcnt(15)
  v_mfma_f32_16x16x32_bf16 a[24:27], v[76:79], v[160:163], a[24:27]
  ds_read_b64_tr_b16 v[64:65], v19 offset:0
  v_mfma_f32_16x16x32_bf16 a[56:59], v[76:79], v[164:167], a[56:59]
  ds_read_b64_tr_b16 v[66:67], v19 offset:1024
  v_mfma_f32_16x16x32_bf16 a[88:91], v[76:79], v[168:171], a[88:91]
  v_mfma_f32_16x16x32_bf16 a[120:123], v[76:79], v[172:175], a[120:123]
  s_add_u32 m0, s44, 102400
  s_xor_b32 s36, s49, 7
  s_lshl_b32 s36, s36, 7
  s_add_u32 s36, s36, 32768
  v_mfma_f32_16x16x32_bf16 a[152:155], v[76:79], v[176:179], a[152:155]
  v_mfma_f32_16x16x32_bf16 a[184:187], v[76:79], v[180:183], a[184:187]
  v_mfma_f32_16x16x32_bf16 a[216:219], v[76:79], v[184:187], a[216:219]
  v_mfma_f32_16x16x32_bf16 a[248:251], v[76:79], v[188:191], a[248:251]
  buffer_load_dwordx4 v32, s[12:15], s36 offen offset:0 lds
  s_waitcnt lgkmcnt(15)
  v_mfma_f32_16x16x32_bf16 a[28:31], v[80:83], v[160:163], a[28:31]
  ds_read_b64_tr_b16 v[68:69], v20 offset:0
  v_mfma_f32_16x16x32_bf16 a[60:63], v[80:83], v[164:167], a[60:63]
  ds_read_b64_tr_b16 v[70:71], v20 offset:1024
  v_mfma_f32_16x16x32_bf16 a[92:95], v[80:83], v[168:171], a[92:95]
  v_mfma_f32_16x16x32_bf16 a[124:127], v[80:83], v[172:175], a[124:127]
  buffer_load_dwordx4 v33, s[12:15], s36 offen offset:1024 lds
  v_mfma_f32_16x16x32_bf16 a[156:159], v[80:83], v[176:179], a[156:159]
  v_mfma_f32_16x16x32_bf16 a[188:191], v[80:83], v[180:183], a[188:191]
  v_mfma_f32_16x16x32_bf16 a[220:223], v[80:83], v[184:187], a[220:223]
  v_mfma_f32_16x16x32_bf16 a[252:255], v[80:83], v[188:191], a[252:255]
  buffer_load_dwordx4 v34, s[12:15], s36 offen offset:2048 lds
  s_waitcnt lgkmcnt(4)
  v_mfma_f32_16x16x32_bf16 a[0:3], v[52:55], v[128:131], a[0:3]
  ds_read_b64_tr_b16 v[72:73], v21 offset:0
  v_mfma_f32_16x16x32_bf16 a[32:35], v[52:55], v[132:135], a[32:35]
  ds_read_b64_tr_b16 v[74:75], v21 offset:1024
  v_mfma_f32_16x16x32_bf16 a[64:67], v[52:55], v[136:139], a[64:67]
  v_mfma_f32_16x16x32_bf16 a[96:99], v[52:55], v[140:143], a[96:99]
  buffer_load_dwordx4 v35, s[12:15], s36 offen offset:3072 lds
  v_mfma_f32_16x16x32_bf16 a[128:131], v[52:55], v[144:147], a[128:131]
  v_mfma_f32_16x16x32_bf16 a[160:163], v[52:55], v[148:151], a[160:163]
  v_mfma_f32_16x16x32_bf16 a[192:195], v[52:55], v[152:155], a[192:195]
  v_mfma_f32_16x16x32_bf16 a[224:227], v[52:55], v[156:159], a[224:227]
  v_mfma_f32_16x16x32_bf16 a[4:7], v[56:59], v[128:131], a[4:7]
  ds_read_b64_tr_b16 v[76:77], v22 offset:0
  v_mfma_f32_16x16x32_bf16 a[36:39], v[56:59], v[132:135], a[36:39]
  ds_read_b64_tr_b16 v[78:79], v22 offset:1024
  v_mfma_f32_16x16x32_bf16 a[68:71], v[56:59], v[136:139], a[68:71]
  v_mfma_f32_16x16x32_bf16 a[100:103], v[56:59], v[140:143], a[100:103]
  v_mfma_f32_16x16x32_bf16 a[132:135], v[56:59], v[144:147], a[132:135]
  v_mfma_f32_16x16x32_bf16 a[164:167], v[56:59], v[148:151], a[164:167]
  v_mfma_f32_16x16x32_bf16 a[196:199], v[56:59], v[152:155], a[196:199]
  v_mfma_f32_16x16x32_bf16 a[228:231], v[56:59], v[156:159], a[228:231]
  v_mfma_f32_16x16x32_bf16 a[8:11], v[60:63], v[128:131], a[8:11]
  ds_read_b64_tr_b16 v[80:81], v23 offset:0
  v_mfma_f32_16x16x32_bf16 a[40:43], v[60:63], v[132:135], a[40:43]
  ds_read_b64_tr_b16 v[82:83], v23 offset:1024
  v_mfma_f32_16x16x32_bf16 a[72:75], v[60:63], v[136:139], a[72:75]
  v_mfma_f32_16x16x32_bf16 a[104:107], v[60:63], v[140:143], a[104:107]
  v_mfma_f32_16x16x32_bf16 a[136:139], v[60:63], v[144:147], a[136:139]
  v_mfma_f32_16x16x32_bf16 a[168:171], v[60:63], v[148:151], a[168:171]
  v_mfma_f32_16x16x32_bf16 a[200:203], v[60:63], v[152:155], a[200:203]
  v_mfma_f32_16x16x32_bf16 a[232:235], v[60:63], v[156:159], a[232:235]
  s_waitcnt lgkmcnt(8)
  v_mfma_f32_16x16x32_bf16 a[12:15], v[64:67], v[128:131], a[12:15]
  s_waitcnt vmcnt(13)
  s_barrier
  s_waitcnt vmcnt(8)
  s_mov_b32 s29, 0
k1_sp0_again:
  v_cmp_ne_u32 vcc, 1, v241
  s_cmp_gt_u32 s29, 400000
  s_cbranch_scc1 k1_sp0_done
  s_cbranch_vccz k1_sp0_done
  s_sleep 4
  buffer_load_dword v241, v240, s[8:11], s53 offen sc1
  s_add_u32 s29, s29, 1
  s_waitcnt vmcnt(0)
  s_branch k1_sp0_again
k1_sp0_done:
  ds_read_b64_tr_b16 v[52:53], v16 offset:16384
  v_mfma_f32_16x16x32_bf16 a[44:47], v[64:67], v[132:135], a[44:47]
  ds_read_b64_tr_b16 v[54:55], v16 offset:17408
  v_mfma_f32_16x16x32_bf16 a[76:79], v[64:67], v[136:139], a[76:79]
  ds_read_b128 v[160:163], v41 offset:0
  v_mfma_f32_16x16x32_bf16 a[108:111], v[64:67], v[140:143], a[108:111]
  s_add_u32 m0, s50, 49152
  s_xor_b32 s36, s49, 7
  s_lshl_b32 s36, s36, 19
  s_add_u32 s36, s36, 262144
  v_mfma_f32_16x16x32_bf16 a[140:143], v[64:67], v[144:147], a[140:143]
  ds_read_b128 v[164:167], v41 offset:2048
  v_mfma_f32_16x16x32_bf16 a[172:175], v[64:67], v[148:151], a[172:175]
  v_mfma_f32_16x16x32_bf16 a[204:207], v[64:67], v[152:155], a[204:207]
  ds_read_b128 v[168:171], v41 offset:4096
  v_mfma_f32_16x16x32_bf16 a[236:239], v[64:67], v[156:159], a[236:239]
  buffer_load_dwordx4 v46, s[16:19], s36 offen offset:0 lds
  s_waitcnt lgkmcnt(11)
  v_mfma_f32_16x16x32_bf16 a[16:19], v[68:71], v[128:131], a[16:19]
  ds_read_b64_tr_b16 v[56:57], v17 offset:16384
  v_mfma_f32_16x16x32_bf16 a[48:51], v[68:71], v[132:135], a[48:51]
  ds_read_b64_tr_b16 v[58:59], v17 offset:17408
  v_mfma_f32_16x16x32_bf16 a[80:83], v[68:71], v[136:139], a[80:83]
  ds_read_b128 v[172:175], v41 offset:6144
  v_mfma_f32_16x16x32_bf16 a[112:115], v[68:71], v[140:143], a[112:115]
  buffer_load_dwordx4 v47, s[16:19], s36 offen offset:1024 lds
  v_mfma_f32_16x16x32_bf16 a[144:147], v[68:71], v[144:147], a[144:147]
  ds_read_b128 v[176:179], v41 offset:8192
  v_mfma_f32_16x16x32_bf16 a[176:179], v[68:71], v[148:151], a[176:179]
  v_mfma_f32_16x16x32_bf16 a[208:211], v[68:71], v[152:155], a[208:211]
  ds_read_b128 v[180:183], v41 offset:10240
  v_mfma_f32_16x16x32_bf16 a[240:243], v[68:71], v[156:159], a[240:243]
  s_add_u32 m0, s50, 57344
  s_nop 0
  s_waitcnt lgkmcnt(14)
  v_mfma_f32_16x16x32_bf16 a[20:23], v[72:75], v[128:131], a[20:23]
  ds_read_b64_tr_b16 v[60:61], v18 offset:16384
  v_mfma_f32_16x16x32_bf16 a[52:55], v[72:75], v[132:135], a[52:55]
  ds_read_b64_tr_b16 v[62:63], v18 offset:17408
  v_mfma_f32_16x16x32_bf16 a[84:87], v[72:75], v[136:139], a[84:87]
  ds_read_b128 v[184:187], v41 offset:12288
  v_mfma_f32_16x16x32_bf16 a[116:119], v[72:75], v[140:143], a[116:119]
  buffer_load_dwordx4 v46, s[20:23], s36 offen offset:0 lds
  v_mfma_f32_16x16x32_bf16 a[148:151], v[72:75], v[144:147], a[148:151]
  ds_read_b128 v[188:191], v41 offset:14336
  v_mfma_f32_16x16x32_bf16 a[180:183], v[72:75], v[148:151], a[180:183]
  v_mfma_f32_16x16x32_bf16 a[212:215], v[72:75], v[152:155], a[212:215]
  v_mfma_f32_16x16x32_bf16 a[244:247], v[72:75], v[156:159], a[244:247]
  buffer_load_dwordx4 v47, s[20:23], s36 offen offset:1024 lds
  s_waitcnt lgkmcnt(15)
  v_mfma_f32_16x16x32_bf16 a[24:27], v[76:79], v[128:131], a[24:27]
  ds_read_b64_tr_b16 v[64:65], v19 offset:16384
  v_mfma_f32_16x16x32_bf16 a[56:59], v[76:79], v[132:135], a[56:59]
  ds_read_b64_tr_b16 v[66:67], v19 offset:17408
  v_mfma_f32_16x16x32_bf16 a[88:91], v[76:79], v[136:139], a[88:91]
  v_mfma_f32_16x16x32_bf16 a[120:123], v[76:79], v[140:143], a[120:123]
  s_lshr_b32 s29, s2, 3
  s_lshl_b32 s29, s29, 2
  s_add_u32 s29, s29, s32
  s_and_b32 s28, s2, 7
  s_mov_b32 s24, s96
  s_and_b32 s25, s97, 0xffff
  s_mov_b32 s26, 0x400000
  s_mov_b32 s27, 0x20000
  v_bfe_u32 v12, v1, 3, 2
  v_lshlrev_b32 v13, 13, v12
  v_lshl_add_u32 v13, v11, 7, v13
  s_lshl_b32 s57, s29, 15
  s_lshl_b32 s30, s28, 10
  s_add_u32 s57, s57, s30
  buffer_load_dword v15, v13, s[24:27], s57 offen
  s_mov_b32 s24, s98
  s_and_b32 s25, s99, 0xffff
  s_mov_b32 s26, 0x158000
  s_mov_b32 s27, 0x20000
  v_mul_u32_u24 v13, 2752, v12
  v_lshl_add_u32 v13, v11, 6, v13
  s_mul_i32 s57, s29, 11008
  s_mul_i32 s30, s28, 384
  s_add_u32 s57, s57, s30
  buffer_load_dword v15, v13, s[24:27], s57 offen
  s_lshl_b32 s57, s29, 13
  s_getpc_b64 s[24:25]
k1_kernel_pc5:
  s_add_u32 s24, s24, k2_kernel-k1_kernel_pc5
  s_addc_u32 s25, s25, 0
  s_and_b32 s25, s25, 0xffff
  s_mov_b32 s26, k2_slow_0-k2_kernel
  s_mov_b32 s27, 0x20000
  v_lshlrev_b32 v13, 7, v1
  buffer_load_dword v15, v13, s[24:27], s57 offen
  v_mfma_f32_16x16x32_bf16 a[152:155], v[76:79], v[144:147], a[152:155]
  v_mfma_f32_16x16x32_bf16 a[184:187], v[76:79], v[148:151], a[184:187]
  v_mfma_f32_16x16x32_bf16 a[216:219], v[76:79], v[152:155], a[216:219]
  v_mfma_f32_16x16x32_bf16 a[248:251], v[76:79], v[156:159], a[248:251]
  s_lshl_b32 s28, s35, 17
  s_lshl_b32 s29, s32, 15
  s_and_b32 s30, s33, 3
  s_lshl_b32 s30, s30, 12
  s_add_u32 s29, s29, s30
  s_add_u32 s57, s28, s29
  v_lshrrev_b32 v12, 5, v1
  v_and_b32 v13, 31, v1
  v_lshlrev_b32 v13, 7, v13
  v_lshl_add_u32 v13, v12, 14, v13
  buffer_load_dword v15, v13, s[8:11], s57 offen sc1
  s_sub_u32 s57, 1966080, s28
  s_add_u32 s57, s57, s29
  buffer_load_dword v15, v13, s[8:11], s57 offen sc1
  s_waitcnt lgkmcnt(15)
  v_mfma_f32_16x16x32_bf16 a[28:31], v[80:83], v[128:131], a[28:31]
  ds_read_b64_tr_b16 v[68:69], v20 offset:16384
  v_mfma_f32_16x16x32_bf16 a[60:63], v[80:83], v[132:135], a[60:63]
  ds_read_b64_tr_b16 v[70:71], v20 offset:17408
  v_mfma_f32_16x16x32_bf16 a[92:95], v[80:83], v[136:139], a[92:95]
  v_mfma_f32_16x16x32_bf16 a[124:127], v[80:83], v[140:143], a[124:127]
  v_mfma_f32_16x16x32_bf16 a[156:159], v[80:83], v[144:147], a[156:159]
  v_mfma_f32_16x16x32_bf16 a[188:191], v[80:83], v[148:151], a[188:191]
  v_mfma_f32_16x16x32_bf16 a[220:223], v[80:83], v[152:155], a[220:223]
  v_mfma_f32_16x16x32_bf16 a[252:255], v[80:83], v[156:159], a[252:255]
  s_waitcnt lgkmcnt(4)
  v_mfma_f32_16x16x32_bf16 a[0:3], v[52:55], v[160:163], a[0:3]
  ds_read_b64_tr_b16 v[72:73], v21 offset:16384
  v_mfma_f32_16x16x32_bf16 a[32:35], v[52:55], v[164:167], a[32:35]
  ds_read_b64_tr_b16 v[74:75], v21 offset:17408
  v_mfma_f32_16x16x32_bf16 a[64:67], v[52:55], v[168:171], a[64:67]
  v_mfma_f32_16x16x32_bf16 a[96:99], v[52:55], v[172:175], a[96:99]
  v_mfma_f32_16x16x32_bf16 a[128:131], v[52:55], v[176:179], a[128:131]
  v_mfma_f32_16x16x32_bf16 a[160:163], v[52:55], v[180:183], a[160:163]
  v_mfma_f32_16x16x32_bf16 a[192:195], v[52:55], v[184:187], a[192:195]
  v_mfma_f32_16x16x32_bf16 a[224:227], v[52:55], v[188:191], a[224:227]
  v_mfma_f32_16x16x32_bf16 a[4:7], v[56:59], v[160:163], a[4:7]
  ds_read_b64_tr_b16 v[76:77], v22 offset:16384
  v_mfma_f32_16x16x32_bf16 a[36:39], v[56:59], v[164:167], a[36:39]
  ds_read_b64_tr_b16 v[78:79], v22 offset:17408
  v_mfma_f32_16x16x32_bf16 a[68:71], v[56:59], v[168:171], a[68:71]
  v_mfma_f32_16x16x32_bf16 a[100:103], v[56:59], v[172:175], a[100:103]
  v_mfma_f32_16x16x32_bf16 a[132:135], v[56:59], v[176:179], a[132:135]
  v_mfma_f32_16x16x32_bf16 a[164:167], v[56:59], v[180:183], a[164:167]
  v_mfma_f32_16x16x32_bf16 a[196:199], v[56:59], v[184:187], a[196:199]
  v_mfma_f32_16x16x32_bf16 a[228:231], v[56:59], v[188:191], a[228:231]
  v_mfma_f32_16x16x32_bf16 a[8:11], v[60:63], v[160:163], a[8:11]
  ds_read_b64_tr_b16 v[80:81], v23 offset:16384
  v_mfma_f32_16x16x32_bf16 a[40:43], v[60:63], v[164:167], a[40:43]
  ds_read_b64_tr_b16 v[82:83], v23 offset:17408
  v_mfma_f32_16x16x32_bf16 a[72:75], v[60:63], v[168:171], a[72:75]
  v_mfma_f32_16x16x32_bf16 a[104:107], v[60:63], v[172:175], a[104:107]
  v_mfma_f32_16x16x32_bf16 a[136:139], v[60:63], v[176:179], a[136:139]
  v_mfma_f32_16x16x32_bf16 a[168:171], v[60:63], v[180:183], a[168:171]
  v_mfma_f32_16x16x32_bf16 a[200:203], v[60:63], v[184:187], a[200:203]
  v_mfma_f32_16x16x32_bf16 a[232:235], v[60:63], v[188:191], a[232:235]
  s_waitcnt lgkmcnt(8)
  v_mfma_f32_16x16x32_bf16 a[12:15], v[64:67], v[160:163], a[12:15]
  s_waitcnt vmcnt(9)
  s_barrier
  ds_read_b64_tr_b16 v[52:53], v16 offset:32768
  v_mfma_f32_16x16x32_bf16 a[44:47], v[64:67], v[164:167], a[44:47]
  ds_read_b64_tr_b16 v[54:55], v16 offset:33792
  v_mfma_f32_16x16x32_bf16 a[76:79], v[64:67], v[168:171], a[76:79]
  ds_read_b128 v[128:131], v40 offset:32768
  v_mfma_f32_16x16x32_bf16 a[108:111], v[64:67], v[172:175], a[108:111]
  s_mov_b32 s12, s96
  v_mfma_f32_16x16x32_bf16 a[140:143], v[64:67], v[176:179], a[140:143]
  ds_read_b128 v[132:135], v40 offset:34816
  v_mfma_f32_16x16x32_bf16 a[172:175], v[64:67], v[180:183], a[172:175]
  v_mfma_f32_16x16x32_bf16 a[204:207], v[64:67], v[184:187], a[204:207]
  ds_read_b128 v[136:139], v40 offset:36864
  v_mfma_f32_16x16x32_bf16 a[236:239], v[64:67], v[188:191], a[236:239]
  s_and_b32 s13, s97, 0xffff
  s_waitcnt lgkmcnt(11)
  v_mfma_f32_16x16x32_bf16 a[16:19], v[68:71], v[160:163], a[16:19]
  ds_read_b64_tr_b16 v[56:57], v17 offset:32768
  v_mfma_f32_16x16x32_bf16 a[48:51], v[68:71], v[164:167], a[48:51]
  ds_read_b64_tr_b16 v[58:59], v17 offset:33792
  v_mfma_f32_16x16x32_bf16 a[80:83], v[68:71], v[168:171], a[80:83]
  ds_read_b128 v[140:143], v40 offset:38912
  v_mfma_f32_16x16x32_bf16 a[112:115], v[68:71], v[172:175], a[112:115]
  s_mov_b32 s14, 0x400000
  v_mfma_f32_16x16x32_bf16 a[144:147], v[68:71], v[176:179], a[144:147]
  ds_read_b128 v[144:147], v40 offset:40960
  v_mfma_f32_16x16x32_bf16 a[176:179], v[68:71], v[180:183], a[176:179]
  v_mfma_f32_16x16x32_bf16 a[208:211], v[68:71], v[184:187], a[208:211]
  ds_read_b128 v[148:151], v40 offset:43008
  v_mfma_f32_16x16x32_bf16 a[240:243], v[68:71], v[188:191], a[240:243]
  s_mov_b32 s15, 0x20000
  s_waitcnt lgkmcnt(14)
  v_mfma_f32_16x16x32_bf16 a[20:23], v[72:75], v[160:163], a[20:23]
  ds_read_b64_tr_b16 v[60:61], v18 offset:32768
  v_mfma_f32_16x16x32_bf16 a[52:55], v[72:75], v[164:167], a[52:55]
  ds_read_b64_tr_b16 v[62:63], v18 offset:33792
  v_mfma_f32_16x16x32_bf16 a[84:87], v[72:75], v[168:171], a[84:87]
  ds_read_b128 v[152:155], v40 offset:45056
  v_mfma_f32_16x16x32_bf16 a[116:119], v[72:75], v[172:175], a[116:119]
  s_mov_b32 s16, s98
  v_mfma_f32_16x16x32_bf16 a[148:151], v[72:75], v[176:179], a[148:151]
  ds_read_b128 v[156:159], v40 offset:47104
  v_mfma_f32_16x16x32_bf16 a[180:183], v[72:75], v[180:183], a[180:183]
  v_mfma_f32_16x16x32_bf16 a[212:215], v[72:75], v[184:187], a[212:215]
  v_mfma_f32_16x16x32_bf16 a[244:247], v[72:75], v[188:191], a[244:247]
  s_and_b32 s17, s99, 0xffff
  s_waitcnt lgkmcnt(15)
  v_mfma_f32_16x16x32_bf16 a[24:27], v[76:79], v[160:163], a[24:27]
  ds_read_b64_tr_b16 v[64:65], v19 offset:32768
  v_mfma_f32_16x16x32_bf16 a[56:59], v[76:79], v[164:167], a[56:59]
  ds_read_b64_tr_b16 v[66:67], v19 offset:33792
  v_mfma_f32_16x16x32_bf16 a[88:91], v[76:79], v[168:171], a[88:91]
  v_mfma_f32_16x16x32_bf16 a[120:123], v[76:79], v[172:175], a[120:123]
  s_mov_b32 s18, 0x158000
  v_mfma_f32_16x16x32_bf16 a[152:155], v[76:79], v[176:179], a[152:155]
  v_mfma_f32_16x16x32_bf16 a[184:187], v[76:79], v[180:183], a[184:187]
  v_mfma_f32_16x16x32_bf16 a[216:219], v[76:79], v[184:187], a[216:219]
  v_mfma_f32_16x16x32_bf16 a[248:251], v[76:79], v[188:191], a[248:251]
  s_mov_b32 s19, 0x20000
  s_waitcnt lgkmcnt(15)
  v_mfma_f32_16x16x32_bf16 a[28:31], v[80:83], v[160:163], a[28:31]
  ds_read_b64_tr_b16 v[68:69], v20 offset:32768
  v_mfma_f32_16x16x32_bf16 a[60:63], v[80:83], v[164:167], a[60:63]
  ds_read_b64_tr_b16 v[70:71], v20 offset:33792
  v_mfma_f32_16x16x32_bf16 a[92:95], v[80:83], v[168:171], a[92:95]
  v_mfma_f32_16x16x32_bf16 a[124:127], v[80:83], v[172:175], a[124:127]
  v_mov_b32 v108, v36
  v_mfma_f32_16x16x32_bf16 a[156:159], v[80:83], v[176:179], a[156:159]
  v_mfma_f32_16x16x32_bf16 a[188:191], v[80:83], v[180:183], a[188:191]
  v_mfma_f32_16x16x32_bf16 a[220:223], v[80:83], v[184:187], a[220:223]
  v_mfma_f32_16x16x32_bf16 a[252:255], v[80:83], v[188:191], a[252:255]
  v_mov_b32 v109, v37
  s_waitcnt lgkmcnt(4)
  v_mfma_f32_16x16x32_bf16 a[0:3], v[52:55], v[128:131], a[0:3]
  ds_read_b64_tr_b16 v[72:73], v21 offset:32768
  v_mfma_f32_16x16x32_bf16 a[32:35], v[52:55], v[132:135], a[32:35]
  ds_read_b64_tr_b16 v[74:75], v21 offset:33792
  v_mfma_f32_16x16x32_bf16 a[64:67], v[52:55], v[136:139], a[64:67]
  v_mov_b32 v110, v38
  v_mfma_f32_16x16x32_bf16 a[96:99], v[52:55], v[140:143], a[96:99]
  v_mov_b32 v111, v39
  v_mfma_f32_16x16x32_bf16 a[128:131], v[52:55], v[144:147], a[128:131]
  v_lshlrev_b32 v84, 1, v8
  v_mfma_f32_16x16x32_bf16 a[160:163], v[52:55], v[148:151], a[160:163]
  v_xor_b32 v84, v84, v11
  v_mfma_f32_16x16x32_bf16 a[192:195], v[52:55], v[152:155], a[192:195]
  v_lshlrev_b32 v84, 4, v84
  v_mfma_f32_16x16x32_bf16 a[224:227], v[52:55], v[156:159], a[224:227]
  v_lshrrev_b32 v85, 3, v1
  v_mfma_f32_16x16x32_bf16 a[4:7], v[56:59], v[128:131], a[4:7]
  ds_read_b64_tr_b16 v[76:77], v22 offset:32768
  v_mfma_f32_16x16x32_bf16 a[36:39], v[56:59], v[132:135], a[36:39]
  ds_read_b64_tr_b16 v[78:79], v22 offset:33792
  v_mfma_f32_16x16x32_bf16 a[68:71], v[56:59], v[136:139], a[68:71]
  v_mul_u32_u24 v85, 2752, v85
  v_mfma_f32_16x16x32_bf16 a[100:103], v[56:59], v[140:143], a[100:103]
  s_mul_i32 s38, s32, 88064
  v_mfma_f32_16x16x32_bf16 a[132:135], v[56:59], v[144:147], a[132:135]
  s_mul_i32 s39, s33, 96
  v_mfma_f32_16x16x32_bf16 a[164:167], v[56:59], v[148:151], a[164:167]
  s_add_u32 s38, s38, s39
  v_mfma_f32_16x16x32_bf16 a[196:199], v[56:59], v[152:155], a[196:199]
  v_add_u32 v85, s38, v85
  v_mfma_f32_16x16x32_bf16 a[228:231], v[56:59], v[156:159], a[228:231]
  v_add_u32 v112, v85, v84
  v_mfma_f32_16x16x32_bf16 a[8:11], v[60:63], v[128:131], a[8:11]
  ds_read_b64_tr_b16 v[80:81], v23 offset:32768
  v_mfma_f32_16x16x32_bf16 a[40:43], v[60:63], v[132:135], a[40:43]
  ds_read_b64_tr_b16 v[82:83], v23 offset:33792
  v_mfma_f32_16x16x32_bf16 a[72:75], v[60:63], v[136:139], a[72:75]
  v_xor_b32 v84, 64, v84
  v_mfma_f32_16x16x32_bf16 a[104:107], v[60:63], v[140:143], a[104:107]
  v_add_u32 v113, v85, v84
  v_mfma_f32_16x16x32_bf16 a[136:139], v[60:63], v[144:147], a[136:139]
  v_add_u32 v113, 20992, v113
  v_mfma_f32_16x16x32_bf16 a[168:171], v[60:63], v[148:151], a[168:171]
  v_add_u32 v114, 41984, v112
  v_mfma_f32_16x16x32_bf16 a[200:203], v[60:63], v[152:155], a[200:203]
  v_add_u32 v115, 41984, v113
  v_mfma_f32_16x16x32_bf16 a[232:235], v[60:63], v[156:159], a[232:235]
  s_lshl_b32 s38, s35, 17
  s_waitcnt lgkmcnt(8)
  v_mfma_f32_16x16x32_bf16 a[12:15], v[64:67], v[128:131], a[12:15]
  s_waitcnt vmcnt(5)
  s_barrier
  s_lshl_b32 s39, s32, 15
  s_add_u32 s98, s38, s39
  s_add_u32 s99, s98, 16384
  s_sub_u32 s100, 1966080, s38
  s_add_u32 s100, s100, s39
  s_add_u32 s101, s100, 16384
  ds_read_b64_tr_b16 v[52:53], v16 offset:49152
  v_mfma_f32_16x16x32_bf16 a[44:47], v[64:67], v[132:135], a[44:47]
  ds_read_b64_tr_b16 v[54:55], v16 offset:50176
  v_mfma_f32_16x16x32_bf16 a[76:79], v[64:67], v[136:139], a[76:79]
  ds_read_b128 v[160:163], v41 offset:32768
  v_mfma_f32_16x16x32_bf16 a[108:111], v[64:67], v[140:143], a[108:111]
  v_mfma_f32_16x16x32_bf16 a[140:143], v[64:67], v[144:147], a[140:143]
  ds_read_b128 v[164:167], v41 offset:34816
  v_mfma_f32_16x16x32_bf16 a[172:175], v[64:67], v[148:151], a[172:175]
  v_mfma_f32_16x16x32_bf16 a[204:207], v[64:67], v[152:155], a[204:207]
  ds_read_b128 v[168:171], v41 offset:36864
  v_mfma_f32_16x16x32_bf16 a[236:239], v[64:67], v[156:159], a[236:239]
  s_waitcnt lgkmcnt(11)
  v_mfma_f32_16x16x32_bf16 a[16:19], v[68:71], v[128:131], a[16:19]
  ds_read_b64_tr_b16 v[56:57], v17 offset:49152
  v_mfma_f32_16x16x32_bf16 a[48:51], v[68:71], v[132:135], a[48:51]
  ds_read_b64_tr_b16 v[58:59], v17 offset:50176
  v_mfma_f32_16x16x32_bf16 a[80:83], v[68:71], v[136:139], a[80:83]
  ds_read_b128 v[172:175], v41 offset:38912
  v_mfma_f32_16x16x32_bf16 a[112:115], v[68:71], v[140:143], a[112:115]
  v_mfma_f32_16x16x32_bf16 a[144:147], v[68:71], v[144:147], a[144:147]
  ds_read_b128 v[176:179], v41 offset:40960
  v_mfma_f32_16x16x32_bf16 a[176:179], v[68:71], v[148:151], a[176:179]
  v_mfma_f32_16x16x32_bf16 a[208:211], v[68:71], v[152:155], a[208:211]
  ds_read_b128 v[180:183], v41 offset:43008
  v_mfma_f32_16x16x32_bf16 a[240:243], v[68:71], v[156:159], a[240:243]
  s_waitcnt lgkmcnt(14)
  v_mfma_f32_16x16x32_bf16 a[20:23], v[72:75], v[128:131], a[20:23]
  ds_read_b64_tr_b16 v[60:61], v18 offset:49152
  v_mfma_f32_16x16x32_bf16 a[52:55], v[72:75], v[132:135], a[52:55]
  ds_read_b64_tr_b16 v[62:63], v18 offset:50176
  v_mfma_f32_16x16x32_bf16 a[84:87], v[72:75], v[136:139], a[84:87]
  ds_read_b128 v[184:187], v41 offset:45056
  v_mfma_f32_16x16x32_bf16 a[116:119], v[72:75], v[140:143], a[116:119]
  v_mfma_f32_16x16x32_bf16 a[148:151], v[72:75], v[144:147], a[148:151]
  ds_read_b128 v[188:191], v41 offset:47104
  v_mfma_f32_16x16x32_bf16 a[180:183], v[72:75], v[148:151], a[180:183]
  v_mfma_f32_16x16x32_bf16 a[212:215], v[72:75], v[152:155], a[212:215]
  v_mfma_f32_16x16x32_bf16 a[244:247], v[72:75], v[156:159], a[244:247]
  s_waitcnt lgkmcnt(15)
  v_mfma_f32_16x16x32_bf16 a[24:27], v[76:79], v[128:131], a[24:27]
  ds_read_b64_tr_b16 v[64:65], v19 offset:49152
  v_mfma_f32_16x16x32_bf16 a[56:59], v[76:79], v[132:135], a[56:59]
  ds_read_b64_tr_b16 v[66:67], v19 offset:50176
  v_mfma_f32_16x16x32_bf16 a[88:91], v[76:79], v[136:139], a[88:91]
  v_mfma_f32_16x16x32_bf16 a[120:123], v[76:79], v[140:143], a[120:123]
  v_mfma_f32_16x16x32_bf16 a[152:155], v[76:79], v[144:147], a[152:155]
  v_mfma_f32_16x16x32_bf16 a[184:187], v[76:79], v[148:151], a[184:187]
  v_mfma_f32_16x16x32_bf16 a[216:219], v[76:79], v[152:155], a[216:219]
  v_mfma_f32_16x16x32_bf16 a[248:251], v[76:79], v[156:159], a[248:251]
  s_waitcnt lgkmcnt(15)
  v_mfma_f32_16x16x32_bf16 a[28:31], v[80:83], v[128:131], a[28:31]
  ds_read_b64_tr_b16 v[68:69], v20 offset:49152
  v_mfma_f32_16x16x32_bf16 a[60:63], v[80:83], v[132:135], a[60:63]
  ds_read_b64_tr_b16 v[70:71], v20 offset:50176
  v_mfma_f32_16x16x32_bf16 a[92:95], v[80:83], v[136:139], a[92:95]
  v_mfma_f32_16x16x32_bf16 a[124:127], v[80:83], v[140:143], a[124:127]
  v_mfma_f32_16x16x32_bf16 a[156:159], v[80:83], v[144:147], a[156:159]
  v_mfma_f32_16x16x32_bf16 a[188:191], v[80:83], v[148:151], a[188:191]
  v_mfma_f32_16x16x32_bf16 a[220:223], v[80:83], v[152:155], a[220:223]
  v_mfma_f32_16x16x32_bf16 a[252:255], v[80:83], v[156:159], a[252:255]
  s_waitcnt lgkmcnt(4)
  v_mfma_f32_16x16x32_bf16 a[0:3], v[52:55], v[160:163], a[0:3]
  ds_read_b64_tr_b16 v[72:73], v21 offset:49152
  v_mfma_f32_16x16x32_bf16 a[32:35], v[52:55], v[164:167], a[32:35]
  ds_read_b64_tr_b16 v[74:75], v21 offset:50176
  v_mfma_f32_16x16x32_bf16 a[64:67], v[52:55], v[168:171], a[64:67]
  v_mfma_f32_16x16x32_bf16 a[96:99], v[52:55], v[172:175], a[96:99]
  v_mfma_f32_16x16x32_bf16 a[128:131], v[52:55], v[176:179], a[128:131]
  v_mfma_f32_16x16x32_bf16 a[160:163], v[52:55], v[180:183], a[160:163]
  v_mfma_f32_16x16x32_bf16 a[192:195], v[52:55], v[184:187], a[192:195]
  v_mfma_f32_16x16x32_bf16 a[224:227], v[52:55], v[188:191], a[224:227]
  v_mfma_f32_16x16x32_bf16 a[4:7], v[56:59], v[160:163], a[4:7]
  ds_read_b64_tr_b16 v[76:77], v22 offset:49152
  v_mfma_f32_16x16x32_bf16 a[36:39], v[56:59], v[164:167], a[36:39]
  ds_read_b64_tr_b16 v[78:79], v22 offset:50176
  v_mfma_f32_16x16x32_bf16 a[68:71], v[56:59], v[168:171], a[68:71]
  v_mfma_f32_16x16x32_bf16 a[100:103], v[56:59], v[172:175], a[100:103]
  v_mfma_f32_16x16x32_bf16 a[132:135], v[56:59], v[176:179], a[132:135]
  v_mfma_f32_16x16x32_bf16 a[164:167], v[56:59], v[180:183], a[164:167]
  v_mfma_f32_16x16x32_bf16 a[196:199], v[56:59], v[184:187], a[196:199]
  v_mfma_f32_16x16x32_bf16 a[228:231], v[56:59], v[188:191], a[228:231]
  v_mfma_f32_16x16x32_bf16 a[8:11], v[60:63], v[160:163], a[8:11]
  ds_read_b64_tr_b16 v[80:81], v23 offset:49152
  v_mfma_f32_16x16x32_bf16 a[40:43], v[60:63], v[164:167], a[40:43]
  ds_read_b64_tr_b16 v[82:83], v23 offset:50176
  v_mfma_f32_16x16x32_bf16 a[72:75], v[60:63], v[168:171], a[72:75]
  v_mfma_f32_16x16x32_bf16 a[104:107], v[60:63], v[172:175], a[104:107]
  v_mfma_f32_16x16x32_bf16 a[136:139], v[60:63], v[176:179], a[136:139]
  v_mfma_f32_16x16x32_bf16 a[168:171], v[60:63], v[180:183], a[168:171]
  v_mfma_f32_16x16x32_bf16 a[200:203], v[60:63], v[184:187], a[200:203]
  v_mfma_f32_16x16x32_bf16 a[232:235], v[60:63], v[188:191], a[232:235]
  s_waitcnt lgkmcnt(8)
  v_mfma_f32_16x16x32_bf16 a[12:15], v[64:67], v[160:163], a[12:15]
  v_accvgpr_read_b32 v192, a0
  v_accvgpr_read_b32 v193, a1
  v_mfma_f32_16x16x32_bf16 a[44:47], v[64:67], v[164:167], a[44:47]
  v_accvgpr_read_b32 v194, a2
  v_accvgpr_read_b32 v195, a3
  v_mfma_f32_16x16x32_bf16 a[76:79], v[64:67], v[168:171], a[76:79]
  v_accvgpr_read_b32 v196, a4
  v_accvgpr_read_b32 v197, a5
  v_mfma_f32_16x16x32_bf16 a[108:111], v[64:67], v[172:175], a[108:111]
  v_accvgpr_read_b32 v198, a6
  v_accvgpr_read_b32 v199, a7
  v_mfma_f32_16x16x32_bf16 a[140:143], v[64:67], v[176:179], a[140:143]
  v_cvt_pk_bf16_f32 v192, v192, v193
  v_cvt_pk_bf16_f32 v193, v194, v195
  v_mfma_f32_16x16x32_bf16 a[172:175], v[64:67], v[180:183], a[172:175]
  v_cvt_pk_bf16_f32 v194, v196, v197
  v_cvt_pk_bf16_f32 v195, v198, v199
  v_mfma_f32_16x16x32_bf16 a[204:207], v[64:67], v[184:187], a[204:207]
  s_add_u32 s37, s43, 0
  buffer_store_dwordx4 v[192:195], v2, s[8:11], s37 offen sc1
  v_mfma_f32_16x16x32_bf16 a[236:239], v[64:67], v[188:191], a[236:239]
  v_accvgpr_read_b32 v200, a32
  v_accvgpr_read_b32 v201, a33
  s_waitcnt lgkmcnt(6)
  v_mfma_f32_16x16x32_bf16 a[16:19], v[68:71], v[160:163], a[16:19]
  v_accvgpr_read_b32 v202, a34
  v_accvgpr_read_b32 v203, a35
  v_mfma_f32_16x16x32_bf16 a[48:51], v[68:71], v[164:167], a[48:51]
  v_accvgpr_read_b32 v204, a36
  v_accvgpr_read_b32 v205, a37
  v_mfma_f32_16x16x32_bf16 a[80:83], v[68:71], v[168:171], a[80:83]
  v_accvgpr_read_b32 v206, a38
  v_accvgpr_read_b32 v207, a39
  v_mfma_f32_16x16x32_bf16 a[112:115], v[68:71], v[172:175], a[112:115]
  v_cvt_pk_bf16_f32 v200, v200, v201
  v_cvt_pk_bf16_f32 v201, v202, v203
  v_mfma_f32_16x16x32_bf16 a[144:147], v[68:71], v[176:179], a[144:147]
  v_cvt_pk_bf16_f32 v202, v204, v205
  v_cvt_pk_bf16_f32 v203, v206, v207
  v_mfma_f32_16x16x32_bf16 a[176:179], v[68:71], v[180:183], a[176:179]
  s_add_u32 s37, s43, 4096
  buffer_store_dwordx4 v[200:203], v2, s[8:11], s37 offen sc1
  v_mfma_f32_16x16x32_bf16 a[208:211], v[68:71], v[184:187], a[208:211]
  v_mfma_f32_16x16x32_bf16 a[240:243], v[68:71], v[188:191], a[240:243]
  s_waitcnt lgkmcnt(4)
  v_mfma_f32_16x16x32_bf16 a[20:23], v[72:75], v[160:163], a[20:23]
  v_accvgpr_read_b32 v208, a8
  v_accvgpr_read_b32 v209, a9
  v_mfma_f32_16x16x32_bf16 a[52:55], v[72:75], v[164:167], a[52:55]
  v_accvgpr_read_b32 v210, a10
  v_accvgpr_read_b32 v211, a11
  v_mfma_f32_16x16x32_bf16 a[84:87], v[72:75], v[168:171], a[84:87]
  v_accvgpr_read_b32 v212, a12
  v_accvgpr_read_b32 v213, a13
  v_mfma_f32_16x16x32_bf16 a[116:119], v[72:75], v[172:175], a[116:119]
  v_accvgpr_read_b32 v214, a14
  v_accvgpr_read_b32 v215, a15
  v_mfma_f32_16x16x32_bf16 a[148:151], v[72:75], v[176:179], a[148:151]
  v_cvt_pk_bf16_f32 v208, v208, v209
  v_cvt_pk_bf16_f32 v209, v210, v211
  v_mfma_f32_16x16x32_bf16 a[180:183], v[72:75], v[180:183], a[180:183]
  v_cvt_pk_bf16_f32 v210, v212, v213
  v_cvt_pk_bf16_f32 v211, v214, v215
  v_mfma_f32_16x16x32_bf16 a[212:215], v[72:75], v[184:187], a[212:215]
  s_add_u32 s37, s43, 1024
  buffer_store_dwordx4 v[208:211], v2, s[8:11], s37 offen sc1
  v_mfma_f32_16x16x32_bf16 a[244:247], v[72:75], v[188:191], a[244:247]
  v_accvgpr_read_b32 v216, a40
  v_accvgpr_read_b32 v217, a41
  s_waitcnt lgkmcnt(2)
  v_mfma_f32_16x16x32_bf16 a[24:27], v[76:79], v[160:163], a[24:27]
  v_accvgpr_read_b32 v218, a42
  v_accvgpr_read_b32 v219, a43
  v_mfma_f32_16x16x32_bf16 a[56:59], v[76:79], v[164:167], a[56:59]
  v_accvgpr_read_b32 v220, a44
  v_accvgpr_read_b32 v221, a45
  v_mfma_f32_16x16x32_bf16 a[88:91], v[76:79], v[168:171], a[88:91]
  v_accvgpr_read_b32 v222, a46
  v_accvgpr_read_b32 v223, a47
  v_mfma_f32_16x16x32_bf16 a[120:123], v[76:79], v[172:175], a[120:123]
  v_cvt_pk_bf16_f32 v216, v216, v217
  v_cvt_pk_bf16_f32 v217, v218, v219
  v_mfma_f32_16x16x32_bf16 a[152:155], v[76:79], v[176:179], a[152:155]
  v_cvt_pk_bf16_f32 v218, v220, v221
  v_cvt_pk_bf16_f32 v219, v222, v223
  v_mfma_f32_16x16x32_bf16 a[184:187], v[76:79], v[180:183], a[184:187]
  s_add_u32 s37, s43, 5120
  buffer_store_dwordx4 v[216:219], v2, s[8:11], s37 offen sc1
  v_mfma_f32_16x16x32_bf16 a[216:219], v[76:79], v[184:187], a[216:219]
  v_mfma_f32_16x16x32_bf16 a[248:251], v[76:79], v[188:191], a[248:251]
  s_waitcnt lgkmcnt(0)
  v_mfma_f32_16x16x32_bf16 a[28:31], v[80:83], v[160:163], a[28:31]
  v_accvgpr_read_b32 v192, a16
  v_accvgpr_read_b32 v193, a17
  v_mfma_f32_16x16x32_bf16 a[60:63], v[80:83], v[164:167], a[60:63]
  v_accvgpr_read_b32 v194, a18
  v_accvgpr_read_b32 v195, a19
  v_mfma_f32_16x16x32_bf16 a[92:95], v[80:83], v[168:171], a[92:95]
  v_accvgpr_read_b32 v196, a20
  v_accvgpr_read_b32 v197, a21
  v_mfma_f32_16x16x32_bf16 a[124:127], v[80:83], v[172:175], a[124:127]
  v_accvgpr_read_b32 v198, a22
  v_accvgpr_read_b32 v199, a23
  v_mfma_f32_16x16x32_bf16 a[156:159], v[80:83], v[176:179], a[156:159]
  v_cvt_pk_bf16_f32 v192, v192, v193
  v_cvt_pk_bf16_f32 v193, v194, v195
  v_mfma_f32_16x16x32_bf16 a[188:191], v[80:83], v[180:183], a[188:191]
  v_cvt_pk_bf16_f32 v194, v196, v197
  v_cvt_pk_bf16_f32 v195, v198, v199
  v_mfma_f32_16x16x32_bf16 a[220:223], v[80:83], v[184:187], a[220:223]
  s_add_u32 s37, s43, 2048
  buffer_store_dwordx4 v[192:195], v2, s[8:11], s37 offen sc1
  v_mfma_f32_16x16x32_bf16 a[252:255], v[80:83], v[188:191], a[252:255]
  v_accvgpr_read_b32 v200, a48
  v_accvgpr_read_b32 v201, a49
  s_barrier
  v_accvgpr_read_b32 v202, a50
  v_accvgpr_read_b32 v203, a51
  v_accvgpr_read_b32 v204, a52
  v_accvgpr_read_b32 v205, a53
  v_accvgpr_read_b32 v206, a54
  s_add_u32 m0, s48, 0
  s_mov_b32 s41, 0
  v_accvgpr_read_b32 v207, a55
  v_cvt_pk_bf16_f32 v200, v200, v201
  v_cvt_pk_bf16_f32 v201, v202, v203
  v_cvt_pk_bf16_f32 v202, v204, v205
  v_cvt_pk_bf16_f32 v203, v206, v207
  buffer_load_dwordx4 v112, s[16:19], s41 offen offset:0 lds
  s_add_u32 s37, s43, 6144
  buffer_store_dwordx4 v[200:203], v2, s[8:11], s37 offen sc1
  v_accvgpr_read_b32 v208, a24
  v_accvgpr_read_b32 v209, a25
  v_accvgpr_read_b32 v210, a26
  buffer_load_dwordx4 v113, s[16:19], s41 offen offset:1024 lds
  v_accvgpr_read_b32 v211, a27
  v_accvgpr_read_b32 v212, a28
  v_accvgpr_read_b32 v213, a29
  v_accvgpr_read_b32 v214, a30
  v_accvgpr_read_b32 v215, a31
  buffer_load_dwordx4 v114, s[16:19], s41 offen offset:2048 lds
  v_cvt_pk_bf16_f32 v208, v208, v209
  v_cvt_pk_bf16_f32 v209, v210, v211
  v_cvt_pk_bf16_f32 v210, v212, v213
  v_cvt_pk_bf16_f32 v211, v214, v215
  s_add_u32 s37, s43, 3072
  buffer_load_dwordx4 v115, s[16:19], s41 offen offset:3072 lds
  buffer_store_dwordx4 v[208:211], v2, s[8:11], s37 offen sc1
  v_accvgpr_read_b32 v216, a56
  v_accvgpr_read_b32 v217, a57
  v_accvgpr_read_b32 v218, a58
  v_accvgpr_read_b32 v219, a59
  s_add_u32 m0, s48, 16384
  s_mov_b32 s41, 0
  v_accvgpr_read_b32 v220, a60
  v_accvgpr_read_b32 v221, a61
  v_accvgpr_read_b32 v222, a62
  v_accvgpr_read_b32 v223, a63
  v_cvt_pk_bf16_f32 v216, v216, v217
  buffer_load_dwordx4 v108, s[12:15], s41 offen offset:0 lds
  v_cvt_pk_bf16_f32 v217, v218, v219
  v_cvt_pk_bf16_f32 v218, v220, v221
  v_cvt_pk_bf16_f32 v219, v222, v223
  s_add_u32 s37, s43, 7168
  buffer_store_dwordx4 v[216:219], v2, s[8:11], s37 offen sc1
  buffer_load_dwordx4 v109, s[12:15], s41 offen offset:1024 lds
  v_accvgpr_read_b32 v192, a64
  v_accvgpr_read_b32 v193, a65
  v_accvgpr_read_b32 v194, a66
  v_accvgpr_read_b32 v195, a67
  v_accvgpr_read_b32 v196, a68
  v_accvgpr_read_b32 v197, a69
  v_accvgpr_read_b32 v198, a70
  v_accvgpr_read_b32 v199, a71
  v_cvt_pk_bf16_f32 v128, v192, v193
  buffer_load_dwordx4 v110, s[12:15], s41 offen offset:2048 lds
  v_cvt_pk_bf16_f32 v129, v194, v195
  v_cvt_pk_bf16_f32 v130, v196, v197
  v_cvt_pk_bf16_f32 v131, v198, v199
  v_accvgpr_read_b32 v200, a72
  v_accvgpr_read_b32 v201, a73
  v_accvgpr_read_b32 v202, a74
  v_accvgpr_read_b32 v203, a75
  v_accvgpr_read_b32 v204, a76
  v_accvgpr_read_b32 v205, a77
  buffer_load_dwordx4 v111, s[12:15], s41 offen offset:3072 lds
  v_accvgpr_read_b32 v206, a78
  v_accvgpr_read_b32 v207, a79
  v_cvt_pk_bf16_f32 v132, v200, v201
  v_cvt_pk_bf16_f32 v133, v202, v203
  v_cvt_pk_bf16_f32 v134, v204, v205
  v_cvt_pk_bf16_f32 v135, v206, v207
  v_accvgpr_read_b32 v208, a80
  v_accvgpr_read_b32 v209, a81
  v_accvgpr_read_b32 v210, a82
  s_add_u32 m0, s48, 32768
  s_mov_b32 s41, 524288
  v_accvgpr_read_b32 v211, a83
  v_accvgpr_read_b32 v212, a84
  v_accvgpr_read_b32 v213, a85
  v_accvgpr_read_b32 v214, a86
  v_accvgpr_read_b32 v215, a87
  v_cvt_pk_bf16_f32 v136, v208, v209
  v_cvt_pk_bf16_f32 v137, v210, v211
  v_cvt_pk_bf16_f32 v138, v212, v213
  v_cvt_pk_bf16_f32 v139, v214, v215
  buffer_load_dwordx4 v108, s[12:15], s41 offen offset:0 lds
  v_accvgpr_read_b32 v216, a88
  v_accvgpr_read_b32 v217, a89
  v_accvgpr_read_b32 v218, a90
  v_accvgpr_read_b32 v219, a91
  v_accvgpr_read_b32 v220, a92
  v_accvgpr_read_b32 v221, a93
  v_accvgpr_read_b32 v222, a94
  v_accvgpr_read_b32 v223, a95
  v_cvt_pk_bf16_f32 v140, v216, v217
  buffer_load_dwordx4 v109, s[12:15], s41 offen offset:1024 lds
  v_cvt_pk_bf16_f32 v141, v218, v219
  v_cvt_pk_bf16_f32 v142, v220, v221
  v_cvt_pk_bf16_f32 v143, v222, v223
  v_accvgpr_read_b32 v192, a96
  v_accvgpr_read_b32 v193, a97
  v_accvgpr_read_b32 v194, a98
  v_accvgpr_read_b32 v195, a99
  v_accvgpr_read_b32 v196, a100
  v_accvgpr_read_b32 v197, a101
  buffer_load_dwordx4 v110, s[12:15], s41 offen offset:2048 lds
  v_accvgpr_read_b32 v198, a102
  v_accvgpr_read_b32 v199, a103
  v_cvt_pk_bf16_f32 v144, v192, v193
  v_cvt_pk_bf16_f32 v145, v194, v195
  v_cvt_pk_bf16_f32 v146, v196, v197
  v_cvt_pk_bf16_f32 v147, v198, v199
  v_accvgpr_read_b32 v200, a104
  v_accvgpr_read_b32 v201, a105
  v_accvgpr_read_b32 v202, a106
  buffer_load_dwordx4 v111, s[12:15], s41 offen offset:3072 lds
  v_accvgpr_read_b32 v203, a107
  v_accvgpr_read_b32 v204, a108
  v_accvgpr_read_b32 v205, a109
  v_accvgpr_read_b32 v206, a110
  v_accvgpr_read_b32 v207, a111
  v_cvt_pk_bf16_f32 v148, v200, v201
  v_cvt_pk_bf16_f32 v149, v202, v203
  v_cvt_pk_bf16_f32 v150, v204, v205
  v_cvt_pk_bf16_f32 v151, v206, v207
  buffer_load_dwordx4 a[0:3], v2, s[8:11], s98 offen offset:0 sc1
  v_accvgpr_read_b32 v208, a112
  v_accvgpr_read_b32 v209, a113
  v_accvgpr_read_b32 v210, a114
  v_accvgpr_read_b32 v211, a115
  v_accvgpr_read_b32 v212, a116
  v_accvgpr_read_b32 v213, a117
  v_accvgpr_read_b32 v214, a118
  v_accvgpr_read_b32 v215, a119
  v_cvt_pk_bf16_f32 v152, v208, v209
  buffer_load_dwordx4 a[4:7], v2, s[8:11], s99 offen offset:0 sc1
  v_cvt_pk_bf16_f32 v153, v210, v211
  v_cvt_pk_bf16_f32 v154, v212, v213
  v_cvt_pk_bf16_f32 v155, v214, v215
  v_accvgpr_read_b32 v216, a120
  v_accvgpr_read_b32 v217, a121
  v_accvgpr_read_b32 v218, a122
  v_accvgpr_read_b32 v219, a123
  v_accvgpr_read_b32 v220, a124
  v_accvgpr_read_b32 v221, a125
  buffer_load_dwordx4 a[8:11], v2, s[8:11], s100 offen offset:0 sc1
  v_accvgpr_read_b32 v222, a126
  v_accvgpr_read_b32 v223, a127
  v_cvt_pk_bf16_f32 v156, v216, v217
  v_cvt_pk_bf16_f32 v157, v218, v219
  v_cvt_pk_bf16_f32 v158, v220, v221
  v_cvt_pk_bf16_f32 v159, v222, v223
  v_accvgpr_read_b32 v192, a128
  v_accvgpr_read_b32 v193, a129
  v_accvgpr_read_b32 v194, a130
  buffer_load_dwordx4 a[12:15], v2, s[8:11], s101 offen offset:0 sc1
  v_accvgpr_read_b32 v195, a131
  v_accvgpr_read_b32 v196, a132
  v_accvgpr_read_b32 v197, a133
  v_accvgpr_read_b32 v198, a134
  v_accvgpr_read_b32 v199, a135
  v_cvt_pk_bf16_f32 v160, v192, v193
  v_cvt_pk_bf16_f32 v161, v194, v195
  v_cvt_pk_bf16_f32 v162, v196, v197
  v_cvt_pk_bf16_f32 v163, v198, v199
  buffer_load_dwordx4 a[16:19], v2, s[8:11], s98 offen offset:1024 sc1
  v_accvgpr_read_b32 v200, a136
  v_accvgpr_read_b32 v201, a137
  v_accvgpr_read_b32 v202, a138
  v_accvgpr_read_b32 v203, a139
  v_accvgpr_read_b32 v204, a140
  v_accvgpr_read_b32 v205, a141
  v_accvgpr_read_b32 v206, a142
  v_accvgpr_read_b32 v207, a143
  v_cvt_pk_bf16_f32 v164, v200, v201
  buffer_load_dwordx4 a[20:23], v2, s[8:11], s99 offen offset:1024 sc1
  v_cvt_pk_bf16_f32 v165, v202, v203
  v_cvt_pk_bf16_f32 v166, v204, v205
  v_cvt_pk_bf16_f32 v167, v206, v207
  v_accvgpr_read_b32 v208, a144
  v_accvgpr_read_b32 v209, a145
  v_accvgpr_read_b32 v210, a146
  v_accvgpr_read_b32 v211, a147
  v_accvgpr_read_b32 v212, a148
  v_accvgpr_read_b32 v213, a149
  buffer_load_dwordx4 a[24:27], v2, s[8:11], s100 offen offset:1024 sc1
  v_accvgpr_read_b32 v214, a150
  v_accvgpr_read_b32 v215, a151
  v_cvt_pk_bf16_f32 v168, v208, v209
  v_cvt_pk_bf16_f32 v169, v210, v211
  v_cvt_pk_bf16_f32 v170, v212, v213
  v_cvt_pk_bf16_f32 v171, v214, v215
  v_accvgpr_read_b32 v216, a152
  v_accvgpr_read_b32 v217, a153
  v_accvgpr_read_b32 v218, a154
  buffer_load_dwordx4 a[28:31], v2, s[8:11], s101 offen offset:1024 sc1
  v_accvgpr_read_b32 v219, a155
  v_accvgpr_read_b32 v220, a156
  v_accvgpr_read_b32 v221, a157
  v_accvgpr_read_b32 v222, a158
  v_accvgpr_read_b32 v223, a159
  v_cvt_pk_bf16_f32 v172, v216, v217
  v_cvt_pk_bf16_f32 v173, v218, v219
  v_cvt_pk_bf16_f32 v174, v220, v221
  v_cvt_pk_bf16_f32 v175, v222, v223
  buffer_load_dwordx4 a[32:35], v2, s[8:11], s98 offen offset:2048 sc1
  v_accvgpr_read_b32 v192, a160
  v_accvgpr_read_b32 v193, a161
  v_accvgpr_read_b32 v194, a162
  v_accvgpr_read_b32 v195, a163
  v_accvgpr_read_b32 v196, a164
  v_accvgpr_read_b32 v197, a165
  v_accvgpr_read_b32 v198, a166
  v_accvgpr_read_b32 v199, a167
  v_cvt_pk_bf16_f32 v176, v192, v193
  buffer_load_dwordx4 a[36:39], v2, s[8:11], s99 offen offset:2048 sc1
  v_cvt_pk_bf16_f32 v177, v194, v195
  v_cvt_pk_bf16_f32 v178, v196, v197
  v_cvt_pk_bf16_f32 v179, v198, v199
  v_accvgpr_read_b32 v200, a168
  v_accvgpr_read_b32 v201, a169
  v_accvgpr_read_b32 v202, a170
  v_accvgpr_read_b32 v203, a171
  v_accvgpr_read_b32 v204, a172
  v_accvgpr_read_b32 v205, a173
  buffer_load_dwordx4 a[40:43], v2, s[8:11], s100 offen offset:2048 sc1
  v_accvgpr_read_b32 v206, a174
  v_accvgpr_read_b32 v207, a175
  v_cvt_pk_bf16_f32 v180, v200, v201
  v_cvt_pk_bf16_f32 v181, v202, v203
  v_cvt_pk_bf16_f32 v182, v204, v205
  v_cvt_pk_bf16_f32 v183, v206, v207
  v_accvgpr_read_b32 v208, a176
  v_accvgpr_read_b32 v209, a177
  v_accvgpr_read_b32 v210, a178
  buffer_load_dwordx4 a[44:47], v2, s[8:11], s101 offen offset:2048 sc1
  v_accvgpr_read_b32 v211, a179
  v_accvgpr_read_b32 v212, a180
  v_accvgpr_read_b32 v213, a181
  v_accvgpr_read_b32 v214, a182
  v_accvgpr_read_b32 v215, a183
  v_cvt_pk_bf16_f32 v184, v208, v209
  v_cvt_pk_bf16_f32 v185, v210, v211
  v_cvt_pk_bf16_f32 v186, v212, v213
  v_cvt_pk_bf16_f32 v187, v214, v215
  buffer_load_dwordx4 a[48:51], v2, s[8:11], s98 offen offset:3072 sc1
  v_accvgpr_read_b32 v216, a184
  v_accvgpr_read_b32 v217, a185
  v_accvgpr_read_b32 v218, a186
  v_accvgpr_read_b32 v219, a187
  v_accvgpr_read_b32 v220, a188
  v_accvgpr_read_b32 v221, a189
  v_accvgpr_read_b32 v222, a190
  v_accvgpr_read_b32 v223, a191
  v_cvt_pk_bf16_f32 v188, v216, v217
  buffer_load_dwordx4 a[52:55], v2, s[8:11], s99 offen offset:3072 sc1
  v_cvt_pk_bf16_f32 v189, v218, v219
  v_cvt_pk_bf16_f32 v190, v220, v221
  v_cvt_pk_bf16_f32 v191, v222, v223
  v_accvgpr_read_b32 v192, a192
  v_accvgpr_read_b32 v193, a193
  v_accvgpr_read_b32 v194, a194
  v_accvgpr_read_b32 v195, a195
  v_accvgpr_read_b32 v196, a196
  v_accvgpr_read_b32 v197, a197
  buffer_load_dwordx4 a[56:59], v2, s[8:11], s100 offen offset:3072 sc1
  v_accvgpr_read_b32 v198, a198
  v_accvgpr_read_b32 v199, a199
  v_cvt_pk_bf16_f32 v52, v192, v193
  v_cvt_pk_bf16_f32 v53, v194, v195
  v_cvt_pk_bf16_f32 v54, v196, v197
  v_cvt_pk_bf16_f32 v55, v198, v199
  v_accvgpr_read_b32 v200, a200
  v_accvgpr_read_b32 v201, a201
  v_accvgpr_read_b32 v202, a202
  buffer_load_dwordx4 a[60:63], v2, s[8:11], s101 offen offset:3072 sc1
  v_accvgpr_read_b32 v203, a203
  v_accvgpr_read_b32 v204, a204
  v_accvgpr_read_b32 v205, a205
  v_accvgpr_read_b32 v206, a206
  v_accvgpr_read_b32 v207, a207
  v_cvt_pk_bf16_f32 v56, v200, v201
  v_cvt_pk_bf16_f32 v57, v202, v203
  v_cvt_pk_bf16_f32 v58, v204, v205
  v_cvt_pk_bf16_f32 v59, v206, v207
  v_accvgpr_read_b32 v208, a208
  v_accvgpr_read_b32 v209, a209
  v_accvgpr_read_b32 v210, a210
  v_accvgpr_read_b32 v211, a211
  v_accvgpr_read_b32 v212, a212
  v_accvgpr_read_b32 v213, a213
  v_accvgpr_read_b32 v214, a214
  v_accvgpr_read_b32 v215, a215
  v_cvt_pk_bf16_f32 v60, v208, v209
  v_cvt_pk_bf16_f32 v61, v210, v211
  v_cvt_pk_bf16_f32 v62, v212, v213
  v_cvt_pk_bf16_f32 v63, v214, v215
  v_accvgpr_read_b32 v216, a216
  v_accvgpr_read_b32 v217, a217
  v_accvgpr_read_b32 v218, a218
  v_accvgpr_read_b32 v219, a219
  v_accvgpr_read_b32 v220, a220
  v_accvgpr_read_b32 v221, a221
  v_accvgpr_read_b32 v222, a222
  v_accvgpr_read_b32 v223, a223
  v_cvt_pk_bf16_f32 v64, v216, v217
  v_cvt_pk_bf16_f32 v65, v218, v219
  v_cvt_pk_bf16_f32 v66, v220, v221
  v_cvt_pk_bf16_f32 v67, v222, v223
  v_accvgpr_read_b32 v192, a224
  v_accvgpr_read_b32 v193, a225
  v_accvgpr_read_b32 v194, a226
  v_accvgpr_read_b32 v195, a227
  v_accvgpr_read_b32 v196, a228
  v_accvgpr_read_b32 v197, a229
  v_accvgpr_read_b32 v198, a230
  v_accvgpr_read_b32 v199, a231
  v_cvt_pk_bf16_f32 v68, v192, v193
  v_cvt_pk_bf16_f32 v69, v194, v195
  v_cvt_pk_bf16_f32 v70, v196, v197
  v_cvt_pk_bf16_f32 v71, v198, v199
  v_accvgpr_read_b32 v200, a232
  v_accvgpr_read_b32 v201, a233
  v_accvgpr_read_b32 v202, a234
  v_accvgpr_read_b32 v203, a235
  v_accvgpr_read_b32 v204, a236
  v_accvgpr_read_b32 v205, a237
  v_accvgpr_read_b32 v206, a238
  v_accvgpr_read_b32 v207, a239
  v_cvt_pk_bf16_f32 v72, v200, v201
  v_cvt_pk_bf16_f32 v73, v202, v203
  v_cvt_pk_bf16_f32 v74, v204, v205
  v_cvt_pk_bf16_f32 v75, v206, v207
  v_accvgpr_read_b32 v208, a240
  v_accvgpr_read_b32 v209, a241
  v_accvgpr_read_b32 v210, a242
  v_accvgpr_read_b32 v211, a243
  v_accvgpr_read_b32 v212, a244
  v_accvgpr_read_b32 v213, a245
  v_accvgpr_read_b32 v214, a246
  v_accvgpr_read_b32 v215, a247
  v_cvt_pk_bf16_f32 v76, v208, v209
  v_cvt_pk_bf16_f32 v77, v210, v211
  v_cvt_pk_bf16_f32 v78, v212, v213
  v_cvt_pk_bf16_f32 v79, v214, v215
  v_accvgpr_read_b32 v216, a248
  v_accvgpr_read_b32 v217, a249
  v_accvgpr_read_b32 v218, a250
  v_accvgpr_read_b32 v219, a251
  v_accvgpr_read_b32 v220, a252
  v_accvgpr_read_b32 v221, a253
  v_accvgpr_read_b32 v222, a254
  v_accvgpr_read_b32 v223, a255
  v_cvt_pk_bf16_f32 v80, v216, v217
  v_cvt_pk_bf16_f32 v81, v218, v219
  v_cvt_pk_bf16_f32 v82, v220, v221
  v_cvt_pk_bf16_f32 v83, v222, v223
  v_accvgpr_write_b32 a96, v128
  v_accvgpr_write_b32 a97, v129
  v_accvgpr_write_b32 a98, v130
  v_accvgpr_write_b32 a99, v131
  v_accvgpr_write_b32 a100, v132
  v_accvgpr_write_b32 a101, v133
  v_accvgpr_write_b32 a102, v134
  v_accvgpr_write_b32 a103, v135
  v_accvgpr_write_b32 a104, v136
  v_accvgpr_write_b32 a105, v137
  v_accvgpr_write_b32 a106, v138
  v_accvgpr_write_b32 a107, v139
  v_accvgpr_write_b32 a108, v140
  v_accvgpr_write_b32 a109, v141
  v_accvgpr_write_b32 a110, v142
  v_accvgpr_write_b32 a111, v143
  v_accvgpr_write_b32 a112, v144
  v_accvgpr_write_b32 a113, v145
  v_accvgpr_write_b32 a114, v146
  v_accvgpr_write_b32 a115, v147
  v_accvgpr_write_b32 a116, v148
  v_accvgpr_write_b32 a117, v149
  v_accvgpr_write_b32 a118, v150
  v_accvgpr_write_b32 a119, v151
  v_accvgpr_write_b32 a120, v152
  v_accvgpr_write_b32 a121, v153
  v_accvgpr_write_b32 a122, v154
  v_accvgpr_write_b32 a123, v155
  v_accvgpr_write_b32 a124, v156
  v_accvgpr_write_b32 a125, v157
  v_accvgpr_write_b32 a126, v158
  v_accvgpr_write_b32 a127, v159
  v_accvgpr_write_b32 a128, v160
  v_accvgpr_write_b32 a129, v161
  v_accvgpr_write_b32 a130, v162
  v_accvgpr_write_b32 a131, v163
  v_accvgpr_write_b32 a132, v164
  v_accvgpr_write_b32 a133, v165
  v_accvgpr_write_b32 a134, v166
  v_accvgpr_write_b32 a135, v167
  v_accvgpr_write_b32 a136, v168
  v_accvgpr_write_b32 a137, v169
  v_accvgpr_write_b32 a138, v170
  v_accvgpr_write_b32 a139, v171
  v_accvgpr_write_b32 a140, v172
  v_accvgpr_write_b32 a141, v173
  v_accvgpr_write_b32 a142, v174
  v_accvgpr_write_b32 a143, v175
  v_accvgpr_write_b32 a144, v176
  v_accvgpr_write_b32 a145, v177
  v_accvgpr_write_b32 a146, v178
  v_accvgpr_write_b32 a147, v179
  v_accvgpr_write_b32 a148, v180
  v_accvgpr_write_b32 a149, v181
  v_accvgpr_write_b32 a150, v182
  v_accvgpr_write_b32 a151, v183
  v_accvgpr_write_b32 a152, v184
  v_accvgpr_write_b32 a153, v185
  v_accvgpr_write_b32 a154, v186
  v_accvgpr_write_b32 a155, v187
  v_accvgpr_write_b32 a156, v188
  v_accvgpr_write_b32 a157, v189
  v_accvgpr_write_b32 a158, v190
  v_accvgpr_write_b32 a159, v191
  v_accvgpr_write_b32 a160, v52
  v_accvgpr_write_b32 a161, v53
  v_accvgpr_write_b32 a162, v54
  v_accvgpr_write_b32 a163, v55
  v_accvgpr_write_b32 a164, v56
  v_accvgpr_write_b32 a165, v57
  v_accvgpr_write_b32 a166, v58
  v_accvgpr_write_b32 a167, v59
  v_accvgpr_write_b32 a168, v60
  v_accvgpr_write_b32 a169, v61
  v_accvgpr_write_b32 a170, v62
  v_accvgpr_write_b32 a171, v63
  v_accvgpr_write_b32 a172, v64
  v_accvgpr_write_b32 a173, v65
  v_accvgpr_write_b32 a174, v66
  v_accvgpr_write_b32 a175, v67
  v_accvgpr_write_b32 a176, v68
  v_accvgpr_write_b32 a177, v69
  v_accvgpr_write_b32 a178, v70
  v_accvgpr_write_b32 a179, v71
  v_accvgpr_write_b32 a180, v72
  v_accvgpr_write_b32 a181, v73
  v_accvgpr_write_b32 a182, v74
  v_accvgpr_write_b32 a183, v75
  v_accvgpr_write_b32 a184, v76
  v_accvgpr_write_b32 a185, v77
  v_accvgpr_write_b32 a186, v78
  v_accvgpr_write_b32 a187, v79
  v_accvgpr_write_b32 a188, v80
  v_accvgpr_write_b32 a189, v81
  v_accvgpr_write_b32 a190, v82
  v_accvgpr_write_b32 a191, v83
  s_add_u32 s50, s43, 8192
  s_mov_b32 s3, s54
  s_branch k2_kernel
  s_endpgm
k1_V:
  s_waitcnt vmcnt(19)
  s_barrier
  ds_read_b64_tr_b16 v[52:53], v16 offset:0
  ds_read_b64_tr_b16 v[54:55], v16 offset:1024
  ds_read_b128 v[128:131], v40 offset:0
  ds_read_b128 v[132:135], v40 offset:2048
  ds_read_b128 v[136:139], v40 offset:4096
  ds_read_b128 v[140:143], v40 offset:6144
  ds_read_b128 v[144:147], v40 offset:8192
  ds_read_b128 v[148:151], v40 offset:10240
  ds_read_b128 v[152:155], v40 offset:12288
  ds_read_b128 v[156:159], v40 offset:14336
  ds_read_b64_tr_b16 v[56:57], v17 offset:0
  ds_read_b64_tr_b16 v[58:59], v17 offset:1024
  ds_read_b64_tr_b16 v[60:61], v18 offset:0
  ds_read_b64_tr_b16 v[62:63], v18 offset:1024
  ds_read_b64_tr_b16 v[64:65], v19 offset:0
  ds_read_b64_tr_b16 v[66:67], v19 offset:1024
  ds_read_b64_tr_b16 v[68:69], v20 offset:0
  ds_read_b64_tr_b16 v[70:71], v20 offset:1024
  s_waitcnt lgkmcnt(8)
  v_mfma_f32_16x16x32_bf16 a[0:3], v[128:131], v[52:55], 0
  ds_read_b64_tr_b16 v[72:73], v21 offset:0
  v_mfma_f32_16x16x32_bf16 a[32:35], v[132:135], v[52:55], 0
  ds_read_b64_tr_b16 v[74:75], v21 offset:1024
  v_mfma_f32_16x16x32_bf16 a[64:67], v[136:139], v[52:55], 0
  v_mfma_f32_16x16x32_bf16 a[96:99], v[140:143], v[52:55], 0
  v_mfma_f32_16x16x32_bf16 a[128:131], v[144:147], v[52:55], 0
  v_mfma_f32_16x16x32_bf16 a[160:163], v[148:151], v[52:55], 0
  v_mfma_f32_16x16x32_bf16 a[192:195], v[152:155], v[52:55], 0
  v_mfma_f32_16x16x32_bf16 a[224:227], v[156:159], v[52:55], 0
  s_waitcnt lgkmcnt(8)
  v_mfma_f32_16x16x32_bf16 a[4:7], v[128:131], v[56:59], 0
  ds_read_b64_tr_b16 v[76:77], v22 offset:0
  v_mfma_f32_16x16x32_bf16 a[36:39], v[132:135], v[56:59], 0
  ds_read_b64_tr_b16 v[78:79], v22 offset:1024
  v_mfma_f32_16x16x32_bf16 a[68:71], v[136:139], v[56:59], 0
  v_mfma_f32_16x16x32_bf16 a[100:103], v[140:143], v[56:59], 0
  v_mfma_f32_16x16x32_bf16 a[132:135], v[144:147], v[56:59], 0
  v_mfma_f32_16x16x32_bf16 a[164:167], v[148:151], v[56:59], 0
  v_mfma_f32_16x16x32_bf16 a[196:199], v[152:155], v[56:59], 0
  v_mfma_f32_16x16x32_bf16 a[228:231], v[156:159], v[56:59], 0
  s_waitcnt lgkmcnt(8)
  v_mfma_f32_16x16x32_bf16 a[8:11], v[128:131], v[60:63], 0
  ds_read_b64_tr_b16 v[80:81], v23 offset:0
  v_mfma_f32_16x16x32_bf16 a[40:43], v[132:135], v[60:63], 0
  ds_read_b64_tr_b16 v[82:83], v23 offset:1024
  v_mfma_f32_16x16x32_bf16 a[72:75], v[136:139], v[60:63], 0
  v_mfma_f32_16x16x32_bf16 a[104:107], v[140:143], v[60:63], 0
  v_mfma_f32_16x16x32_bf16 a[136:139], v[144:147], v[60:63], 0
  v_mfma_f32_16x16x32_bf16 a[168:171], v[148:151], v[60:63], 0
  v_mfma_f32_16x16x32_bf16 a[200:203], v[152:155], v[60:63], 0
  v_mfma_f32_16x16x32_bf16 a[232:235], v[156:159], v[60:63], 0
  s_waitcnt lgkmcnt(8)
  v_mfma_f32_16x16x32_bf16 a[12:15], v[128:131], v[64:67], 0
  s_waitcnt vmcnt(15)
  s_barrier
  ds_read_b64_tr_b16 v[52:53], v16 offset:16384
  v_mfma_f32_16x16x32_bf16 a[44:47], v[132:135], v[64:67], 0
  ds_read_b64_tr_b16 v[54:55], v16 offset:17408
  v_mfma_f32_16x16x32_bf16 a[76:79], v[136:139], v[64:67], 0
  ds_read_b128 v[160:163], v41 offset:0
  v_mfma_f32_16x16x32_bf16 a[108:111], v[140:143], v[64:67], 0
  s_add_u32 m0, s50, 49152
  s_xor_b32 s36, s49, 1
  s_lshl_b32 s36, s36, 19
  s_add_u32 s36, s36, 262144
  v_mfma_f32_16x16x32_bf16 a[140:143], v[144:147], v[64:67], 0
  ds_read_b128 v[164:167], v41 offset:2048
  v_mfma_f32_16x16x32_bf16 a[172:175], v[148:151], v[64:67], 0
  v_mfma_f32_16x16x32_bf16 a[204:207], v[152:155], v[64:67], 0
  ds_read_b128 v[168:171], v41 offset:4096
  v_mfma_f32_16x16x32_bf16 a[236:239], v[156:159], v[64:67], 0
  buffer_load_dwordx4 v46, s[16:19], s36 offen offset:0 lds
  s_waitcnt lgkmcnt(11)
  v_mfma_f32_16x16x32_bf16 a[16:19], v[128:131], v[68:71], 0
  ds_read_b64_tr_b16 v[56:57], v17 offset:16384
  v_mfma_f32_16x16x32_bf16 a[48:51], v[132:135], v[68:71], 0
  ds_read_b64_tr_b16 v[58:59], v17 offset:17408
  v_mfma_f32_16x16x32_bf16 a[80:83], v[136:139], v[68:71], 0
  ds_read_b128 v[172:175], v41 offset:6144
  v_mfma_f32_16x16x32_bf16 a[112:115], v[140:143], v[68:71], 0
  buffer_load_dwordx4 v47, s[16:19], s36 offen offset:1024 lds
  v_mfma_f32_16x16x32_bf16 a[144:147], v[144:147], v[68:71], 0
  ds_read_b128 v[176:179], v41 offset:8192
  v_mfma_f32_16x16x32_bf16 a[176:179], v[148:151], v[68:71], 0
  v_mfma_f32_16x16x32_bf16 a[208:211], v[152:155], v[68:71], 0
  ds_read_b128 v[180:183], v41 offset:10240
  v_mfma_f32_16x16x32_bf16 a[240:243], v[156:159], v[68:71], 0
  s_add_u32 m0, s50, 57344
  s_nop 0
  s_waitcnt lgkmcnt(14)
  v_mfma_f32_16x16x32_bf16 a[20:23], v[128:131], v[72:75], 0
  ds_read_b64_tr_b16 v[60:61], v18 offset:16384
  v_mfma_f32_16x16x32_bf16 a[52:55], v[132:135], v[72:75], 0
  ds_read_b64_tr_b16 v[62:63], v18 offset:17408
  v_mfma_f32_16x16x32_bf16 a[84:87], v[136:139], v[72:75], 0
  ds_read_b128 v[184:187], v41 offset:12288
  v_mfma_f32_16x16x32_bf16 a[116:119], v[140:143], v[72:75], 0
  buffer_load_dwordx4 v46, s[20:23], s36 offen offset:0 lds
  v_mfma_f32_16x16x32_bf16 a[148:151], v[144:147], v[72:75], 0
  ds_read_b128 v[188:191], v41 offset:14336
  v_mfma_f32_16x16x32_bf16 a[180:183], v[148:151], v[72:75], 0
  v_mfma_f32_16x16x32_bf16 a[212:215], v[152:155], v[72:75], 0
  v_mfma_f32_16x16x32_bf16 a[244:247], v[156:159], v[72:75], 0
  buffer_load_dwordx4 v47, s[20:23], s36 offen offset:1024 lds
  s_waitcnt lgkmcnt(15)
  v_mfma_f32_16x16x32_bf16 a[24:27], v[128:131], v[76:79], 0
  ds_read_b64_tr_b16 v[64:65], v19 offset:16384
  v_mfma_f32_16x16x32_bf16 a[56:59], v[132:135], v[76:79], 0
  ds_read_b64_tr_b16 v[66:67], v19 offset:17408
  v_mfma_f32_16x16x32_bf16 a[88:91], v[136:139], v[76:79], 0
  v_mfma_f32_16x16x32_bf16 a[120:123], v[140:143], v[76:79], 0
  s_add_u32 m0, s44, 131072
  s_xor_b32 s36, s49, 2
  s_lshl_b32 s36, s36, 7
  v_mfma_f32_16x16x32_bf16 a[152:155], v[144:147], v[76:79], 0
  v_mfma_f32_16x16x32_bf16 a[184:187], v[148:151], v[76:79], 0
  v_mfma_f32_16x16x32_bf16 a[216:219], v[152:155], v[76:79], 0
  v_mfma_f32_16x16x32_bf16 a[248:251], v[156:159], v[76:79], 0
  buffer_load_dwordx4 v32, s[12:15], s36 offen offset:0 lds
  s_waitcnt lgkmcnt(15)
  v_mfma_f32_16x16x32_bf16 a[28:31], v[128:131], v[80:83], 0
  ds_read_b64_tr_b16 v[68:69], v20 offset:16384
  v_mfma_f32_16x16x32_bf16 a[60:63], v[132:135], v[80:83], 0
  ds_read_b64_tr_b16 v[70:71], v20 offset:17408
  v_mfma_f32_16x16x32_bf16 a[92:95], v[136:139], v[80:83], 0
  v_mfma_f32_16x16x32_bf16 a[124:127], v[140:143], v[80:83], 0
  buffer_load_dwordx4 v33, s[12:15], s36 offen offset:1024 lds
  v_mfma_f32_16x16x32_bf16 a[156:159], v[144:147], v[80:83], 0
  v_mfma_f32_16x16x32_bf16 a[188:191], v[148:151], v[80:83], 0
  v_mfma_f32_16x16x32_bf16 a[220:223], v[152:155], v[80:83], 0
  v_mfma_f32_16x16x32_bf16 a[252:255], v[156:159], v[80:83], 0
  buffer_load_dwordx4 v34, s[12:15], s36 offen offset:2048 lds
  s_waitcnt lgkmcnt(4)
  v_mfma_f32_16x16x32_bf16 a[0:3], v[160:163], v[52:55], a[0:3]
  ds_read_b64_tr_b16 v[72:73], v21 offset:16384
  v_mfma_f32_16x16x32_bf16 a[32:35], v[164:167], v[52:55], a[32:35]
  ds_read_b64_tr_b16 v[74:75], v21 offset:17408
  v_mfma_f32_16x16x32_bf16 a[64:67], v[168:171], v[52:55], a[64:67]
  v_mfma_f32_16x16x32_bf16 a[96:99], v[172:175], v[52:55], a[96:99]
  buffer_load_dwordx4 v35, s[12:15], s36 offen offset:3072 lds
  v_mfma_f32_16x16x32_bf16 a[128:131], v[176:179], v[52:55], a[128:131]
  v_mfma_f32_16x16x32_bf16 a[160:163], v[180:183], v[52:55], a[160:163]
  v_mfma_f32_16x16x32_bf16 a[192:195], v[184:187], v[52:55], a[192:195]
  v_mfma_f32_16x16x32_bf16 a[224:227], v[188:191], v[52:55], a[224:227]
  v_mfma_f32_16x16x32_bf16 a[4:7], v[160:163], v[56:59], a[4:7]
  ds_read_b64_tr_b16 v[76:77], v22 offset:16384
  v_mfma_f32_16x16x32_bf16 a[36:39], v[164:167], v[56:59], a[36:39]
  ds_read_b64_tr_b16 v[78:79], v22 offset:17408
  v_mfma_f32_16x16x32_bf16 a[68:71], v[168:171], v[56:59], a[68:71]
  v_mfma_f32_16x16x32_bf16 a[100:103], v[172:175], v[56:59], a[100:103]
  v_mfma_f32_16x16x32_bf16 a[132:135], v[176:179], v[56:59], a[132:135]
  v_mfma_f32_16x16x32_bf16 a[164:167], v[180:183], v[56:59], a[164:167]
  v_mfma_f32_16x16x32_bf16 a[196:199], v[184:187], v[56:59], a[196:199]
  v_mfma_f32_16x16x32_bf16 a[228:231], v[188:191], v[56:59], a[228:231]
  v_mfma_f32_16x16x32_bf16 a[8:11], v[160:163], v[60:63], a[8:11]
  ds_read_b64_tr_b16 v[80:81], v23 offset:16384
  v_mfma_f32_16x16x32_bf16 a[40:43], v[164:167], v[60:63], a[40:43]
  ds_read_b64_tr_b16 v[82:83], v23 offset:17408
  v_mfma_f32_16x16x32_bf16 a[72:75], v[168:171], v[60:63], a[72:75]
  v_mfma_f32_16x16x32_bf16 a[104:107], v[172:175], v[60:63], a[104:107]
  v_mfma_f32_16x16x32_bf16 a[136:139], v[176:179], v[60:63], a[136:139]
  v_mfma_f32_16x16x32_bf16 a[168:171], v[180:183], v[60:63], a[168:171]
  v_mfma_f32_16x16x32_bf16 a[200:203], v[184:187], v[60:63], a[200:203]
  v_mfma_f32_16x16x32_bf16 a[232:235], v[188:191], v[60:63], a[232:235]
  s_waitcnt lgkmcnt(8)
  v_mfma_f32_16x16x32_bf16 a[12:15], v[160:163], v[64:67], a[12:15]
  s_waitcnt vmcnt(11)
  s_barrier
  ds_read_b64_tr_b16 v[52:53], v16 offset:32768
  v_mfma_f32_16x16x32_bf16 a[44:47], v[164:167], v[64:67], a[44:47]
  ds_read_b64_tr_b16 v[54:55], v16 offset:33792
  v_mfma_f32_16x16x32_bf16 a[76:79], v[168:171], v[64:67], a[76:79]
  ds_read_b128 v[128:131], v40 offset:32768
  v_mfma_f32_16x16x32_bf16 a[108:111], v[172:175], v[64:67], a[108:111]
  s_add_u32 m0, s50, 0
  s_xor_b32 s36, s49, 2
  s_lshl_b32 s36, s36, 19
  v_mfma_f32_16x16x32_bf16 a[140:143], v[176:179], v[64:67], a[140:143]
  ds_read_b128 v[132:135], v40 offset:34816
  v_mfma_f32_16x16x32_bf16 a[172:175], v[180:183], v[64:67], a[172:175]
  v_mfma_f32_16x16x32_bf16 a[204:207], v[184:187], v[64:67], a[204:207]
  ds_read_b128 v[136:139], v40 offset:36864
  v_mfma_f32_16x16x32_bf16 a[236:239], v[188:191], v[64:67], a[236:239]
  buffer_load_dwordx4 v46, s[16:19], s36 offen offset:0 lds
  s_waitcnt lgkmcnt(11)
  v_mfma_f32_16x16x32_bf16 a[16:19], v[160:163], v[68:71], a[16:19]
  ds_read_b64_tr_b16 v[56:57], v17 offset:32768
  v_mfma_f32_16x16x32_bf16 a[48:51], v[164:167], v[68:71], a[48:51]
  ds_read_b64_tr_b16 v[58:59], v17 offset:33792
  v_mfma_f32_16x16x32_bf16 a[80:83], v[168:171], v[68:71], a[80:83]
  ds_read_b128 v[140:143], v40 offset:38912
  v_mfma_f32_16x16x32_bf16 a[112:115], v[172:175], v[68:71], a[112:115]
  buffer_load_dwordx4 v47, s[16:19], s36 offen offset:1024 lds
  v_mfma_f32_16x16x32_bf16 a[144:147], v[176:179], v[68:71], a[144:147]
  ds_read_b128 v[144:147], v40 offset:40960
  v_mfma_f32_16x16x32_bf16 a[176:179], v[180:183], v[68:71], a[176:179]
  v_mfma_f32_16x16x32_bf16 a[208:211], v[184:187], v[68:71], a[208:211]
  ds_read_b128 v[148:151], v40 offset:43008
  v_mfma_f32_16x16x32_bf16 a[240:243], v[188:191], v[68:71], a[240:243]
  s_add_u32 m0, s50, 8192
  s_nop 0
  s_waitcnt lgkmcnt(14)
  v_mfma_f32_16x16x32_bf16 a[20:23], v[160:163], v[72:75], a[20:23]
  ds_read_b64_tr_b16 v[60:61], v18 offset:32768
  v_mfma_f32_16x16x32_bf16 a[52:55], v[164:167], v[72:75], a[52:55]
  ds_read_b64_tr_b16 v[62:63], v18 offset:33792
  v_mfma_f32_16x16x32_bf16 a[84:87], v[168:171], v[72:75], a[84:87]
  ds_read_b128 v[152:155], v40 offset:45056
  v_mfma_f32_16x16x32_bf16 a[116:119], v[172:175], v[72:75], a[116:119]
  buffer_load_dwordx4 v46, s[20:23], s36 offen offset:0 lds
  v_mfma_f32_16x16x32_bf16 a[148:151], v[176:179], v[72:75], a[148:151]
  ds_read_b128 v[156:159], v40 offset:47104
  v_mfma_f32_16x16x32_bf16 a[180:183], v[180:183], v[72:75], a[180:183]
  v_mfma_f32_16x16x32_bf16 a[212:215], v[184:187], v[72:75], a[212:215]
  v_mfma_f32_16x16x32_bf16 a[244:247], v[188:191], v[72:75], a[244:247]
  buffer_load_dwordx4 v47, s[20:23], s36 offen offset:1024 lds
  s_waitcnt lgkmcnt(15)
  v_mfma_f32_16x16x32_bf16 a[24:27], v[160:163], v[76:79], a[24:27]
  ds_read_b64_tr_b16 v[64:65], v19 offset:32768
  v_mfma_f32_16x16x32_bf16 a[56:59], v[164:167], v[76:79], a[56:59]
  ds_read_b64_tr_b16 v[66:67], v19 offset:33792
  v_mfma_f32_16x16x32_bf16 a[88:91], v[168:171], v[76:79], a[88:91]
  v_mfma_f32_16x16x32_bf16 a[120:123], v[172:175], v[76:79], a[120:123]
  s_add_u32 m0, s44, 135168
  s_xor_b32 s36, s49, 2
  s_lshl_b32 s36, s36, 7
  s_add_u32 s36, s36, 32768
  v_mfma_f32_16x16x32_bf16 a[152:155], v[176:179], v[76:79], a[152:155]
  v_mfma_f32_16x16x32_bf16 a[184:187], v[180:183], v[76:79], a[184:187]
  v_mfma_f32_16x16x32_bf16 a[216:219], v[184:187], v[76:79], a[216:219]
  v_mfma_f32_16x16x32_bf16 a[248:251], v[188:191], v[76:79], a[248:251]
  buffer_load_dwordx4 v32, s[12:15], s36 offen offset:0 lds
  s_waitcnt lgkmcnt(15)
  v_mfma_f32_16x16x32_bf16 a[28:31], v[160:163], v[80:83], a[28:31]
  ds_read_b64_tr_b16 v[68:69], v20 offset:32768
  v_mfma_f32_16x16x32_bf16 a[60:63], v[164:167], v[80:83], a[60:63]
  ds_read_b64_tr_b16 v[70:71], v20 offset:33792
  v_mfma_f32_16x16x32_bf16 a[92:95], v[168:171], v[80:83], a[92:95]
  v_mfma_f32_16x16x32_bf16 a[124:127], v[172:175], v[80:83], a[124:127]
  buffer_load_dwordx4 v33, s[12:15], s36 offen offset:1024 lds
  v_mfma_f32_16x16x32_bf16 a[156:159], v[176:179], v[80:83], a[156:159]
  v_mfma_f32_16x16x32_bf16 a[188:191], v[180:183], v[80:83], a[188:191]
  v_mfma_f32_16x16x32_bf16 a[220:223], v[184:187], v[80:83], a[220:223]
  v_mfma_f32_16x16x32_bf16 a[252:255], v[188:191], v[80:83], a[252:255]
  buffer_load_dwordx4 v34, s[12:15], s36 offen offset:2048 lds
  s_waitcnt lgkmcnt(4)
  v_mfma_f32_16x16x32_bf16 a[0:3], v[128:131], v[52:55], a[0:3]
  ds_read_b64_tr_b16 v[72:73], v21 offset:32768
  v_mfma_f32_16x16x32_bf16 a[32:35], v[132:135], v[52:55], a[32:35]
  ds_read_b64_tr_b16 v[74:75], v21 offset:33792
  v_mfma_f32_16x16x32_bf16 a[64:67], v[136:139], v[52:55], a[64:67]
  v_mfma_f32_16x16x32_bf16 a[96:99], v[140:143], v[52:55], a[96:99]
  buffer_load_dwordx4 v35, s[12:15], s36 offen offset:3072 lds
  v_mfma_f32_16x16x32_bf16 a[128:131], v[144:147], v[52:55], a[128:131]
  v_mfma_f32_16x16x32_bf16 a[160:163], v[148:151], v[52:55], a[160:163]
  v_mfma_f32_16x16x32_bf16 a[192:195], v[152:155], v[52:55], a[192:195]
  v_mfma_f32_16x16x32_bf16 a[224:227], v[156:159], v[52:55], a[224:227]
  v_mov_b32 v237, 1
  s_cmp_lg_u32 s32, 0
  s_cbranch_scc1 k1_kernel_noz6
  s_mov_b64 exec, 1
  buffer_store_byte v237, v233, s[4:7], s2 offen sc1
  s_mov_b64 exec, -1
k1_kernel_noz6:
  v_mfma_f32_16x16x32_bf16 a[4:7], v[128:131], v[56:59], a[4:7]
  ds_read_b64_tr_b16 v[76:77], v22 offset:32768
  v_mfma_f32_16x16x32_bf16 a[36:39], v[132:135], v[56:59], a[36:39]
  ds_read_b64_tr_b16 v[78:79], v22 offset:33792
  v_mfma_f32_16x16x32_bf16 a[68:71], v[136:139], v[56:59], a[68:71]
  v_mfma_f32_16x16x32_bf16 a[100:103], v[140:143], v[56:59], a[100:103]
  v_mfma_f32_16x16x32_bf16 a[132:135], v[144:147], v[56:59], a[132:135]
  v_mfma_f32_16x16x32_bf16 a[164:167], v[148:151], v[56:59], a[164:167]
  v_mfma_f32_16x16x32_bf16 a[196:199], v[152:155], v[56:59], a[196:199]
  v_mfma_f32_16x16x32_bf16 a[228:231], v[156:159], v[56:59], a[228:231]
  v_mfma_f32_16x16x32_bf16 a[8:11], v[128:131], v[60:63], a[8:11]
  ds_read_b64_tr_b16 v[80:81], v23 offset:32768
  v_mfma_f32_16x16x32_bf16 a[40:43], v[132:135], v[60:63], a[40:43]
  ds_read_b64_tr_b16 v[82:83], v23 offset:33792
  v_mfma_f32_16x16x32_bf16 a[72:75], v[136:139], v[60:63], a[72:75]
  v_mfma_f32_16x16x32_bf16 a[104:107], v[140:143], v[60:63], a[104:107]
  v_mfma_f32_16x16x32_bf16 a[136:139], v[144:147], v[60:63], a[136:139]
  v_mfma_f32_16x16x32_bf16 a[168:171], v[148:151], v[60:63], a[168:171]
  v_mfma_f32_16x16x32_bf16 a[200:203], v[152:155], v[60:63], a[200:203]
  v_mfma_f32_16x16x32_bf16 a[232:235], v[156:159], v[60:63], a[232:235]
  s_waitcnt lgkmcnt(8)
  v_mfma_f32_16x16x32_bf16 a[12:15], v[128:131], v[64:67], a[12:15]
  s_waitcnt vmcnt(12)
  s_barrier
  ds_read_b64_tr_b16 v[52:53], v16 offset:49152
  v_mfma_f32_16x16x32_bf16 a[44:47], v[132:135], v[64:67], a[44:47]
  ds_read_b64_tr_b16 v[54:55], v16 offset:50176
  v_mfma_f32_16x16x32_bf16 a[76:79], v[136:139], v[64:67], a[76:79]
  ds_read_b128 v[160:163], v41 offset:32768
  v_mfma_f32_16x16x32_bf16 a[108:111], v[140:143], v[64:67], a[108:111]
  s_add_u32 m0, s50, 16384
  s_xor_b32 s36, s49, 2
  s_lshl_b32 s36, s36, 19
  s_add_u32 s36, s36, 262144
  v_mfma_f32_16x16x32_bf16 a[140:143], v[144:147], v[64:67], a[140:143]
  ds_read_b128 v[164:167], v41 offset:34816
  v_mfma_f32_16x16x32_bf16 a[172:175], v[148:151], v[64:67], a[172:175]
  v_mfma_f32_16x16x32_bf16 a[204:207], v[152:155], v[64:67], a[204:207]
  ds_read_b128 v[168:171], v41 offset:36864
  v_mfma_f32_16x16x32_bf16 a[236:239], v[156:159], v[64:67], a[236:239]
  buffer_load_dwordx4 v46, s[16:19], s36 offen offset:0 lds
  s_waitcnt lgkmcnt(11)
  v_mfma_f32_16x16x32_bf16 a[16:19], v[128:131], v[68:71], a[16:19]
  ds_read_b64_tr_b16 v[56:57], v17 offset:49152
  v_mfma_f32_16x16x32_bf16 a[48:51], v[132:135], v[68:71], a[48:51]
  ds_read_b64_tr_b16 v[58:59], v17 offset:50176
  v_mfma_f32_16x16x32_bf16 a[80:83], v[136:139], v[68:71], a[80:83]
  ds_read_b128 v[172:175], v41 offset:38912
  v_mfma_f32_16x16x32_bf16 a[112:115], v[140:143], v[68:71], a[112:115]
  buffer_load_dwordx4 v47, s[16:19], s36 offen offset:1024 lds
  v_mfma_f32_16x16x32_bf16 a[144:147], v[144:147], v[68:71], a[144:147]
  ds_read_b128 v[176:179], v41 offset:40960
  v_mfma_f32_16x16x32_bf16 a[176:179], v[148:151], v[68:71], a[176:179]
  v_mfma_f32_16x16x32_bf16 a[208:211], v[152:155], v[68:71], a[208:211]
  ds_read_b128 v[180:183], v41 offset:43008
  v_mfma_f32_16x16x32_bf16 a[240:243], v[156:159], v[68:71], a[240:243]
  s_add_u32 m0, s50, 24576
  s_nop 0
  s_waitcnt lgkmcnt(14)
  v_mfma_f32_16x16x32_bf16 a[20:23], v[128:131], v[72:75], a[20:23]
  ds_read_b64_tr_b16 v[60:61], v18 offset:49152
  v_mfma_f32_16x16x32_bf16 a[52:55], v[132:135], v[72:75], a[52:55]
  ds_read_b64_tr_b16 v[62:63], v18 offset:50176
  v_mfma_f32_16x16x32_bf16 a[84:87], v[136:139], v[72:75], a[84:87]
  ds_read_b128 v[184:187], v41 offset:45056
  v_mfma_f32_16x16x32_bf16 a[116:119], v[140:143], v[72:75], a[116:119]
  buffer_load_dwordx4 v46, s[20:23], s36 offen offset:0 lds
  v_mfma_f32_16x16x32_bf16 a[148:151], v[144:147], v[72:75], a[148:151]
  ds_read_b128 v[188:191], v41 offset:47104
  v_mfma_f32_16x16x32_bf16 a[180:183], v[148:151], v[72:75], a[180:183]
  v_mfma_f32_16x16x32_bf16 a[212:215], v[152:155], v[72:75], a[212:215]
  v_mfma_f32_16x16x32_bf16 a[244:247], v[156:159], v[72:75], a[244:247]
  buffer_load_dwordx4 v47, s[20:23], s36 offen offset:1024 lds
  s_waitcnt lgkmcnt(15)
  v_mfma_f32_16x16x32_bf16 a[24:27], v[128:131], v[76:79], a[24:27]
  ds_read_b64_tr_b16 v[64:65], v19 offset:49152
  v_mfma_f32_16x16x32_bf16 a[56:59], v[132:135], v[76:79], a[56:59]
  ds_read_b64_tr_b16 v[66:67], v19 offset:50176
  v_mfma_f32_16x16x32_bf16 a[88:91], v[136:139], v[76:79], a[88:91]
  v_mfma_f32_16x16x32_bf16 a[120:123], v[140:143], v[76:79], a[120:123]
  s_add_u32 m0, s44, 65536
  s_xor_b32 s36, s49, 3
  s_lshl_b32 s36, s36, 7
  v_mfma_f32_16x16x32_bf16 a[152:155], v[144:147], v[76:79], a[152:155]
  v_mfma_f32_16x16x32_bf16 a[184:187], v[148:151], v[76:79], a[184:187]
  v_mfma_f32_16x16x32_bf16 a[216:219], v[152:155], v[76:79], a[216:219]
  v_mfma_f32_16x16x32_bf16 a[248:251], v[156:159], v[76:79], a[248:251]
  buffer_load_dwordx4 v32, s[12:15], s36 offen offset:0 lds
  s_waitcnt lgkmcnt(15)
  v_mfma_f32_16x16x32_bf16 a[28:31], v[128:131], v[80:83], a[28:31]
  ds_read_b64_tr_b16 v[68:69], v20 offset:49152
  v_mfma_f32_16x16x32_bf16 a[60:63], v[132:135], v[80:83], a[60:63]
  ds_read_b64_tr_b16 v[70:71], v20 offset:50176
  v_mfma_f32_16x16x32_bf16 a[92:95], v[136:139], v[80:83], a[92:95]
  v_mfma_f32_16x16x32_bf16 a[124:127], v[140:143], v[80:83], a[124:127]
  buffer_load_dwordx4 v33, s[12:15], s36 offen offset:1024 lds
  v_mfma_f32_16x16x32_bf16 a[156:159], v[144:147], v[80:83], a[156:159]
  v_mfma_f32_16x16x32_bf16 a[188:191], v[148:151], v[80:83], a[188:191]
  v_mfma_f32_16x16x32_bf16 a[220:223], v[152:155], v[80:83], a[220:223]
  v_mfma_f32_16x16x32_bf16 a[252:255], v[156:159], v[80:83], a[252:255]
  buffer_load_dwordx4 v34, s[12:15], s36 offen offset:2048 lds
  s_waitcnt lgkmcnt(4)
  v_mfma_f32_16x16x32_bf16 a[0:3], v[160:163], v[52:55], a[0:3]
  ds_read_b64_tr_b16 v[72:73], v21 offset:49152
  v_mfma_f32_16x16x32_bf16 a[32:35], v[164:167], v[52:55], a[32:35]
  ds_read_b64_tr_b16 v[74:75], v21 offset:50176
  v_mfma_f32_16x16x32_bf16 a[64:67], v[168:171], v[52:55], a[64:67]
  v_mfma_f32_16x16x32_bf16 a[96:99], v[172:175], v[52:55], a[96:99]
  buffer_load_dwordx4 v35, s[12:15], s36 offen offset:3072 lds
  v_mfma_f32_16x16x32_bf16 a[128:131], v[176:179], v[52:55], a[128:131]
  v_mfma_f32_16x16x32_bf16 a[160:163], v[180:183], v[52:55], a[160:163]
  v_mfma_f32_16x16x32_bf16 a[192:195], v[184:187], v[52:55], a[192:195]
  v_mfma_f32_16x16x32_bf16 a[224:227], v[188:191], v[52:55], a[224:227]
  v_mov_b32 v236, 0
  v_mov_b32 v237, 1
  s_cmp_lg_u32 s32, 0
  s_cbranch_scc1 k1_kernel_skip17
  s_mov_b64 exec, 1
  buffer_store_dword v237, v236, s[8:11], s53 offen sc1
  s_mov_b64 exec, -1
k1_kernel_skip17:
  v_mfma_f32_16x16x32_bf16 a[4:7], v[160:163], v[56:59], a[4:7]
  ds_read_b64_tr_b16 v[76:77], v22 offset:49152
  v_mfma_f32_16x16x32_bf16 a[36:39], v[164:167], v[56:59], a[36:39]
  ds_read_b64_tr_b16 v[78:79], v22 offset:50176
  v_mfma_f32_16x16x32_bf16 a[68:71], v[168:171], v[56:59], a[68:71]
  v_mfma_f32_16x16x32_bf16 a[100:103], v[172:175], v[56:59], a[100:103]
  v_mfma_f32_16x16x32_bf16 a[132:135], v[176:179], v[56:59], a[132:135]
  v_mfma_f32_16x16x32_bf16 a[164:167], v[180:183], v[56:59], a[164:167]
  v_mfma_f32_16x16x32_bf16 a[196:199], v[184:187], v[56:59], a[196:199]
  v_mfma_f32_16x16x32_bf16 a[228:231], v[188:191], v[56:59], a[228:231]
  v_mfma_f32_16x16x32_bf16 a[8:11], v[160:163], v[60:63], a[8:11]
  ds_read_b64_tr_b16 v[80:81], v23 offset:49152
  v_mfma_f32_16x16x32_bf16 a[40:43], v[164:167], v[60:63], a[40:43]
  ds_read_b64_tr_b16 v[82:83], v23 offset:50176
  v_mfma_f32_16x16x32_bf16 a[72:75], v[168:171], v[60:63], a[72:75]
  v_mfma_f32_16x16x32_bf16 a[104:107], v[172:175], v[60:63], a[104:107]
  v_mfma_f32_16x16x32_bf16 a[136:139], v[176:179], v[60:63], a[136:139]
  v_mfma_f32_16x16x32_bf16 a[168:171], v[180:183], v[60:63], a[168:171]
  v_mfma_f32_16x16x32_bf16 a[200:203], v[184:187], v[60:63], a[200:203]
  v_mfma_f32_16x16x32_bf16 a[232:235], v[188:191], v[60:63], a[232:235]
  s_waitcnt lgkmcnt(8)
  v_mfma_f32_16x16x32_bf16 a[12:15], v[160:163], v[64:67], a[12:15]
  s_waitcnt vmcnt(8)
  s_barrier
  ds_read_b64_tr_b16 v[52:53], v16 offset:0
  v_mfma_f32_16x16x32_bf16 a[44:47], v[164:167], v[64:67], a[44:47]
  ds_read_b64_tr_b16 v[54:55], v16 offset:1024
  v_mfma_f32_16x16x32_bf16 a[76:79], v[168:171], v[64:67], a[76:79]
  ds_read_b128 v[128:131], v42 offset:0
  v_mfma_f32_16x16x32_bf16 a[108:111], v[172:175], v[64:67], a[108:111]
  s_add_u32 m0, s50, 32768
  s_xor_b32 s36, s49, 3
  s_lshl_b32 s36, s36, 19
  v_mfma_f32_16x16x32_bf16 a[140:143], v[176:179], v[64:67], a[140:143]
  ds_read_b128 v[132:135], v42 offset:2048
  v_mfma_f32_16x16x32_bf16 a[172:175], v[180:183], v[64:67], a[172:175]
  v_mfma_f32_16x16x32_bf16 a[204:207], v[184:187], v[64:67], a[204:207]
  ds_read_b128 v[136:139], v42 offset:4096
  v_mfma_f32_16x16x32_bf16 a[236:239], v[188:191], v[64:67], a[236:239]
  buffer_load_dwordx4 v46, s[16:19], s36 offen offset:0 lds
  s_waitcnt lgkmcnt(11)
  v_mfma_f32_16x16x32_bf16 a[16:19], v[160:163], v[68:71], a[16:19]
  ds_read_b64_tr_b16 v[56:57], v17 offset:0
  v_mfma_f32_16x16x32_bf16 a[48:51], v[164:167], v[68:71], a[48:51]
  ds_read_b64_tr_b16 v[58:59], v17 offset:1024
  v_mfma_f32_16x16x32_bf16 a[80:83], v[168:171], v[68:71], a[80:83]
  ds_read_b128 v[140:143], v42 offset:6144
  v_mfma_f32_16x16x32_bf16 a[112:115], v[172:175], v[68:71], a[112:115]
  buffer_load_dwordx4 v47, s[16:19], s36 offen offset:1024 lds
  v_mfma_f32_16x16x32_bf16 a[144:147], v[176:179], v[68:71], a[144:147]
  ds_read_b128 v[144:147], v42 offset:8192
  v_mfma_f32_16x16x32_bf16 a[176:179], v[180:183], v[68:71], a[176:179]
  v_mfma_f32_16x16x32_bf16 a[208:211], v[184:187], v[68:71], a[208:211]
  ds_read_b128 v[148:151], v42 offset:10240
  v_mfma_f32_16x16x32_bf16 a[240:243], v[188:191], v[68:71], a[240:243]
  s_add_u32 m0, s50, 40960
  s_nop 0
  s_waitcnt lgkmcnt(14)
  v_mfma_f32_16x16x32_bf16 a[20:23], v[160:163], v[72:75], a[20:23]
  ds_read_b64_tr_b16 v[60:61], v18 offset:0
  v_mfma_f32_16x16x32_bf16 a[52:55], v[164:167], v[72:75], a[52:55]
  ds_read_b64_tr_b16 v[62:63], v18 offset:1024
  v_mfma_f32_16x16x32_bf16 a[84:87], v[168:171], v[72:75], a[84:87]
  ds_read_b128 v[152:155], v42 offset:12288
  v_mfma_f32_16x16x32_bf16 a[116:119], v[172:175], v[72:75], a[116:119]
  buffer_load_dwordx4 v46, s[20:23], s36 offen offset:0 lds
  v_mfma_f32_16x16x32_bf16 a[148:151], v[176:179], v[72:75], a[148:151]
  ds_read_b128 v[156:159], v42 offset:14336
  v_mfma_f32_16x16x32_bf16 a[180:183], v[180:183], v[72:75], a[180:183]
  v_mfma_f32_16x16x32_bf16 a[212:215], v[184:187], v[72:75], a[212:215]
  v_mfma_f32_16x16x32_bf16 a[244:247], v[188:191], v[72:75], a[244:247]
  buffer_load_dwordx4 v47, s[20:23], s36 offen offset:1024 lds
  s_waitcnt lgkmcnt(15)
  v_mfma_f32_16x16x32_bf16 a[24:27], v[160:163], v[76:79], a[24:27]
  ds_read_b64_tr_b16 v[64:65], v19 offset:0
  v_mfma_f32_16x16x32_bf16 a[56:59], v[164:167], v[76:79], a[56:59]
  ds_read_b64_tr_b16 v[66:67], v19 offset:1024
  v_mfma_f32_16x16x32_bf16 a[88:91], v[168:171], v[76:79], a[88:91]
  v_mfma_f32_16x16x32_bf16 a[120:123], v[172:175], v[76:79], a[120:123]
  s_add_u32 m0, s44, 69632
  s_xor_b32 s36, s49, 3
  s_lshl_b32 s36, s36, 7
  s_add_u32 s36, s36, 32768
  v_mfma_f32_16x16x32_bf16 a[152:155], v[176:179], v[76:79], a[152:155]
  v_mfma_f32_16x16x32_bf16 a[184:187], v[180:183], v[76:79], a[184:187]
  v_mfma_f32_16x16x32_bf16 a[216:219], v[184:187], v[76:79], a[216:219]
  v_mfma_f32_16x16x32_bf16 a[248:251], v[188:191], v[76:79], a[248:251]
  buffer_load_dwordx4 v32, s[12:15], s36 offen offset:0 lds
  s_waitcnt lgkmcnt(15)
  v_mfma_f32_16x16x32_bf16 a[28:31], v[160:163], v[80:83], a[28:31]
  ds_read_b64_tr_b16 v[68:69], v20 offset:0
  v_mfma_f32_16x16x32_bf16 a[60:63], v[164:167], v[80:83], a[60:63]
  ds_read_b64_tr_b16 v[70:71], v20 offset:1024
  v_mfma_f32_16x16x32_bf16 a[92:95], v[168:171], v[80:83], a[92:95]
  v_mfma_f32_16x16x32_bf16 a[124:127], v[172:175], v[80:83], a[124:127]
  buffer_load_dwordx4 v33, s[12:15], s36 offen offset:1024 lds
  v_mfma_f32_16x16x32_bf16 a[156:159], v[176:179], v[80:83], a[156:159]
  v_mfma_f32_16x16x32_bf16 a[188:191], v[180:183], v[80:83], a[188:191]
  v_mfma_f32_16x16x32_bf16 a[220:223], v[184:187], v[80:83], a[220:223]
  v_mfma_f32_16x16x32_bf16 a[252:255], v[188:191], v[80:83], a[252:255]
  buffer_load_dwordx4 v34, s[12:15], s36 offen offset:2048 lds
  s_waitcnt lgkmcnt(4)
  v_mfma_f32_16x16x32_bf16 a[0:3], v[128:131], v[52:55], a[0:3]
  ds_read_b64_tr_b16 v[72:73], v21 offset:0
  v_mfma_f32_16x16x32_bf16 a[32:35], v[132:135], v[52:55], a[32:35]
  ds_read_b64_tr_b16 v[74:75], v21 offset:1024
  v_mfma_f32_16x16x32_bf16 a[64:67], v[136:139], v[52:55], a[64:67]
  v_mfma_f32_16x16x32_bf16 a[96:99], v[140:143], v[52:55], a[96:99]
  buffer_load_dwordx4 v35, s[12:15], s36 offen offset:3072 lds
  v_mfma_f32_16x16x32_bf16 a[128:131], v[144:147], v[52:55], a[128:131]
  v_mfma_f32_16x16x32_bf16 a[160:163], v[148:151], v[52:55], a[160:163]
  v_mfma_f32_16x16x32_bf16 a[192:195], v[152:155], v[52:55], a[192:195]
  v_mfma_f32_16x16x32_bf16 a[224:227], v[156:159], v[52:55], a[224:227]
  v_mfma_f32_16x16x32_bf16 a[4:7], v[128:131], v[56:59], a[4:7]
  ds_read_b64_tr_b16 v[76:77], v22 offset:0
  v_mfma_f32_16x16x32_bf16 a[36:39], v[132:135], v[56:59], a[36:39]
  ds_read_b64_tr_b16 v[78:79], v22 offset:1024
  v_mfma_f32_16x16x32_bf16 a[68:71], v[136:139], v[56:59], a[68:71]
  v_mfma_f32_16x16x32_bf16 a[100:103], v[140:143], v[56:59], a[100:103]
  v_mfma_f32_16x16x32_bf16 a[132:135], v[144:147], v[56:59], a[132:135]
  v_mfma_f32_16x16x32_bf16 a[164:167], v[148:151], v[56:59], a[164:167]
  v_mfma_f32_16x16x32_bf16 a[196:199], v[152:155], v[56:59], a[196:199]
  v_mfma_f32_16x16x32_bf16 a[228:231], v[156:159], v[56:59], a[228:231]
  v_mfma_f32_16x16x32_bf16 a[8:11], v[128:131], v[60:63], a[8:11]
  ds_read_b64_tr_b16 v[80:81], v23 offset:0
  v_mfma_f32_16x16x32_bf16 a[40:43], v[132:135], v[60:63], a[40:43]
  ds_read_b64_tr_b16 v[82:83], v23 offset:1024
  v_mfma_f32_16x16x32_bf16 a[72:75], v[136:139], v[60:63], a[72:75]
  v_mfma_f32_16x16x32_bf16 a[104:107], v[140:143], v[60:63], a[104:107]
  v_mfma_f32_16x16x32_bf16 a[136:139], v[144:147], v[60:63], a[136:139]
  v_mfma_f32_16x16x32_bf16 a[168:171], v[148:151], v[60:63], a[168:171]
  v_mfma_f32_16x16x32_bf16 a[200:203], v[152:155], v[60:63], a[200:203]
  v_mfma_f32_16x16x32_bf16 a[232:235], v[156:159], v[60:63], a[232:235]
  s_waitcnt lgkmcnt(8)
  v_mfma_f32_16x16x32_bf16 a[12:15], v[128:131], v[64:67], a[12:15]
  s_waitcnt vmcnt(12)
  s_barrier
  ds_read_b64_tr_b16 v[52:53], v16 offset:16384
  v_mfma_f32_16x16x32_bf16 a[44:47], v[132:135], v[64:67], a[44:47]
  ds_read_b64_tr_b16 v[54:55], v16 offset:17408
  v_mfma_f32_16x16x32_bf16 a[76:79], v[136:139], v[64:67], a[76:79]
  ds_read_b128 v[160:163], v43 offset:0
  v_mfma_f32_16x16x32_bf16 a[108:111], v[140:143], v[64:67], a[108:111]
  s_add_u32 m0, s50, 49152
  s_xor_b32 s36, s49, 3
  s_lshl_b32 s36, s36, 19
  s_add_u32 s36, s36, 262144
  v_mfma_f32_16x16x32_bf16 a[140:143], v[144:147], v[64:67], a[140:143]
  ds_read_b128 v[164:167], v43 offset:2048
  v_mfma_f32_16x16x32_bf16 a[172:175], v[148:151], v[64:67], a[172:175]
  v_mfma_f32_16x16x32_bf16 a[204:207], v[152:155], v[64:67], a[204:207]
  ds_read_b128 v[168:171], v43 offset:4096
  v_mfma_f32_16x16x32_bf16 a[236:239], v[156:159], v[64:67], a[236:239]
  buffer_load_dwordx4 v46, s[16:19], s36 offen offset:0 lds
  s_waitcnt lgkmcnt(11)
  v_mfma_f32_16x16x32_bf16 a[16:19], v[128:131], v[68:71], a[16:19]
  ds_read_b64_tr_b16 v[56:57], v17 offset:16384
  v_mfma_f32_16x16x32_bf16 a[48:51], v[132:135], v[68:71], a[48:51]
  ds_read_b64_tr_b16 v[58:59], v17 offset:17408
  v_mfma_f32_16x16x32_bf16 a[80:83], v[136:139], v[68:71], a[80:83]
  ds_read_b128 v[172:175], v43 offset:6144
  v_mfma_f32_16x16x32_bf16 a[112:115], v[140:143], v[68:71], a[112:115]
  buffer_load_dwordx4 v47, s[16:19], s36 offen offset:1024 lds
  v_mfma_f32_16x16x32_bf16 a[144:147], v[144:147], v[68:71], a[144:147]
  ds_read_b128 v[176:179], v43 offset:8192
  v_mfma_f32_16x16x32_bf16 a[176:179], v[148:151], v[68:71], a[176:179]
  v_mfma_f32_16x16x32_bf16 a[208:211], v[152:155], v[68:71], a[208:211]
  ds_read_b128 v[180:183], v43 offset:10240
  v_mfma_f32_16x16x32_bf16 a[240:243], v[156:159], v[68:71], a[240:243]
  s_add_u32 m0, s50, 57344
  s_nop 0
  s_waitcnt lgkmcnt(14)
  v_mfma_f32_16x16x32_bf16 a[20:23], v[128:131], v[72:75], a[20:23]
  ds_read_b64_tr_b16 v[60:61], v18 offset:16384
  v_mfma_f32_16x16x32_bf16 a[52:55], v[132:135], v[72:75], a[52:55]
  ds_read_b64_tr_b16 v[62:63], v18 offset:17408
  v_mfma_f32_16x16x32_bf16 a[84:87], v[136:139], v[72:75], a[84:87]
  ds_read_b128 v[184:187], v43 offset:12288
  v_mfma_f32_16x16x32_bf16 a[116:119], v[140:143], v[72:75], a[116:119]
  buffer_load_dwordx4 v46, s[20:23], s36 offen offset:0 lds
  v_mfma_f32_16x16x32_bf16 a[148:151], v[144:147], v[72:75], a[148:151]
  ds_read_b128 v[188:191], v43 offset:14336
  v_mfma_f32_16x16x32_bf16 a[180:183], v[148:151], v[72:75], a[180:183]
  v_mfma_f32_16x16x32_bf16 a[212:215], v[152:155], v[72:75], a[212:215]
  v_mfma_f32_16x16x32_bf16 a[244:247], v[156:159], v[72:75], a[244:247]
  buffer_load_dwordx4 v47, s[20:23], s36 offen offset:1024 lds
  s_waitcnt lgkmcnt(15)
  v_mfma_f32_16x16x32_bf16 a[24:27], v[128:131], v[76:79], a[24:27]
  ds_read_b64_tr_b16 v[64:65], v19 offset:16384
  v_mfma_f32_16x16x32_bf16 a[56:59], v[132:135], v[76:79], a[56:59]
  ds_read_b64_tr_b16 v[66:67], v19 offset:17408
  v_mfma_f32_16x16x32_bf16 a[88:91], v[136:139], v[76:79], a[88:91]
  v_mfma_f32_16x16x32_bf16 a[120:123], v[140:143], v[76:79], a[120:123]
  s_add_u32 m0, s44, 98304
  s_xor_b32 s36, s49, 4
  s_lshl_b32 s36, s36, 7
  v_mfma_f32_16x16x32_bf16 a[152:155], v[144:147], v[76:79], a[152:155]
  v_mfma_f32_16x16x32_bf16 a[184:187], v[148:151], v[76:79], a[184:187]
  v_mfma_f32_16x16x32_bf16 a[216:219], v[152:155], v[76:79], a[216:219]
  v_mfma_f32_16x16x32_bf16 a[248:251], v[156:159], v[76:79], a[248:251]
  buffer_load_dwordx4 v32, s[12:15], s36 offen offset:0 lds
  s_waitcnt lgkmcnt(15)
  v_mfma_f32_16x16x32_bf16 a[28:31], v[128:131], v[80:83], a[28:31]
  ds_read_b64_tr_b16 v[68:69], v20 offset:16384
  v_mfma_f32_16x16x32_bf16 a[60:63], v[132:135], v[80:83], a[60:63]
  ds_read_b64_tr_b16 v[70:71], v20 offset:17408
  v_mfma_f32_16x16x32_bf16 a[92:95], v[136:139], v[80:83], a[92:95]
  v_mfma_f32_16x16x32_bf16 a[124:127], v[140:143], v[80:83], a[124:127]
  buffer_load_dwordx4 v33, s[12:15], s36 offen offset:1024 lds
  v_mfma_f32_16x16x32_bf16 a[156:159], v[144:147], v[80:83], a[156:159]
  v_mfma_f32_16x16x32_bf16 a[188:191], v[148:151], v[80:83], a[188:191]
  v_mfma_f32_16x16x32_bf16 a[220:223], v[152:155], v[80:83], a[220:223]
  v_mfma_f32_16x16x32_bf16 a[252:255], v[156:159], v[80:83], a[252:255]
  buffer_load_dwordx4 v34, s[12:15], s36 offen offset:2048 lds
  s_waitcnt lgkmcnt(4)
  v_mfma_f32_16x16x32_bf16 a[0:3], v[160:163], v[52:55], a[0:3]
  ds_read_b64_tr_b16 v[72:73], v21 offset:16384
  v_mfma_f32_16x16x32_bf16 a[32:35], v[164:167], v[52:55], a[32:35]
  ds_read_b64_tr_b16 v[74:75], v21 offset:17408
  v_mfma_f32_16x16x32_bf16 a[64:67], v[168:171], v[52:55], a[64:67]
  v_mfma_f32_16x16x32_bf16 a[96:99], v[172:175], v[52:55], a[96:99]
  buffer_load_dwordx4 v35, s[12:15], s36 offen offset:3072 lds
  v_mfma_f32_16x16x32_bf16 a[128:131], v[176:179], v[52:55], a[128:131]
  v_mfma_f32_16x16x32_bf16 a[160:163], v[180:183], v[52:55], a[160:163]
  v_mfma_f32_16x16x32_bf16 a[192:195], v[184:187], v[52:55], a[192:195]
  v_mfma_f32_16x16x32_bf16 a[224:227], v[188:191], v[52:55], a[224:227]
  v_mfma_f32_16x16x32_bf16 a[4:7], v[160:163], v[56:59], a[4:7]
  ds_read_b64_tr_b16 v[76:77], v22 offset:16384
  v_mfma_f32_16x16x32_bf16 a[36:39], v[164:167], v[56:59], a[36:39]
  ds_read_b64_tr_b16 v[78:79], v22 offset:17408
  v_mfma_f32_16x16x32_bf16 a[68:71], v[168:171], v[56:59], a[68:71]
  v_mfma_f32_16x16x32_bf16 a[100:103], v[172:175], v[56:59], a[100:103]
  v_mfma_f32_16x16x32_bf16 a[132:135], v[176:179], v[56:59], a[132:135]
  v_mfma_f32_16x16x32_bf16 a[164:167], v[180:183], v[56:59], a[164:167]
  v_mfma_f32_16x16x32_bf16 a[196:199], v[184:187], v[56:59], a[196:199]
  v_mfma_f32_16x16x32_bf16 a[228:231], v[188:191], v[56:59], a[228:231]
  v_mfma_f32_16x16x32_bf16 a[8:11], v[160:163], v[60:63], a[8:11]
  ds_read_b64_tr_b16 v[80:81], v23 offset:16384
  v_mfma_f32_16x16x32_bf16 a[40:43], v[164:167], v[60:63], a[40:43]
  ds_read_b64_tr_b16 v[82:83], v23 offset:17408
  v_mfma_f32_16x16x32_bf16 a[72:75], v[168:171], v[60:63], a[72:75]
  v_mfma_f32_16x16x32_bf16 a[104:107], v[172:175], v[60:63], a[104:107]
  v_mfma_f32_16x16x32_bf16 a[136:139], v[176:179], v[60:63], a[136:139]
  v_mfma_f32_16x16x32_bf16 a[168:171], v[180:183], v[60:63], a[168:171]
  v_mfma_f32_16x16x32_bf16 a[200:203], v[184:187], v[60:63], a[200:203]
  v_mfma_f32_16x16x32_bf16 a[232:235], v[188:191], v[60:63], a[232:235]
  s_waitcnt lgkmcnt(8)
  v_mfma_f32_16x16x32_bf16 a[12:15], v[160:163], v[64:67], a[12:15]
  s_waitcnt vmcnt(8)
  s_barrier
  ds_read_b64_tr_b16 v[52:53], v16 offset:32768
  v_mfma_f32_16x16x32_bf16 a[44:47], v[164:167], v[64:67], a[44:47]
  ds_read_b64_tr_b16 v[54:55], v16 offset:33792
  v_mfma_f32_16x16x32_bf16 a[76:79], v[168:171], v[64:67], a[76:79]
  ds_read_b128 v[128:131], v40 offset:0
  v_mfma_f32_16x16x32_bf16 a[108:111], v[172:175], v[64:67], a[108:111]
  s_add_u32 m0, s50, 0
  s_xor_b32 s36, s49, 4
  s_lshl_b32 s36, s36, 19
  v_mfma_f32_16x16x32_bf16 a[140:143], v[176:179], v[64:67], a[140:143]
  ds_read_b128 v[132:135], v40 offset:2048
  v_mfma_f32_16x16x32_bf16 a[172:175], v[180:183], v[64:67], a[172:175]
  v_mfma_f32_16x16x32_bf16 a[204:207], v[184:187], v[64:67], a[204:207]
  ds_read_b128 v[136:139], v40 offset:4096
  v_mfma_f32_16x16x32_bf16 a[236:239], v[188:191], v[64:67], a[236:239]
  buffer_load_dwordx4 v46, s[16:19], s36 offen offset:0 lds
  s_waitcnt lgkmcnt(11)
  v_mfma_f32_16x16x32_bf16 a[16:19], v[160:163], v[68:71], a[16:19]
  ds_read_b64_tr_b16 v[56:57], v17 offset:32768
  v_mfma_f32_16x16x32_bf16 a[48:51], v[164:167], v[68:71], a[48:51]
  ds_read_b64_tr_b16 v[58:59], v17 offset:33792
  v_mfma_f32_16x16x32_bf16 a[80:83], v[168:171], v[68:71], a[80:83]
  ds_read_b128 v[140:143], v40 offset:6144
  v_mfma_f32_16x16x32_bf16 a[112:115], v[172:175], v[68:71], a[112:115]
  buffer_load_dwordx4 v47, s[16:19], s36 offen offset:1024 lds
  v_mfma_f32_16x16x32_bf16 a[144:147], v[176:179], v[68:71], a[144:147]
  ds_read_b128 v[144:147], v40 offset:8192
  v_mfma_f32_16x16x32_bf16 a[176:179], v[180:183], v[68:71], a[176:179]
  v_mfma_f32_16x16x32_bf16 a[208:211], v[184:187], v[68:71], a[208:211]
  ds_read_b128 v[148:151], v40 offset:10240
  v_mfma_f32_16x16x32_bf16 a[240:243], v[188:191], v[68:71], a[240:243]
  s_add_u32 m0, s50, 8192
  s_nop 0
  s_waitcnt lgkmcnt(14)
  v_mfma_f32_16x16x32_bf16 a[20:23], v[160:163], v[72:75], a[20:23]
  ds_read_b64_tr_b16 v[60:61], v18 offset:32768
  v_mfma_f32_16x16x32_bf16 a[52:55], v[164:167], v[72:75], a[52:55]
  ds_read_b64_tr_b16 v[62:63], v18 offset:33792
  v_mfma_f32_16x16x32_bf16 a[84:87], v[168:171], v[72:75], a[84:87]
  ds_read_b128 v[152:155], v40 offset:12288
  v_mfma_f32_16x16x32_bf16 a[116:119], v[172:175], v[72:75], a[116:119]
  buffer_load_dwordx4 v46, s[20:23], s36 offen offset:0 lds
  v_mfma_f32_16x16x32_bf16 a[148:151], v[176:179], v[72:75], a[148:151]
  ds_read_b128 v[156:159], v40 offset:14336
  v_mfma_f32_16x16x32_bf16 a[180:183], v[180:183], v[72:75], a[180:183]
  v_mfma_f32_16x16x32_bf16 a[212:215], v[184:187], v[72:75], a[212:215]
  v_mfma_f32_16x16x32_bf16 a[244:247], v[188:191], v[72:75], a[244:247]
  buffer_load_dwordx4 v47, s[20:23], s36 offen offset:1024 lds
  s_waitcnt lgkmcnt(15)
  v_mfma_f32_16x16x32_bf16 a[24:27], v[160:163], v[76:79], a[24:27]
  ds_read_b64_tr_b16 v[64:65], v19 offset:32768
  v_mfma_f32_16x16x32_bf16 a[56:59], v[164:167], v[76:79], a[56:59]
  ds_read_b64_tr_b16 v[66:67], v19 offset:33792
  v_mfma_f32_16x16x32_bf16 a[88:91], v[168:171], v[76:79], a[88:91]
  v_mfma_f32_16x16x32_bf16 a[120:123], v[172:175], v[76:79], a[120:123]
  s_add_u32 m0, s44, 102400
  s_xor_b32 s36, s49, 4
  s_lshl_b32 s36, s36, 7
  s_add_u32 s36, s36, 32768
  v_mfma_f32_16x16x32_bf16 a[152:155], v[176:179], v[76:79], a[152:155]
  v_mfma_f32_16x16x32_bf16 a[184:187], v[180:183], v[76:79], a[184:187]
  v_mfma_f32_16x16x32_bf16 a[216:219], v[184:187], v[76:79], a[216:219]
  v_mfma_f32_16x16x32_bf16 a[248:251], v[188:191], v[76:79], a[248:251]
  buffer_load_dwordx4 v32, s[12:15], s36 offen offset:0 lds
  s_waitcnt lgkmcnt(15)
  v_mfma_f32_16x16x32_bf16 a[28:31], v[160:163], v[80:83], a[28:31]
  ds_read_b64_tr_b16 v[68:69], v20 offset:32768
  v_mfma_f32_16x16x32_bf16 a[60:63], v[164:167], v[80:83], a[60:63]
  ds_read_b64_tr_b16 v[70:71], v20 offset:33792
  v_mfma_f32_16x16x32_bf16 a[92:95], v[168:171], v[80:83], a[92:95]
  v_mfma_f32_16x16x32_bf16 a[124:127], v[172:175], v[80:83], a[124:127]
  buffer_load_dwordx4 v33, s[12:15], s36 offen offset:1024 lds
  v_mfma_f32_16x16x32_bf16 a[156:159], v[176:179], v[80:83], a[156:159]
  v_mfma_f32_16x16x32_bf16 a[188:191], v[180:183], v[80:83], a[188:191]
  v_mfma_f32_16x16x32_bf16 a[220:223], v[184:187], v[80:83], a[220:223]
  v_mfma_f32_16x16x32_bf16 a[252:255], v[188:191], v[80:83], a[252:255]
  buffer_load_dwordx4 v34, s[12:15], s36 offen offset:2048 lds
  s_waitcnt lgkmcnt(4)
  v_mfma_f32_16x16x32_bf16 a[0:3], v[128:131], v[52:55], a[0:3]
  ds_read_b64_tr_b16 v[72:73], v21 offset:32768
  v_mfma_f32_16x16x32_bf16 a[32:35], v[132:135], v[52:55], a[32:35]
  ds_read_b64_tr_b16 v[74:75], v21 offset:33792
  v_mfma_f32_16x16x32_bf16 a[64:67], v[136:139], v[52:55], a[64:67]
  v_mfma_f32_16x16x32_bf16 a[96:99], v[140:143], v[52:55], a[96:99]
  buffer_load_dwordx4 v35, s[12:15], s36 offen offset:3072 lds
  v_mfma_f32_16x16x32_bf16 a[128:131], v[144:147], v[52:55], a[128:131]
  v_mfma_f32_16x16x32_bf16 a[160:163], v[148:151], v[52:55], a[160:163]
  v_mfma_f32_16x16x32_bf16 a[192:195], v[152:155], v[52:55], a[192:195]
  v_mfma_f32_16x16x32_bf16 a[224:227], v[156:159], v[52:55], a[224:227]
  v_mfma_f32_16x16x32_bf16 a[4:7], v[128:131], v[56:59], a[4:7]
  ds_read_b64_tr_b16 v[76:77], v22 offset:32768
  v_mfma_f32_16x16x32_bf16 a[36:39], v[132:135], v[56:59], a[36:39]
  ds_read_b64_tr_b16 v[78:79], v22 offset:33792
  v_mfma_f32_16x16x32_bf16 a[68:71], v[136:139], v[56:59], a[68:71]
  v_mfma_f32_16x16x32_bf16 a[100:103], v[140:143], v[56:59], a[100:103]
  v_mfma_f32_16x16x32_bf16 a[132:135], v[144:147], v[56:59], a[132:135]
  v_mfma_f32_16x16x32_bf16 a[164:167], v[148:151], v[56:59], a[164:167]
  v_mfma_f32_16x16x32_bf16 a[196:199], v[152:155], v[56:59], a[196:199]
  v_mfma_f32_16x16x32_bf16 a[228:231], v[156:159], v[56:59], a[228:231]
  v_mfma_f32_16x16x32_bf16 a[8:11], v[128:131], v[60:63], a[8:11]
  ds_read_b64_tr_b16 v[80:81], v23 offset:32768
  v_mfma_f32_16x16x32_bf16 a[40:43], v[132:135], v[60:63], a[40:43]
  ds_read_b64_tr_b16 v[82:83], v23 offset:33792
  v_mfma_f32_16x16x32_bf16 a[72:75], v[136:139], v[60:63], a[72:75]
  v_mfma_f32_16x16x32_bf16 a[104:107], v[140:143], v[60:63], a[104:107]
  v_mfma_f32_16x16x32_bf16 a[136:139], v[144:147], v[60:63], a[136:139]
  v_mfma_f32_16x16x32_bf16 a[168:171], v[148:151], v[60:63], a[168:171]
  v_mfma_f32_16x16x32_bf16 a[200:203], v[152:155], v[60:63], a[200:203]
  v_mfma_f32_16x16x32_bf16 a[232:235], v[156:159], v[60:63], a[232:235]
  s_waitcnt lgkmcnt(8)
  v_mfma_f32_16x16x32_bf16 a[12:15], v[128:131], v[64:67], a[12:15]
  s_waitcnt vmcnt(12)
  s_barrier
  ds_read_b64_tr_b16 v[52:53], v16 offset:49152
  v_mfma_f32_16x16x32_bf16 a[44:47], v[132:135], v[64:67], a[44:47]
  ds_read_b64_tr_b16 v[54:55], v16 offset:50176
  v_mfma_f32_16x16x32_bf16 a[76:79], v[136:139], v[64:67], a[76:79]
  ds_read_b128 v[160:163], v41 offset:0
  v_mfma_f32_16x16x32_bf16 a[108:111], v[140:143], v[64:67], a[108:111]
  s_add_u32 m0, s50, 16384
  s_xor_b32 s36, s49, 4
  s_lshl_b32 s36, s36, 19
  s_add_u32 s36, s36, 262144
  v_mfma_f32_16x16x32_bf16 a[140:143], v[144:147], v[64:67], a[140:143]
  ds_read_b128 v[164:167], v41 offset:2048
  v_mfma_f32_16x16x32_bf16 a[172:175], v[148:151], v[64:67], a[172:175]
  v_mfma_f32_16x16x32_bf16 a[204:207], v[152:155], v[64:67], a[204:207]
  ds_read_b128 v[168:171], v41 offset:4096
  v_mfma_f32_16x16x32_bf16 a[236:239], v[156:159], v[64:67], a[236:239]
  buffer_load_dwordx4 v46, s[16:19], s36 offen offset:0 lds
  s_waitcnt lgkmcnt(11)
  v_mfma_f32_16x16x32_bf16 a[16:19], v[128:131], v[68:71], a[16:19]
  ds_read_b64_tr_b16 v[56:57], v17 offset:49152
  v_mfma_f32_16x16x32_bf16 a[48:51], v[132:135], v[68:71], a[48:51]
  ds_read_b64_tr_b16 v[58:59], v17 offset:50176
  v_mfma_f32_16x16x32_bf16 a[80:83], v[136:139], v[68:71], a[80:83]
  ds_read_b128 v[172:175], v41 offset:6144
  v_mfma_f32_16x16x32_bf16 a[112:115], v[140:143], v[68:71], a[112:115]
  buffer_load_dwordx4 v47, s[16:19], s36 offen offset:1024 lds
  v_mfma_f32_16x16x32_bf16 a[144:147], v[144:147], v[68:71], a[144:147]
  ds_read_b128 v[176:179], v41 offset:8192
  v_mfma_f32_16x16x32_bf16 a[176:179], v[148:151], v[68:71], a[176:179]
  v_mfma_f32_16x16x32_bf16 a[208:211], v[152:155], v[68:71], a[208:211]
  ds_read_b128 v[180:183], v41 offset:10240
  v_mfma_f32_16x16x32_bf16 a[240:243], v[156:159], v[68:71], a[240:243]
  s_add_u32 m0, s50, 24576
  s_nop 0
  s_waitcnt lgkmcnt(14)
  v_mfma_f32_16x16x32_bf16 a[20:23], v[128:131], v[72:75], a[20:23]
  ds_read_b64_tr_b16 v[60:61], v18 offset:49152
  v_mfma_f32_16x16x32_bf16 a[52:55], v[132:135], v[72:75], a[52:55]
  ds_read_b64_tr_b16 v[62:63], v18 offset:50176
  v_mfma_f32_16x16x32_bf16 a[84:87], v[136:139], v[72:75], a[84:87]
  ds_read_b128 v[184:187], v41 offset:12288
  v_mfma_f32_16x16x32_bf16 a[116:119], v[140:143], v[72:75], a[116:119]
  buffer_load_dwordx4 v46, s[20:23], s36 offen offset:0 lds
  v_mfma_f32_16x16x32_bf16 a[148:151], v[144:147], v[72:75], a[148:151]
  ds_read_b128 v[188:191], v41 offset:14336
  v_mfma_f32_16x16x32_bf16 a[180:183], v[148:151], v[72:75], a[180:183]
  v_mfma_f32_16x16x32_bf16 a[212:215], v[152:155], v[72:75], a[212:215]
  v_mfma_f32_16x16x32_bf16 a[244:247], v[156:159], v[72:75], a[244:247]
  buffer_load_dwordx4 v47, s[20:23], s36 offen offset:1024 lds
  s_waitcnt lgkmcnt(15)
  v_mfma_f32_16x16x32_bf16 a[24:27], v[128:131], v[76:79], a[24:27]
  ds_read_b64_tr_b16 v[64:65], v19 offset:49152
  v_mfma_f32_16x16x32_bf16 a[56:59], v[132:135], v[76:79], a[56:59]
  ds_read_b64_tr_b16 v[66:67], v19 offset:50176
  v_mfma_f32_16x16x32_bf16 a[88:91], v[136:139], v[76:79], a[88:91]
  v_mfma_f32_16x16x32_bf16 a[120:123], v[140:143], v[76:79], a[120:123]
  s_add_u32 m0, s44, 131072
  s_xor_b32 s36, s49, 5
  s_lshl_b32 s36, s36, 7
  v_mfma_f32_16x16x32_bf16 a[152:155], v[144:147], v[76:79], a[152:155]
  v_mfma_f32_16x16x32_bf16 a[184:187], v[148:151], v[76:79], a[184:187]
  v_mfma_f32_16x16x32_bf16 a[216:219], v[152:155], v[76:79], a[216:219]
  v_mfma_f32_16x16x32_bf16 a[248:251], v[156:159], v[76:79], a[248:251]
  buffer_load_dwordx4 v32, s[12:15], s36 offen offset:0 lds
  s_waitcnt lgkmcnt(15)
  v_mfma_f32_16x16x32_bf16 a[28:31], v[128:131], v[80:83], a[28:31]
  ds_read_b64_tr_b16 v[68:69], v20 offset:49152
  v_mfma_f32_16x16x32_bf16 a[60:63], v[132:135], v[80:83], a[60:63]
  ds_read_b64_tr_b16 v[70:71], v20 offset:50176
  v_mfma_f32_16x16x32_bf16 a[92:95], v[136:139], v[80:83], a[92:95]
  v_mfma_f32_16x16x32_bf16 a[124:127], v[140:143], v[80:83], a[124:127]
  buffer_load_dwordx4 v33, s[12:15], s36 offen offset:1024 lds
  v_mfma_f32_16x16x32_bf16 a[156:159], v[144:147], v[80:83], a[156:159]
  v_mfma_f32_16x16x32_bf16 a[188:191], v[148:151], v[80:83], a[188:191]
  v_mfma_f32_16x16x32_bf16 a[220:223], v[152:155], v[80:83], a[220:223]
  v_mfma_f32_16x16x32_bf16 a[252:255], v[156:159], v[80:83], a[252:255]
  buffer_load_dwordx4 v34, s[12:15], s36 offen offset:2048 lds
  s_waitcnt lgkmcnt(4)
  v_mfma_f32_16x16x32_bf16 a[0:3], v[160:163], v[52:55], a[0:3]
  ds_read_b64_tr_b16 v[72:73], v21 offset:49152
  v_mfma_f32_16x16x32_bf16 a[32:35], v[164:167], v[52:55], a[32:35]
  ds_read_b64_tr_b16 v[74:75], v21 offset:50176
  v_mfma_f32_16x16x32_bf16 a[64:67], v[168:171], v[52:55], a[64:67]
  v_mfma_f32_16x16x32_bf16 a[96:99], v[172:175], v[52:55], a[96:99]
  buffer_load_dwordx4 v35, s[12:15], s36 offen offset:3072 lds
  v_mfma_f32_16x16x32_bf16 a[128:131], v[176:179], v[52:55], a[128:131]
  v_mfma_f32_16x16x32_bf16 a[160:163], v[180:183], v[52:55], a[160:163]
  v_mfma_f32_16x16x32_bf16 a[192:195], v[184:187], v[52:55], a[192:195]
  v_mfma_f32_16x16x32_bf16 a[224:227], v[188:191], v[52:55], a[224:227]
  v_mfma_f32_16x16x32_bf16 a[4:7], v[160:163], v[56:59], a[4:7]
  ds_read_b64_tr_b16 v[76:77], v22 offset:49152
  v_mfma_f32_16x16x32_bf16 a[36:39], v[164:167], v[56:59], a[36:39]
  ds_read_b64_tr_b16 v[78:79], v22 offset:50176
  v_mfma_f32_16x16x32_bf16 a[68:71], v[168:171], v[56:59], a[68:71]
  v_mfma_f32_16x16x32_bf16 a[100:103], v[172:175], v[56:59], a[100:103]
  v_mfma_f32_16x16x32_bf16 a[132:135], v[176:179], v[56:59], a[132:135]
  v_mfma_f32_16x16x32_bf16 a[164:167], v[180:183], v[56:59], a[164:167]
  v_mfma_f32_16x16x32_bf16 a[196:199], v[184:187], v[56:59], a[196:199]
  v_mfma_f32_16x16x32_bf16 a[228:231], v[188:191], v[56:59], a[228:231]
  v_mfma_f32_16x16x32_bf16 a[8:11], v[160:163], v[60:63], a[8:11]
  ds_read_b64_tr_b16 v[80:81], v23 offset:49152
  v_mfma_f32_16x16x32_bf16 a[40:43], v[164:167], v[60:63], a[40:43]
  ds_read_b64_tr_b16 v[82:83], v23 offset:50176
  v_mfma_f32_16x16x32_bf16 a[72:75], v[168:171], v[60:63], a[72:75]
  v_mfma_f32_16x16x32_bf16 a[104:107], v[172:175], v[60:63], a[104:107]
  v_mfma_f32_16x16x32_bf16 a[136:139], v[176:179], v[60:63], a[136:139]
  v_mfma_f32_16x16x32_bf16 a[168:171], v[180:183], v[60:63], a[168:171]
  v_mfma_f32_16x16x32_bf16 a[200:203], v[184:187], v[60:63], a[200:203]
  v_mfma_f32_16x16x32_bf16 a[232:235], v[188:191], v[60:63], a[232:235]
  s_waitcnt lgkmcnt(8)
  v_mfma_f32_16x16x32_bf16 a[12:15], v[160:163], v[64:67], a[12:15]
  s_waitcnt vmcnt(8)
  s_barrier
  ds_read_b64_tr_b16 v[52:53], v16 offset:0
  v_mfma_f32_16x16x32_bf16 a[44:47], v[164:167], v[64:67], a[44:47]
  ds_read_b64_tr_b16 v[54:55], v16 offset:1024
  v_mfma_f32_16x16x32_bf16 a[76:79], v[168:171], v[64:67], a[76:79]
  ds_read_b128 v[128:131], v40 offset:32768
  v_mfma_f32_16x16x32_bf16 a[108:111], v[172:175], v[64:67], a[108:111]
  s_add_u32 m0, s50, 32768
  s_xor_b32 s36, s49, 5
  s_lshl_b32 s36, s36, 19
  v_mfma_f32_16x16x32_bf16 a[140:143], v[176:179], v[64:67], a[140:143]
  ds_read_b128 v[132:135], v40 offset:34816
  v_mfma_f32_16x16x32_bf16 a[172:175], v[180:183], v[64:67], a[172:175]
  v_mfma_f32_16x16x32_bf16 a[204:207], v[184:187], v[64:67], a[204:207]
  ds_read_b128 v[136:139], v40 offset:36864
  v_mfma_f32_16x16x32_bf16 a[236:239], v[188:191], v[64:67], a[236:239]
  buffer_load_dwordx4 v46, s[16:19], s36 offen offset:0 lds
  s_waitcnt lgkmcnt(11)
  v_mfma_f32_16x16x32_bf16 a[16:19], v[160:163], v[68:71], a[16:19]
  ds_read_b64_tr_b16 v[56:57], v17 offset:0
  v_mfma_f32_16x16x32_bf16 a[48:51], v[164:167], v[68:71], a[48:51]
  ds_read_b64_tr_b16 v[58:59], v17 offset:1024
  v_mfma_f32_16x16x32_bf16 a[80:83], v[168:171], v[68:71], a[80:83]
  ds_read_b128 v[140:143], v40 offset:38912
  v_mfma_f32_16x16x32_bf16 a[112:115], v[172:175], v[68:71], a[112:115]
  buffer_load_dwordx4 v47, s[16:19], s36 offen offset:1024 lds
  v_mfma_f32_16x16x32_bf16 a[144:147], v[176:179], v[68:71], a[144:147]
  ds_read_b128 v[144:147], v40 offset:40960
  v_mfma_f32_16x16x32_bf16 a[176:179], v[180:183], v[68:71], a[176:179]
  v_mfma_f32_16x16x32_bf16 a[208:211], v[184:187], v[68:71], a[208:211]
  ds_read_b128 v[148:151], v40 offset:43008
  v_mfma_f32_16x16x32_bf16 a[240:243], v[188:191], v[68:71], a[240:243]
  s_add_u32 m0, s50, 40960
  s_nop 0
  s_waitcnt lgkmcnt(14)
  v_mfma_f32_16x16x32_bf16 a[20:23], v[160:163], v[72:75], a[20:23]
  ds_read_b64_tr_b16 v[60:61], v18 offset:0
  v_mfma_f32_16x16x32_bf16 a[52:55], v[164:167], v[72:75], a[52:55]
  ds_read_b64_tr_b16 v[62:63], v18 offset:1024
  v_mfma_f32_16x16x32_bf16 a[84:87], v[168:171], v[72:75], a[84:87]
  ds_read_b128 v[152:155], v40 offset:45056
  v_mfma_f32_16x16x32_bf16 a[116:119], v[172:175], v[72:75], a[116:119]
  buffer_load_dwordx4 v46, s[20:23], s36 offen offset:0 lds
  v_mfma_f32_16x16x32_bf16 a[148:151], v[176:179], v[72:75], a[148:151]
  ds_read_b128 v[156:159], v40 offset:47104
  v_mfma_f32_16x16x32_bf16 a[180:183], v[180:183], v[72:75], a[180:183]
  v_mfma_f32_16x16x32_bf16 a[212:215], v[184:187], v[72:75], a[212:215]
  v_mfma_f32_16x16x32_bf16 a[244:247], v[188:191], v[72:75], a[244:247]
  buffer_load_dwordx4 v47, s[20:23], s36 offen offset:1024 lds
  s_waitcnt lgkmcnt(15)
  v_mfma_f32_16x16x32_bf16 a[24:27], v[160:163], v[76:79], a[24:27]
  ds_read_b64_tr_b16 v[64:65], v19 offset:0
  v_mfma_f32_16x16x32_bf16 a[56:59], v[164:167], v[76:79], a[56:59]
  ds_read_b64_tr_b16 v[66:67], v19 offset:1024
  v_mfma_f32_16x16x32_bf16 a[88:91], v[168:171], v[76:79], a[88:91]
  v_mfma_f32_16x16x32_bf16 a[120:123], v[172:175], v[76:79], a[120:123]
  s_add_u32 m0, s44, 135168
  s_xor_b32 s36, s49, 5
  s_lshl_b32 s36, s36, 7
  s_add_u32 s36, s36, 32768
  v_mfma_f32_16x16x32_bf16 a[152:155], v[176:179], v[76:79], a[152:155]
  v_mfma_f32_16x16x32_bf16 a[184:187], v[180:183], v[76:79], a[184:187]
  v_mfma_f32_16x16x32_bf16 a[216:219], v[184:187], v[76:79], a[216:219]
  v_mfma_f32_16x16x32_bf16 a[248:251], v[188:191], v[76:79], a[248:251]
  buffer_load_dwordx4 v32, s[12:15], s36 offen offset:0 lds
  s_waitcnt lgkmcnt(15)
  v_mfma_f32_16x16x32_bf16 a[28:31], v[160:163], v[80:83], a[28:31]
  ds_read_b64_tr_b16 v[68:69], v20 offset:0
  v_mfma_f32_16x16x32_bf16 a[60:63], v[164:167], v[80:83], a[60:63]
  ds_read_b64_tr_b16 v[70:71], v20 offset:1024
  v_mfma_f32_16x16x32_bf16 a[92:95], v[168:171], v[80:83], a[92:95]
  v_mfma_f32_16x16x32_bf16 a[124:127], v[172:175], v[80:83], a[124:127]
  buffer_load_dwordx4 v33, s[12:15], s36 offen offset:1024 lds
  v_mfma_f32_16x16x32_bf16 a[156:159], v[176:179], v[80:83], a[156:159]
  v_mfma_f32_16x16x32_bf16 a[188:191], v[180:183], v[80:83], a[188:191]
  v_mfma_f32_16x16x32_bf16 a[220:223], v[184:187], v[80:83], a[220:223]
  v_mfma_f32_16x16x32_bf16 a[252:255], v[188:191], v[80:83], a[252:255]
  buffer_load_dwordx4 v34, s[12:15], s36 offen offset:2048 lds
  s_waitcnt lgkmcnt(4)
  v_mfma_f32_16x16x32_bf16 a[0:3], v[128:131], v[52:55], a[0:3]
  ds_read_b64_tr_b16 v[72:73], v21 offset:0
  v_mfma_f32_16x16x32_bf16 a[32:35], v[132:135], v[52:55], a[32:35]
  ds_read_b64_tr_b16 v[74:75], v21 offset:1024
  v_mfma_f32_16x16x32_bf16 a[64:67], v[136:139], v[52:55], a[64:67]
  v_mfma_f32_16x16x32_bf16 a[96:99], v[140:143], v[52:55], a[96:99]
  buffer_load_dwordx4 v35, s[12:15], s36 offen offset:3072 lds
  v_mfma_f32_16x16x32_bf16 a[128:131], v[144:147], v[52:55], a[128:131]
  v_mfma_f32_16x16x32_bf16 a[160:163], v[148:151], v[52:55], a[160:163]
  v_mfma_f32_16x16x32_bf16 a[192:195], v[152:155], v[52:55], a[192:195]
  v_mfma_f32_16x16x32_bf16 a[224:227], v[156:159], v[52:55], a[224:227]
  v_lshlrev_b32 v243, 2, v1
  buffer_load_dword v242, v243, s[4:7], 0 offen sc1
  v_mfma_f32_16x16x32_bf16 a[4:7], v[128:131], v[56:59], a[4:7]
  ds_read_b64_tr_b16 v[76:77], v22 offset:0
  v_mfma_f32_16x16x32_bf16 a[36:39], v[132:135], v[56:59], a[36:39]
  ds_read_b64_tr_b16 v[78:79], v22 offset:1024
  v_mfma_f32_16x16x32_bf16 a[68:71], v[136:139], v[56:59], a[68:71]
  v_mfma_f32_16x16x32_bf16 a[100:103], v[140:143], v[56:59], a[100:103]
  v_mfma_f32_16x16x32_bf16 a[132:135], v[144:147], v[56:59], a[132:135]
  v_mfma_f32_16x16x32_bf16 a[164:167], v[148:151], v[56:59], a[164:167]
  v_mfma_f32_16x16x32_bf16 a[196:199], v[152:155], v[56:59], a[196:199]
  v_mfma_f32_16x16x32_bf16 a[228:231], v[156:159], v[56:59], a[228:231]
  v_mfma_f32_16x16x32_bf16 a[8:11], v[128:131], v[60:63], a[8:11]
  ds_read_b64_tr_b16 v[80:81], v23 offset:0
  v_mfma_f32_16x16x32_bf16 a[40:43], v[132:135], v[60:63], a[40:43]
  ds_read_b64_tr_b16 v[82:83], v23 offset:1024
  v_mfma_f32_16x16x32_bf16 a[72:75], v[136:139], v[60:63], a[72:75]
  v_mfma_f32_16x16x32_bf16 a[104:107], v[140:143], v[60:63], a[104:107]
  v_mfma_f32_16x16x32_bf16 a[136:139], v[144:147], v[60:63], a[136:139]
  v_mfma_f32_16x16x32_bf16 a[168:171], v[148:151], v[60:63], a[168:171]
  v_mfma_f32_16x16x32_bf16 a[200:203], v[152:155], v[60:63], a[200:203]
  v_mfma_f32_16x16x32_bf16 a[232:235], v[156:159], v[60:63], a[232:235]
  s_waitcnt lgkmcnt(8)
  v_mfma_f32_16x16x32_bf16 a[12:15], v[128:131], v[64:67], a[12:15]
  s_waitcnt vmcnt(13)
  s_barrier
  ds_read_b64_tr_b16 v[52:53], v16 offset:16384
  v_mfma_f32_16x16x32_bf16 a[44:47], v[132:135], v[64:67], a[44:47]
  ds_read_b64_tr_b16 v[54:55], v16 offset:17408
  v_mfma_f32_16x16x32_bf16 a[76:79], v[136:139], v[64:67], a[76:79]
  ds_read_b128 v[160:163], v41 offset:32768
  v_mfma_f32_16x16x32_bf16 a[108:111], v[140:143], v[64:67], a[108:111]
  s_add_u32 m0, s50, 49152
  s_xor_b32 s36, s49, 5
  s_lshl_b32 s36, s36, 19
  s_add_u32 s36, s36, 262144
  v_mfma_f32_16x16x32_bf16 a[140:143], v[144:147], v[64:67], a[140:143]
  ds_read_b128 v[164:167], v41 offset:34816
  v_mfma_f32_16x16x32_bf16 a[172:175], v[148:151], v[64:67], a[172:175]
  v_mfma_f32_16x16x32_bf16 a[204:207], v[152:155], v[64:67], a[204:207]
  ds_read_b128 v[168:171], v41 offset:36864
  v_mfma_f32_16x16x32_bf16 a[236:239], v[156:159], v[64:67], a[236:239]
  buffer_load_dwordx4 v46, s[16:19], s36 offen offset:0 lds
  s_waitcnt lgkmcnt(11)
  v_mfma_f32_16x16x32_bf16 a[16:19], v[128:131], v[68:71], a[16:19]
  ds_read_b64_tr_b16 v[56:57], v17 offset:16384
  v_mfma_f32_16x16x32_bf16 a[48:51], v[132:135], v[68:71], a[48:51]
  ds_read_b64_tr_b16 v[58:59], v17 offset:17408
  v_mfma_f32_16x16x32_bf16 a[80:83], v[136:139], v[68:71], a[80:83]
  ds_read_b128 v[172:175], v41 offset:38912
  v_mfma_f32_16x16x32_bf16 a[112:115], v[140:143], v[68:71], a[112:115]
  buffer_load_dwordx4 v47, s[16:19], s36 offen offset:1024 lds
  v_mfma_f32_16x16x32_bf16 a[144:147], v[144:147], v[68:71], a[144:147]
  ds_read_b128 v[176:179], v41 offset:40960
  v_mfma_f32_16x16x32_bf16 a[176:179], v[148:151], v[68:71], a[176:179]
  v_mfma_f32_16x16x32_bf16 a[208:211], v[152:155], v[68:71], a[208:211]
  ds_read_b128 v[180:183], v41 offset:43008
  v_mfma_f32_16x16x32_bf16 a[240:243], v[156:159], v[68:71], a[240:243]
  s_add_u32 m0, s50, 57344
  s_nop 0
  s_waitcnt lgkmcnt(14)
  v_mfma_f32_16x16x32_bf16 a[20:23], v[128:131], v[72:75], a[20:23]
  ds_read_b64_tr_b16 v[60:61], v18 offset:16384
  v_mfma_f32_16x16x32_bf16 a[52:55], v[132:135], v[72:75], a[52:55]
  ds_read_b64_tr_b16 v[62:63], v18 offset:17408
  v_mfma_f32_16x16x32_bf16 a[84:87], v[136:139], v[72:75], a[84:87]
  ds_read_b128 v[184:187], v41 offset:45056
  v_mfma_f32_16x16x32_bf16 a[116:119], v[140:143], v[72:75], a[116:119]
  buffer_load_dwordx4 v46, s[20:23], s36 offen offset:0 lds
  v_mfma_f32_16x16x32_bf16 a[148:151], v[144:147], v[72:75], a[148:151]
  ds_read_b128 v[188:191], v41 offset:47104
  v_mfma_f32_16x16x32_bf16 a[180:183], v[148:151], v[72:75], a[180:183]
  v_mfma_f32_16x16x32_bf16 a[212:215], v[152:155], v[72:75], a[212:215]
  v_mfma_f32_16x16x32_bf16 a[244:247], v[156:159], v[72:75], a[244:247]
  buffer_load_dwordx4 v47, s[20:23], s36 offen offset:1024 lds
  s_waitcnt lgkmcnt(15)
  v_mfma_f32_16x16x32_bf16 a[24:27], v[128:131], v[76:79], a[24:27]
  ds_read_b64_tr_b16 v[64:65], v19 offset:16384
  v_mfma_f32_16x16x32_bf16 a[56:59], v[132:135], v[76:79], a[56:59]
  ds_read_b64_tr_b16 v[66:67], v19 offset:17408
  v_mfma_f32_16x16x32_bf16 a[88:91], v[136:139], v[76:79], a[88:91]
  v_mfma_f32_16x16x32_bf16 a[120:123], v[140:143], v[76:79], a[120:123]
  s_add_u32 m0, s44, 65536
  s_xor_b32 s36, s49, 6
  s_lshl_b32 s36, s36, 7
  v_mfma_f32_16x16x32_bf16 a[152:155], v[144:147], v[76:79], a[152:155]
  v_mfma_f32_16x16x32_bf16 a[184:187], v[148:151], v[76:79], a[184:187]
  v_mfma_f32_16x16x32_bf16 a[216:219], v[152:155], v[76:79], a[216:219]
  v_mfma_f32_16x16x32_bf16 a[248:251], v[156:159], v[76:79], a[248:251]
  buffer_load_dwordx4 v32, s[12:15], s36 offen offset:0 lds
  s_waitcnt lgkmcnt(15)
  v_mfma_f32_16x16x32_bf16 a[28:31], v[128:131], v[80:83], a[28:31]
  ds_read_b64_tr_b16 v[68:69], v20 offset:16384
  v_mfma_f32_16x16x32_bf16 a[60:63], v[132:135], v[80:83], a[60:63]
  ds_read_b64_tr_b16 v[70:71], v20 offset:17408
  v_mfma_f32_16x16x32_bf16 a[92:95], v[136:139], v[80:83], a[92:95]
  v_mfma_f32_16x16x32_bf16 a[124:127], v[140:143], v[80:83], a[124:127]
  buffer_load_dwordx4 v33, s[12:15], s36 offen offset:1024 lds
  v_mfma_f32_16x16x32_bf16 a[156:159], v[144:147], v[80:83], a[156:159]
  v_mfma_f32_16x16x32_bf16 a[188:191], v[148:151], v[80:83], a[188:191]
  v_mfma_f32_16x16x32_bf16 a[220:223], v[152:155], v[80:83], a[220:223]
  v_mfma_f32_16x16x32_bf16 a[252:255], v[156:159], v[80:83], a[252:255]
  buffer_load_dwordx4 v34, s[12:15], s36 offen offset:2048 lds
  s_waitcnt lgkmcnt(4)
  v_mfma_f32_16x16x32_bf16 a[0:3], v[160:163], v[52:55], a[0:3]
  ds_read_b64_tr_b16 v[72:73], v21 offset:16384
  v_mfma_f32_16x16x32_bf16 a[32:35], v[164:167], v[52:55], a[32:35]
  ds_read_b64_tr_b16 v[74:75], v21 offset:17408
  v_mfma_f32_16x16x32_bf16 a[64:67], v[168:171], v[52:55], a[64:67]
  v_mfma_f32_16x16x32_bf16 a[96:99], v[172:175], v[52:55], a[96:99]
  buffer_load_dwordx4 v35, s[12:15], s36 offen offset:3072 lds
  v_mfma_f32_16x16x32_bf16 a[128:131], v[176:179], v[52:55], a[128:131]
  v_mfma_f32_16x16x32_bf16 a[160:163], v[180:183], v[52:55], a[160:163]
  v_mfma_f32_16x16x32_bf16 a[192:195], v[184:187], v[52:55], a[192:195]
  v_mfma_f32_16x16x32_bf16 a[224:227], v[188:191], v[52:55], a[224:227]
  v_mfma_f32_16x16x32_bf16 a[4:7], v[160:163], v[56:59], a[4:7]
  ds_read_b64_tr_b16 v[76:77], v22 offset:16384
  v_mfma_f32_16x16x32_bf16 a[36:39], v[164:167], v[56:59], a[36:39]
  ds_read_b64_tr_b16 v[78:79], v22 offset:17408
  v_mfma_f32_16x16x32_bf16 a[68:71], v[168:171], v[56:59], a[68:71]
  v_mfma_f32_16x16x32_bf16 a[100:103], v[172:175], v[56:59], a[100:103]
  v_mfma_f32_16x16x32_bf16 a[132:135], v[176:179], v[56:59], a[132:135]
  v_mfma_f32_16x16x32_bf16 a[164:167], v[180:183], v[56:59], a[164:167]
  v_mfma_f32_16x16x32_bf16 a[196:199], v[184:187], v[56:59], a[196:199]
  v_mfma_f32_16x16x32_bf16 a[228:231], v[188:191], v[56:59], a[228:231]
  v_mfma_f32_16x16x32_bf16 a[8:11], v[160:163], v[60:63], a[8:11]
  ds_read_b64_tr_b16 v[80:81], v23 offset:16384
  v_mfma_f32_16x16x32_bf16 a[40:43], v[164:167], v[60:63], a[40:43]
  ds_read_b64_tr_b16 v[82:83], v23 offset:17408
  v_mfma_f32_16x16x32_bf16 a[72:75], v[168:171], v[60:63], a[72:75]
  v_mfma_f32_16x16x32_bf16 a[104:107], v[172:175], v[60:63], a[104:107]
  v_mfma_f32_16x16x32_bf16 a[136:139], v[176:179], v[60:63], a[136:139]
  v_mfma_f32_16x16x32_bf16 a[168:171], v[180:183], v[60:63], a[168:171]
  v_mfma_f32_16x16x32_bf16 a[200:203], v[184:187], v[60:63], a[200:203]
  v_mfma_f32_16x16x32_bf16 a[232:235], v[188:191], v[60:63], a[232:235]
  s_waitcnt lgkmcnt(8)
  v_mfma_f32_16x16x32_bf16 a[12:15], v[160:163], v[64:67], a[12:15]
  s_waitcnt vmcnt(9)
  s_barrier
  s_waitcnt vmcnt(8)
  s_mov_b32 s29, 0
k1_sz1_again:
  v_cmp_ne_u32 vcc, 0x01010101, v242
  s_cmp_gt_u32 s29, 400000
  s_cbranch_scc1 k1_sz1_done
  s_cbranch_vccz k1_sz1_done
  s_sleep 4
  buffer_load_dword v242, v243, s[4:7], 0 offen sc1
  s_add_u32 s29, s29, 1
  s_waitcnt vmcnt(0)
  s_branch k1_sz1_again
k1_sz1_done:
  ds_read_b64_tr_b16 v[52:53], v16 offset:32768
  v_mfma_f32_16x16x32_bf16 a[44:47], v[164:167], v[64:67], a[44:47]
  ds_read_b64_tr_b16 v[54:55], v16 offset:33792
  v_mfma_f32_16x16x32_bf16 a[76:79], v[168:171], v[64:67], a[76:79]
  ds_read_b128 v[128:131], v42 offset:0
  v_mfma_f32_16x16x32_bf16 a[108:111], v[172:175], v[64:67], a[108:111]
  s_add_u32 m0, s50, 0
  s_xor_b32 s36, s49, 6
  s_lshl_b32 s36, s36, 19
  v_mfma_f32_16x16x32_bf16 a[140:143], v[176:179], v[64:67], a[140:143]
  ds_read_b128 v[132:135], v42 offset:2048
  v_mfma_f32_16x16x32_bf16 a[172:175], v[180:183], v[64:67], a[172:175]
  v_mfma_f32_16x16x32_bf16 a[204:207], v[184:187], v[64:67], a[204:207]
  ds_read_b128 v[136:139], v42 offset:4096
  v_mfma_f32_16x16x32_bf16 a[236:239], v[188:191], v[64:67], a[236:239]
  buffer_load_dwordx4 v46, s[16:19], s36 offen offset:0 lds
  s_waitcnt lgkmcnt(11)
  v_mfma_f32_16x16x32_bf16 a[16:19], v[160:163], v[68:71], a[16:19]
  ds_read_b64_tr_b16 v[56:57], v17 offset:32768
  v_mfma_f32_16x16x32_bf16 a[48:51], v[164:167], v[68:71], a[48:51]
  ds_read_b64_tr_b16 v[58:59], v17 offset:33792
  v_mfma_f32_16x16x32_bf16 a[80:83], v[168:171], v[68:71], a[80:83]
  ds_read_b128 v[140:143], v42 offset:6144
  v_mfma_f32_16x16x32_bf16 a[112:115], v[172:175], v[68:71], a[112:115]
  buffer_load_dwordx4 v47, s[16:19], s36 offen offset:1024 lds
  v_mfma_f32_16x16x32_bf16 a[144:147], v[176:179], v[68:71], a[144:147]
  ds_read_b128 v[144:147], v42 offset:8192
  v_mfma_f32_16x16x32_bf16 a[176:179], v[180:183], v[68:71], a[176:179]
  v_mfma_f32_16x16x32_bf16 a[208:211], v[184:187], v[68:71], a[208:211]
  ds_read_b128 v[148:151], v42 offset:10240
  v_mfma_f32_16x16x32_bf16 a[240:243], v[188:191], v[68:71], a[240:243]
  s_add_u32 m0, s50, 8192
  s_nop 0
  s_waitcnt lgkmcnt(14)
  v_mfma_f32_16x16x32_bf16 a[20:23], v[160:163], v[72:75], a[20:23]
  ds_read_b64_tr_b16 v[60:61], v18 offset:32768
  v_mfma_f32_16x16x32_bf16 a[52:55], v[164:167], v[72:75], a[52:55]
  ds_read_b64_tr_b16 v[62:63], v18 offset:33792
  v_mfma_f32_16x16x32_bf16 a[84:87], v[168:171], v[72:75], a[84:87]
  ds_read_b128 v[152:155], v42 offset:12288
  v_mfma_f32_16x16x32_bf16 a[116:119], v[172:175], v[72:75], a[116:119]
  buffer_load_dwordx4 v46, s[20:23], s36 offen offset:0 lds
  v_mfma_f32_16x16x32_bf16 a[148:151], v[176:179], v[72:75], a[148:151]
  ds_read_b128 v[156:159], v42 offset:14336
  v_mfma_f32_16x16x32_bf16 a[180:183], v[180:183], v[72:75], a[180:183]
  v_mfma_f32_16x16x32_bf16 a[212:215], v[184:187], v[72:75], a[212:215]
  v_mfma_f32_16x16x32_bf16 a[244:247], v[188:191], v[72:75], a[244:247]
  buffer_load_dwordx4 v47, s[20:23], s36 offen offset:1024 lds
  s_waitcnt lgkmcnt(15)
  v_mfma_f32_16x16x32_bf16 a[24:27], v[160:163], v[76:79], a[24:27]
  ds_read_b64_tr_b16 v[64:65], v19 offset:32768
  v_mfma_f32_16x16x32_bf16 a[56:59], v[164:167], v[76:79], a[56:59]
  ds_read_b64_tr_b16 v[66:67], v19 offset:33792
  v_mfma_f32_16x16x32_bf16 a[88:91], v[168:171], v[76:79], a[88:91]
  v_mfma_f32_16x16x32_bf16 a[120:123], v[172:175], v[76:79], a[120:123]
  s_add_u32 m0, s44, 69632
  s_xor_b32 s36, s49, 6
  s_lshl_b32 s36, s36, 7
  s_add_u32 s36, s36, 32768
  v_mfma_f32_16x16x32_bf16 a[152:155], v[176:179], v[76:79], a[152:155]
  v_mfma_f32_16x16x32_bf16 a[184:187], v[180:183], v[76:79], a[184:187]
  v_mfma_f32_16x16x32_bf16 a[216:219], v[184:187], v[76:79], a[216:219]
  v_mfma_f32_16x16x32_bf16 a[248:251], v[188:191], v[76:79], a[248:251]
  buffer_load_dwordx4 v32, s[12:15], s36 offen offset:0 lds
  s_waitcnt lgkmcnt(15)
  v_mfma_f32_16x16x32_bf16 a[28:31], v[160:163], v[80:83], a[28:31]
  ds_read_b64_tr_b16 v[68:69], v20 offset:32768
  v_mfma_f32_16x16x32_bf16 a[60:63], v[164:167], v[80:83], a[60:63]
  ds_read_b64_tr_b16 v[70:71], v20 offset:33792
  v_mfma_f32_16x16x32_bf16 a[92:95], v[168:171], v[80:83], a[92:95]
  v_mfma_f32_16x16x32_bf16 a[124:127], v[172:175], v[80:83], a[124:127]
  buffer_load_dwordx4 v33, s[12:15], s36 offen offset:1024 lds
  v_mfma_f32_16x16x32_bf16 a[156:159], v[176:179], v[80:83], a[156:159]
  v_mfma_f32_16x16x32_bf16 a[188:191], v[180:183], v[80:83], a[188:191]
  v_mfma_f32_16x16x32_bf16 a[220:223], v[184:187], v[80:83], a[220:223]
  v_mfma_f32_16x16x32_bf16 a[252:255], v[188:191], v[80:83], a[252:255]
  buffer_load_dwordx4 v34, s[12:15], s36 offen offset:2048 lds
  s_waitcnt lgkmcnt(4)
  v_mfma_f32_16x16x32_bf16 a[0:3], v[128:131], v[52:55], a[0:3]
  ds_read_b64_tr_b16 v[72:73], v21 offset:32768
  v_mfma_f32_16x16x32_bf16 a[32:35], v[132:135], v[52:55], a[32:35]
  ds_read_b64_tr_b16 v[74:75], v21 offset:33792
  v_mfma_f32_16x16x32_bf16 a[64:67], v[136:139], v[52:55], a[64:67]
  v_mfma_f32_16x16x32_bf16 a[96:99], v[140:143], v[52:55], a[96:99]
  buffer_load_dwordx4 v35, s[12:15], s36 offen offset:3072 lds
  v_mfma_f32_16x16x32_bf16 a[128:131], v[144:147], v[52:55], a[128:131]
  v_mfma_f32_16x16x32_bf16 a[160:163], v[148:151], v[52:55], a[160:163]
  v_mfma_f32_16x16x32_bf16 a[192:195], v[152:155], v[52:55], a[192:195]
  v_mfma_f32_16x16x32_bf16 a[224:227], v[156:159], v[52:55], a[224:227]
  v_mfma_f32_16x16x32_bf16 a[4:7], v[128:131], v[56:59], a[4:7]
  ds_read_b64_tr_b16 v[76:77], v22 offset:32768
  v_mfma_f32_16x16x32_bf16 a[36:39], v[132:135], v[56:59], a[36:39]
  ds_read_b64_tr_b16 v[78:79], v22 offset:33792
  v_mfma_f32_16x16x32_bf16 a[68:71], v[136:139], v[56:59], a[68:71]
  v_mfma_f32_16x16x32_bf16 a[100:103], v[140:143], v[56:59], a[100:103]
  v_mfma_f32_16x16x32_bf16 a[132:135], v[144:147], v[56:59], a[132:135]
  v_mfma_f32_16x16x32_bf16 a[164:167], v[148:151], v[56:59], a[164:167]
  v_mfma_f32_16x16x32_bf16 a[196:199], v[152:155], v[56:59], a[196:199]
  v_mfma_f32_16x16x32_bf16 a[228:231], v[156:159], v[56:59], a[228:231]
  v_mfma_f32_16x16x32_bf16 a[8:11], v[128:131], v[60:63], a[8:11]
  ds_read_b64_tr_b16 v[80:81], v23 offset:32768
  v_mfma_f32_16x16x32_bf16 a[40:43], v[132:135], v[60:63], a[40:43]
  ds_read_b64_tr_b16 v[82:83], v23 offset:33792
  v_mfma_f32_16x16x32_bf16 a[72:75], v[136:139], v[60:63], a[72:75]
  v_mfma_f32_16x16x32_bf16 a[104:107], v[140:143], v[60:63], a[104:107]
  v_mfma_f32_16x16x32_bf16 a[136:139], v[144:147], v[60:63], a[136:139]
  v_mfma_f32_16x16x32_bf16 a[168:171], v[148:151], v[60:63], a[168:171]
  v_mfma_f32_16x16x32_bf16 a[200:203], v[152:155], v[60:63], a[200:203]
  v_mfma_f32_16x16x32_bf16 a[232:235], v[156:159], v[60:63], a[232:235]
  s_waitcnt lgkmcnt(8)
  v_mfma_f32_16x16x32_bf16 a[12:15], v[128:131], v[64:67], a[12:15]
  s_waitcnt vmcnt(12)
  s_barrier
  ds_read_b64_tr_b16 v[52:53], v16 offset:49152
  v_mfma_f32_16x16x32_bf16 a[44:47], v[132:135], v[64:67], a[44:47]
  ds_read_b64_tr_b16 v[54:55], v16 offset:50176
  v_mfma_f32_16x16x32_bf16 a[76:79], v[136:139], v[64:67], a[76:79]
  ds_read_b128 v[160:163], v43 offset:0
  v_mfma_f32_16x16x32_bf16 a[108:111], v[140:143], v[64:67], a[108:111]
  s_add_u32 m0, s50, 16384
  s_xor_b32 s36, s49, 6
  s_lshl_b32 s36, s36, 19
  s_add_u32 s36, s36, 262144
  v_mfma_f32_16x16x32_bf16 a[140:143], v[144:147], v[64:67], a[140:143]
  ds_read_b128 v[164:167], v43 offset:2048
  v_mfma_f32_16x16x32_bf16 a[172:175], v[148:151], v[64:67], a[172:175]
  v_mfma_f32_16x16x32_bf16 a[204:207], v[152:155], v[64:67], a[204:207]
  ds_read_b128 v[168:171], v43 offset:4096
  v_mfma_f32_16x16x32_bf16 a[236:239], v[156:159], v[64:67], a[236:239]
  buffer_load_dwordx4 v46, s[16:19], s36 offen offset:0 lds
  s_waitcnt lgkmcnt(11)
  v_mfma_f32_16x16x32_bf16 a[16:19], v[128:131], v[68:71], a[16:19]
  ds_read_b64_tr_b16 v[56:57], v17 offset:49152
  v_mfma_f32_16x16x32_bf16 a[48:51], v[132:135], v[68:71], a[48:51]
  ds_read_b64_tr_b16 v[58:59], v17 offset:50176
  v_mfma_f32_16x16x32_bf16 a[80:83], v[136:139], v[68:71], a[80:83]
  ds_read_b128 v[172:175], v43 offset:6144
  v_mfma_f32_16x16x32_bf16 a[112:115], v[140:143], v[68:71], a[112:115]
  buffer_load_dwordx4 v47, s[16:19], s36 offen offset:1024 lds
  v_mfma_f32_16x16x32_bf16 a[144:147], v[144:147], v[68:71], a[144:147]
  ds_read_b128 v[176:179], v43 offset:8192
  v_mfma_f32_16x16x32_bf16 a[176:179], v[148:151], v[68:71], a[176:179]
  v_mfma_f32_16x16x32_bf16 a[208:211], v[152:155], v[68:71], a[208:211]
  ds_read_b128 v[180:183], v43 offset:10240
  v_mfma_f32_16x16x32_bf16 a[240:243], v[156:159], v[68:71], a[240:243]
  s_add_u32 m0, s50, 24576
  s_nop 0
  s_waitcnt lgkmcnt(14)
  v_mfma_f32_16x16x32_bf16 a[20:23], v[128:131], v[72:75], a[20:23]
  ds_read_b64_tr_b16 v[60:61], v18 offset:49152
  v_mfma_f32_16x16x32_bf16 a[52:55], v[132:135], v[72:75], a[52:55]
  ds_read_b64_tr_b16 v[62:63], v18 offset:50176
  v_mfma_f32_16x16x32_bf16 a[84:87], v[136:139], v[72:75], a[84:87]
  ds_read_b128 v[184:187], v43 offset:12288
  v_mfma_f32_16x16x32_bf16 a[116:119], v[140:143], v[72:75], a[116:119]
  buffer_load_dwordx4 v46, s[20:23], s36 offen offset:0 lds
  v_mfma_f32_16x16x32_bf16 a[148:151], v[144:147], v[72:75], a[148:151]
  ds_read_b128 v[188:191], v43 offset:14336
  v_mfma_f32_16x16x32_bf16 a[180:183], v[148:151], v[72:75], a[180:183]
  v_mfma_f32_16x16x32_bf16 a[212:215], v[152:155], v[72:75], a[212:215]
  v_mfma_f32_16x16x32_bf16 a[244:247], v[156:159], v[72:75], a[244:247]
  buffer_load_dwordx4 v47, s[20:23], s36 offen offset:1024 lds
  s_waitcnt lgkmcnt(15)
  v_mfma_f32_16x16x32_bf16 a[24:27], v[128:131], v[76:79], a[24:27]
  ds_read_b64_tr_b16 v[64:65], v19 offset:49152
  v_mfma_f32_16x16x32_bf16 a[56:59], v[132:135], v[76:79], a[56:59]
  ds_read_b64_tr_b16 v[66:67], v19 offset:50176
  v_mfma_f32_16x16x32_bf16 a[88:91], v[136:139], v[76:79], a[88:91]
  v_mfma_f32_16x16x32_bf16 a[120:123], v[140:143], v[76:79], a[120:123]
  s_add_u32 m0, s44, 98304
  s_xor_b32 s36, s49, 7
  s_lshl_b32 s36, s36, 7
  v_mfma_f32_16x16x32_bf16 a[152:155], v[144:147], v[76:79], a[152:155]
  v_mfma_f32_16x16x32_bf16 a[184:187], v[148:151], v[76:79], a[184:187]
  v_mfma_f32_16x16x32_bf16 a[216:219], v[152:155], v[76:79], a[216:219]
  v_mfma_f32_16x16x32_bf16 a[248:251], v[156:159], v[76:79], a[248:251]
  buffer_load_dwordx4 v32, s[12:15], s36 offen offset:0 lds
  s_waitcnt lgkmcnt(15)
  v_mfma_f32_16x16x32_bf16 a[28:31], v[128:131], v[80:83], a[28:31]
  ds_read_b64_tr_b16 v[68:69], v20 offset:49152
  v_mfma_f32_16x16x32_bf16 a[60:63], v[132:135], v[80:83], a[60:63]
  ds_read_b64_tr_b16 v[70:71], v20 offset:50176
  v_mfma_f32_16x16x32_bf16 a[92:95], v[136:139], v[80:83], a[92:95]
  v_mfma_f32_16x16x32_bf16 a[124:127], v[140:143], v[80:83], a[124:127]
  buffer_load_dwordx4 v33, s[12:15], s36 offen offset:1024 lds
  v_mfma_f32_16x16x32_bf16 a[156:159], v[144:147], v[80:83], a[156:159]
  v_mfma_f32_16x16x32_bf16 a[188:191], v[148:151], v[80:83], a[188:191]
  v_mfma_f32_16x16x32_bf16 a[220:223], v[152:155], v[80:83], a[220:223]
  v_mfma_f32_16x16x32_bf16 a[252:255], v[156:159], v[80:83], a[252:255]
  buffer_load_dwordx4 v34, s[12:15], s36 offen offset:2048 lds
  s_waitcnt lgkmcnt(4)
  v_mfma_f32_16x16x32_bf16 a[0:3], v[160:163], v[52:55], a[0:3]
  ds_read_b64_tr_b16 v[72:73], v21 offset:49152
  v_mfma_f32_16x16x32_bf16 a[32:35], v[164:167], v[52:55], a[32:35]
  ds_read_b64_tr_b16 v[74:75], v21 offset:50176
  v_mfma_f32_16x16x32_bf16 a[64:67], v[168:171], v[52:55], a[64:67]
  v_mfma_f32_16x16x32_bf16 a[96:99], v[172:175], v[52:55], a[96:99]
  buffer_load_dwordx4 v35, s[12:15], s36 offen offset:3072 lds
  v_mfma_f32_16x16x32_bf16 a[128:131], v[176:179], v[52:55], a[128:131]
  v_mfma_f32_16x16x32_bf16 a[160:163], v[180:183], v[52:55], a[160:163]
  v_mfma_f32_16x16x32_bf16 a[192:195], v[184:187], v[52:55], a[192:195]
  v_mfma_f32_16x16x32_bf16 a[224:227], v[188:191], v[52:55], a[224:227]
  s_lshl_b32 s29, s35, 6
  s_sub_u32 s30, 960, s29
  v_mov_b32 v240, s29
  v_mov_b32 v241, s30
  v_cmp_eq_u32 vcc, 0, v8
  s_mov_b32 s53, 61935616
  s_nop 0
  v_cndmask_b32 v240, v241, v240, vcc
  v_lshl_add_u32 v240, v5, 2, v240
  buffer_load_dword v241, v240, s[8:11], s53 offen sc1
  v_mfma_f32_16x16x32_bf16 a[4:7], v[160:163], v[56:59], a[4:7]
  ds_read_b64_tr_b16 v[76:77], v22 offset:49152
  v_mfma_f32_16x16x32_bf16 a[36:39], v[164:167], v[56:59], a[36:39]
  ds_read_b64_tr_b16 v[78:79], v22 offset:50176
  v_mfma_f32_16x16x32_bf16 a[68:71], v[168:171], v[56:59], a[68:71]
  v_mfma_f32_16x16x32_bf16 a[100:103], v[172:175], v[56:59], a[100:103]
  v_mfma_f32_16x16x32_bf16 a[132:135], v[176:179], v[56:59], a[132:135]
  v_mfma_f32_16x16x32_bf16 a[164:167], v[180:183], v[56:59], a[164:167]
  v_mfma_f32_16x16x32_bf16 a[196:199], v[184:187], v[56:59], a[196:199]
  v_mfma_f32_16x16x32_bf16 a[228:231], v[188:191], v[56:59], a[228:231]
  v_mfma_f32_16x16x32_bf16 a[8:11], v[160:163], v[60:63], a[8:11]
  ds_read_b64_tr_b16 v[80:81], v23 offset:49152
  v_mfma_f32_16x16x32_bf16 a[40:43], v[164:167], v[60:63], a[40:43]
  ds_read_b64_tr_b16 v[82:83], v23 offset:50176
  v_mfma_f32_16x16x32_bf16 a[72:75], v[168:171], v[60:63], a[72:75]
  v_mfma_f32_16x16x32_bf16 a[104:107], v[172:175], v[60:63], a[104:107]
  v_mfma_f32_16x16x32_bf16 a[136:139], v[176:179], v[60:63], a[136:139]
  v_mfma_f32_16x16x32_bf16 a[168:171], v[180:183], v[60:63], a[168:171]
  v_mfma_f32_16x16x32_bf16 a[200:203], v[184:187], v[60:63], a[200:203]
  v_mfma_f32_16x16x32_bf16 a[232:235], v[188:191], v[60:63], a[232:235]
  s_waitcnt lgkmcnt(8)
  v_mfma_f32_16x16x32_bf16 a[12:15], v[160:163], v[64:67], a[12:15]
  s_waitcnt vmcnt(9)
  s_barrier
  ds_read_b64_tr_b16 v[52:53], v16 offset:0
  v_mfma_f32_16x16x32_bf16 a[44:47], v[164:167], v[64:67], a[44:47]
  ds_read_b64_tr_b16 v[54:55], v16 offset:1024
  v_mfma_f32_16x16x32_bf16 a[76:79], v[168:171], v[64:67], a[76:79]
  ds_read_b128 v[128:131], v40 offset:0
  v_mfma_f32_16x16x32_bf16 a[108:111], v[172:175], v[64:67], a[108:111]
  s_add_u32 m0, s50, 32768
  s_xor_b32 s36, s49, 7
  s_lshl_b32 s36, s36, 19
  v_mfma_f32_16x16x32_bf16 a[140:143], v[176:179], v[64:67], a[140:143]
  ds_read_b128 v[132:135], v40 offset:2048
  v_mfma_f32_16x16x32_bf16 a[172:175], v[180:183], v[64:67], a[172:175]
  v_mfma_f32_16x16x32_bf16 a[204:207], v[184:187], v[64:67], a[204:207]
  ds_read_b128 v[136:139], v40 offset:4096
  v_mfma_f32_16x16x32_bf16 a[236:239], v[188:191], v[64:67], a[236:239]
  buffer_load_dwordx4 v46, s[16:19], s36 offen offset:0 lds
  s_waitcnt lgkmcnt(11)
  v_mfma_f32_16x16x32_bf16 a[16:19], v[160:163], v[68:71], a[16:19]
  ds_read_b64_tr_b16 v[56:57], v17 offset:0
  v_mfma_f32_16x16x32_bf16 a[48:51], v[164:167], v[68:71], a[48:51]
  ds_read_b64_tr_b16 v[58:59], v17 offset:1024
  v_mfma_f32_16x16x32_bf16 a[80:83], v[168:171], v[68:71], a[80:83]
  ds_read_b128 v[140:143], v40 offset:6144
  v_mfma_f32_16x16x32_bf16 a[112:115], v[172:175], v[68:71], a[112:115]
  buffer_load_dwordx4 v47, s[16:19], s36 offen offset:1024 lds
  v_mfma_f32_16x16x32_bf16 a[144:147], v[176:179], v[68:71], a[144:147]
  ds_read_b128 v[144:147], v40 offset:8192
  v_mfma_f32_16x16x32_bf16 a[176:179], v[180:183], v[68:71], a[176:179]
  v_mfma_f32_16x16x32_bf16 a[208:211], v[184:187], v[68:71], a[208:211]
  ds_read_b128 v[148:151], v40 offset:10240
  v_mfma_f32_16x16x32_bf16 a[240:243], v[188:191], v[68:71], a[240:243]
  s_add_u32 m0, s50, 40960
  s_nop 0
  s_waitcnt lgkmcnt(14)
  v_mfma_f32_16x16x32_bf16 a[20:23], v[160:163], v[72:75], a[20:23]
  ds_read_b64_tr_b16 v[60:61], v18 offset:0
  v_mfma_f32_16x16x32_bf16 a[52:55], v[164:167], v[72:75], a[52:55]
  ds_read_b64_tr_b16 v[62:63], v18 offset:1024
  v_mfma_f32_16x16x32_bf16 a[84:87], v[168:171], v[72:75], a[84:87]
  ds_read_b128 v[152:155], v40 offset:12288
  v_mfma_f32_16x16x32_bf16 a[116:119], v[172:175], v[72:75], a[116:119]
  buffer_load_dwordx4 v46, s[20:23], s36 offen offset:0 lds
  v_mfma_f32_16x16x32_bf16 a[148:151], v[176:179], v[72:75], a[148:151]
  ds_read_b128 v[156:159], v40 offset:14336
  v_mfma_f32_16x16x32_bf16 a[180:183], v[180:183], v[72:75], a[180:183]
  v_mfma_f32_16x16x32_bf16 a[212:215], v[184:187], v[72:75], a[212:215]
  v_mfma_f32_16x16x32_bf16 a[244:247], v[188:191], v[72:75], a[244:247]
  buffer_load_dwordx4 v47, s[20:23], s36 offen offset:1024 lds
  s_waitcnt lgkmcnt(15)
  v_mfma_f32_16x16x32_bf16 a[24:27], v[160:163], v[76:79], a[24:27]
  ds_read_b64_tr_b16 v[64:65], v19 offset:0
  v_mfma_f32_16x16x32_bf16 a[56:59], v[164:167], v[76:79], a[56:59]
  ds_read_b64_tr_b16 v[66:67], v19 offset:1024
  v_mfma_f32_16x16x32_bf16 a[88:91], v[168:171], v[76:79], a[88:91]
  v_mfma_f32_16x16x32_bf16 a[120:123], v[172:175], v[76:79], a[120:123]
  s_add_u32 m0, s44, 102400
  s_xor_b32 s36, s49, 7
  s_lshl_b32 s36, s36, 7
  s_add_u32 s36, s36, 32768
  v_mfma_f32_16x16x32_bf16 a[152:155], v[176:179], v[76:79], a[152:155]
  v_mfma_f32_16x16x32_bf16 a[184:187], v[180:183], v[76:79], a[184:187]
  v_mfma_f32_16x16x32_bf16 a[216:219], v[184:187], v[76:79], a[216:219]
  v_mfma_f32_16x16x32_bf16 a[248:251], v[188:191], v[76:79], a[248:251]
  buffer_load_dwordx4 v32, s[12:15], s36 offen offset:0 lds
  s_waitcnt lgkmcnt(15)
  v_mfma_f32_16x16x32_bf16 a[28:31], v[160:163], v[80:83], a[28:31]
  ds_read_b64_tr_b16 v[68:69], v20 offset:0
  v_mfma_f32_16x16x32_bf16 a[60:63], v[164:167], v[80:83], a[60:63]
  ds_read_b64_tr_b16 v[70:71], v20 offset:1024
  v_mfma_f32_16x16x32_bf16 a[92:95], v[168:171], v[80:83], a[92:95]
  v_mfma_f32_16x16x32_bf16 a[124:127], v[172:175], v[80:83], a[124:127]
  buffer_load_dwordx4 v33, s[12:15], s36 offen offset:1024 lds
  v_mfma_f32_16x16x32_bf16 a[156:159], v[176:179], v[80:83], a[156:159]
  v_mfma_f32_16x16x32_bf16 a[188:191], v[180:183], v[80:83], a[188:191]
  v_mfma_f32_16x16x32_bf16 a[220:223], v[184:187], v[80:83], a[220:223]
  v_mfma_f32_16x16x32_bf16 a[252:255], v[188:191], v[80:83], a[252:255]
  buffer_load_dwordx4 v34, s[12:15], s36 offen offset:2048 lds
  s_waitcnt lgkmcnt(4)
  v_mfma_f32_16x16x32_bf16 a[0:3], v[128:131], v[52:55], a[0:3]
  ds_read_b64_tr_b16 v[72:73], v21 offset:0
  v_mfma_f32_16x16x32_bf16 a[32:35], v[132:135], v[52:55], a[32:35]
  ds_read_b64_tr_b16 v[74:75], v21 offset:1024
  v_mfma_f32_16x16x32_bf16 a[64:67], v[136:139], v[52:55], a[64:67]
  v_mfma_f32_16x16x32_bf16 a[96:99], v[140:143], v[52:55], a[96:99]
  buffer_load_dwordx4 v35, s[12:15], s36 offen offset:3072 lds
  v_mfma_f32_16x16x32_bf16 a[128:131], v[144:147], v[52:55], a[128:131]
  v_mfma_f32_16x16x32_bf16 a[160:163], v[148:151], v[52:55], a[160:163]
  v_mfma_f32_16x16x32_bf16 a[192:195], v[152:155], v[52:55], a[192:195]
  v_mfma_f32_16x16x32_bf16 a[224:227], v[156:159], v[52:55], a[224:227]
  v_mfma_f32_16x16x32_bf16 a[4:7], v[128:131], v[56:59], a[4:7]
  ds_read_b64_tr_b16 v[76:77], v22 offset:0
  v_mfma_f32_16x16x32_bf16 a[36:39], v[132:135], v[56:59], a[36:39]
  ds_read_b64_tr_b16 v[78:79], v22 offset:1024
  v_mfma_f32_16x16x32_bf16 a[68:71], v[136:139], v[56:59], a[68:71]
  v_mfma_f32_16x16x32_bf16 a[100:103], v[140:143], v[56:59], a[100:103]
  v_mfma_f32_16x16x32_bf16 a[132:135], v[144:147], v[56:59], a[132:135]
  v_mfma_f32_16x16x32_bf16 a[164:167], v[148:151], v[56:59], a[164:167]
  v_mfma_f32_16x16x32_bf16 a[196:199], v[152:155], v[56:59], a[196:199]
  v_mfma_f32_16x16x32_bf16 a[228:231], v[156:159], v[56:59], a[228:231]
  v_mfma_f32_16x16x32_bf16 a[8:11], v[128:131], v[60:63], a[8:11]
  ds_read_b64_tr_b16 v[80:81], v23 offset:0
  v_mfma_f32_16x16x32_bf16 a[40:43], v[132:135], v[60:63], a[40:43]
  ds_read_b64_tr_b16 v[82:83], v23 offset:1024
  v_mfma_f32_16x16x32_bf16 a[72:75], v[136:139], v[60:63], a[72:75]
  v_mfma_f32_16x16x32_bf16 a[104:107], v[140:143], v[60:63], a[104:107]
  v_mfma_f32_16x16x32_bf16 a[136:139], v[144:147], v[60:63], a[136:139]
  v_mfma_f32_16x16x32_bf16 a[168:171], v[148:151], v[60:63], a[168:171]
  v_mfma_f32_16x16x32_bf16 a[200:203], v[152:155], v[60:63], a[200:203]
  v_mfma_f32_16x16x32_bf16 a[232:235], v[156:159], v[60:63], a[232:235]
  s_waitcnt lgkmcnt(8)
  v_mfma_f32_16x16x32_bf16 a[12:15], v[128:131], v[64:67], a[12:15]
  s_waitcnt vmcnt(13)
  s_barrier
  s_waitcnt vmcnt(8)
  s_mov_b32 s29, 0
k1_sp1_again:
  v_cmp_ne_u32 vcc, 1, v241
  s_cmp_gt_u32 s29, 400000
  s_cbranch_scc1 k1_sp1_done
  s_cbranch_vccz k1_sp1_done
  s_sleep 4
  buffer_load_dword v241, v240, s[8:11], s53 offen sc1
  s_add_u32 s29, s29, 1
  s_waitcnt vmcnt(0)
  s_branch k1_sp1_again
k1_sp1_done:
  ds_read_b64_tr_b16 v[52:53], v16 offset:16384
  v_mfma_f32_16x16x32_bf16 a[44:47], v[132:135], v[64:67], a[44:47]
  ds_read_b64_tr_b16 v[54:55], v16 offset:17408
  v_mfma_f32_16x16x32_bf16 a[76:79], v[136:139], v[64:67], a[76:79]
  ds_read_b128 v[160:163], v41 offset:0
  v_mfma_f32_16x16x32_bf16 a[108:111], v[140:143], v[64:67], a[108:111]
  s_add_u32 m0, s50, 49152
  s_xor_b32 s36, s49, 7
  s_lshl_b32 s36, s36, 19
  s_add_u32 s36, s36, 262144
  v_mfma_f32_16x16x32_bf16 a[140:143], v[144:147], v[64:67], a[140:143]
  ds_read_b128 v[164:167], v41 offset:2048
  v_mfma_f32_16x16x32_bf16 a[172:175], v[148:151], v[64:67], a[172:175]
  v_mfma_f32_16x16x32_bf16 a[204:207], v[152:155], v[64:67], a[204:207]
  ds_read_b128 v[168:171], v41 offset:4096
  v_mfma_f32_16x16x32_bf16 a[236:239], v[156:159], v[64:67], a[236:239]
  buffer_load_dwordx4 v46, s[16:19], s36 offen offset:0 lds
  s_waitcnt lgkmcnt(11)
  v_mfma_f32_16x16x32_bf16 a[16:19], v[128:131], v[68:71], a[16:19]
  ds_read_b64_tr_b16 v[56:57], v17 offset:16384
  v_mfma_f32_16x16x32_bf16 a[48:51], v[132:135], v[68:71], a[48:51]
  ds_read_b64_tr_b16 v[58:59], v17 offset:17408
  v_mfma_f32_16x16x32_bf16 a[80:83], v[136:139], v[68:71], a[80:83]
  ds_read_b128 v[172:175], v41 offset:6144
  v_mfma_f32_16x16x32_bf16 a[112:115], v[140:143], v[68:71], a[112:115]
  buffer_load_dwordx4 v47, s[16:19], s36 offen offset:1024 lds
  v_mfma_f32_16x16x32_bf16 a[144:147], v[144:147], v[68:71], a[144:147]
  ds_read_b128 v[176:179], v41 offset:8192
  v_mfma_f32_16x16x32_bf16 a[176:179], v[148:151], v[68:71], a[176:179]
  v_mfma_f32_16x16x32_bf16 a[208:211], v[152:155], v[68:71], a[208:211]
  ds_read_b128 v[180:183], v41 offset:10240
  v_mfma_f32_16x16x32_bf16 a[240:243], v[156:159], v[68:71], a[240:243]
  s_add_u32 m0, s50, 57344
  s_nop 0
  s_waitcnt lgkmcnt(14)
  v_mfma_f32_16x16x32_bf16 a[20:23], v[128:131], v[72:75], a[20:23]
  ds_read_b64_tr_b16 v[60:61], v18 offset:16384
  v_mfma_f32_16x16x32_bf16 a[52:55], v[132:135], v[72:75], a[52:55]
  ds_read_b64_tr_b16 v[62:63], v18 offset:17408
  v_mfma_f32_16x16x32_bf16 a[84:87], v[136:139], v[72:75], a[84:87]
  ds_read_b128 v[184:187], v41 offset:12288
  v_mfma_f32_16x16x32_bf16 a[116:119], v[140:143], v[72:75], a[116:119]
  buffer_load_dwordx4 v46, s[20:23], s36 offen offset:0 lds
  v_mfma_f32_16x16x32_bf16 a[148:151], v[144:147], v[72:75], a[148:151]
  ds_read_b128 v[188:191], v41 offset:14336
  v_mfma_f32_16x16x32_bf16 a[180:183], v[148:151], v[72:75], a[180:183]
  v_mfma_f32_16x16x32_bf16 a[212:215], v[152:155], v[72:75], a[212:215]
  v_mfma_f32_16x16x32_bf16 a[244:247], v[156:159], v[72:75], a[244:247]
  buffer_load_dwordx4 v47, s[20:23], s36 offen offset:1024 lds
  s_waitcnt lgkmcnt(15)
  v_mfma_f32_16x16x32_bf16 a[24:27], v[128:131], v[76:79], a[24:27]
  ds_read_b64_tr_b16 v[64:65], v19 offset:16384
  v_mfma_f32_16x16x32_bf16 a[56:59], v[132:135], v[76:79], a[56:59]
  ds_read_b64_tr_b16 v[66:67], v19 offset:17408
  v_mfma_f32_16x16x32_bf16 a[88:91], v[136:139], v[76:79], a[88:91]
  v_mfma_f32_16x16x32_bf16 a[120:123], v[140:143], v[76:79], a[120:123]
  s_lshr_b32 s29, s2, 3
  s_lshl_b32 s29, s29, 2
  s_add_u32 s29, s29, s32
  s_and_b32 s28, s2, 7
  s_mov_b32 s24, s96
  s_and_b32 s25, s97, 0xffff
  s_mov_b32 s26, 0x400000
  s_mov_b32 s27, 0x20000
  v_bfe_u32 v12, v1, 3, 2
  v_lshlrev_b32 v13, 13, v12
  v_lshl_add_u32 v13, v11, 7, v13
  s_lshl_b32 s57, s29, 15
  s_lshl_b32 s30, s28, 10
  s_add_u32 s57, s57, s30
  buffer_load_dword v15, v13, s[24:27], s57 offen
  s_mov_b32 s24, s98
  s_and_b32 s25, s99, 0xffff
  s_mov_b32 s26, 0x158000
  s_mov_b32 s27, 0x20000
  v_mul_u32_u24 v13, 2752, v12
  v_lshl_add_u32 v13, v11, 6, v13
  s_mul_i32 s57, s29, 11008
  s_mul_i32 s30, s28, 384
  s_add_u32 s57, s57, s30
  buffer_load_dword v15, v13, s[24:27], s57 offen
  s_lshl_b32 s57, s29, 13
  s_getpc_b64 s[24:25]
k1_kernel_pc8:
  s_add_u32 s24, s24, k2_kernel-k1_kernel_pc8
  s_addc_u32 s25, s25, 0
  s_and_b32 s25, s25, 0xffff
  s_mov_b32 s26, k2_slow_0-k2_kernel
  s_mov_b32 s27, 0x20000
  v_lshlrev_b32 v13, 7, v1
  buffer_load_dword v15, v13, s[24:27], s57 offen
  v_mfma_f32_16x16x32_bf16 a[152:155], v[144:147], v[76:79], a[152:155]
  v_mfma_f32_16x16x32_bf16 a[184:187], v[148:151], v[76:79], a[184:187]
  v_mfma_f32_16x16x32_bf16 a[216:219], v[152:155], v[76:79], a[216:219]
  v_mfma_f32_16x16x32_bf16 a[248:251], v[156:159], v[76:79], a[248:251]
  s_lshl_b32 s28, s35, 17
  s_lshl_b32 s29, s32, 15
  s_and_b32 s30, s33, 3
  s_lshl_b32 s30, s30, 12
  s_add_u32 s29, s29, s30
  s_add_u32 s57, s28, s29
  v_lshrrev_b32 v12, 5, v1
  v_and_b32 v13, 31, v1
  v_lshlrev_b32 v13, 7, v13
  v_lshl_add_u32 v13, v12, 14, v13
  buffer_load_dword v15, v13, s[8:11], s57 offen sc1
  s_sub_u32 s57, 1966080, s28
  s_add_u32 s57, s57, s29
  buffer_load_dword v15, v13, s[8:11], s57 offen sc1
  s_waitcnt lgkmcnt(15)
  v_mfma_f32_16x16x32_bf16 a[28:31], v[128:131], v[80:83], a[28:31]
  ds_read_b64_tr_b16 v[68:69], v20 offset:16384
  v_mfma_f32_16x16x32_bf16 a[60:63], v[132:135], v[80:83], a[60:63]
  ds_read_b64_tr_b16 v[70:71], v20 offset:17408
  v_mfma_f32_16x16x32_bf16 a[92:95], v[136:139], v[80:83], a[92:95]
  v_mfma_f32_16x16x32_bf16 a[124:127], v[140:143], v[80:83], a[124:127]
  v_mfma_f32_16x16x32_bf16 a[156:159], v[144:147], v[80:83], a[156:159]
  v_mfma_f32_16x16x32_bf16 a[188:191], v[148:151], v[80:83], a[188:191]
  v_mfma_f32_16x16x32_bf16 a[220:223], v[152:155], v[80:83], a[220:223]
  v_mfma_f32_16x16x32_bf16 a[252:255], v[156:159], v[80:83], a[252:255]
  s_waitcnt lgkmcnt(4)
  v_mfma_f32_16x16x32_bf16 a[0:3], v[160:163], v[52:55], a[0:3]
  ds_read_b64_tr_b16 v[72:73], v21 offset:16384
  v_mfma_f32_16x16x32_bf16 a[32:35], v[164:167], v[52:55], a[32:35]
  ds_read_b64_tr_b16 v[74:75], v21 offset:17408
  v_mfma_f32_16x16x32_bf16 a[64:67], v[168:171], v[52:55], a[64:67]
  v_mfma_f32_16x16x32_bf16 a[96:99], v[172:175], v[52:55], a[96:99]
  v_mfma_f32_16x16x32_bf16 a[128:131], v[176:179], v[52:55], a[128:131]
  v_mfma_f32_16x16x32_bf16 a[160:163], v[180:183], v[52:55], a[160:163]
  v_mfma_f32_16x16x32_bf16 a[192:195], v[184:187], v[52:55], a[192:195]
  v_mfma_f32_16x16x32_bf16 a[224:227], v[188:191], v[52:55], a[224:227]
  v_mfma_f32_16x16x32_bf16 a[4:7], v[160:163], v[56:59], a[4:7]
  ds_read_b64_tr_b16 v[76:77], v22 offset:16384
  v_mfma_f32_16x16x32_bf16 a[36:39], v[164:167], v[56:59], a[36:39]
  ds_read_b64_tr_b16 v[78:79], v22 offset:17408
  v_mfma_f32_16x16x32_bf16 a[68:71], v[168:171], v[56:59], a[68:71]
  v_mfma_f32_16x16x32_bf16 a[100:103], v[172:175], v[56:59], a[100:103]
  v_mfma_f32_16x16x32_bf16 a[132:135], v[176:179], v[56:59], a[132:135]
  v_mfma_f32_16x16x32_bf16 a[164:167], v[180:183], v[56:59], a[164:167]
  v_mfma_f32_16x16x32_bf16 a[196:199], v[184:187], v[56:59], a[196:199]
  v_mfma_f32_16x16x32_bf16 a[228:231], v[188:191], v[56:59], a[228:231]
  v_mfma_f32_16x16x32_bf16 a[8:11], v[160:163], v[60:63], a[8:11]
  ds_read_b64_tr_b16 v[80:81], v23 offset:16384
  v_mfma_f32_16x16x32_bf16 a[40:43], v[164:167], v[60:63], a[40:43]
  ds_read_b64_tr_b16 v[82:83], v23 offset:17408
  v_mfma_f32_16x16x32_bf16 a[72:75], v[168:171], v[60:63], a[72:75]
  v_mfma_f32_16x16x32_bf16 a[104:107], v[172:175], v[60:63], a[104:107]
  v_mfma_f32_16x16x32_bf16 a[136:139], v[176:179], v[60:63], a[136:139]
  v_mfma_f32_16x16x32_bf16 a[168:171], v[180:183], v[60:63], a[168:171]
  v_mfma_f32_16x16x32_bf16 a[200:203], v[184:187], v[60:63], a[200:203]
  v_mfma_f32_16x16x32_bf16 a[232:235], v[188:191], v[60:63], a[232:235]
  s_waitcnt lgkmcnt(8)
  v_mfma_f32_16x16x32_bf16 a[12:15], v[160:163], v[64:67], a[12:15]
  s_waitcnt vmcnt(9)
  s_barrier
  ds_read_b64_tr_b16 v[52:53], v16 offset:32768
  v_mfma_f32_16x16x32_bf16 a[44:47], v[164:167], v[64:67], a[44:47]
  ds_read_b64_tr_b16 v[54:55], v16 offset:33792
  v_mfma_f32_16x16x32_bf16 a[76:79], v[168:171], v[64:67], a[76:79]
  ds_read_b128 v[128:131], v40 offset:32768
  v_mfma_f32_16x16x32_bf16 a[108:111], v[172:175], v[64:67], a[108:111]
  s_mov_b32 s12, s96
  v_mfma_f32_16x16x32_bf16 a[140:143], v[176:179], v[64:67], a[140:143]
  ds_read_b128 v[132:135], v40 offset:34816
  v_mfma_f32_16x16x32_bf16 a[172:175], v[180:183], v[64:67], a[172:175]
  v_mfma_f32_16x16x32_bf16 a[204:207], v[184:187], v[64:67], a[204:207]
  ds_read_b128 v[136:139], v40 offset:36864
  v_mfma_f32_16x16x32_bf16 a[236:239], v[188:191], v[64:67], a[236:239]
  s_and_b32 s13, s97, 0xffff
  s_waitcnt lgkmcnt(11)
  v_mfma_f32_16x16x32_bf16 a[16:19], v[160:163], v[68:71], a[16:19]
  ds_read_b64_tr_b16 v[56:57], v17 offset:32768
  v_mfma_f32_16x16x32_bf16 a[48:51], v[164:167], v[68:71], a[48:51]
  ds_read_b64_tr_b16 v[58:59], v17 offset:33792
  v_mfma_f32_16x16x32_bf16 a[80:83], v[168:171], v[68:71], a[80:83]
  ds_read_b128 v[140:143], v40 offset:38912
  v_mfma_f32_16x16x32_bf16 a[112:115], v[172:175], v[68:71], a[112:115]
  s_mov_b32 s14, 0x400000
  v_mfma_f32_16x16x32_bf16 a[144:147], v[176:179], v[68:71], a[144:147]
  ds_read_b128 v[144:147], v40 offset:40960
  v_mfma_f32_16x16x32_bf16 a[176:179], v[180:183], v[68:71], a[176:179]
  v_mfma_f32_16x16x32_bf16 a[208:211], v[184:187], v[68:71], a[208:211]
  ds_read_b128 v[148:151], v40 offset:43008
  v_mfma_f32_16x16x32_bf16 a[240:243], v[188:191], v[68:71], a[240:243]
  s_mov_b32 s15, 0x20000
  s_waitcnt lgkmcnt(14)
  v_mfma_f32_16x16x32_bf16 a[20:23], v[160:163], v[72:75], a[20:23]
  ds_read_b64_tr_b16 v[60:61], v18 offset:32768
  v_mfma_f32_16x16x32_bf16 a[52:55], v[164:167], v[72:75], a[52:55]
  ds_read_b64_tr_b16 v[62:63], v18 offset:33792
  v_mfma_f32_16x16x32_bf16 a[84:87], v[168:171], v[72:75], a[84:87]
  ds_read_b128 v[152:155], v40 offset:45056
  v_mfma_f32_16x16x32_bf16 a[116:119], v[172:175], v[72:75], a[116:119]
  s_mov_b32 s16, s98
  v_mfma_f32_16x16x32_bf16 a[148:151], v[176:179], v[72:75], a[148:151]
  ds_read_b128 v[156:159], v40 offset:47104
  v_mfma_f32_16x16x32_bf16 a[180:183], v[180:183], v[72:75], a[180:183]
  v_mfma_f32_16x16x32_bf16 a[212:215], v[184:187], v[72:75], a[212:215]
  v_mfma_f32_16x16x32_bf16 a[244:247], v[188:191], v[72:75], a[244:247]
  s_and_b32 s17, s99, 0xffff
  s_waitcnt lgkmcnt(15)
  v_mfma_f32_16x16x32_bf16 a[24:27], v[160:163], v[76:79], a[24:27]
  ds_read_b64_tr_b16 v[64:65], v19 offset:32768
  v_mfma_f32_16x16x32_bf16 a[56:59], v[164:167], v[76:79], a[56:59]
  ds_read_b64_tr_b16 v[66:67], v19 offset:33792
  v_mfma_f32_16x16x32_bf16 a[88:91], v[168:171], v[76:79], a[88:91]
  v_mfma_f32_16x16x32_bf16 a[120:123], v[172:175], v[76:79], a[120:123]
  s_mov_b32 s18, 0x158000
  v_mfma_f32_16x16x32_bf16 a[152:155], v[176:179], v[76:79], a[152:155]
  v_mfma_f32_16x16x32_bf16 a[184:187], v[180:183], v[76:79], a[184:187]
  v_mfma_f32_16x16x32_bf16 a[216:219], v[184:187], v[76:79], a[216:219]
  v_mfma_f32_16x16x32_bf16 a[248:251], v[188:191], v[76:79], a[248:251]
  s_mov_b32 s19, 0x20000
  s_waitcnt lgkmcnt(15)
  v_mfma_f32_16x16x32_bf16 a[28:31], v[160:163], v[80:83], a[28:31]
  ds_read_b64_tr_b16 v[68:69], v20 offset:32768
  v_mfma_f32_16x16x32_bf16 a[60:63], v[164:167], v[80:83], a[60:63]
  ds_read_b64_tr_b16 v[70:71], v20 offset:33792
  v_mfma_f32_16x16x32_bf16 a[92:95], v[168:171], v[80:83], a[92:95]
  v_mfma_f32_16x16x32_bf16 a[124:127], v[172:175], v[80:83], a[124:127]
  v_mov_b32 v108, v36
  v_mfma_f32_16x16x32_bf16 a[156:159], v[176:179], v[80:83], a[156:159]
  v_mfma_f32_16x16x32_bf16 a[188:191], v[180:183], v[80:83], a[188:191]
  v_mfma_f32_16x16x32_bf16 a[220:223], v[184:187], v[80:83], a[220:223]
  v_mfma_f32_16x16x32_bf16 a[252:255], v[188:191], v[80:83], a[252:255]
  v_mov_b32 v109, v37
  s_waitcnt lgkmcnt(4)
  v_mfma_f32_16x16x32_bf16 a[0:3], v[128:131], v[52:55], a[0:3]
  ds_read_b64_tr_b16 v[72:73], v21 offset:32768
  v_mfma_f32_16x16x32_bf16 a[32:35], v[132:135], v[52:55], a[32:35]
  ds_read_b64_tr_b16 v[74:75], v21 offset:33792
  v_mfma_f32_16x16x32_bf16 a[64:67], v[136:139], v[52:55], a[64:67]
  v_mov_b32 v110, v38
  v_mfma_f32_16x16x32_bf16 a[96:99], v[140:143], v[52:55], a[96:99]
  v_mov_b32 v111, v39
  v_mfma_f32_16x16x32_bf16 a[128:131], v[144:147], v[52:55], a[128:131]
  v_lshlrev_b32 v84, 1, v8
  v_mfma_f32_16x16x32_bf16 a[160:163], v[148:151], v[52:55], a[160:163]
  v_xor_b32 v84, v84, v11
  v_mfma_f32_16x16x32_bf16 a[192:195], v[152:155], v[52:55], a[192:195]
  v_lshlrev_b32 v84, 4, v84
  v_mfma_f32_16x16x32_bf16 a[224:227], v[156:159], v[52:55], a[224:227]
  v_lshrrev_b32 v85, 3, v1
  v_mfma_f32_16x16x32_bf16 a[4:7], v[128:131], v[56:59], a[4:7]
  ds_read_b64_tr_b16 v[76:77], v22 offset:32768
  v_mfma_f32_16x16x32_bf16 a[36:39], v[132:135], v[56:59], a[36:39]
  ds_read_b64_tr_b16 v[78:79], v22 offset:33792
  v_mfma_f32_16x16x32_bf16 a[68:71], v[136:139], v[56:59], a[68:71]
  v_mul_u32_u24 v85, 2752, v85
  v_mfma_f32_16x16x32_bf16 a[100:103], v[140:143], v[56:59], a[100:103]
  s_mul_i32 s38, s32, 88064
  v_mfma_f32_16x16x32_bf16 a[132:135], v[144:147], v[56:59], a[132:135]
  s_mul_i32 s39, s33, 96
  v_mfma_f32_16x16x32_bf16 a[164:167], v[148:151], v[56:59], a[164:167]
  s_add_u32 s38, s38, s39
  v_mfma_f32_16x16x32_bf16 a[196:199], v[152:155], v[56:59], a[196:199]
  v_add_u32 v85, s38, v85
  v_mfma_f32_16x16x32_bf16 a[228:231], v[156:159], v[56:59], a[228:231]
  v_add_u32 v112, v85, v84
  v_mfma_f32_16x16x32_bf16 a[8:11], v[128:131], v[60:63], a[8:11]
  ds_read_b64_tr_b16 v[80:81], v23 offset:32768
  v_mfma_f32_16x16x32_bf16 a[40:43], v[132:135], v[60:63], a[40:43]
  ds_read_b64_tr_b16 v[82:83], v23 offset:33792
  v_mfma_f32_16x16x32_bf16 a[72:75], v[136:139], v[60:63], a[72:75]
  v_xor_b32 v84, 64, v84
  v_mfma_f32_16x16x32_bf16 a[104:107], v[140:143], v[60:63], a[104:107]
  v_add_u32 v113, v85, v84
  v_mfma_f32_16x16x32_bf16 a[136:139], v[144:147], v[60:63], a[136:139]
  v_add_u32 v113, 20992, v113
  v_mfma_f32_16x16x32_bf16 a[168:171], v[148:151], v[60:63], a[168:171]
  v_add_u32 v114, 41984, v112
  v_mfma_f32_16x16x32_bf16 a[200:203], v[152:155], v[60:63], a[200:203]
  v_add_u32 v115, 41984, v113
  v_mfma_f32_16x16x32_bf16 a[232:235], v[156:159], v[60:63], a[232:235]
  s_lshl_b32 s38, s35, 17
  s_waitcnt lgkmcnt(8)
  v_mfma_f32_16x16x32_bf16 a[12:15], v[128:131], v[64:67], a[12:15]
  s_waitcnt vmcnt(5)
  s_barrier
  s_lshl_b32 s39, s32, 15
  s_add_u32 s98, s38, s39
  s_add_u32 s99, s98, 16384
  s_sub_u32 s100, 1966080, s38
  s_add_u32 s100, s100, s39
  s_add_u32 s101, s100, 16384
  ds_read_b64_tr_b16 v[52:53], v16 offset:49152
  v_mfma_f32_16x16x32_bf16 a[44:47], v[132:135], v[64:67], a[44:47]
  ds_read_b64_tr_b16 v[54:55], v16 offset:50176
  v_mfma_f32_16x16x32_bf16 a[76:79], v[136:139], v[64:67], a[76:79]
  ds_read_b128 v[160:163], v41 offset:32768
  v_mfma_f32_16x16x32_bf16 a[108:111], v[140:143], v[64:67], a[108:111]
  v_mfma_f32_16x16x32_bf16 a[140:143], v[144:147], v[64:67], a[140:143]
  ds_read_b128 v[164:167], v41 offset:34816
  v_mfma_f32_16x16x32_bf16 a[172:175], v[148:151], v[64:67], a[172:175]
  v_mfma_f32_16x16x32_bf16 a[204:207], v[152:155], v[64:67], a[204:207]
  ds_read_b128 v[168:171], v41 offset:36864
  v_mfma_f32_16x16x32_bf16 a[236:239], v[156:159], v[64:67], a[236:239]
  s_waitcnt lgkmcnt(11)
  v_mfma_f32_16x16x32_bf16 a[16:19], v[128:131], v[68:71], a[16:19]
  ds_read_b64_tr_b16 v[56:57], v17 offset:49152
  v_mfma_f32_16x16x32_bf16 a[48:51], v[132:135], v[68:71], a[48:51]
  ds_read_b64_tr_b16 v[58:59], v17 offset:50176
  v_mfma_f32_16x16x32_bf16 a[80:83], v[136:139], v[68:71], a[80:83]
  ds_read_b128 v[172:175], v41 offset:38912
  v_mfma_f32_16x16x32_bf16 a[112:115], v[140:143], v[68:71], a[112:115]
  v_mfma_f32_16x16x32_bf16 a[144:147], v[144:147], v[68:71], a[144:147]
  ds_read_b128 v[176:179], v41 offset:40960
  v_mfma_f32_16x16x32_bf16 a[176:179], v[148:151], v[68:71], a[176:179]
  v_mfma_f32_16x16x32_bf16 a[208:211], v[152:155], v[68:71], a[208:211]
  ds_read_b128 v[180:183], v41 offset:43008
  v_mfma_f32_16x16x32_bf16 a[240:243], v[156:159], v[68:71], a[240:243]
  s_waitcnt lgkmcnt(14)
  v_mfma_f32_16x16x32_bf16 a[20:23], v[128:131], v[72:75], a[20:23]
  ds_read_b64_tr_b16 v[60:61], v18 offset:49152
  v_mfma_f32_16x16x32_bf16 a[52:55], v[132:135], v[72:75], a[52:55]
  ds_read_b64_tr_b16 v[62:63], v18 offset:50176
  v_mfma_f32_16x16x32_bf16 a[84:87], v[136:139], v[72:75], a[84:87]
  ds_read_b128 v[184:187], v41 offset:45056
  v_mfma_f32_16x16x32_bf16 a[116:119], v[140:143], v[72:75], a[116:119]
  v_mfma_f32_16x16x32_bf16 a[148:151], v[144:147], v[72:75], a[148:151]
  ds_read_b128 v[188:191], v41 offset:47104
  v_mfma_f32_16x16x32_bf16 a[180:183], v[148:151], v[72:75], a[180:183]
  v_mfma_f32_16x16x32_bf16 a[212:215], v[152:155], v[72:75], a[212:215]
  v_mfma_f32_16x16x32_bf16 a[244:247], v[156:159], v[72:75], a[244:247]
  s_waitcnt lgkmcnt(15)
  v_mfma_f32_16x16x32_bf16 a[24:27], v[128:131], v[76:79], a[24:27]
  ds_read_b64_tr_b16 v[64:65], v19 offset:49152
  v_mfma_f32_16x16x32_bf16 a[56:59], v[132:135], v[76:79], a[56:59]
  ds_read_b64_tr_b16 v[66:67], v19 offset:50176
  v_mfma_f32_16x16x32_bf16 a[88:91], v[136:139], v[76:79], a[88:91]
  v_mfma_f32_16x16x32_bf16 a[120:123], v[140:143], v[76:79], a[120:123]
  v_mfma_f32_16x16x32_bf16 a[152:155], v[144:147], v[76:79], a[152:155]
  v_mfma_f32_16x16x32_bf16 a[184:187], v[148:151], v[76:79], a[184:187]
  v_mfma_f32_16x16x32_bf16 a[216:219], v[152:155], v[76:79], a[216:219]
  v_mfma_f32_16x16x32_bf16 a[248:251], v[156:159], v[76:79], a[248:251]
  s_waitcnt lgkmcnt(15)
  v_mfma_f32_16x16x32_bf16 a[28:31], v[128:131], v[80:83], a[28:31]
  ds_read_b64_tr_b16 v[68:69], v20 offset:49152
  v_mfma_f32_16x16x32_bf16 a[60:63], v[132:135], v[80:83], a[60:63]
  ds_read_b64_tr_b16 v[70:71], v20 offset:50176
  v_mfma_f32_16x16x32_bf16 a[92:95], v[136:139], v[80:83], a[92:95]
  v_mfma_f32_16x16x32_bf16 a[124:127], v[140:143], v[80:83], a[124:127]
  v_mfma_f32_16x16x32_bf16 a[156:159], v[144:147], v[80:83], a[156:159]
  v_mfma_f32_16x16x32_bf16 a[188:191], v[148:151], v[80:83], a[188:191]
  v_mfma_f32_16x16x32_bf16 a[220:223], v[152:155], v[80:83], a[220:223]
  v_mfma_f32_16x16x32_bf16 a[252:255], v[156:159], v[80:83], a[252:255]
  s_waitcnt lgkmcnt(4)
  v_mfma_f32_16x16x32_bf16 a[0:3], v[160:163], v[52:55], a[0:3]
  ds_read_b64_tr_b16 v[72:73], v21 offset:49152
  v_mfma_f32_16x16x32_bf16 a[32:35], v[164:167], v[52:55], a[32:35]
  ds_read_b64_tr_b16 v[74:75], v21 offset:50176
  v_mfma_f32_16x16x32_bf16 a[64:67], v[168:171], v[52:55], a[64:67]
  v_mfma_f32_16x16x32_bf16 a[96:99], v[172:175], v[52:55], a[96:99]
  v_mfma_f32_16x16x32_bf16 a[128:131], v[176:179], v[52:55], a[128:131]
  v_mfma_f32_16x16x32_bf16 a[160:163], v[180:183], v[52:55], a[160:163]
  v_mfma_f32_16x16x32_bf16 a[192:195], v[184:187], v[52:55], a[192:195]
  v_mfma_f32_16x16x32_bf16 a[224:227], v[188:191], v[52:55], a[224:227]
  v_mfma_f32_16x16x32_bf16 a[4:7], v[160:163], v[56:59], a[4:7]
  ds_read_b64_tr_b16 v[76:77], v22 offset:49152
  v_mfma_f32_16x16x32_bf16 a[36:39], v[164:167], v[56:59], a[36:39]
  ds_read_b64_tr_b16 v[78:79], v22 offset:50176
  v_mfma_f32_16x16x32_bf16 a[68:71], v[168:171], v[56:59], a[68:71]
  v_mfma_f32_16x16x32_bf16 a[100:103], v[172:175], v[56:59], a[100:103]
  v_mfma_f32_16x16x32_bf16 a[132:135], v[176:179], v[56:59], a[132:135]
  v_mfma_f32_16x16x32_bf16 a[164:167], v[180:183], v[56:59], a[164:167]
  v_mfma_f32_16x16x32_bf16 a[196:199], v[184:187], v[56:59], a[196:199]
  v_mfma_f32_16x16x32_bf16 a[228:231], v[188:191], v[56:59], a[228:231]
  v_mfma_f32_16x16x32_bf16 a[8:11], v[160:163], v[60:63], a[8:11]
  ds_read_b64_tr_b16 v[80:81], v23 offset:49152
  v_accvgpr_read_b32 v192, a0
  v_accvgpr_read_b32 v193, a1
  v_mfma_f32_16x16x32_bf16 a[40:43], v[164:167], v[60:63], a[40:43]
  ds_read_b64_tr_b16 v[82:83], v23 offset:50176
  v_accvgpr_read_b32 v194, a2
  v_accvgpr_read_b32 v195, a3
  v_mfma_f32_16x16x32_bf16 a[72:75], v[168:171], v[60:63], a[72:75]
  v_accvgpr_read_b32 v196, a32
  v_accvgpr_read_b32 v197, a33
  v_mfma_f32_16x16x32_bf16 a[104:107], v[172:175], v[60:63], a[104:107]
  v_accvgpr_read_b32 v198, a34
  v_accvgpr_read_b32 v199, a35
  v_mfma_f32_16x16x32_bf16 a[136:139], v[176:179], v[60:63], a[136:139]
  v_cvt_pk_bf16_f32 v192, v192, v193
  v_cvt_pk_bf16_f32 v193, v194, v195
  v_mfma_f32_16x16x32_bf16 a[168:171], v[180:183], v[60:63], a[168:171]
  v_cvt_pk_bf16_f32 v194, v196, v197
  v_cvt_pk_bf16_f32 v195, v198, v199
  v_mfma_f32_16x16x32_bf16 a[200:203], v[184:187], v[60:63], a[200:203]
  s_add_u32 s37, s43, 0
  buffer_store_dwordx4 v[192:195], v2, s[8:11], s37 offen sc1
  v_mfma_f32_16x16x32_bf16 a[232:235], v[188:191], v[60:63], a[232:235]
  s_waitcnt lgkmcnt(8)
  v_mfma_f32_16x16x32_bf16 a[12:15], v[160:163], v[64:67], a[12:15]
  v_accvgpr_read_b32 v200, a4
  v_accvgpr_read_b32 v201, a5
  v_mfma_f32_16x16x32_bf16 a[44:47], v[164:167], v[64:67], a[44:47]
  v_accvgpr_read_b32 v202, a6
  v_accvgpr_read_b32 v203, a7
  v_mfma_f32_16x16x32_bf16 a[76:79], v[168:171], v[64:67], a[76:79]
  v_accvgpr_read_b32 v204, a36
  v_accvgpr_read_b32 v205, a37
  v_mfma_f32_16x16x32_bf16 a[108:111], v[172:175], v[64:67], a[108:111]
  v_accvgpr_read_b32 v206, a38
  v_accvgpr_read_b32 v207, a39
  v_mfma_f32_16x16x32_bf16 a[140:143], v[176:179], v[64:67], a[140:143]
  v_cvt_pk_bf16_f32 v200, v200, v201
  v_cvt_pk_bf16_f32 v201, v202, v203
  v_mfma_f32_16x16x32_bf16 a[172:175], v[180:183], v[64:67], a[172:175]
  v_cvt_pk_bf16_f32 v202, v204, v205
  v_cvt_pk_bf16_f32 v203, v206, v207
  v_mfma_f32_16x16x32_bf16 a[204:207], v[184:187], v[64:67], a[204:207]
  s_add_u32 s37, s43, 1024
  buffer_store_dwordx4 v[200:203], v2, s[8:11], s37 offen sc1
  v_mfma_f32_16x16x32_bf16 a[236:239], v[188:191], v[64:67], a[236:239]
  s_waitcnt lgkmcnt(6)
  v_mfma_f32_16x16x32_bf16 a[16:19], v[160:163], v[68:71], a[16:19]
  v_accvgpr_read_b32 v208, a8
  v_accvgpr_read_b32 v209, a9
  v_mfma_f32_16x16x32_bf16 a[48:51], v[164:167], v[68:71], a[48:51]
  v_accvgpr_read_b32 v210, a10
  v_accvgpr_read_b32 v211, a11
  v_mfma_f32_16x16x32_bf16 a[80:83], v[168:171], v[68:71], a[80:83]
  v_accvgpr_read_b32 v212, a40
  v_accvgpr_read_b32 v213, a41
  v_mfma_f32_16x16x32_bf16 a[112:115], v[172:175], v[68:71], a[112:115]
  v_accvgpr_read_b32 v214, a42
  v_accvgpr_read_b32 v215, a43
  v_mfma_f32_16x16x32_bf16 a[144:147], v[176:179], v[68:71], a[144:147]
  v_cvt_pk_bf16_f32 v208, v208, v209
  v_cvt_pk_bf16_f32 v209, v210, v211
  v_mfma_f32_16x16x32_bf16 a[176:179], v[180:183], v[68:71], a[176:179]
  v_cvt_pk_bf16_f32 v210, v212, v213
  v_cvt_pk_bf16_f32 v211, v214, v215
  v_mfma_f32_16x16x32_bf16 a[208:211], v[184:187], v[68:71], a[208:211]
  s_add_u32 s37, s43, 2048
  buffer_store_dwordx4 v[208:211], v2, s[8:11], s37 offen sc1
  v_mfma_f32_16x16x32_bf16 a[240:243], v[188:191], v[68:71], a[240:243]
  s_waitcnt lgkmcnt(4)
  v_mfma_f32_16x16x32_bf16 a[20:23], v[160:163], v[72:75], a[20:23]
  v_accvgpr_read_b32 v216, a12
  v_accvgpr_read_b32 v217, a13
  v_mfma_f32_16x16x32_bf16 a[52:55], v[164:167], v[72:75], a[52:55]
  v_accvgpr_read_b32 v218, a14
  v_accvgpr_read_b32 v219, a15
  v_mfma_f32_16x16x32_bf16 a[84:87], v[168:171], v[72:75], a[84:87]
  v_accvgpr_read_b32 v220, a44
  v_accvgpr_read_b32 v221, a45
  v_mfma_f32_16x16x32_bf16 a[116:119], v[172:175], v[72:75], a[116:119]
  v_accvgpr_read_b32 v222, a46
  v_accvgpr_read_b32 v223, a47
  v_mfma_f32_16x16x32_bf16 a[148:151], v[176:179], v[72:75], a[148:151]
  v_cvt_pk_bf16_f32 v216, v216, v217
  v_cvt_pk_bf16_f32 v217, v218, v219
  v_mfma_f32_16x16x32_bf16 a[180:183], v[180:183], v[72:75], a[180:183]
  v_cvt_pk_bf16_f32 v218, v220, v221
  v_cvt_pk_bf16_f32 v219, v222, v223
  v_mfma_f32_16x16x32_bf16 a[212:215], v[184:187], v[72:75], a[212:215]
  s_add_u32 s37, s43, 3072
  buffer_store_dwordx4 v[216:219], v2, s[8:11], s37 offen sc1
  v_mfma_f32_16x16x32_bf16 a[244:247], v[188:191], v[72:75], a[244:247]
  s_waitcnt lgkmcnt(2)
  v_mfma_f32_16x16x32_bf16 a[24:27], v[160:163], v[76:79], a[24:27]
  v_accvgpr_read_b32 v192, a16
  v_accvgpr_read_b32 v193, a17
  v_mfma_f32_16x16x32_bf16 a[56:59], v[164:167], v[76:79], a[56:59]
  v_accvgpr_read_b32 v194, a18
  v_accvgpr_read_b32 v195, a19
  v_mfma_f32_16x16x32_bf16 a[88:91], v[168:171], v[76:79], a[88:91]
  v_accvgpr_read_b32 v196, a48
  v_accvgpr_read_b32 v197, a49
  v_mfma_f32_16x16x32_bf16 a[120:123], v[172:175], v[76:79], a[120:123]
  v_accvgpr_read_b32 v198, a50
  v_accvgpr_read_b32 v199, a51
  v_mfma_f32_16x16x32_bf16 a[152:155], v[176:179], v[76:79], a[152:155]
  v_cvt_pk_bf16_f32 v192, v192, v193
  v_cvt_pk_bf16_f32 v193, v194, v195
  v_mfma_f32_16x16x32_bf16 a[184:187], v[180:183], v[76:79], a[184:187]
  v_cvt_pk_bf16_f32 v194, v196, v197
  v_cvt_pk_bf16_f32 v195, v198, v199
  v_mfma_f32_16x16x32_bf16 a[216:219], v[184:187], v[76:79], a[216:219]
  s_add_u32 s37, s43, 4096
  buffer_store_dwordx4 v[192:195], v2, s[8:11], s37 offen sc1
  v_mfma_f32_16x16x32_bf16 a[248:251], v[188:191], v[76:79], a[248:251]
  s_waitcnt lgkmcnt(0)
  v_mfma_f32_16x16x32_bf16 a[28:31], v[160:163], v[80:83], a[28:31]
  v_accvgpr_read_b32 v200, a20
  v_accvgpr_read_b32 v201, a21
  v_mfma_f32_16x16x32_bf16 a[60:63], v[164:167], v[80:83], a[60:63]
  v_accvgpr_read_b32 v202, a22
  v_accvgpr_read_b32 v203, a23
  v_mfma_f32_16x16x32_bf16 a[92:95], v[168:171], v[80:83], a[92:95]
  v_accvgpr_read_b32 v204, a52
  v_accvgpr_read_b32 v205, a53
  v_mfma_f32_16x16x32_bf16 a[124:127], v[172:175], v[80:83], a[124:127]
  v_accvgpr_read_b32 v206, a54
  v_accvgpr_read_b32 v207, a55
  v_mfma_f32_16x16x32_bf16 a[156:159], v[176:179], v[80:83], a[156:159]
  v_cvt_pk_bf16_f32 v200, v200, v201
  v_cvt_pk_bf16_f32 v201, v202, v203
  v_mfma_f32_16x16x32_bf16 a[188:191], v[180:183], v[80:83], a[188:191]
  v_cvt_pk_bf16_f32 v202, v204, v205
  v_cvt_pk_bf16_f32 v203, v206, v207
  v_mfma_f32_16x16x32_bf16 a[220:223], v[184:187], v[80:83], a[220:223]
  s_add_u32 s37, s43, 5120
  buffer_store_dwordx4 v[200:203], v2, s[8:11], s37 offen sc1
  v_mfma_f32_16x16x32_bf16 a[252:255], v[188:191], v[80:83], a[252:255]
  s_barrier
  v_accvgpr_read_b32 v208, a24
  v_accvgpr_read_b32 v209, a25
  v_accvgpr_read_b32 v210, a26
  v_accvgpr_read_b32 v211, a27
  v_accvgpr_read_b32 v212, a56
  s_add_u32 m0, s48, 0
  s_mov_b32 s41, 0
  v_accvgpr_read_b32 v213, a57
  v_accvgpr_read_b32 v214, a58
  v_accvgpr_read_b32 v215, a59
  v_cvt_pk_bf16_f32 v208, v208, v209
  v_cvt_pk_bf16_f32 v209, v210, v211
  buffer_load_dwordx4 v112, s[16:19], s41 offen offset:0 lds
  v_cvt_pk_bf16_f32 v210, v212, v213
  v_cvt_pk_bf16_f32 v211, v214, v215
  s_add_u32 s37, s43, 6144
  buffer_store_dwordx4 v[208:211], v2, s[8:11], s37 offen sc1
  v_accvgpr_read_b32 v216, a28
  buffer_load_dwordx4 v113, s[16:19], s41 offen offset:1024 lds
  v_accvgpr_read_b32 v217, a29
  v_accvgpr_read_b32 v218, a30
  v_accvgpr_read_b32 v219, a31
  v_accvgpr_read_b32 v220, a60
  v_accvgpr_read_b32 v221, a61
  buffer_load_dwordx4 v114, s[16:19], s41 offen offset:2048 lds
  v_accvgpr_read_b32 v222, a62
  v_accvgpr_read_b32 v223, a63
  v_cvt_pk_bf16_f32 v216, v216, v217
  v_cvt_pk_bf16_f32 v217, v218, v219
  v_cvt_pk_bf16_f32 v218, v220, v221
  buffer_load_dwordx4 v115, s[16:19], s41 offen offset:3072 lds
  v_cvt_pk_bf16_f32 v219, v222, v223
  s_add_u32 s37, s43, 7168
  buffer_store_dwordx4 v[216:219], v2, s[8:11], s37 offen sc1
  s_add_u32 m0, s48, 16384
  s_mov_b32 s41, 0
  v_accvgpr_read_b32 v192, a64
  v_accvgpr_read_b32 v193, a65
  v_accvgpr_read_b32 v194, a66
  v_accvgpr_read_b32 v195, a67
  v_accvgpr_read_b32 v196, a96
  v_accvgpr_read_b32 v197, a97
  v_accvgpr_read_b32 v198, a98
  v_accvgpr_read_b32 v199, a99
  v_cvt_pk_bf16_f32 v128, v192, v193
  buffer_load_dwordx4 v108, s[12:15], s41 offen offset:0 lds
  v_cvt_pk_bf16_f32 v129, v194, v195
  v_cvt_pk_bf16_f32 v130, v196, v197
  v_cvt_pk_bf16_f32 v131, v198, v199
  v_accvgpr_read_b32 v200, a68
  v_accvgpr_read_b32 v201, a69
  v_accvgpr_read_b32 v202, a70
  v_accvgpr_read_b32 v203, a71
  v_accvgpr_read_b32 v204, a100
  v_accvgpr_read_b32 v205, a101
  buffer_load_dwordx4 v109, s[12:15], s41 offen offset:1024 lds
  v_accvgpr_read_b32 v206, a102
  v_accvgpr_read_b32 v207, a103
  v_cvt_pk_bf16_f32 v132, v200, v201
  v_cvt_pk_bf16_f32 v133, v202, v203
  v_cvt_pk_bf16_f32 v134, v204, v205
  v_cvt_pk_bf16_f32 v135, v206, v207
  v_accvgpr_read_b32 v208, a72
  v_accvgpr_read_b32 v209, a73
  v_accvgpr_read_b32 v210, a74
  buffer_load_dwordx4 v110, s[12:15], s41 offen offset:2048 lds
  v_accvgpr_read_b32 v211, a75
  v_accvgpr_read_b32 v212, a104
  v_accvgpr_read_b32 v213, a105
  v_accvgpr_read_b32 v214, a106
  v_accvgpr_read_b32 v215, a107
  v_cvt_pk_bf16_f32 v136, v208, v209
  v_cvt_pk_bf16_f32 v137, v210, v211
  v_cvt_pk_bf16_f32 v138, v212, v213
  v_cvt_pk_bf16_f32 v139, v214, v215
  buffer_load_dwordx4 v111, s[12:15], s41 offen offset:3072 lds
  v_accvgpr_read_b32 v216, a76
  v_accvgpr_read_b32 v217, a77
  v_accvgpr_read_b32 v218, a78
  v_accvgpr_read_b32 v219, a79
  v_accvgpr_read_b32 v220, a108
  v_accvgpr_read_b32 v221, a109
  v_accvgpr_read_b32 v222, a110
  v_accvgpr_read_b32 v223, a111
  v_cvt_pk_bf16_f32 v140, v216, v217
  s_add_u32 m0, s48, 32768
  s_mov_b32 s41, 524288
  v_cvt_pk_bf16_f32 v141, v218, v219
  v_cvt_pk_bf16_f32 v142, v220, v221
  v_cvt_pk_bf16_f32 v143, v222, v223
  v_accvgpr_read_b32 v192, a80
  v_accvgpr_read_b32 v193, a81
  v_accvgpr_read_b32 v194, a82
  v_accvgpr_read_b32 v195, a83
  v_accvgpr_read_b32 v196, a112
  v_accvgpr_read_b32 v197, a113
  buffer_load_dwordx4 v108, s[12:15], s41 offen offset:0 lds
  v_accvgpr_read_b32 v198, a114
  v_accvgpr_read_b32 v199, a115
  v_cvt_pk_bf16_f32 v144, v192, v193
  v_cvt_pk_bf16_f32 v145, v194, v195
  v_cvt_pk_bf16_f32 v146, v196, v197
  v_cvt_pk_bf16_f32 v147, v198, v199
  v_accvgpr_read_b32 v200, a84
  v_accvgpr_read_b32 v201, a85
  v_accvgpr_read_b32 v202, a86
  buffer_load_dwordx4 v109, s[12:15], s41 offen offset:1024 lds
  v_accvgpr_read_b32 v203, a87
  v_accvgpr_read_b32 v204, a116
  v_accvgpr_read_b32 v205, a117
  v_accvgpr_read_b32 v206, a118
  v_accvgpr_read_b32 v207, a119
  v_cvt_pk_bf16_f32 v148, v200, v201
  v_cvt_pk_bf16_f32 v149, v202, v203
  v_cvt_pk_bf16_f32 v150, v204, v205
  v_cvt_pk_bf16_f32 v151, v206, v207
  buffer_load_dwordx4 v110, s[12:15], s41 offen offset:2048 lds
  v_accvgpr_read_b32 v208, a88
  v_accvgpr_read_b32 v209, a89
  v_accvgpr_read_b32 v210, a90
  v_accvgpr_read_b32 v211, a91
  v_accvgpr_read_b32 v212, a120
  v_accvgpr_read_b32 v213, a121
  v_accvgpr_read_b32 v214, a122
  v_accvgpr_read_b32 v215, a123
  v_cvt_pk_bf16_f32 v152, v208, v209
  buffer_load_dwordx4 v111, s[12:15], s41 offen offset:3072 lds
  v_cvt_pk_bf16_f32 v153, v210, v211
  v_cvt_pk_bf16_f32 v154, v212, v213
  v_cvt_pk_bf16_f32 v155, v214, v215
  v_accvgpr_read_b32 v216, a92
  v_accvgpr_read_b32 v217, a93
  v_accvgpr_read_b32 v218, a94
  v_accvgpr_read_b32 v219, a95
  v_accvgpr_read_b32 v220, a124
  v_accvgpr_read_b32 v221, a125
  buffer_load_dwordx4 a[0:3], v2, s[8:11], s98 offen offset:0 sc1
  v_accvgpr_read_b32 v222, a126
  v_accvgpr_read_b32 v223, a127
  v_cvt_pk_bf16_f32 v156, v216, v217
  v_cvt_pk_bf16_f32 v157, v218, v219
  v_cvt_pk_bf16_f32 v158, v220, v221
  v_cvt_pk_bf16_f32 v159, v222, v223
  v_accvgpr_read_b32 v192, a128
  v_accvgpr_read_b32 v193, a129
  v_accvgpr_read_b32 v194, a130
  buffer_load_dwordx4 a[4:7], v2, s[8:11], s99 offen offset:0 sc1
  v_accvgpr_read_b32 v195, a131
  v_accvgpr_read_b32 v196, a160
  v_accvgpr_read_b32 v197, a161
  v_accvgpr_read_b32 v198, a162
  v_accvgpr_read_b32 v199, a163
  v_cvt_pk_bf16_f32 v160, v192, v193
  v_cvt_pk_bf16_f32 v161, v194, v195
  v_cvt_pk_bf16_f32 v162, v196, v197
  v_cvt_pk_bf16_f32 v163, v198, v199
  buffer_load_dwordx4 a[8:11], v2, s[8:11], s100 offen offset:0 sc1
  v_accvgpr_read_b32 v200, a132
  v_accvgpr_read_b32 v201, a133
  v_accvgpr_read_b32 v202, a134
  v_accvgpr_read_b32 v203, a135
  v_accvgpr_read_b32 v204, a164
  v_accvgpr_read_b32 v205, a165
  v_accvgpr_read_b32 v206, a166
  v_accvgpr_read_b32 v207, a167
  v_cvt_pk_bf16_f32 v164, v200, v201
  buffer_load_dwordx4 a[12:15], v2, s[8:11], s101 offen offset:0 sc1
  v_cvt_pk_bf16_f32 v165, v202, v203
  v_cvt_pk_bf16_f32 v166, v204, v205
  v_cvt_pk_bf16_f32 v167, v206, v207
  v_accvgpr_read_b32 v208, a136
  v_accvgpr_read_b32 v209, a137
  v_accvgpr_read_b32 v210, a138
  v_accvgpr_read_b32 v211, a139
  v_accvgpr_read_b32 v212, a168
  v_accvgpr_read_b32 v213, a169
  buffer_load_dwordx4 a[16:19], v2, s[8:11], s98 offen offset:1024 sc1
  v_accvgpr_read_b32 v214, a170
  v_accvgpr_read_b32 v215, a171
  v_cvt_pk_bf16_f32 v168, v208, v209
  v_cvt_pk_bf16_f32 v169, v210, v211
  v_cvt_pk_bf16_f32 v170, v212, v213
  v_cvt_pk_bf16_f32 v171, v214, v215
  v_accvgpr_read_b32 v216, a140
  v_accvgpr_read_b32 v217, a141
  v_accvgpr_read_b32 v218, a142
  buffer_load_dwordx4 a[20:23], v2, s[8:11], s99 offen offset:1024 sc1
  v_accvgpr_read_b32 v219, a143
  v_accvgpr_read_b32 v220, a172
  v_accvgpr_read_b32 v221, a173
  v_accvgpr_read_b32 v222, a174
  v_accvgpr_read_b32 v223, a175
  v_cvt_pk_bf16_f32 v172, v216, v217
  v_cvt_pk_bf16_f32 v173, v218, v219
  v_cvt_pk_bf16_f32 v174, v220, v221
  v_cvt_pk_bf16_f32 v175, v222, v223
  buffer_load_dwordx4 a[24:27], v2, s[8:11], s100 offen offset:1024 sc1
  v_accvgpr_read_b32 v192, a144
  v_accvgpr_read_b32 v193, a145
  v_accvgpr_read_b32 v194, a146
  v_accvgpr_read_b32 v195, a147
  v_accvgpr_read_b32 v196, a176
  v_accvgpr_read_b32 v197, a177
  v_accvgpr_read_b32 v198, a178
  v_accvgpr_read_b32 v199, a179
  v_cvt_pk_bf16_f32 v176, v192, v193
  buffer_load_dwordx4 a[28:31], v2, s[8:11], s101 offen offset:1024 sc1
  v_cvt_pk_bf16_f32 v177, v194, v195
  v_cvt_pk_bf16_f32 v178, v196, v197
  v_cvt_pk_bf16_f32 v179, v198, v199
  v_accvgpr_read_b32 v200, a148
  v_accvgpr_read_b32 v201, a149
  v_accvgpr_read_b32 v202, a150
  v_accvgpr_read_b32 v203, a151
  v_accvgpr_read_b32 v204, a180
  v_accvgpr_read_b32 v205, a181
  buffer_load_dwordx4 a[32:35], v2, s[8:11], s98 offen offset:2048 sc1
  v_accvgpr_read_b32 v206, a182
  v_accvgpr_read_b32 v207, a183
  v_cvt_pk_bf16_f32 v180, v200, v201
  v_cvt_pk_bf16_f32 v181, v202, v203
  v_cvt_pk_bf16_f32 v182, v204, v205
  v_cvt_pk_bf16_f32 v183, v206, v207
  v_accvgpr_read_b32 v208, a152
  v_accvgpr_read_b32 v209, a153
  v_accvgpr_read_b32 v210, a154
  buffer_load_dwordx4 a[36:39], v2, s[8:11], s99 offen offset:2048 sc1
  v_accvgpr_read_b32 v211, a155
  v_accvgpr_read_b32 v212, a184
  v_accvgpr_read_b32 v213, a185
  v_accvgpr_read_b32 v214, a186
  v_accvgpr_read_b32 v215, a187
  v_cvt_pk_bf16_f32 v184, v208, v209
  v_cvt_pk_bf16_f32 v185, v210, v211
  v_cvt_pk_bf16_f32 v186, v212, v213
  v_cvt_pk_bf16_f32 v187, v214, v215
  buffer_load_dwordx4 a[40:43], v2, s[8:11], s100 offen offset:2048 sc1
  v_accvgpr_read_b32 v216, a156
  v_accvgpr_read_b32 v217, a157
  v_accvgpr_read_b32 v218, a158
  v_accvgpr_read_b32 v219, a159
  v_accvgpr_read_b32 v220, a188
  v_accvgpr_read_b32 v221, a189
  v_accvgpr_read_b32 v222, a190
  v_accvgpr_read_b32 v223, a191
  v_cvt_pk_bf16_f32 v188, v216, v217
  buffer_load_dwordx4 a[44:47], v2, s[8:11], s101 offen offset:2048 sc1
  v_cvt_pk_bf16_f32 v189, v218, v219
  v_cvt_pk_bf16_f32 v190, v220, v221
  v_cvt_pk_bf16_f32 v191, v222, v223
  v_accvgpr_read_b32 v192, a192
  v_accvgpr_read_b32 v193, a193
  v_accvgpr_read_b32 v194, a194
  v_accvgpr_read_b32 v195, a195
  v_accvgpr_read_b32 v196, a224
  v_accvgpr_read_b32 v197, a225
  buffer_load_dwordx4 a[48:51], v2, s[8:11], s98 offen offset:3072 sc1
  v_accvgpr_read_b32 v198, a226
  v_accvgpr_read_b32 v199, a227
  v_cvt_pk_bf16_f32 v52, v192, v193
  v_cvt_pk_bf16_f32 v53, v194, v195
  v_cvt_pk_bf16_f32 v54, v196, v197
  v_cvt_pk_bf16_f32 v55, v198, v199
  v_accvgpr_read_b32 v200, a196
  v_accvgpr_read_b32 v201, a197
  v_accvgpr_read_b32 v202, a198
  buffer_load_dwordx4 a[52:55], v2, s[8:11], s99 offen offset:3072 sc1
  v_accvgpr_read_b32 v203, a199
  v_accvgpr_read_b32 v204, a228
  v_accvgpr_read_b32 v205, a229
  v_accvgpr_read_b32 v206, a230
  v_accvgpr_read_b32 v207, a231
  v_cvt_pk_bf16_f32 v56, v200, v201
  v_cvt_pk_bf16_f32 v57, v202, v203
  v_cvt_pk_bf16_f32 v58, v204, v205
  v_cvt_pk_bf16_f32 v59, v206, v207
  buffer_load_dwordx4 a[56:59], v2, s[8:11], s100 offen offset:3072 sc1
  v_accvgpr_read_b32 v208, a200
  v_accvgpr_read_b32 v209, a201
  v_accvgpr_read_b32 v210, a202
  v_accvgpr_read_b32 v211, a203
  v_accvgpr_read_b32 v212, a232
  v_accvgpr_read_b32 v213, a233
  v_accvgpr_read_b32 v214, a234
  v_accvgpr_read_b32 v215, a235
  v_cvt_pk_bf16_f32 v60, v208, v209
  buffer_load_dwordx4 a[60:63], v2, s[8:11], s101 offen offset:3072 sc1
  v_cvt_pk_bf16_f32 v61, v210, v211
  v_cvt_pk_bf16_f32 v62, v212, v213
  v_cvt_pk_bf16_f32 v63, v214, v215
  v_accvgpr_read_b32 v216, a204
  v_accvgpr_read_b32 v217, a205
  v_accvgpr_read_b32 v218, a206
  v_accvgpr_read_b32 v219, a207
  v_accvgpr_read_b32 v220, a236
  v_accvgpr_read_b32 v221, a237
  v_accvgpr_read_b32 v222, a238
  v_accvgpr_read_b32 v223, a239
  v_cvt_pk_bf16_f32 v64, v216, v217
  v_cvt_pk_bf16_f32 v65, v218, v219
  v_cvt_pk_bf16_f32 v66, v220, v221
  v_cvt_pk_bf16_f32 v67, v222, v223
  v_accvgpr_read_b32 v192, a208
  v_accvgpr_read_b32 v193, a209
  v_accvgpr_read_b32 v194, a210
  v_accvgpr_read_b32 v195, a211
  v_accvgpr_read_b32 v196, a240
  v_accvgpr_read_b32 v197, a241
  v_accvgpr_read_b32 v198, a242
  v_accvgpr_read_b32 v199, a243
  v_cvt_pk_bf16_f32 v68, v192, v193
  v_cvt_pk_bf16_f32 v69, v194, v195
  v_cvt_pk_bf16_f32 v70, v196, v197
  v_cvt_pk_bf16_f32 v71, v198, v199
  v_accvgpr_read_b32 v200, a212
  v_accvgpr_read_b32 v201, a213
  v_accvgpr_read_b32 v202, a214
  v_accvgpr_read_b32 v203, a215
  v_accvgpr_read_b32 v204, a244
  v_accvgpr_read_b32 v205, a245
  v_accvgpr_read_b32 v206, a246
  v_accvgpr_read_b32 v207, a247
  v_cvt_pk_bf16_f32 v72, v200, v201
  v_cvt_pk_bf16_f32 v73, v202, v203
  v_cvt_pk_bf16_f32 v74, v204, v205
  v_cvt_pk_bf16_f32 v75, v206, v207
  v_accvgpr_read_b32 v208, a216
  v_accvgpr_read_b32 v209, a217
  v_accvgpr_read_b32 v210, a218
  v_accvgpr_read_b32 v211, a219
  v_accvgpr_read_b32 v212, a248
  v_accvgpr_read_b32 v213, a249
  v_accvgpr_read_b32 v214, a250
  v_accvgpr_read_b32 v215, a251
  v_cvt_pk_bf16_f32 v76, v208, v209
  v_cvt_pk_bf16_f32 v77, v210, v211
  v_cvt_pk_bf16_f32 v78, v212, v213
  v_cvt_pk_bf16_f32 v79, v214, v215
  v_accvgpr_read_b32 v216, a220
  v_accvgpr_read_b32 v217, a221
  v_accvgpr_read_b32 v218, a222
  v_accvgpr_read_b32 v219, a223
  v_accvgpr_read_b32 v220, a252
  v_accvgpr_read_b32 v221, a253
  v_accvgpr_read_b32 v222, a254
  v_accvgpr_read_b32 v223, a255
  v_cvt_pk_bf16_f32 v80, v216, v217
  v_cvt_pk_bf16_f32 v81, v218, v219
  v_cvt_pk_bf16_f32 v82, v220, v221
  v_cvt_pk_bf16_f32 v83, v222, v223
  v_accvgpr_write_b32 a96, v128
  v_accvgpr_write_b32 a97, v129
  v_accvgpr_write_b32 a98, v130
  v_accvgpr_write_b32 a99, v131
  v_accvgpr_write_b32 a100, v132
  v_accvgpr_write_b32 a101, v133
  v_accvgpr_write_b32 a102, v134
  v_accvgpr_write_b32 a103, v135
  v_accvgpr_write_b32 a104, v136
  v_accvgpr_write_b32 a105, v137
  v_accvgpr_write_b32 a106, v138
  v_accvgpr_write_b32 a107, v139
  v_accvgpr_write_b32 a108, v140
  v_accvgpr_write_b32 a109, v141
  v_accvgpr_write_b32 a110, v142
  v_accvgpr_write_b32 a111, v143
  v_accvgpr_write_b32 a112, v144
  v_accvgpr_write_b32 a113, v145
  v_accvgpr_write_b32 a114, v146
  v_accvgpr_write_b32 a115, v147
  v_accvgpr_write_b32 a116, v148
  v_accvgpr_write_b32 a117, v149
  v_accvgpr_write_b32 a118, v150
  v_accvgpr_write_b32 a119, v151
  v_accvgpr_write_b32 a120, v152
  v_accvgpr_write_b32 a121, v153
  v_accvgpr_write_b32 a122, v154
  v_accvgpr_write_b32 a123, v155
  v_accvgpr_write_b32 a124, v156
  v_accvgpr_write_b32 a125, v157
  v_accvgpr_write_b32 a126, v158
  v_accvgpr_write_b32 a127, v159
  v_accvgpr_write_b32 a128, v160
  v_accvgpr_write_b32 a129, v161
  v_accvgpr_write_b32 a130, v162
  v_accvgpr_write_b32 a131, v163
  v_accvgpr_write_b32 a132, v164
  v_accvgpr_write_b32 a133, v165
  v_accvgpr_write_b32 a134, v166
  v_accvgpr_write_b32 a135, v167
  v_accvgpr_write_b32 a136, v168
  v_accvgpr_write_b32 a137, v169
  v_accvgpr_write_b32 a138, v170
  v_accvgpr_write_b32 a139, v171
  v_accvgpr_write_b32 a140, v172
  v_accvgpr_write_b32 a141, v173
  v_accvgpr_write_b32 a142, v174
  v_accvgpr_write_b32 a143, v175
  v_accvgpr_write_b32 a144, v176
  v_accvgpr_write_b32 a145, v177
  v_accvgpr_write_b32 a146, v178
  v_accvgpr_write_b32 a147, v179
  v_accvgpr_write_b32 a148, v180
  v_accvgpr_write_b32 a149, v181
  v_accvgpr_write_b32 a150, v182
  v_accvgpr_write_b32 a151, v183
  v_accvgpr_write_b32 a152, v184
  v_accvgpr_write_b32 a153, v185
  v_accvgpr_write_b32 a154, v186
  v_accvgpr_write_b32 a155, v187
  v_accvgpr_write_b32 a156, v188
  v_accvgpr_write_b32 a157, v189
  v_accvgpr_write_b32 a158, v190
  v_accvgpr_write_b32 a159, v191
  v_accvgpr_write_b32 a160, v52
  v_accvgpr_write_b32 a161, v53
  v_accvgpr_write_b32 a162, v54
  v_accvgpr_write_b32 a163, v55
  v_accvgpr_write_b32 a164, v56
  v_accvgpr_write_b32 a165, v57
  v_accvgpr_write_b32 a166, v58
  v_accvgpr_write_b32 a167, v59
  v_accvgpr_write_b32 a168, v60
  v_accvgpr_write_b32 a169, v61
  v_accvgpr_write_b32 a170, v62
  v_accvgpr_write_b32 a171, v63
  v_accvgpr_write_b32 a172, v64
  v_accvgpr_write_b32 a173, v65
  v_accvgpr_write_b32 a174, v66
  v_accvgpr_write_b32 a175, v67
  v_accvgpr_write_b32 a176, v68
  v_accvgpr_write_b32 a177, v69
  v_accvgpr_write_b32 a178, v70
  v_accvgpr_write_b32 a179, v71
  v_accvgpr_write_b32 a180, v72
  v_accvgpr_write_b32 a181, v73
  v_accvgpr_write_b32 a182, v74
  v_accvgpr_write_b32 a183, v75
  v_accvgpr_write_b32 a184, v76
  v_accvgpr_write_b32 a185, v77
  v_accvgpr_write_b32 a186, v78
  v_accvgpr_write_b32 a187, v79
  v_accvgpr_write_b32 a188, v80
  v_accvgpr_write_b32 a189, v81
  v_accvgpr_write_b32 a190, v82
  v_accvgpr_write_b32 a191, v83
  s_add_u32 s50, s43, 8192
  s_mov_b32 s3, s54
  s_branch k2_kernel
  s_endpgm
k1_end:
  s_endpgm
.p2align 6
k2_kernel:
  s_cmp_ge_u32 s2, 256
  s_cbranch_scc1 k2_end
  s_load_dwordx2 s[84:85], s[0:1], 16
  s_load_dwordx4 s[88:91], s[0:1], 56
  s_load_dwordx2 s[92:93], s[0:1], 104
  s_load_dwordx2 s[86:87], s[0:1], 40
  s_load_dwordx2 s[96:97], s[0:1], 72
  v_and_b32 v1, 63, v0
  v_lshrrev_b32 v13, 6, v0
  s_and_b32 s38, s2, 7
  v_readfirstlane_b32 s32, v13
  s_lshr_b32 s39, s2, 3
  s_and_b32 s40, s39, 3
  s_lshl_b32 s33, s38, 2
  s_add_u32 s33, s33, s40
  s_lshr_b32 s34, s39, 2
  v_lshlrev_b32 v2, 4, v1
  s_lshl_b32 s48, s32, 12
  v_add_u32 v4, s48, v2
  v_lshrrev_b32 v22, 4, v1
  v_and_b32 v23, 15, v1
  v_and_b32 v24, 7, v1
  v_lshrrev_b32 v25, 3, v1
  v_bfe_u32 v26, v1, 2, 2
  v_and_b32 v27, 3, v1
  v_and_b32 v28, 1, v22
  v_lshlrev_b32 v29, 1, v22
  v_xor_b32 v29, v29, v23
  v_lshlrev_b32 v29, 4, v29
  v_lshl_add_u32 v29, v22, 13, v29
  s_lshl_b32 s38, s32, 17
  s_lshl_b32 s39, s33, 8
  s_add_u32 s38, s38, s39
  v_add_u32 v108, s38, v29
  v_add_u32 v109, 31744, v108
  v_xor_b32 v110, 128, v108
  v_add_u32 v110, 63488, v110
  v_add_u32 v111, 31744, v110
  v_lshlrev_b32 v29, 1, v28
  v_xor_b32 v29, v29, v24
  v_lshlrev_b32 v29, 4, v29
  v_mul_u32_u24 v30, 2752, v25
  s_mul_i32 s38, s32, 88064
  s_mul_i32 s39, s33, 96
  s_add_u32 s38, s38, s39
  v_add_u32 v30, s38, v30
  v_add_u32 v112, v30, v29
  v_xor_b32 v29, 64, v29
  v_add_u32 v113, v30, v29
  v_add_u32 v113, 20992, v113
  v_add_u32 v114, 41984, v112
  v_add_u32 v115, 41984, v113
  s_lshl_b32 s38, s34, 7
  s_lshl_b32 s39, s32, 5
  s_add_u32 s51, s38, s39
  s_sub_u32 s52, 1920, s38
  s_add_u32 s52, s52, s39
  s_lshl_b32 s40, s33, 12
  s_add_u32 s40, s40, 37748736
  s_lshl_b32 s53, s51, 13
  s_add_u32 s53, s53, s40
  s_lshl_b32 s54, s52, 13
  s_add_u32 s54, s54, s40
  s_mov_b32 s94, s51
  s_mov_b32 s95, s52
  s_lshr_b32 s56, s94, 4
  s_add_u32 s56, s56, 0
  s_mul_i32 s56, s56, 44032
  s_lshr_b32 s57, s94, 4
  s_add_u32 s57, s57, 1
  s_mul_i32 s57, s57, 44032
  s_lshr_b32 s58, s95, 4
  s_add_u32 s58, s58, 0
  s_mul_i32 s58, s58, 44032
  s_lshr_b32 s59, s95, 4
  s_add_u32 s59, s59, 1
  s_mul_i32 s59, s59, 44032
  s_lshl_b32 s51, s51, 10
  s_lshl_b32 s52, s52, 10
  s_lshr_b32 s39, s32, 1
  s_lshl_b32 s38, s34, 1
  s_add_u32 s35, s38, s39
  s_add_u32 s35, s35, 1
  s_sub_u32 s36, 31, s38
  s_add_u32 s36, s36, s39
  s_waitcnt lgkmcnt(0)
  s_mov_b32 s12, s84
  s_and_b32 s13, s85, 0xffff
  s_mov_b32 s14, 0x400000
  s_mov_b32 s15, 0x20000
  s_mov_b32 s16, s88
  s_and_b32 s17, s89, 0xffff
  s_mov_b32 s18, 0x158000
  s_mov_b32 s19, 0x20000
  s_mov_b32 s8, s92
  s_and_b32 s9, s93, 0xffff
  s_mov_b32 s10, 0x4000000
  s_mov_b32 s11, 0x20000
  s_mov_b32 s28, s90
  s_and_b32 s29, s91, 0xffff
  s_mov_b32 s30, 0xac0
  s_mov_b32 s31, 0x20000
  s_lshl_b32 s38, s33, 19
  s_add_u32 s39, s38, 4194304
  s_add_u32 s20, s92, s39
  s_addc_u32 s21, s93, 0
  s_and_b32 s21, s21, 0xffff
  s_lshl_b32 s40, s34, 15
  s_sub_u32 s22, 524288, s40
  s_mov_b32 s23, 0x20000
  s_add_u32 s39, s38, 20955136
  s_add_u32 s24, s92, s39
  s_addc_u32 s25, s93, 0
  s_and_b32 s25, s25, 0xffff
  s_add_u32 s26, s22, 16384
  s_mov_b32 s27, 0x20000
  v_lshl_or_b32 v30, v28, 2, v26
  v_lshl_add_u32 v31, v22, 3, v26
  v_lshlrev_b32 v29, 8, v31
  v_lshl_add_u32 v29, v27, 3, v29
  v_xor_b32 v13, 0, v30
  v_lshl_add_u32 v96, v13, 5, v29
  v_xor_b32 v13, 1, v30
  v_lshl_add_u32 v97, v13, 5, v29
  v_xor_b32 v13, 2, v30
  v_lshl_add_u32 v98, v13, 5, v29
  v_xor_b32 v13, 3, v30
  v_lshl_add_u32 v99, v13, 5, v29
  v_xor_b32 v13, 4, v30
  v_lshl_add_u32 v100, v13, 5, v29
  v_xor_b32 v13, 5, v30
  v_lshl_add_u32 v101, v13, 5, v29
  v_xor_b32 v13, 6, v30
  v_lshl_add_u32 v102, v13, 5, v29
  v_xor_b32 v13, 7, v30
  v_lshl_add_u32 v103, v13, 5, v29
  v_lshrrev_b32 v13, 1, v26
  v_lshl_or_b32 v30, v28, 1, v13
  v_lshlrev_b32 v29, 7, v31
  v_lshl_add_u32 v29, v27, 3, v29
  v_xor_b32 v13, 0, v30
  v_lshl_add_u32 v104, v13, 5, v29
  v_xor_b32 v13, 1, v30
  v_lshl_add_u32 v105, v13, 5, v29
  v_xor_b32 v13, 2, v30
  v_lshl_add_u32 v106, v13, 5, v29
  v_mov_b32 v116, 0x3f803f80
  v_mov_b32 v117, 0x3f803f80
  v_mov_b32 v118, 0x3f803f80
  v_mov_b32 v119, 0x3f803f80
  v_lshlrev_b32 v13, 3, v23
  s_lshl_b32 s38, s94, 3
  s_add_u32 s38, s38, 2097152
  buffer_load_dwordx2 v[120:121], v13, s[8:11], s38 offen sc1
  s_lshl_b32 s38, s94, 3
  s_add_u32 s38, s38, 2097280
  buffer_load_dwordx2 v[122:123], v13, s[8:11], s38 offen sc1
  s_lshl_b32 s38, s95, 3
  s_add_u32 s38, s38, 2097152
  buffer_load_dwordx2 v[124:125], v13, s[8:11], s38 offen sc1
  s_lshl_b32 s38, s95, 3
  s_add_u32 s38, s38, 2097280
  buffer_load_dwordx2 v[126:127], v13, s[8:11], s38 offen sc1
  v_lshlrev_b32 v14, 3, v22
  s_mul_i32 s39, s33, 96
  buffer_load_dwordx2 v[92:93], v14, s[28:31], s39 offen offset:0
  buffer_load_dwordx2 v[94:95], v14, s[28:31], s39 offen offset:32
  buffer_load_dwordx2 v[30:31], v14, s[28:31], s39 offen offset:64
  s_waitcnt vmcnt(27)
  s_barrier
  ds_read_b64_tr_b16 a[192:193], v104 offset:0
  ds_read_b64_tr_b16 a[194:195], v104 offset:512
  ds_read_b64_tr_b16 a[196:197], v105 offset:0
  ds_read_b64_tr_b16 a[198:199], v105 offset:512
  ds_read_b64_tr_b16 a[200:201], v106 offset:0
  ds_read_b64_tr_b16 a[202:203], v106 offset:512
  ds_read_b64_tr_b16 a[204:205], v96 offset:16384
  ds_read_b64_tr_b16 a[206:207], v96 offset:17408
  ds_read_b64_tr_b16 a[208:209], v97 offset:16384
  ds_read_b64_tr_b16 a[210:211], v97 offset:17408
  ds_read_b64_tr_b16 a[212:213], v98 offset:16384
  ds_read_b64_tr_b16 a[214:215], v98 offset:17408
  s_waitcnt vmcnt(19)
  s_waitcnt lgkmcnt(8)
  v_mfma_f32_16x16x32_bf16 v[32:35], a[192:195], a[0:3], 0
  ds_read_b64_tr_b16 a[216:217], v99 offset:16384
  v_mfma_f32_16x16x32_bf16 v[36:39], a[192:195], a[4:7], 0
  ds_read_b64_tr_b16 a[218:219], v99 offset:17408
  v_mfma_f32_16x16x32_bf16 v[40:43], a[192:195], a[8:11], 0
  s_add_u32 s98, s51, 4096
  buffer_load_dwordx4 a[64:67], v2, s[8:11], s98 offen offset:0 sc1
  v_mfma_f32_16x16x32_bf16 v[44:47], a[192:195], a[12:15], 0
  s_add_u32 s99, s51, 20480
  buffer_load_dwordx4 a[68:71], v2, s[8:11], s99 offen offset:0 sc1
  v_mfma_f32_16x16x32_bf16 v[80:83], a[192:195], v[116:119], 0
  v_mfma_f32_16x16x32_bf16 v[48:51], a[196:199], a[0:3], 0
  ds_read_b64_tr_b16 a[220:221], v100 offset:16384
  v_mfma_f32_16x16x32_bf16 v[52:55], a[196:199], a[4:7], 0
  ds_read_b64_tr_b16 a[222:223], v100 offset:17408
  v_mfma_f32_16x16x32_bf16 v[56:59], a[196:199], a[8:11], 0
  s_add_u32 s100, s52, 4096
  buffer_load_dwordx4 a[72:75], v2, s[8:11], s100 offen offset:0 sc1
  v_mfma_f32_16x16x32_bf16 v[60:63], a[196:199], a[12:15], 0
  s_add_u32 s101, s52, 20480
  buffer_load_dwordx4 a[76:79], v2, s[8:11], s101 offen offset:0 sc1
  v_mfma_f32_16x16x32_bf16 v[84:87], a[196:199], v[116:119], 0
  s_waitcnt lgkmcnt(8)
  v_mfma_f32_16x16x32_bf16 v[64:67], a[200:203], a[0:3], 0
  ds_read_b64_tr_b16 a[224:225], v101 offset:16384
  v_mfma_f32_16x16x32_bf16 v[68:71], a[200:203], a[4:7], 0
  ds_read_b64_tr_b16 a[226:227], v101 offset:17408
  v_mfma_f32_16x16x32_bf16 v[72:75], a[200:203], a[8:11], 0
  s_add_u32 m0, s48, 49152
  s_mov_b32 s41, 352256
  v_mfma_f32_16x16x32_bf16 v[76:79], a[200:203], a[12:15], 0
  buffer_load_dwordx4 v112, s[16:19], s41 offen offset:0 lds
  v_mfma_f32_16x16x32_bf16 v[88:91], a[200:203], v[116:119], 0
  v_mfma_f32_16x16x32_bf16 v[128:131], a[204:207], a[0:3], 0
  ds_read_b64_tr_b16 a[228:229], v102 offset:16384
  v_mfma_f32_16x16x32_bf16 v[132:135], a[204:207], a[4:7], 0
  ds_read_b64_tr_b16 a[230:231], v102 offset:17408
  v_mfma_f32_16x16x32_bf16 v[136:139], a[204:207], a[8:11], 0
  buffer_load_dwordx4 v113, s[16:19], s41 offen offset:1024 lds
  v_mfma_f32_16x16x32_bf16 v[140:143], a[204:207], a[12:15], 0
  buffer_load_dwordx4 v114, s[16:19], s41 offen offset:2048 lds
  s_waitcnt lgkmcnt(8)
  v_mfma_f32_16x16x32_bf16 v[144:147], a[208:211], a[0:3], 0
  ds_read_b64_tr_b16 a[232:233], v103 offset:16384
  v_mfma_f32_16x16x32_bf16 v[148:151], a[208:211], a[4:7], 0
  ds_read_b64_tr_b16 a[234:235], v103 offset:17408
  v_mfma_f32_16x16x32_bf16 v[152:155], a[208:211], a[8:11], 0
  buffer_load_dwordx4 v115, s[16:19], s41 offen offset:3072 lds
  v_mfma_f32_16x16x32_bf16 v[156:159], a[208:211], a[12:15], 0
  s_add_u32 m0, s48, 65536
  s_mov_b32 s41, 1048576
  v_mfma_f32_16x16x32_bf16 v[160:163], a[212:215], a[0:3], 0
  ds_read_b64_tr_b16 a[236:237], v104 offset:4096
  v_mfma_f32_16x16x32_bf16 v[164:167], a[212:215], a[4:7], 0
  ds_read_b64_tr_b16 a[238:239], v104 offset:4608
  v_mfma_f32_16x16x32_bf16 v[168:171], a[212:215], a[8:11], 0
  buffer_load_dwordx4 v108, s[12:15], s41 offen offset:0 lds
  v_mfma_f32_16x16x32_bf16 v[172:175], a[212:215], a[12:15], 0
  buffer_load_dwordx4 v109, s[12:15], s41 offen offset:1024 lds
  s_waitcnt lgkmcnt(8)
  v_mfma_f32_16x16x32_bf16 v[176:179], a[216:219], a[0:3], 0
  ds_read_b64_tr_b16 a[240:241], v105 offset:4096
  v_mfma_f32_16x16x32_bf16 v[180:183], a[216:219], a[4:7], 0
  ds_read_b64_tr_b16 a[242:243], v105 offset:4608
  v_mfma_f32_16x16x32_bf16 v[184:187], a[216:219], a[8:11], 0
  buffer_load_dwordx4 v110, s[12:15], s41 offen offset:2048 lds
  v_mfma_f32_16x16x32_bf16 v[188:191], a[216:219], a[12:15], 0
  v_mfma_f32_16x16x32_bf16 v[192:195], a[220:223], a[0:3], 0
  ds_read_b64_tr_b16 a[244:245], v106 offset:4096
  v_mfma_f32_16x16x32_bf16 v[196:199], a[220:223], a[4:7], 0
  ds_read_b64_tr_b16 a[246:247], v106 offset:4608
  v_mfma_f32_16x16x32_bf16 v[200:203], a[220:223], a[8:11], 0
  buffer_load_dwordx4 v111, s[12:15], s41 offen offset:3072 lds
  v_mfma_f32_16x16x32_bf16 v[204:207], a[220:223], a[12:15], 0
  s_waitcnt lgkmcnt(8)
  v_mfma_f32_16x16x32_bf16 v[208:211], a[224:227], a[0:3], 0
  ds_read_b64_tr_b16 a[248:249], v96 offset:24576
  v_mfma_f32_16x16x32_bf16 v[212:215], a[224:227], a[4:7], 0
  ds_read_b64_tr_b16 a[250:251], v96 offset:25600
  v_mfma_f32_16x16x32_bf16 v[216:219], a[224:227], a[8:11], 0
  buffer_store_dwordx4 a[96:99], v2, s[8:11], s50 offen offset:0 sc1
  v_mfma_f32_16x16x32_bf16 v[220:223], a[224:227], a[12:15], 0
  v_mfma_f32_16x16x32_bf16 v[224:227], a[228:231], a[0:3], 0
  ds_read_b64_tr_b16 a[252:253], v97 offset:24576
  v_mfma_f32_16x16x32_bf16 v[228:231], a[228:231], a[4:7], 0
  ds_read_b64_tr_b16 a[254:255], v97 offset:25600
  v_mfma_f32_16x16x32_bf16 v[232:235], a[228:231], a[8:11], 0
  buffer_store_dwordx4 a[100:103], v2, s[8:11], s50 offen offset:1024 sc1
  v_mfma_f32_16x16x32_bf16 v[236:239], a[228:231], a[12:15], 0
  s_waitcnt lgkmcnt(8)
  v_mfma_f32_16x16x32_bf16 v[240:243], a[232:235], a[0:3], 0
  ds_read_b64_tr_b16 a[192:193], v98 offset:24576
  v_mfma_f32_16x16x32_bf16 v[244:247], a[232:235], a[4:7], 0
  ds_read_b64_tr_b16 a[194:195], v98 offset:25600
  v_mfma_f32_16x16x32_bf16 v[248:251], a[232:235], a[8:11], 0
  buffer_load_dwordx4 a[80:83], v2, s[8:11], s98 offen offset:1024 sc1
  v_mfma_f32_16x16x32_bf16 v[252:255], a[232:235], a[12:15], 0
  s_waitcnt vmcnt(30)
  v_mfma_f32_16x16x32_bf16 v[32:35], a[236:239], a[16:19], v[32:35]
  ds_read_b64_tr_b16 a[196:197], v99 offset:24576
  v_mfma_f32_16x16x32_bf16 v[36:39], a[236:239], a[20:23], v[36:39]
  ds_read_b64_tr_b16 a[198:199], v99 offset:25600
  v_mfma_f32_16x16x32_bf16 v[40:43], a[236:239], a[24:27], v[40:43]
  buffer_load_dwordx4 a[84:87], v2, s[8:11], s99 offen offset:1024 sc1
  v_mfma_f32_16x16x32_bf16 v[44:47], a[236:239], a[28:31], v[44:47]
  v_mfma_f32_16x16x32_bf16 v[80:83], a[236:239], v[116:119], v[80:83]
  s_waitcnt lgkmcnt(8)
  v_mfma_f32_16x16x32_bf16 v[48:51], a[240:243], a[16:19], v[48:51]
  ds_read_b64_tr_b16 a[200:201], v100 offset:24576
  v_mfma_f32_16x16x32_bf16 v[52:55], a[240:243], a[20:23], v[52:55]
  ds_read_b64_tr_b16 a[202:203], v100 offset:25600
  v_mfma_f32_16x16x32_bf16 v[56:59], a[240:243], a[24:27], v[56:59]
  buffer_load_dwordx4 a[88:91], v2, s[8:11], s100 offen offset:1024 sc1
  v_mfma_f32_16x16x32_bf16 v[60:63], a[240:243], a[28:31], v[60:63]
  v_mfma_f32_16x16x32_bf16 v[84:87], a[240:243], v[116:119], v[84:87]
  v_mfma_f32_16x16x32_bf16 v[64:67], a[244:247], a[16:19], v[64:67]
  ds_read_b64_tr_b16 a[204:205], v101 offset:24576
  v_mfma_f32_16x16x32_bf16 v[68:71], a[244:247], a[20:23], v[68:71]
  ds_read_b64_tr_b16 a[206:207], v101 offset:25600
  v_mfma_f32_16x16x32_bf16 v[72:75], a[244:247], a[24:27], v[72:75]
  buffer_load_dwordx4 a[92:95], v2, s[8:11], s101 offen offset:1024 sc1
  v_mfma_f32_16x16x32_bf16 v[76:79], a[244:247], a[28:31], v[76:79]
  v_mfma_f32_16x16x32_bf16 v[88:91], a[244:247], v[116:119], v[88:91]
  s_waitcnt lgkmcnt(8)
  v_mfma_f32_16x16x32_bf16 v[128:131], a[248:251], a[16:19], v[128:131]
  ds_read_b64_tr_b16 a[208:209], v102 offset:24576
  v_mfma_f32_16x16x32_bf16 v[132:135], a[248:251], a[20:23], v[132:135]
  ds_read_b64_tr_b16 a[210:211], v102 offset:25600
  v_mfma_f32_16x16x32_bf16 v[136:139], a[248:251], a[24:27], v[136:139]
  buffer_store_dwordx4 a[104:107], v2, s[8:11], s50 offen offset:2048 sc1
  v_mfma_f32_16x16x32_bf16 v[140:143], a[248:251], a[28:31], v[140:143]
  v_mfma_f32_16x16x32_bf16 v[144:147], a[252:255], a[16:19], v[144:147]
  ds_read_b64_tr_b16 a[212:213], v103 offset:24576
  v_mfma_f32_16x16x32_bf16 v[148:151], a[252:255], a[20:23], v[148:151]
  ds_read_b64_tr_b16 a[214:215], v103 offset:25600
  v_mfma_f32_16x16x32_bf16 v[152:155], a[252:255], a[24:27], v[152:155]
  buffer_store_dwordx4 a[108:111], v2, s[8:11], s50 offen offset:3072 sc1
  s_add_u32 s50, s50, 4096
  v_mfma_f32_16x16x32_bf16 v[156:159], a[252:255], a[28:31], v[156:159]
  s_waitcnt lgkmcnt(8)
  v_mfma_f32_16x16x32_bf16 v[160:163], a[192:195], a[16:19], v[160:163]
  s_barrier
  buffer_store_dwordx4 a[112:115], v2, s[8:11], s50 offen offset:0 sc1
  ds_read_b64_tr_b16 a[216:217], v104 offset:8192
  v_mfma_f32_16x16x32_bf16 v[164:167], a[192:195], a[20:23], v[164:167]
  ds_read_b64_tr_b16 a[218:219], v104 offset:8704
  v_mfma_f32_16x16x32_bf16 v[168:171], a[192:195], a[24:27], v[168:171]
  buffer_load_dwordx4 a[0:3], v2, s[8:11], s98 offen offset:2048 sc1
  v_mfma_f32_16x16x32_bf16 v[172:175], a[192:195], a[28:31], v[172:175]
  v_mfma_f32_16x16x32_bf16 v[176:179], a[196:199], a[16:19], v[176:179]
  ds_read_b64_tr_b16 a[220:221], v105 offset:8192
  v_mfma_f32_16x16x32_bf16 v[180:183], a[196:199], a[20:23], v[180:183]
  ds_read_b64_tr_b16 a[222:223], v105 offset:8704
  v_mfma_f32_16x16x32_bf16 v[184:187], a[196:199], a[24:27], v[184:187]
  buffer_load_dwordx4 a[4:7], v2, s[8:11], s99 offen offset:2048 sc1
  v_mfma_f32_16x16x32_bf16 v[188:191], a[196:199], a[28:31], v[188:191]
  s_waitcnt lgkmcnt(8)
  v_mfma_f32_16x16x32_bf16 v[192:195], a[200:203], a[16:19], v[192:195]
  ds_read_b64_tr_b16 a[224:225], v106 offset:8192
  v_mfma_f32_16x16x32_bf16 v[196:199], a[200:203], a[20:23], v[196:199]
  ds_read_b64_tr_b16 a[226:227], v106 offset:8704
  v_mfma_f32_16x16x32_bf16 v[200:203], a[200:203], a[24:27], v[200:203]
  buffer_load_dwordx4 a[8:11], v2, s[8:11], s100 offen offset:2048 sc1
  v_mfma_f32_16x16x32_bf16 v[204:207], a[200:203], a[28:31], v[204:207]
  v_mfma_f32_16x16x32_bf16 v[208:211], a[204:207], a[16:19], v[208:211]
  ds_read_b64_tr_b16 a[228:229], v96 offset:32768
  v_mfma_f32_16x16x32_bf16 v[212:215], a[204:207], a[20:23], v[212:215]
  ds_read_b64_tr_b16 a[230:231], v96 offset:33792
  v_mfma_f32_16x16x32_bf16 v[216:219], a[204:207], a[24:27], v[216:219]
  buffer_load_dwordx4 a[12:15], v2, s[8:11], s101 offen offset:2048 sc1
  v_mfma_f32_16x16x32_bf16 v[220:223], a[204:207], a[28:31], v[220:223]
  s_waitcnt lgkmcnt(8)
  v_mfma_f32_16x16x32_bf16 v[224:227], a[208:211], a[16:19], v[224:227]
  ds_read_b64_tr_b16 a[232:233], v97 offset:32768
  v_mfma_f32_16x16x32_bf16 v[228:231], a[208:211], a[20:23], v[228:231]
  ds_read_b64_tr_b16 a[234:235], v97 offset:33792
  v_mfma_f32_16x16x32_bf16 v[232:235], a[208:211], a[24:27], v[232:235]
  s_add_u32 m0, s48, 81920
  s_mov_b32 s41, 1572864
  v_mfma_f32_16x16x32_bf16 v[236:239], a[208:211], a[28:31], v[236:239]
  v_mfma_f32_16x16x32_bf16 v[240:243], a[212:215], a[16:19], v[240:243]
  ds_read_b64_tr_b16 a[236:237], v98 offset:32768
  v_mfma_f32_16x16x32_bf16 v[244:247], a[212:215], a[20:23], v[244:247]
  ds_read_b64_tr_b16 a[238:239], v98 offset:33792
  v_mfma_f32_16x16x32_bf16 v[248:251], a[212:215], a[24:27], v[248:251]
  buffer_load_dwordx4 v108, s[12:15], s41 offen offset:0 lds
  v_mfma_f32_16x16x32_bf16 v[252:255], a[212:215], a[28:31], v[252:255]
  s_waitcnt vmcnt(37)
  s_waitcnt lgkmcnt(8)
  v_mfma_f32_16x16x32_bf16 v[32:35], a[216:219], a[32:35], v[32:35]
  ds_read_b64_tr_b16 a[240:241], v99 offset:32768
  v_mfma_f32_16x16x32_bf16 v[36:39], a[216:219], a[36:39], v[36:39]
  ds_read_b64_tr_b16 a[242:243], v99 offset:33792
  v_mfma_f32_16x16x32_bf16 v[40:43], a[216:219], a[40:43], v[40:43]
  buffer_load_dwordx4 v109, s[12:15], s41 offen offset:1024 lds
  v_mfma_f32_16x16x32_bf16 v[44:47], a[216:219], a[44:47], v[44:47]
  v_mfma_f32_16x16x32_bf16 v[80:83], a[216:219], v[116:119], v[80:83]
  v_mfma_f32_16x16x32_bf16 v[48:51], a[220:223], a[32:35], v[48:51]
  ds_read_b64_tr_b16 a[244:245], v100 offset:32768
  v_mfma_f32_16x16x32_bf16 v[52:55], a[220:223], a[36:39], v[52:55]
  ds_read_b64_tr_b16 a[246:247], v100 offset:33792
  v_mfma_f32_16x16x32_bf16 v[56:59], a[220:223], a[40:43], v[56:59]
  buffer_load_dwordx4 v110, s[12:15], s41 offen offset:2048 lds
  v_mfma_f32_16x16x32_bf16 v[60:63], a[220:223], a[44:47], v[60:63]
  v_mfma_f32_16x16x32_bf16 v[84:87], a[220:223], v[116:119], v[84:87]
  s_waitcnt lgkmcnt(8)
  v_mfma_f32_16x16x32_bf16 v[64:67], a[224:227], a[32:35], v[64:67]
  ds_read_b64_tr_b16 a[248:249], v101 offset:32768
  v_mfma_f32_16x16x32_bf16 v[68:71], a[224:227], a[36:39], v[68:71]
  ds_read_b64_tr_b16 a[250:251], v101 offset:33792
  v_mfma_f32_16x16x32_bf16 v[72:75], a[224:227], a[40:43], v[72:75]
  buffer_load_dwordx4 v111, s[12:15], s41 offen offset:3072 lds
  v_mfma_f32_16x16x32_bf16 v[76:79], a[224:227], a[44:47], v[76:79]
  v_mfma_f32_16x16x32_bf16 v[88:91], a[224:227], v[116:119], v[88:91]
  v_mfma_f32_16x16x32_bf16 v[128:131], a[228:231], a[32:35], v[128:131]
  ds_read_b64_tr_b16 a[252:253], v102 offset:32768
  v_mfma_f32_16x16x32_bf16 v[132:135], a[228:231], a[36:39], v[132:135]
  ds_read_b64_tr_b16 a[254:255], v102 offset:33792
  v_mfma_f32_16x16x32_bf16 v[136:139], a[228:231], a[40:43], v[136:139]
  buffer_store_dwordx4 a[116:119], v2, s[8:11], s50 offen offset:1024 sc1
  v_mfma_f32_16x16x32_bf16 v[140:143], a[228:231], a[44:47], v[140:143]
  s_waitcnt lgkmcnt(8)
  v_mfma_f32_16x16x32_bf16 v[144:147], a[232:235], a[32:35], v[144:147]
  ds_read_b64_tr_b16 a[192:193], v103 offset:32768
  v_mfma_f32_16x16x32_bf16 v[148:151], a[232:235], a[36:39], v[148:151]
  ds_read_b64_tr_b16 a[194:195], v103 offset:33792
  v_mfma_f32_16x16x32_bf16 v[152:155], a[232:235], a[40:43], v[152:155]
  buffer_store_dwordx4 a[120:123], v2, s[8:11], s50 offen offset:2048 sc1
  v_mfma_f32_16x16x32_bf16 v[156:159], a[232:235], a[44:47], v[156:159]
  v_mfma_f32_16x16x32_bf16 v[160:163], a[236:239], a[32:35], v[160:163]
  ds_read_b64_tr_b16 a[196:197], v104 offset:12288
  v_mfma_f32_16x16x32_bf16 v[164:167], a[236:239], a[36:39], v[164:167]
  ds_read_b64_tr_b16 a[198:199], v104 offset:12800
  v_mfma_f32_16x16x32_bf16 v[168:171], a[236:239], a[40:43], v[168:171]
  buffer_load_dwordx4 a[16:19], v2, s[8:11], s98 offen offset:3072 sc1
  v_mfma_f32_16x16x32_bf16 v[172:175], a[236:239], a[44:47], v[172:175]
  s_waitcnt lgkmcnt(8)
  v_mfma_f32_16x16x32_bf16 v[176:179], a[240:243], a[32:35], v[176:179]
  ds_read_b64_tr_b16 a[200:201], v105 offset:12288
  v_mfma_f32_16x16x32_bf16 v[180:183], a[240:243], a[36:39], v[180:183]
  ds_read_b64_tr_b16 a[202:203], v105 offset:12800
  v_mfma_f32_16x16x32_bf16 v[184:187], a[240:243], a[40:43], v[184:187]
  buffer_load_dwordx4 a[20:23], v2, s[8:11], s99 offen offset:3072 sc1
  v_mfma_f32_16x16x32_bf16 v[188:191], a[240:243], a[44:47], v[188:191]
  v_mfma_f32_16x16x32_bf16 v[192:195], a[244:247], a[32:35], v[192:195]
  ds_read_b64_tr_b16 a[204:205], v106 offset:12288
  v_mfma_f32_16x16x32_bf16 v[196:199], a[244:247], a[36:39], v[196:199]
  ds_read_b64_tr_b16 a[206:207], v106 offset:12800
  v_mfma_f32_16x16x32_bf16 v[200:203], a[244:247], a[40:43], v[200:203]
  buffer_load_dwordx4 a[24:27], v2, s[8:11], s100 offen offset:3072 sc1
  v_mfma_f32_16x16x32_bf16 v[204:207], a[244:247], a[44:47], v[204:207]
  s_waitcnt lgkmcnt(8)
  v_mfma_f32_16x16x32_bf16 v[208:211], a[248:251], a[32:35], v[208:211]
  ds_read_b64_tr_b16 a[208:209], v96 offset:40960
  v_mfma_f32_16x16x32_bf16 v[212:215], a[248:251], a[36:39], v[212:215]
  ds_read_b64_tr_b16 a[210:211], v96 offset:41984
  v_mfma_f32_16x16x32_bf16 v[216:219], a[248:251], a[40:43], v[216:219]
  buffer_load_dwordx4 a[28:31], v2, s[8:11], s101 offen offset:3072 sc1
  v_mfma_f32_16x16x32_bf16 v[220:223], a[248:251], a[44:47], v[220:223]
  v_mfma_f32_16x16x32_bf16 v[224:227], a[252:255], a[32:35], v[224:227]
  ds_read_b64_tr_b16 a[212:213], v97 offset:40960
  v_mfma_f32_16x16x32_bf16 v[228:231], a[252:255], a[36:39], v[228:231]
  ds_read_b64_tr_b16 a[214:215], v97 offset:41984
  v_mfma_f32_16x16x32_bf16 v[232:235], a[252:255], a[40:43], v[232:235]
  buffer_store_dwordx4 a[124:127], v2, s[8:11], s50 offen offset:3072 sc1
  s_add_u32 s50, s50, 4096
  v_mfma_f32_16x16x32_bf16 v[236:239], a[252:255], a[44:47], v[236:239]
  s_waitcnt lgkmcnt(8)
  v_mfma_f32_16x16x32_bf16 v[240:243], a[192:195], a[32:35], v[240:243]
  ds_read_b64_tr_b16 a[216:217], v98 offset:40960
  v_mfma_f32_16x16x32_bf16 v[244:247], a[192:195], a[36:39], v[244:247]
  ds_read_b64_tr_b16 a[218:219], v98 offset:41984
  v_mfma_f32_16x16x32_bf16 v[248:251], a[192:195], a[40:43], v[248:251]
  buffer_store_dwordx4 a[128:131], v2, s[8:11], s50 offen offset:0 sc1
  v_mfma_f32_16x16x32_bf16 v[252:255], a[192:195], a[44:47], v[252:255]
  s_waitcnt vmcnt(44)
  v_mfma_f32_16x16x32_bf16 v[32:35], a[196:199], a[48:51], v[32:35]
  ds_read_b64_tr_b16 a[220:221], v99 offset:40960
  v_mfma_f32_16x16x32_bf16 v[36:39], a[196:199], a[52:55], v[36:39]
  ds_read_b64_tr_b16 a[222:223], v99 offset:41984
  v_mfma_f32_16x16x32_bf16 v[40:43], a[196:199], a[56:59], v[40:43]
  buffer_store_dwordx4 a[132:135], v2, s[8:11], s50 offen offset:1024 sc1
  v_mfma_f32_16x16x32_bf16 v[44:47], a[196:199], a[60:63], v[44:47]
  v_mfma_f32_16x16x32_bf16 v[80:83], a[196:199], v[116:119], v[80:83]
  s_waitcnt lgkmcnt(8)
  v_mfma_f32_16x16x32_bf16 v[48:51], a[200:203], a[48:51], v[48:51]
  ds_read_b64_tr_b16 a[224:225], v100 offset:40960
  v_mfma_f32_16x16x32_bf16 v[52:55], a[200:203], a[52:55], v[52:55]
  ds_read_b64_tr_b16 a[226:227], v100 offset:41984
  v_mfma_f32_16x16x32_bf16 v[56:59], a[200:203], a[56:59], v[56:59]
  v_mfma_f32_16x16x32_bf16 v[60:63], a[200:203], a[60:63], v[60:63]
  v_mfma_f32_16x16x32_bf16 v[84:87], a[200:203], v[116:119], v[84:87]
  v_mfma_f32_16x16x32_bf16 v[64:67], a[204:207], a[48:51], v[64:67]
  ds_read_b64_tr_b16 a[228:229], v101 offset:40960
  v_mfma_f32_16x16x32_bf16 v[68:71], a[204:207], a[52:55], v[68:71]
  ds_read_b64_tr_b16 a[230:231], v101 offset:41984
  v_mfma_f32_16x16x32_bf16 v[72:75], a[204:207], a[56:59], v[72:75]
  v_mfma_f32_16x16x32_bf16 v[76:79], a[204:207], a[60:63], v[76:79]
  v_mfma_f32_16x16x32_bf16 v[88:91], a[204:207], v[116:119], v[88:91]
  s_waitcnt lgkmcnt(8)
  v_mfma_f32_16x16x32_bf16 v[128:131], a[208:211], a[48:51], v[128:131]
  ds_read_b64_tr_b16 a[232:233], v102 offset:40960
  v_mfma_f32_16x16x32_bf16 v[132:135], a[208:211], a[52:55], v[132:135]
  ds_read_b64_tr_b16 a[234:235], v102 offset:41984
  v_mfma_f32_16x16x32_bf16 v[136:139], a[208:211], a[56:59], v[136:139]
  v_mfma_f32_16x16x32_bf16 v[140:143], a[208:211], a[60:63], v[140:143]
  v_mfma_f32_16x16x32_bf16 v[144:147], a[212:215], a[48:51], v[144:147]
  ds_read_b64_tr_b16 a[236:237], v103 offset:40960
  v_mfma_f32_16x16x32_bf16 v[148:151], a[212:215], a[52:55], v[148:151]
  ds_read_b64_tr_b16 a[238:239], v103 offset:41984
  v_mfma_f32_16x16x32_bf16 v[152:155], a[212:215], a[56:59], v[152:155]
  v_mfma_f32_16x16x32_bf16 v[156:159], a[212:215], a[60:63], v[156:159]
  s_waitcnt lgkmcnt(8)
  v_mfma_f32_16x16x32_bf16 v[160:163], a[216:219], a[48:51], v[160:163]
  s_waitcnt vmcnt(26)
  s_barrier
  ds_read_b64_tr_b16 a[240:241], v104 offset:49152
  v_mfma_f32_16x16x32_bf16 v[164:167], a[216:219], a[52:55], v[164:167]
  ds_read_b64_tr_b16 a[242:243], v104 offset:49664
  v_mfma_f32_16x16x32_bf16 v[168:171], a[216:219], a[56:59], v[168:171]
  s_add_u32 s98, s51, 8192
  buffer_load_dwordx4 a[32:35], v2, s[8:11], s98 offen offset:0 sc1
  v_mfma_f32_16x16x32_bf16 v[172:175], a[216:219], a[60:63], v[172:175]
  v_mfma_f32_16x16x32_bf16 v[176:179], a[220:223], a[48:51], v[176:179]
  ds_read_b64_tr_b16 a[244:245], v105 offset:49152
  v_mfma_f32_16x16x32_bf16 v[180:183], a[220:223], a[52:55], v[180:183]
  ds_read_b64_tr_b16 a[246:247], v105 offset:49664
  v_mfma_f32_16x16x32_bf16 v[184:187], a[220:223], a[56:59], v[184:187]
  s_add_u32 s99, s51, 24576
  buffer_load_dwordx4 a[36:39], v2, s[8:11], s99 offen offset:0 sc1
  v_mfma_f32_16x16x32_bf16 v[188:191], a[220:223], a[60:63], v[188:191]
  s_waitcnt lgkmcnt(8)
  v_mfma_f32_16x16x32_bf16 v[192:195], a[224:227], a[48:51], v[192:195]
  ds_read_b64_tr_b16 a[248:249], v106 offset:49152
  v_mfma_f32_16x16x32_bf16 v[196:199], a[224:227], a[52:55], v[196:199]
  ds_read_b64_tr_b16 a[250:251], v106 offset:49664
  v_mfma_f32_16x16x32_bf16 v[200:203], a[224:227], a[56:59], v[200:203]
  s_add_u32 s100, s52, 8192
  buffer_load_dwordx4 a[40:43], v2, s[8:11], s100 offen offset:0 sc1
  v_mfma_f32_16x16x32_bf16 v[204:207], a[224:227], a[60:63], v[204:207]
  v_mfma_f32_16x16x32_bf16 v[208:211], a[228:231], a[48:51], v[208:211]
  v_add_u32 v96, 0x10000, v96
  v_add_u32 v97, 0x10000, v97
  v_add_u32 v98, 0x10000, v98
  v_add_u32 v99, 0x10000, v99
  v_add_u32 v100, 0x10000, v100
  v_add_u32 v101, 0x10000, v101
  v_add_u32 v102, 0x10000, v102
  v_add_u32 v103, 0x10000, v103
  ds_read_b64_tr_b16 a[252:253], v96 offset:0
  v_mfma_f32_16x16x32_bf16 v[212:215], a[228:231], a[52:55], v[212:215]
  ds_read_b64_tr_b16 a[254:255], v96 offset:1024
  v_mfma_f32_16x16x32_bf16 v[216:219], a[228:231], a[56:59], v[216:219]
  s_add_u32 s101, s52, 24576
  buffer_load_dwordx4 a[44:47], v2, s[8:11], s101 offen offset:0 sc1
  v_mfma_f32_16x16x32_bf16 v[220:223], a[228:231], a[60:63], v[220:223]
  s_waitcnt lgkmcnt(8)
  v_mfma_f32_16x16x32_bf16 v[224:227], a[232:235], a[48:51], v[224:227]
  ds_read_b64_tr_b16 a[192:193], v97 offset:0
  v_mfma_f32_16x16x32_bf16 v[228:231], a[232:235], a[52:55], v[228:231]
  ds_read_b64_tr_b16 a[194:195], v97 offset:1024
  v_mfma_f32_16x16x32_bf16 v[232:235], a[232:235], a[56:59], v[232:235]
  s_add_u32 m0, s48, 98304
  s_mov_b32 s41, 704512
  v_mfma_f32_16x16x32_bf16 v[236:239], a[232:235], a[60:63], v[236:239]
  v_mfma_f32_16x16x32_bf16 v[240:243], a[236:239], a[48:51], v[240:243]
  ds_read_b64_tr_b16 a[196:197], v98 offset:0
  v_mfma_f32_16x16x32_bf16 v[244:247], a[236:239], a[52:55], v[244:247]
  ds_read_b64_tr_b16 a[198:199], v98 offset:1024
  v_mfma_f32_16x16x32_bf16 v[248:251], a[236:239], a[56:59], v[248:251]
  buffer_load_dwordx4 v112, s[16:19], s41 offen offset:0 lds
  v_mfma_f32_16x16x32_bf16 v[252:255], a[236:239], a[60:63], v[252:255]
  s_waitcnt lgkmcnt(8)
  v_mfma_f32_16x16x32_bf16 v[32:35], a[240:243], a[64:67], v[32:35]
  ds_read_b64_tr_b16 a[200:201], v99 offset:0
  v_mfma_f32_16x16x32_bf16 v[36:39], a[240:243], a[68:71], v[36:39]
  ds_read_b64_tr_b16 a[202:203], v99 offset:1024
  v_mfma_f32_16x16x32_bf16 v[40:43], a[240:243], a[72:75], v[40:43]
  buffer_load_dwordx4 v113, s[16:19], s41 offen offset:1024 lds
  v_mfma_f32_16x16x32_bf16 v[44:47], a[240:243], a[76:79], v[44:47]
  v_mfma_f32_16x16x32_bf16 v[80:83], a[240:243], v[116:119], v[80:83]
  v_mfma_f32_16x16x32_bf16 v[48:51], a[244:247], a[64:67], v[48:51]
  ds_read_b64_tr_b16 a[204:205], v100 offset:0
  v_mfma_f32_16x16x32_bf16 v[52:55], a[244:247], a[68:71], v[52:55]
  ds_read_b64_tr_b16 a[206:207], v100 offset:1024
  v_mfma_f32_16x16x32_bf16 v[56:59], a[244:247], a[72:75], v[56:59]
  buffer_load_dwordx4 v114, s[16:19], s41 offen offset:2048 lds
  v_mfma_f32_16x16x32_bf16 v[60:63], a[244:247], a[76:79], v[60:63]
  v_mfma_f32_16x16x32_bf16 v[84:87], a[244:247], v[116:119], v[84:87]
  s_waitcnt lgkmcnt(8)
  v_mfma_f32_16x16x32_bf16 v[64:67], a[248:251], a[64:67], v[64:67]
  ds_read_b64_tr_b16 a[208:209], v101 offset:0
  v_mfma_f32_16x16x32_bf16 v[68:71], a[248:251], a[68:71], v[68:71]
  ds_read_b64_tr_b16 a[210:211], v101 offset:1024
  v_mfma_f32_16x16x32_bf16 v[72:75], a[248:251], a[72:75], v[72:75]
  buffer_load_dwordx4 v115, s[16:19], s41 offen offset:3072 lds
  v_mfma_f32_16x16x32_bf16 v[76:79], a[248:251], a[76:79], v[76:79]
  v_mfma_f32_16x16x32_bf16 v[88:91], a[248:251], v[116:119], v[88:91]
  v_mfma_f32_16x16x32_bf16 v[128:131], a[252:255], a[64:67], v[128:131]
  ds_read_b64_tr_b16 a[212:213], v102 offset:0
  v_mfma_f32_16x16x32_bf16 v[132:135], a[252:255], a[68:71], v[132:135]
  ds_read_b64_tr_b16 a[214:215], v102 offset:1024
  v_mfma_f32_16x16x32_bf16 v[136:139], a[252:255], a[72:75], v[136:139]
  s_add_u32 m0, s48, 114688
  s_mov_b32 s41, 2097152
  v_mfma_f32_16x16x32_bf16 v[140:143], a[252:255], a[76:79], v[140:143]
  s_waitcnt lgkmcnt(8)
  v_mfma_f32_16x16x32_bf16 v[144:147], a[192:195], a[64:67], v[144:147]
  ds_read_b64_tr_b16 a[216:217], v103 offset:0
  v_mfma_f32_16x16x32_bf16 v[148:151], a[192:195], a[68:71], v[148:151]
  ds_read_b64_tr_b16 a[218:219], v103 offset:1024
  v_mfma_f32_16x16x32_bf16 v[152:155], a[192:195], a[72:75], v[152:155]
  buffer_load_dwordx4 v108, s[12:15], s41 offen offset:0 lds
  v_mfma_f32_16x16x32_bf16 v[156:159], a[192:195], a[76:79], v[156:159]
  v_mfma_f32_16x16x32_bf16 v[160:163], a[196:199], a[64:67], v[160:163]
  ds_read_b64_tr_b16 a[220:221], v104 offset:53248
  v_mfma_f32_16x16x32_bf16 v[164:167], a[196:199], a[68:71], v[164:167]
  ds_read_b64_tr_b16 a[222:223], v104 offset:53760
  v_mfma_f32_16x16x32_bf16 v[168:171], a[196:199], a[72:75], v[168:171]
  buffer_load_dwordx4 v109, s[12:15], s41 offen offset:1024 lds
  v_mfma_f32_16x16x32_bf16 v[172:175], a[196:199], a[76:79], v[172:175]
  s_waitcnt lgkmcnt(8)
  v_mfma_f32_16x16x32_bf16 v[176:179], a[200:203], a[64:67], v[176:179]
  ds_read_b64_tr_b16 a[224:225], v105 offset:53248
  v_mfma_f32_16x16x32_bf16 v[180:183], a[200:203], a[68:71], v[180:183]
  ds_read_b64_tr_b16 a[226:227], v105 offset:53760
  v_mfma_f32_16x16x32_bf16 v[184:187], a[200:203], a[72:75], v[184:187]
  buffer_load_dwordx4 v110, s[12:15], s41 offen offset:2048 lds
  v_mfma_f32_16x16x32_bf16 v[188:191], a[200:203], a[76:79], v[188:191]
  v_mfma_f32_16x16x32_bf16 v[192:195], a[204:207], a[64:67], v[192:195]
  ds_read_b64_tr_b16 a[228:229], v106 offset:53248
  v_mfma_f32_16x16x32_bf16 v[196:199], a[204:207], a[68:71], v[196:199]
  ds_read_b64_tr_b16 a[230:231], v106 offset:53760
  v_mfma_f32_16x16x32_bf16 v[200:203], a[204:207], a[72:75], v[200:203]
  buffer_load_dwordx4 v111, s[12:15], s41 offen offset:3072 lds
  v_mfma_f32_16x16x32_bf16 v[204:207], a[204:207], a[76:79], v[204:207]
  s_waitcnt lgkmcnt(8)
  v_mfma_f32_16x16x32_bf16 v[208:211], a[208:211], a[64:67], v[208:211]
  ds_read_b64_tr_b16 a[232:233], v96 offset:8192
  v_mfma_f32_16x16x32_bf16 v[212:215], a[208:211], a[68:71], v[212:215]
  ds_read_b64_tr_b16 a[234:235], v96 offset:9216
  v_mfma_f32_16x16x32_bf16 v[216:219], a[208:211], a[72:75], v[216:219]
  buffer_store_dwordx4 a[136:139], v2, s[8:11], s50 offen offset:2048 sc1
  v_mfma_f32_16x16x32_bf16 v[220:223], a[208:211], a[76:79], v[220:223]
  v_mfma_f32_16x16x32_bf16 v[224:227], a[212:215], a[64:67], v[224:227]
  ds_read_b64_tr_b16 a[236:237], v97 offset:8192
  v_mfma_f32_16x16x32_bf16 v[228:231], a[212:215], a[68:71], v[228:231]
  ds_read_b64_tr_b16 a[238:239], v97 offset:9216
  v_mfma_f32_16x16x32_bf16 v[232:235], a[212:215], a[72:75], v[232:235]
  buffer_store_dwordx4 a[140:143], v2, s[8:11], s50 offen offset:3072 sc1
  s_add_u32 s50, s50, 4096
  v_mfma_f32_16x16x32_bf16 v[236:239], a[212:215], a[76:79], v[236:239]
  s_waitcnt lgkmcnt(8)
  v_mfma_f32_16x16x32_bf16 v[240:243], a[216:219], a[64:67], v[240:243]
  ds_read_b64_tr_b16 a[240:241], v98 offset:8192
  v_mfma_f32_16x16x32_bf16 v[244:247], a[216:219], a[68:71], v[244:247]
  ds_read_b64_tr_b16 a[242:243], v98 offset:9216
  v_mfma_f32_16x16x32_bf16 v[248:251], a[216:219], a[72:75], v[248:251]
  buffer_load_dwordx4 a[48:51], v2, s[8:11], s98 offen offset:1024 sc1
  v_mfma_f32_16x16x32_bf16 v[252:255], a[216:219], a[76:79], v[252:255]
  s_waitcnt vmcnt(35)
  v_mfma_f32_16x16x32_bf16 v[32:35], a[220:223], a[80:83], v[32:35]
  ds_read_b64_tr_b16 a[244:245], v99 offset:8192
  v_mfma_f32_16x16x32_bf16 v[36:39], a[220:223], a[84:87], v[36:39]
  ds_read_b64_tr_b16 a[246:247], v99 offset:9216
  v_mfma_f32_16x16x32_bf16 v[40:43], a[220:223], a[88:91], v[40:43]
  buffer_load_dwordx4 a[52:55], v2, s[8:11], s99 offen offset:1024 sc1
  v_mfma_f32_16x16x32_bf16 v[44:47], a[220:223], a[92:95], v[44:47]
  v_mfma_f32_16x16x32_bf16 v[80:83], a[220:223], v[116:119], v[80:83]
  s_waitcnt lgkmcnt(8)
  v_mfma_f32_16x16x32_bf16 v[48:51], a[224:227], a[80:83], v[48:51]
  ds_read_b64_tr_b16 a[248:249], v100 offset:8192
  v_mfma_f32_16x16x32_bf16 v[52:55], a[224:227], a[84:87], v[52:55]
  ds_read_b64_tr_b16 a[250:251], v100 offset:9216
  v_mfma_f32_16x16x32_bf16 v[56:59], a[224:227], a[88:91], v[56:59]
  buffer_load_dwordx4 a[56:59], v2, s[8:11], s100 offen offset:1024 sc1
  v_mfma_f32_16x16x32_bf16 v[60:63], a[224:227], a[92:95], v[60:63]
  v_mfma_f32_16x16x32_bf16 v[84:87], a[224:227], v[116:119], v[84:87]
  v_mfma_f32_16x16x32_bf16 v[64:67], a[228:231], a[80:83], v[64:67]
  ds_read_b64_tr_b16 a[252:253], v101 offset:8192
  v_mfma_f32_16x16x32_bf16 v[68:71], a[228:231], a[84:87], v[68:71]
  ds_read_b64_tr_b16 a[254:255], v101 offset:9216
  v_mfma_f32_16x16x32_bf16 v[72:75], a[228:231], a[88:91], v[72:75]
  buffer_load_dwordx4 a[60:63], v2, s[8:11], s101 offen offset:1024 sc1
  v_mfma_f32_16x16x32_bf16 v[76:79], a[228:231], a[92:95], v[76:79]
  v_mfma_f32_16x16x32_bf16 v[88:91], a[228:231], v[116:119], v[88:91]
  s_waitcnt lgkmcnt(8)
  v_mfma_f32_16x16x32_bf16 v[128:131], a[232:235], a[80:83], v[128:131]
  ds_read_b64_tr_b16 a[192:193], v102 offset:8192
  v_mfma_f32_16x16x32_bf16 v[132:135], a[232:235], a[84:87], v[132:135]
  ds_read_b64_tr_b16 a[194:195], v102 offset:9216
  v_mfma_f32_16x16x32_bf16 v[136:139], a[232:235], a[88:91], v[136:139]
  buffer_store_dwordx4 a[144:147], v2, s[8:11], s50 offen offset:0 sc1
  v_mfma_f32_16x16x32_bf16 v[140:143], a[232:235], a[92:95], v[140:143]
  v_mfma_f32_16x16x32_bf16 v[144:147], a[236:239], a[80:83], v[144:147]
  ds_read_b64_tr_b16 a[196:197], v103 offset:8192
  v_mfma_f32_16x16x32_bf16 v[148:151], a[236:239], a[84:87], v[148:151]
  ds_read_b64_tr_b16 a[198:199], v103 offset:9216
  v_mfma_f32_16x16x32_bf16 v[152:155], a[236:239], a[88:91], v[152:155]
  buffer_store_dwordx4 a[148:151], v2, s[8:11], s50 offen offset:1024 sc1
  v_mfma_f32_16x16x32_bf16 v[156:159], a[236:239], a[92:95], v[156:159]
  s_waitcnt lgkmcnt(8)
  v_mfma_f32_16x16x32_bf16 v[160:163], a[240:243], a[80:83], v[160:163]
  s_waitcnt vmcnt(29)
  s_barrier
  buffer_store_dwordx4 a[152:155], v2, s[8:11], s50 offen offset:2048 sc1
  ds_read_b64_tr_b16 a[200:201], v104 offset:57344
  v_mfma_f32_16x16x32_bf16 v[164:167], a[240:243], a[84:87], v[164:167]
  ds_read_b64_tr_b16 a[202:203], v104 offset:57856
  v_mfma_f32_16x16x32_bf16 v[168:171], a[240:243], a[88:91], v[168:171]
  buffer_load_dwordx4 a[64:67], v2, s[8:11], s98 offen offset:2048 sc1
  v_mfma_f32_16x16x32_bf16 v[172:175], a[240:243], a[92:95], v[172:175]
  v_mfma_f32_16x16x32_bf16 v[176:179], a[244:247], a[80:83], v[176:179]
  ds_read_b64_tr_b16 a[204:205], v105 offset:57344
  v_mfma_f32_16x16x32_bf16 v[180:183], a[244:247], a[84:87], v[180:183]
  ds_read_b64_tr_b16 a[206:207], v105 offset:57856
  v_mfma_f32_16x16x32_bf16 v[184:187], a[244:247], a[88:91], v[184:187]
  buffer_load_dwordx4 a[68:71], v2, s[8:11], s99 offen offset:2048 sc1
  v_mfma_f32_16x16x32_bf16 v[188:191], a[244:247], a[92:95], v[188:191]
  s_waitcnt lgkmcnt(8)
  v_mfma_f32_16x16x32_bf16 v[192:195], a[248:251], a[80:83], v[192:195]
  ds_read_b64_tr_b16 a[208:209], v106 offset:57344
  v_mfma_f32_16x16x32_bf16 v[196:199], a[248:251], a[84:87], v[196:199]
  ds_read_b64_tr_b16 a[210:211], v106 offset:57856
  v_mfma_f32_16x16x32_bf16 v[200:203], a[248:251], a[88:91], v[200:203]
  buffer_load_dwordx4 a[72:75], v2, s[8:11], s100 offen offset:2048 sc1
  v_mfma_f32_16x16x32_bf16 v[204:207], a[248:251], a[92:95], v[204:207]
  v_mfma_f32_16x16x32_bf16 v[208:211], a[252:255], a[80:83], v[208:211]
  ds_read_b64_tr_b16 a[212:213], v96 offset:16384
  v_mfma_f32_16x16x32_bf16 v[212:215], a[252:255], a[84:87], v[212:215]
  ds_read_b64_tr_b16 a[214:215], v96 offset:17408
  v_mfma_f32_16x16x32_bf16 v[216:219], a[252:255], a[88:91], v[216:219]
  buffer_load_dwordx4 a[76:79], v2, s[8:11], s101 offen offset:2048 sc1
  v_mfma_f32_16x16x32_bf16 v[220:223], a[252:255], a[92:95], v[220:223]
  s_waitcnt lgkmcnt(8)
  v_mfma_f32_16x16x32_bf16 v[224:227], a[192:195], a[80:83], v[224:227]
  ds_read_b64_tr_b16 a[216:217], v97 offset:16384
  v_mfma_f32_16x16x32_bf16 v[228:231], a[192:195], a[84:87], v[228:231]
  ds_read_b64_tr_b16 a[218:219], v97 offset:17408
  v_mfma_f32_16x16x32_bf16 v[232:235], a[192:195], a[88:91], v[232:235]
  s_add_u32 m0, s48, 131072
  s_mov_b32 s41, 2621440
  v_mfma_f32_16x16x32_bf16 v[236:239], a[192:195], a[92:95], v[236:239]
  v_mfma_f32_16x16x32_bf16 v[240:243], a[196:199], a[80:83], v[240:243]
  ds_read_b64_tr_b16 a[220:221], v98 offset:16384
  v_mfma_f32_16x16x32_bf16 v[244:247], a[196:199], a[84:87], v[244:247]
  ds_read_b64_tr_b16 a[222:223], v98 offset:17408
  v_mfma_f32_16x16x32_bf16 v[248:251], a[196:199], a[88:91], v[248:251]
  buffer_load_dwordx4 v108, s[12:15], s41 offen offset:0 lds
  v_mfma_f32_16x16x32_bf16 v[252:255], a[196:199], a[92:95], v[252:255]
  s_waitcnt lgkmcnt(8)
  v_mfma_f32_16x16x32_bf16 v[32:35], a[200:203], a[0:3], v[32:35]
  ds_read_b64_tr_b16 a[224:225], v99 offset:16384
  v_mfma_f32_16x16x32_bf16 v[36:39], a[200:203], a[4:7], v[36:39]
  ds_read_b64_tr_b16 a[226:227], v99 offset:17408
  v_mfma_f32_16x16x32_bf16 v[40:43], a[200:203], a[8:11], v[40:43]
  buffer_load_dwordx4 v109, s[12:15], s41 offen offset:1024 lds
  v_mfma_f32_16x16x32_bf16 v[44:47], a[200:203], a[12:15], v[44:47]
  v_mfma_f32_16x16x32_bf16 v[80:83], a[200:203], v[116:119], v[80:83]
  v_mfma_f32_16x16x32_bf16 v[48:51], a[204:207], a[0:3], v[48:51]
  ds_read_b64_tr_b16 a[228:229], v100 offset:16384
  v_mfma_f32_16x16x32_bf16 v[52:55], a[204:207], a[4:7], v[52:55]
  ds_read_b64_tr_b16 a[230:231], v100 offset:17408
  v_mfma_f32_16x16x32_bf16 v[56:59], a[204:207], a[8:11], v[56:59]
  buffer_load_dwordx4 v110, s[12:15], s41 offen offset:2048 lds
  v_mfma_f32_16x16x32_bf16 v[60:63], a[204:207], a[12:15], v[60:63]
  v_mfma_f32_16x16x32_bf16 v[84:87], a[204:207], v[116:119], v[84:87]
  s_waitcnt lgkmcnt(8)
  v_mfma_f32_16x16x32_bf16 v[64:67], a[208:211], a[0:3], v[64:67]
  ds_read_b64_tr_b16 a[232:233], v101 offset:16384
  v_mfma_f32_16x16x32_bf16 v[68:71], a[208:211], a[4:7], v[68:71]
  ds_read_b64_tr_b16 a[234:235], v101 offset:17408
  v_mfma_f32_16x16x32_bf16 v[72:75], a[208:211], a[8:11], v[72:75]
  buffer_load_dwordx4 v111, s[12:15], s41 offen offset:3072 lds
  v_mfma_f32_16x16x32_bf16 v[76:79], a[208:211], a[12:15], v[76:79]
  v_mfma_f32_16x16x32_bf16 v[88:91], a[208:211], v[116:119], v[88:91]
  v_mfma_f32_16x16x32_bf16 v[128:131], a[212:215], a[0:3], v[128:131]
  ds_read_b64_tr_b16 a[236:237], v102 offset:16384
  v_mfma_f32_16x16x32_bf16 v[132:135], a[212:215], a[4:7], v[132:135]
  ds_read_b64_tr_b16 a[238:239], v102 offset:17408
  v_mfma_f32_16x16x32_bf16 v[136:139], a[212:215], a[8:11], v[136:139]
  buffer_store_dwordx4 a[156:159], v2, s[8:11], s50 offen offset:3072 sc1
  s_add_u32 s50, s50, 4096
  v_mfma_f32_16x16x32_bf16 v[140:143], a[212:215], a[12:15], v[140:143]
  s_waitcnt lgkmcnt(8)
  v_mfma_f32_16x16x32_bf16 v[144:147], a[216:219], a[0:3], v[144:147]
  ds_read_b64_tr_b16 a[240:241], v103 offset:16384
  v_mfma_f32_16x16x32_bf16 v[148:151], a[216:219], a[4:7], v[148:151]
  ds_read_b64_tr_b16 a[242:243], v103 offset:17408
  v_mfma_f32_16x16x32_bf16 v[152:155], a[216:219], a[8:11], v[152:155]
  buffer_store_dwordx4 a[160:163], v2, s[8:11], s50 offen offset:0 sc1
  v_mfma_f32_16x16x32_bf16 v[156:159], a[216:219], a[12:15], v[156:159]
  v_mfma_f32_16x16x32_bf16 v[160:163], a[220:223], a[0:3], v[160:163]
  ds_read_b64_tr_b16 a[244:245], v104 offset:61440
  v_mfma_f32_16x16x32_bf16 v[164:167], a[220:223], a[4:7], v[164:167]
  ds_read_b64_tr_b16 a[246:247], v104 offset:61952
  v_mfma_f32_16x16x32_bf16 v[168:171], a[220:223], a[8:11], v[168:171]
  buffer_load_dwordx4 a[80:83], v2, s[8:11], s98 offen offset:3072 sc1
  v_mfma_f32_16x16x32_bf16 v[172:175], a[220:223], a[12:15], v[172:175]
  s_waitcnt lgkmcnt(8)
  v_mfma_f32_16x16x32_bf16 v[176:179], a[224:227], a[0:3], v[176:179]
  ds_read_b64_tr_b16 a[248:249], v105 offset:61440
  v_mfma_f32_16x16x32_bf16 v[180:183], a[224:227], a[4:7], v[180:183]
  ds_read_b64_tr_b16 a[250:251], v105 offset:61952
  v_mfma_f32_16x16x32_bf16 v[184:187], a[224:227], a[8:11], v[184:187]
  buffer_load_dwordx4 a[84:87], v2, s[8:11], s99 offen offset:3072 sc1
  v_mfma_f32_16x16x32_bf16 v[188:191], a[224:227], a[12:15], v[188:191]
  v_mfma_f32_16x16x32_bf16 v[192:195], a[228:231], a[0:3], v[192:195]
  ds_read_b64_tr_b16 a[252:253], v106 offset:61440
  v_mfma_f32_16x16x32_bf16 v[196:199], a[228:231], a[4:7], v[196:199]
  ds_read_b64_tr_b16 a[254:255], v106 offset:61952
  v_mfma_f32_16x16x32_bf16 v[200:203], a[228:231], a[8:11], v[200:203]
  buffer_load_dwordx4 a[88:91], v2, s[8:11], s100 offen offset:3072 sc1
  v_mfma_f32_16x16x32_bf16 v[204:207], a[228:231], a[12:15], v[204:207]
  s_waitcnt lgkmcnt(8)
  v_mfma_f32_16x16x32_bf16 v[208:211], a[232:235], a[0:3], v[208:211]
  ds_read_b64_tr_b16 a[192:193], v96 offset:24576
  v_mfma_f32_16x16x32_bf16 v[212:215], a[232:235], a[4:7], v[212:215]
  ds_read_b64_tr_b16 a[194:195], v96 offset:25600
  v_mfma_f32_16x16x32_bf16 v[216:219], a[232:235], a[8:11], v[216:219]
  buffer_load_dwordx4 a[92:95], v2, s[8:11], s101 offen offset:3072 sc1
  v_mfma_f32_16x16x32_bf16 v[220:223], a[232:235], a[12:15], v[220:223]
  v_mfma_f32_16x16x32_bf16 v[224:227], a[236:239], a[0:3], v[224:227]
  ds_read_b64_tr_b16 a[196:197], v97 offset:24576
  v_mfma_f32_16x16x32_bf16 v[228:231], a[236:239], a[4:7], v[228:231]
  ds_read_b64_tr_b16 a[198:199], v97 offset:25600
  v_mfma_f32_16x16x32_bf16 v[232:235], a[236:239], a[8:11], v[232:235]
  buffer_store_dwordx4 a[164:167], v2, s[8:11], s50 offen offset:1024 sc1
  v_mfma_f32_16x16x32_bf16 v[236:239], a[236:239], a[12:15], v[236:239]
  s_waitcnt lgkmcnt(8)
  v_mfma_f32_16x16x32_bf16 v[240:243], a[240:243], a[0:3], v[240:243]
  ds_read_b64_tr_b16 a[200:201], v98 offset:24576
  v_mfma_f32_16x16x32_bf16 v[244:247], a[240:243], a[4:7], v[244:247]
  ds_read_b64_tr_b16 a[202:203], v98 offset:25600
  v_mfma_f32_16x16x32_bf16 v[248:251], a[240:243], a[8:11], v[248:251]
  buffer_store_dwordx4 a[168:171], v2, s[8:11], s50 offen offset:2048 sc1
  v_mfma_f32_16x16x32_bf16 v[252:255], a[240:243], a[12:15], v[252:255]
  s_waitcnt vmcnt(40)
  v_mfma_f32_16x16x32_bf16 v[32:35], a[244:247], a[16:19], v[32:35]
  ds_read_b64_tr_b16 a[204:205], v99 offset:24576
  v_mfma_f32_16x16x32_bf16 v[36:39], a[244:247], a[20:23], v[36:39]
  ds_read_b64_tr_b16 a[206:207], v99 offset:25600
  v_mfma_f32_16x16x32_bf16 v[40:43], a[244:247], a[24:27], v[40:43]
  buffer_store_dwordx4 a[172:175], v2, s[8:11], s50 offen offset:3072 sc1
  s_add_u32 s50, s50, 4096
  v_mfma_f32_16x16x32_bf16 v[44:47], a[244:247], a[28:31], v[44:47]
  v_mfma_f32_16x16x32_bf16 v[80:83], a[244:247], v[116:119], v[80:83]
  s_waitcnt lgkmcnt(8)
  v_mfma_f32_16x16x32_bf16 v[48:51], a[248:251], a[16:19], v[48:51]
  ds_read_b64_tr_b16 a[208:209], v100 offset:24576
  v_mfma_f32_16x16x32_bf16 v[52:55], a[248:251], a[20:23], v[52:55]
  ds_read_b64_tr_b16 a[210:211], v100 offset:25600
  v_mfma_f32_16x16x32_bf16 v[56:59], a[248:251], a[24:27], v[56:59]
  v_mfma_f32_16x16x32_bf16 v[60:63], a[248:251], a[28:31], v[60:63]
  v_mfma_f32_16x16x32_bf16 v[84:87], a[248:251], v[116:119], v[84:87]
  v_mfma_f32_16x16x32_bf16 v[64:67], a[252:255], a[16:19], v[64:67]
  ds_read_b64_tr_b16 a[212:213], v101 offset:24576
  v_mfma_f32_16x16x32_bf16 v[68:71], a[252:255], a[20:23], v[68:71]
  ds_read_b64_tr_b16 a[214:215], v101 offset:25600
  v_mfma_f32_16x16x32_bf16 v[72:75], a[252:255], a[24:27], v[72:75]
  v_mfma_f32_16x16x32_bf16 v[76:79], a[252:255], a[28:31], v[76:79]
  v_mfma_f32_16x16x32_bf16 v[88:91], a[252:255], v[116:119], v[88:91]
  s_waitcnt lgkmcnt(8)
  v_mfma_f32_16x16x32_bf16 v[128:131], a[192:195], a[16:19], v[128:131]
  ds_read_b64_tr_b16 a[216:217], v102 offset:24576
  v_mfma_f32_16x16x32_bf16 v[132:135], a[192:195], a[20:23], v[132:135]
  ds_read_b64_tr_b16 a[218:219], v102 offset:25600
  v_mfma_f32_16x16x32_bf16 v[136:139], a[192:195], a[24:27], v[136:139]
  v_mfma_f32_16x16x32_bf16 v[140:143], a[192:195], a[28:31], v[140:143]
  v_mfma_f32_16x16x32_bf16 v[144:147], a[196:199], a[16:19], v[144:147]
  ds_read_b64_tr_b16 a[220:221], v103 offset:24576
  v_mfma_f32_16x16x32_bf16 v[148:151], a[196:199], a[20:23], v[148:151]
  ds_read_b64_tr_b16 a[222:223], v103 offset:25600
  v_mfma_f32_16x16x32_bf16 v[152:155], a[196:199], a[24:27], v[152:155]
  v_mfma_f32_16x16x32_bf16 v[156:159], a[196:199], a[28:31], v[156:159]
  s_waitcnt lgkmcnt(8)
  v_mfma_f32_16x16x32_bf16 v[160:163], a[200:203], a[16:19], v[160:163]
  s_waitcnt vmcnt(26)
  s_barrier
  v_add_u32 v104, 0x10000, v104
  v_add_u32 v105, 0x10000, v105
  v_add_u32 v106, 0x10000, v106
  ds_read_b64_tr_b16 a[224:225], v104 offset:32768
  v_mfma_f32_16x16x32_bf16 v[164:167], a[200:203], a[20:23], v[164:167]
  ds_read_b64_tr_b16 a[226:227], v104 offset:33280
  v_mfma_f32_16x16x32_bf16 v[168:171], a[200:203], a[24:27], v[168:171]
  s_add_u32 s98, s51, 12288
  buffer_load_dwordx4 a[0:3], v2, s[8:11], s98 offen offset:0 sc1
  v_mfma_f32_16x16x32_bf16 v[172:175], a[200:203], a[28:31], v[172:175]
  v_mfma_f32_16x16x32_bf16 v[176:179], a[204:207], a[16:19], v[176:179]
  ds_read_b64_tr_b16 a[228:229], v105 offset:32768
  v_mfma_f32_16x16x32_bf16 v[180:183], a[204:207], a[20:23], v[180:183]
  ds_read_b64_tr_b16 a[230:231], v105 offset:33280
  v_mfma_f32_16x16x32_bf16 v[184:187], a[204:207], a[24:27], v[184:187]
  s_add_u32 s99, s51, 28672
  buffer_load_dwordx4 a[4:7], v2, s[8:11], s99 offen offset:0 sc1
  v_mfma_f32_16x16x32_bf16 v[188:191], a[204:207], a[28:31], v[188:191]
  s_waitcnt lgkmcnt(8)
  v_mfma_f32_16x16x32_bf16 v[192:195], a[208:211], a[16:19], v[192:195]
  ds_read_b64_tr_b16 a[232:233], v106 offset:32768
  v_mfma_f32_16x16x32_bf16 v[196:199], a[208:211], a[20:23], v[196:199]
  ds_read_b64_tr_b16 a[234:235], v106 offset:33280
  v_mfma_f32_16x16x32_bf16 v[200:203], a[208:211], a[24:27], v[200:203]
  s_add_u32 s100, s52, 12288
  buffer_load_dwordx4 a[8:11], v2, s[8:11], s100 offen offset:0 sc1
  v_mfma_f32_16x16x32_bf16 v[204:207], a[208:211], a[28:31], v[204:207]
  v_mfma_f32_16x16x32_bf16 v[208:211], a[212:215], a[16:19], v[208:211]
  ds_read_b64_tr_b16 a[236:237], v96 offset:49152
  v_mfma_f32_16x16x32_bf16 v[212:215], a[212:215], a[20:23], v[212:215]
  ds_read_b64_tr_b16 a[238:239], v96 offset:50176
  v_mfma_f32_16x16x32_bf16 v[216:219], a[212:215], a[24:27], v[216:219]
  s_add_u32 s101, s52, 28672
  buffer_load_dwordx4 a[12:15], v2, s[8:11], s101 offen offset:0 sc1
  v_mfma_f32_16x16x32_bf16 v[220:223], a[212:215], a[28:31], v[220:223]
  s_waitcnt lgkmcnt(8)
  v_mfma_f32_16x16x32_bf16 v[224:227], a[216:219], a[16:19], v[224:227]
  ds_read_b64_tr_b16 a[240:241], v97 offset:49152
  v_mfma_f32_16x16x32_bf16 v[228:231], a[216:219], a[20:23], v[228:231]
  ds_read_b64_tr_b16 a[242:243], v97 offset:50176
  v_mfma_f32_16x16x32_bf16 v[232:235], a[216:219], a[24:27], v[232:235]
  s_add_u32 m0, s48, 147456
  s_mov_b32 s41, 1056768
  v_mfma_f32_16x16x32_bf16 v[236:239], a[216:219], a[28:31], v[236:239]
  v_mfma_f32_16x16x32_bf16 v[240:243], a[220:223], a[16:19], v[240:243]
  ds_read_b64_tr_b16 a[244:245], v98 offset:49152
  v_mfma_f32_16x16x32_bf16 v[244:247], a[220:223], a[20:23], v[244:247]
  ds_read_b64_tr_b16 a[246:247], v98 offset:50176
  v_mfma_f32_16x16x32_bf16 v[248:251], a[220:223], a[24:27], v[248:251]
  buffer_load_dwordx4 v112, s[16:19], s41 offen offset:0 lds
  v_mfma_f32_16x16x32_bf16 v[252:255], a[220:223], a[28:31], v[252:255]
  s_waitcnt lgkmcnt(8)
  v_mfma_f32_16x16x32_bf16 v[32:35], a[224:227], a[32:35], v[32:35]
  ds_read_b64_tr_b16 a[248:249], v99 offset:49152
  v_mfma_f32_16x16x32_bf16 v[36:39], a[224:227], a[36:39], v[36:39]
  ds_read_b64_tr_b16 a[250:251], v99 offset:50176
  v_mfma_f32_16x16x32_bf16 v[40:43], a[224:227], a[40:43], v[40:43]
  buffer_load_dwordx4 v113, s[16:19], s41 offen offset:1024 lds
  v_mfma_f32_16x16x32_bf16 v[44:47], a[224:227], a[44:47], v[44:47]
  v_mfma_f32_16x16x32_bf16 v[80:83], a[224:227], v[116:119], v[80:83]
  v_mfma_f32_16x16x32_bf16 v[48:51], a[228:231], a[32:35], v[48:51]
  ds_read_b64_tr_b16 a[252:253], v100 offset:49152
  v_mfma_f32_16x16x32_bf16 v[52:55], a[228:231], a[36:39], v[52:55]
  ds_read_b64_tr_b16 a[254:255], v100 offset:50176
  v_mfma_f32_16x16x32_bf16 v[56:59], a[228:231], a[40:43], v[56:59]
  buffer_load_dwordx4 v114, s[16:19], s41 offen offset:2048 lds
  v_mfma_f32_16x16x32_bf16 v[60:63], a[228:231], a[44:47], v[60:63]
  v_mfma_f32_16x16x32_bf16 v[84:87], a[228:231], v[116:119], v[84:87]
  s_waitcnt lgkmcnt(8)
  v_mfma_f32_16x16x32_bf16 v[64:67], a[232:235], a[32:35], v[64:67]
  ds_read_b64_tr_b16 a[192:193], v101 offset:49152
  v_mfma_f32_16x16x32_bf16 v[68:71], a[232:235], a[36:39], v[68:71]
  ds_read_b64_tr_b16 a[194:195], v101 offset:50176
  v_mfma_f32_16x16x32_bf16 v[72:75], a[232:235], a[40:43], v[72:75]
  buffer_load_dwordx4 v115, s[16:19], s41 offen offset:3072 lds
  v_mfma_f32_16x16x32_bf16 v[76:79], a[232:235], a[44:47], v[76:79]
  v_mfma_f32_16x16x32_bf16 v[88:91], a[232:235], v[116:119], v[88:91]
  v_mfma_f32_16x16x32_bf16 v[128:131], a[236:239], a[32:35], v[128:131]
  ds_read_b64_tr_b16 a[196:197], v102 offset:49152
  v_mfma_f32_16x16x32_bf16 v[132:135], a[236:239], a[36:39], v[132:135]
  ds_read_b64_tr_b16 a[198:199], v102 offset:50176
  v_mfma_f32_16x16x32_bf16 v[136:139], a[236:239], a[40:43], v[136:139]
  s_add_u32 m0, s48, 0
  s_mov_b32 s41, 3145728
  v_mfma_f32_16x16x32_bf16 v[140:143], a[236:239], a[44:47], v[140:143]
  s_waitcnt lgkmcnt(8)
  v_mfma_f32_16x16x32_bf16 v[144:147], a[240:243], a[32:35], v[144:147]
  ds_read_b64_tr_b16 a[200:201], v103 offset:49152
  v_mfma_f32_16x16x32_bf16 v[148:151], a[240:243], a[36:39], v[148:151]
  ds_read_b64_tr_b16 a[202:203], v103 offset:50176
  v_mfma_f32_16x16x32_bf16 v[152:155], a[240:243], a[40:43], v[152:155]
  buffer_load_dwordx4 v108, s[12:15], s41 offen offset:0 lds
  v_mfma_f32_16x16x32_bf16 v[156:159], a[240:243], a[44:47], v[156:159]
  v_mfma_f32_16x16x32_bf16 v[160:163], a[244:247], a[32:35], v[160:163]
  ds_read_b64_tr_b16 a[204:205], v104 offset:36864
  v_mfma_f32_16x16x32_bf16 v[164:167], a[244:247], a[36:39], v[164:167]
  ds_read_b64_tr_b16 a[206:207], v104 offset:37376
  v_mfma_f32_16x16x32_bf16 v[168:171], a[244:247], a[40:43], v[168:171]
  buffer_load_dwordx4 v109, s[12:15], s41 offen offset:1024 lds
  v_mfma_f32_16x16x32_bf16 v[172:175], a[244:247], a[44:47], v[172:175]
  s_waitcnt lgkmcnt(8)
  v_mfma_f32_16x16x32_bf16 v[176:179], a[248:251], a[32:35], v[176:179]
  ds_read_b64_tr_b16 a[208:209], v105 offset:36864
  v_mfma_f32_16x16x32_bf16 v[180:183], a[248:251], a[36:39], v[180:183]
  ds_read_b64_tr_b16 a[210:211], v105 offset:37376
  v_mfma_f32_16x16x32_bf16 v[184:187], a[248:251], a[40:43], v[184:187]
  buffer_load_dwordx4 v110, s[12:15], s41 offen offset:2048 lds
  v_mfma_f32_16x16x32_bf16 v[188:191], a[248:251], a[44:47], v[188:191]
  v_mfma_f32_16x16x32_bf16 v[192:195], a[252:255], a[32:35], v[192:195]
  ds_read_b64_tr_b16 a[212:213], v106 offset:36864
  v_mfma_f32_16x16x32_bf16 v[196:199], a[252:255], a[36:39], v[196:199]
  ds_read_b64_tr_b16 a[214:215], v106 offset:37376
  v_mfma_f32_16x16x32_bf16 v[200:203], a[252:255], a[40:43], v[200:203]
  buffer_load_dwordx4 v111, s[12:15], s41 offen offset:3072 lds
  v_mfma_f32_16x16x32_bf16 v[204:207], a[252:255], a[44:47], v[204:207]
  s_waitcnt lgkmcnt(8)
  v_mfma_f32_16x16x32_bf16 v[208:211], a[192:195], a[32:35], v[208:211]
  ds_read_b64_tr_b16 a[216:217], v96 offset:57344
  v_mfma_f32_16x16x32_bf16 v[212:215], a[192:195], a[36:39], v[212:215]
  ds_read_b64_tr_b16 a[218:219], v96 offset:58368
  v_mfma_f32_16x16x32_bf16 v[216:219], a[192:195], a[40:43], v[216:219]
  buffer_store_dwordx4 a[176:179], v2, s[8:11], s50 offen offset:0 sc1
  v_mfma_f32_16x16x32_bf16 v[220:223], a[192:195], a[44:47], v[220:223]
  v_mfma_f32_16x16x32_bf16 v[224:227], a[196:199], a[32:35], v[224:227]
  ds_read_b64_tr_b16 a[220:221], v97 offset:57344
  v_mfma_f32_16x16x32_bf16 v[228:231], a[196:199], a[36:39], v[228:231]
  ds_read_b64_tr_b16 a[222:223], v97 offset:58368
  v_mfma_f32_16x16x32_bf16 v[232:235], a[196:199], a[40:43], v[232:235]
  buffer_store_dwordx4 a[180:183], v2, s[8:11], s50 offen offset:1024 sc1
  v_mfma_f32_16x16x32_bf16 v[236:239], a[196:199], a[44:47], v[236:239]
  s_waitcnt lgkmcnt(8)
  v_mfma_f32_16x16x32_bf16 v[240:243], a[200:203], a[32:35], v[240:243]
  ds_read_b64_tr_b16 a[224:225], v98 offset:57344
  v_mfma_f32_16x16x32_bf16 v[244:247], a[200:203], a[36:39], v[244:247]
  ds_read_b64_tr_b16 a[226:227], v98 offset:58368
  v_mfma_f32_16x16x32_bf16 v[248:251], a[200:203], a[40:43], v[248:251]
  buffer_load_dwordx4 a[16:19], v2, s[8:11], s98 offen offset:1024 sc1
  v_mfma_f32_16x16x32_bf16 v[252:255], a[200:203], a[44:47], v[252:255]
  s_waitcnt vmcnt(35)
  v_mfma_f32_16x16x32_bf16 v[32:35], a[204:207], a[48:51], v[32:35]
  ds_read_b64_tr_b16 a[228:229], v99 offset:57344
  v_mfma_f32_16x16x32_bf16 v[36:39], a[204:207], a[52:55], v[36:39]
  ds_read_b64_tr_b16 a[230:231], v99 offset:58368
  v_mfma_f32_16x16x32_bf16 v[40:43], a[204:207], a[56:59], v[40:43]
  buffer_load_dwordx4 a[20:23], v2, s[8:11], s99 offen offset:1024 sc1
  v_mfma_f32_16x16x32_bf16 v[44:47], a[204:207], a[60:63], v[44:47]
  v_mfma_f32_16x16x32_bf16 v[80:83], a[204:207], v[116:119], v[80:83]
  s_waitcnt lgkmcnt(8)
  v_mfma_f32_16x16x32_bf16 v[48:51], a[208:211], a[48:51], v[48:51]
  ds_read_b64_tr_b16 a[232:233], v100 offset:57344
  v_mfma_f32_16x16x32_bf16 v[52:55], a[208:211], a[52:55], v[52:55]
  ds_read_b64_tr_b16 a[234:235], v100 offset:58368
  v_mfma_f32_16x16x32_bf16 v[56:59], a[208:211], a[56:59], v[56:59]
  buffer_load_dwordx4 a[24:27], v2, s[8:11], s100 offen offset:1024 sc1
  v_mfma_f32_16x16x32_bf16 v[60:63], a[208:211], a[60:63], v[60:63]
  v_mfma_f32_16x16x32_bf16 v[84:87], a[208:211], v[116:119], v[84:87]
  v_mfma_f32_16x16x32_bf16 v[64:67], a[212:215], a[48:51], v[64:67]
  ds_read_b64_tr_b16 a[236:237], v101 offset:57344
  v_mfma_f32_16x16x32_bf16 v[68:71], a[212:215], a[52:55], v[68:71]
  ds_read_b64_tr_b16 a[238:239], v101 offset:58368
  v_mfma_f32_16x16x32_bf16 v[72:75], a[212:215], a[56:59], v[72:75]
  buffer_load_dwordx4 a[28:31], v2, s[8:11], s101 offen offset:1024 sc1
  v_mfma_f32_16x16x32_bf16 v[76:79], a[212:215], a[60:63], v[76:79]
  v_mfma_f32_16x16x32_bf16 v[88:91], a[212:215], v[116:119], v[88:91]
  s_waitcnt lgkmcnt(8)
  v_mfma_f32_16x16x32_bf16 v[128:131], a[216:219], a[48:51], v[128:131]
  ds_read_b64_tr_b16 a[240:241], v102 offset:57344
  v_mfma_f32_16x16x32_bf16 v[132:135], a[216:219], a[52:55], v[132:135]
  ds_read_b64_tr_b16 a[242:243], v102 offset:58368
  v_mfma_f32_16x16x32_bf16 v[136:139], a[216:219], a[56:59], v[136:139]
  buffer_store_dwordx4 a[184:187], v2, s[8:11], s50 offen offset:2048 sc1
  v_mfma_f32_16x16x32_bf16 v[140:143], a[216:219], a[60:63], v[140:143]
  v_mfma_f32_16x16x32_bf16 v[144:147], a[220:223], a[48:51], v[144:147]
  ds_read_b64_tr_b16 a[244:245], v103 offset:57344
  v_mfma_f32_16x16x32_bf16 v[148:151], a[220:223], a[52:55], v[148:151]
  ds_read_b64_tr_b16 a[246:247], v103 offset:58368
  v_mfma_f32_16x16x32_bf16 v[152:155], a[220:223], a[56:59], v[152:155]
  buffer_store_dwordx4 a[188:191], v2, s[8:11], s50 offen offset:3072 sc1
  s_add_u32 s50, s50, 4096
  v_mfma_f32_16x16x32_bf16 v[156:159], a[220:223], a[60:63], v[156:159]
  s_waitcnt lgkmcnt(8)
  v_mfma_f32_16x16x32_bf16 v[160:163], a[224:227], a[48:51], v[160:163]
  s_waitcnt vmcnt(29)
  s_barrier
  ds_read_b64_tr_b16 a[248:249], v104 offset:40960
  v_mfma_f32_16x16x32_bf16 v[164:167], a[224:227], a[52:55], v[164:167]
  ds_read_b64_tr_b16 a[250:251], v104 offset:41472
  v_mfma_f32_16x16x32_bf16 v[168:171], a[224:227], a[56:59], v[168:171]
  buffer_load_dwordx4 a[32:35], v2, s[8:11], s98 offen offset:2048 sc1
  v_mfma_f32_16x16x32_bf16 v[172:175], a[224:227], a[60:63], v[172:175]
  v_mfma_f32_16x16x32_bf16 v[176:179], a[228:231], a[48:51], v[176:179]
  ds_read_b64_tr_b16 a[252:253], v105 offset:40960
  v_mfma_f32_16x16x32_bf16 v[180:183], a[228:231], a[52:55], v[180:183]
  ds_read_b64_tr_b16 a[254:255], v105 offset:41472
  v_mfma_f32_16x16x32_bf16 v[184:187], a[228:231], a[56:59], v[184:187]
  buffer_load_dwordx4 a[36:39], v2, s[8:11], s99 offen offset:2048 sc1
  v_mfma_f32_16x16x32_bf16 v[188:191], a[228:231], a[60:63], v[188:191]
  s_waitcnt lgkmcnt(8)
  v_mfma_f32_16x16x32_bf16 v[192:195], a[232:235], a[48:51], v[192:195]
  ds_read_b64_tr_b16 a[192:193], v106 offset:40960
  v_mfma_f32_16x16x32_bf16 v[196:199], a[232:235], a[52:55], v[196:199]
  ds_read_b64_tr_b16 a[194:195], v106 offset:41472
  v_mfma_f32_16x16x32_bf16 v[200:203], a[232:235], a[56:59], v[200:203]
  buffer_load_dwordx4 a[40:43], v2, s[8:11], s100 offen offset:2048 sc1
  v_mfma_f32_16x16x32_bf16 v[204:207], a[232:235], a[60:63], v[204:207]
  v_mfma_f32_16x16x32_bf16 v[208:211], a[236:239], a[48:51], v[208:211]
  v_add_u32 v96, 0x10000, v96
  v_add_u32 v97, 0x10000, v97
  v_add_u32 v98, 0x10000, v98
  v_add_u32 v99, 0x10000, v99
  v_add_u32 v100, 0x10000, v100
  v_add_u32 v101, 0x10000, v101
  v_add_u32 v102, 0x10000, v102
  v_add_u32 v103, 0x10000, v103
  ds_read_b64_tr_b16 a[196:197], v96 offset:0
  v_mfma_f32_16x16x32_bf16 v[212:215], a[236:239], a[52:55], v[212:215]
  ds_read_b64_tr_b16 a[198:199], v96 offset:1024
  v_mfma_f32_16x16x32_bf16 v[216:219], a[236:239], a[56:59], v[216:219]
  buffer_load_dwordx4 a[44:47], v2, s[8:11], s101 offen offset:2048 sc1
  v_mfma_f32_16x16x32_bf16 v[220:223], a[236:239], a[60:63], v[220:223]
  s_waitcnt lgkmcnt(8)
  v_mfma_f32_16x16x32_bf16 v[224:227], a[240:243], a[48:51], v[224:227]
  ds_read_b64_tr_b16 a[200:201], v97 offset:0
  v_mfma_f32_16x16x32_bf16 v[228:231], a[240:243], a[52:55], v[228:231]
  ds_read_b64_tr_b16 a[202:203], v97 offset:1024
  v_mfma_f32_16x16x32_bf16 v[232:235], a[240:243], a[56:59], v[232:235]
  s_add_u32 m0, s48, 16384
  s_mov_b32 s41, 3670016
  v_mfma_f32_16x16x32_bf16 v[236:239], a[240:243], a[60:63], v[236:239]
  v_mfma_f32_16x16x32_bf16 v[240:243], a[244:247], a[48:51], v[240:243]
  ds_read_b64_tr_b16 a[204:205], v98 offset:0
  v_mfma_f32_16x16x32_bf16 v[244:247], a[244:247], a[52:55], v[244:247]
  ds_read_b64_tr_b16 a[206:207], v98 offset:1024
  v_mfma_f32_16x16x32_bf16 v[248:251], a[244:247], a[56:59], v[248:251]
  buffer_load_dwordx4 v108, s[12:15], s41 offen offset:0 lds
  v_mfma_f32_16x16x32_bf16 v[252:255], a[244:247], a[60:63], v[252:255]
  s_waitcnt lgkmcnt(8)
  v_mfma_f32_16x16x32_bf16 v[32:35], a[248:251], a[64:67], v[32:35]
  ds_read_b64_tr_b16 a[208:209], v99 offset:0
  v_mfma_f32_16x16x32_bf16 v[36:39], a[248:251], a[68:71], v[36:39]
  ds_read_b64_tr_b16 a[210:211], v99 offset:1024
  v_mfma_f32_16x16x32_bf16 v[40:43], a[248:251], a[72:75], v[40:43]
  buffer_load_dwordx4 v109, s[12:15], s41 offen offset:1024 lds
  v_mfma_f32_16x16x32_bf16 v[44:47], a[248:251], a[76:79], v[44:47]
  v_mfma_f32_16x16x32_bf16 v[80:83], a[248:251], v[116:119], v[80:83]
  v_mfma_f32_16x16x32_bf16 v[48:51], a[252:255], a[64:67], v[48:51]
  ds_read_b64_tr_b16 a[212:213], v100 offset:0
  v_mfma_f32_16x16x32_bf16 v[52:55], a[252:255], a[68:71], v[52:55]
  ds_read_b64_tr_b16 a[214:215], v100 offset:1024
  v_mfma_f32_16x16x32_bf16 v[56:59], a[252:255], a[72:75], v[56:59]
  buffer_load_dwordx4 v110, s[12:15], s41 offen offset:2048 lds
  v_mfma_f32_16x16x32_bf16 v[60:63], a[252:255], a[76:79], v[60:63]
  v_mfma_f32_16x16x32_bf16 v[84:87], a[252:255], v[116:119], v[84:87]
  s_waitcnt lgkmcnt(8)
  v_mfma_f32_16x16x32_bf16 v[64:67], a[192:195], a[64:67], v[64:67]
  ds_read_b64_tr_b16 a[216:217], v101 offset:0
  v_mfma_f32_16x16x32_bf16 v[68:71], a[192:195], a[68:71], v[68:71]
  ds_read_b64_tr_b16 a[218:219], v101 offset:1024
  v_mfma_f32_16x16x32_bf16 v[72:75], a[192:195], a[72:75], v[72:75]
  buffer_load_dwordx4 v111, s[12:15], s41 offen offset:3072 lds
  v_mfma_f32_16x16x32_bf16 v[76:79], a[192:195], a[76:79], v[76:79]
  v_mfma_f32_16x16x32_bf16 v[88:91], a[192:195], v[116:119], v[88:91]
  v_mfma_f32_16x16x32_bf16 v[128:131], a[196:199], a[64:67], v[128:131]
  ds_read_b64_tr_b16 a[220:221], v102 offset:0
  v_mfma_f32_16x16x32_bf16 v[132:135], a[196:199], a[68:71], v[132:135]
  ds_read_b64_tr_b16 a[222:223], v102 offset:1024
  v_mfma_f32_16x16x32_bf16 v[136:139], a[196:199], a[72:75], v[136:139]
  buffer_load_dwordx4 a[48:51], v2, s[8:11], s98 offen offset:3072 sc1
  v_mfma_f32_16x16x32_bf16 v[140:143], a[196:199], a[76:79], v[140:143]
  s_waitcnt lgkmcnt(8)
  v_mfma_f32_16x16x32_bf16 v[144:147], a[200:203], a[64:67], v[144:147]
  ds_read_b64_tr_b16 a[224:225], v103 offset:0
  v_mfma_f32_16x16x32_bf16 v[148:151], a[200:203], a[68:71], v[148:151]
  ds_read_b64_tr_b16 a[226:227], v103 offset:1024
  v_mfma_f32_16x16x32_bf16 v[152:155], a[200:203], a[72:75], v[152:155]
  buffer_load_dwordx4 a[52:55], v2, s[8:11], s99 offen offset:3072 sc1
  v_mfma_f32_16x16x32_bf16 v[156:159], a[200:203], a[76:79], v[156:159]
  v_mfma_f32_16x16x32_bf16 v[160:163], a[204:207], a[64:67], v[160:163]
  ds_read_b64_tr_b16 a[228:229], v104 offset:45056
  v_mfma_f32_16x16x32_bf16 v[164:167], a[204:207], a[68:71], v[164:167]
  ds_read_b64_tr_b16 a[230:231], v104 offset:45568
  v_mfma_f32_16x16x32_bf16 v[168:171], a[204:207], a[72:75], v[168:171]
  buffer_load_dwordx4 a[56:59], v2, s[8:11], s100 offen offset:3072 sc1
  v_mfma_f32_16x16x32_bf16 v[172:175], a[204:207], a[76:79], v[172:175]
  s_waitcnt lgkmcnt(8)
  v_mfma_f32_16x16x32_bf16 v[176:179], a[208:211], a[64:67], v[176:179]
  ds_read_b64_tr_b16 a[232:233], v105 offset:45056
  v_mfma_f32_16x16x32_bf16 v[180:183], a[208:211], a[68:71], v[180:183]
  ds_read_b64_tr_b16 a[234:235], v105 offset:45568
  v_mfma_f32_16x16x32_bf16 v[184:187], a[208:211], a[72:75], v[184:187]
  buffer_load_dwordx4 a[60:63], v2, s[8:11], s101 offen offset:3072 sc1
  v_mfma_f32_16x16x32_bf16 v[188:191], a[208:211], a[76:79], v[188:191]
  v_mfma_f32_16x16x32_bf16 v[192:195], a[212:215], a[64:67], v[192:195]
  ds_read_b64_tr_b16 a[236:237], v106 offset:45056
  v_mfma_f32_16x16x32_bf16 v[196:199], a[212:215], a[68:71], v[196:199]
  ds_read_b64_tr_b16 a[238:239], v106 offset:45568
  v_mfma_f32_16x16x32_bf16 v[200:203], a[212:215], a[72:75], v[200:203]
  v_mfma_f32_16x16x32_bf16 v[204:207], a[212:215], a[76:79], v[204:207]
  s_waitcnt lgkmcnt(8)
  v_mfma_f32_16x16x32_bf16 v[208:211], a[216:219], a[64:67], v[208:211]
  ds_read_b64_tr_b16 a[240:241], v96 offset:8192
  v_mfma_f32_16x16x32_bf16 v[212:215], a[216:219], a[68:71], v[212:215]
  ds_read_b64_tr_b16 a[242:243], v96 offset:9216
  v_mfma_f32_16x16x32_bf16 v[216:219], a[216:219], a[72:75], v[216:219]
  v_mfma_f32_16x16x32_bf16 v[220:223], a[216:219], a[76:79], v[220:223]
  v_mfma_f32_16x16x32_bf16 v[224:227], a[220:223], a[64:67], v[224:227]
  ds_read_b64_tr_b16 a[244:245], v97 offset:8192
  v_mfma_f32_16x16x32_bf16 v[228:231], a[220:223], a[68:71], v[228:231]
  ds_read_b64_tr_b16 a[246:247], v97 offset:9216
  v_mfma_f32_16x16x32_bf16 v[232:235], a[220:223], a[72:75], v[232:235]
  v_mfma_f32_16x16x32_bf16 v[236:239], a[220:223], a[76:79], v[236:239]
  s_waitcnt lgkmcnt(8)
  v_mfma_f32_16x16x32_bf16 v[240:243], a[224:227], a[64:67], v[240:243]
  ds_read_b64_tr_b16 a[248:249], v98 offset:8192
  v_mfma_f32_16x16x32_bf16 v[244:247], a[224:227], a[68:71], v[244:247]
  ds_read_b64_tr_b16 a[250:251], v98 offset:9216
  v_mfma_f32_16x16x32_bf16 v[248:251], a[224:227], a[72:75], v[248:251]
  v_mfma_f32_16x16x32_bf16 v[252:255], a[224:227], a[76:79], v[252:255]
  s_waitcnt vmcnt(35)
  v_mfma_f32_16x16x32_bf16 v[32:35], a[228:231], a[80:83], v[32:35]
  ds_read_b64_tr_b16 a[252:253], v99 offset:8192
  v_mfma_f32_16x16x32_bf16 v[36:39], a[228:231], a[84:87], v[36:39]
  ds_read_b64_tr_b16 a[254:255], v99 offset:9216
  v_mfma_f32_16x16x32_bf16 v[40:43], a[228:231], a[88:91], v[40:43]
  v_mfma_f32_16x16x32_bf16 v[44:47], a[228:231], a[92:95], v[44:47]
  v_mfma_f32_16x16x32_bf16 v[80:83], a[228:231], v[116:119], v[80:83]
  s_waitcnt lgkmcnt(8)
  v_mfma_f32_16x16x32_bf16 v[48:51], a[232:235], a[80:83], v[48:51]
  ds_read_b64_tr_b16 a[192:193], v100 offset:8192
  v_mfma_f32_16x16x32_bf16 v[52:55], a[232:235], a[84:87], v[52:55]
  ds_read_b64_tr_b16 a[194:195], v100 offset:9216
  v_mfma_f32_16x16x32_bf16 v[56:59], a[232:235], a[88:91], v[56:59]
  v_mfma_f32_16x16x32_bf16 v[60:63], a[232:235], a[92:95], v[60:63]
  v_mfma_f32_16x16x32_bf16 v[84:87], a[232:235], v[116:119], v[84:87]
  v_mfma_f32_16x16x32_bf16 v[64:67], a[236:239], a[80:83], v[64:67]
  ds_read_b64_tr_b16 a[196:197], v101 offset:8192
  v_mfma_f32_16x16x32_bf16 v[68:71], a[236:239], a[84:87], v[68:71]
  ds_read_b64_tr_b16 a[198:199], v101 offset:9216
  v_mfma_f32_16x16x32_bf16 v[72:75], a[236:239], a[88:91], v[72:75]
  v_mfma_f32_16x16x32_bf16 v[76:79], a[236:239], a[92:95], v[76:79]
  v_mfma_f32_16x16x32_bf16 v[88:91], a[236:239], v[116:119], v[88:91]
  s_waitcnt lgkmcnt(8)
  v_mfma_f32_16x16x32_bf16 v[128:131], a[240:243], a[80:83], v[128:131]
  ds_read_b64_tr_b16 a[200:201], v102 offset:8192
  v_mfma_f32_16x16x32_bf16 v[132:135], a[240:243], a[84:87], v[132:135]
  ds_read_b64_tr_b16 a[202:203], v102 offset:9216
  v_mfma_f32_16x16x32_bf16 v[136:139], a[240:243], a[88:91], v[136:139]
  v_mfma_f32_16x16x32_bf16 v[140:143], a[240:243], a[92:95], v[140:143]
  v_mfma_f32_16x16x32_bf16 v[144:147], a[244:247], a[80:83], v[144:147]
  ds_read_b64_tr_b16 a[204:205], v103 offset:8192
  v_mfma_f32_16x16x32_bf16 v[148:151], a[244:247], a[84:87], v[148:151]
  ds_read_b64_tr_b16 a[206:207], v103 offset:9216
  v_mfma_f32_16x16x32_bf16 v[152:155], a[244:247], a[88:91], v[152:155]
  v_mfma_f32_16x16x32_bf16 v[156:159], a[244:247], a[92:95], v[156:159]
  s_waitcnt lgkmcnt(8)
  v_mfma_f32_16x16x32_bf16 v[160:163], a[248:251], a[80:83], v[160:163]
  s_waitcnt vmcnt(20)
  s_waitcnt vmcnt(12)
  s_barrier
  v_mov_b32 v18, 0
  v_mov_b32 v19, 1
  s_cmp_lg_u32 s32, 0
  s_cbranch_scc1 k2_kernel_skip11
  s_mov_b64 exec, 1
  buffer_store_dword v19, v18, s[8:11], s3 offen sc1
  s_mov_b64 exec, -1
k2_kernel_skip11:
  v_add_u32 v104, 0x10000, v104
  v_add_u32 v105, 0x10000, v105
  v_add_u32 v106, 0x10000, v106
  ds_read_b64_tr_b16 a[208:209], v104 offset:16384
  v_mfma_f32_16x16x32_bf16 v[164:167], a[248:251], a[84:87], v[164:167]
  ds_read_b64_tr_b16 a[210:211], v104 offset:16896
  v_mfma_f32_16x16x32_bf16 v[168:171], a[248:251], a[88:91], v[168:171]
  v_mfma_f32_16x16x32_bf16 v[172:175], a[248:251], a[92:95], v[172:175]
  v_mfma_f32_16x16x32_bf16 v[176:179], a[252:255], a[80:83], v[176:179]
  ds_read_b64_tr_b16 a[212:213], v105 offset:16384
  v_mfma_f32_16x16x32_bf16 v[180:183], a[252:255], a[84:87], v[180:183]
  ds_read_b64_tr_b16 a[214:215], v105 offset:16896
  v_mfma_f32_16x16x32_bf16 v[184:187], a[252:255], a[88:91], v[184:187]
  v_mfma_f32_16x16x32_bf16 v[188:191], a[252:255], a[92:95], v[188:191]
  s_waitcnt lgkmcnt(8)
  v_mfma_f32_16x16x32_bf16 v[192:195], a[192:195], a[80:83], v[192:195]
  ds_read_b64_tr_b16 a[216:217], v106 offset:16384
  v_mfma_f32_16x16x32_bf16 v[196:199], a[192:195], a[84:87], v[196:199]
  ds_read_b64_tr_b16 a[218:219], v106 offset:16896
  v_mfma_f32_16x16x32_bf16 v[200:203], a[192:195], a[88:91], v[200:203]
  v_mfma_f32_16x16x32_bf16 v[204:207], a[192:195], a[92:95], v[204:207]
  v_mfma_f32_16x16x32_bf16 v[208:211], a[196:199], a[80:83], v[208:211]
  v_add_u32 v96, 0xfffe0000, v96
  v_add_u32 v97, 0xfffe0000, v97
  v_add_u32 v98, 0xfffe0000, v98
  v_add_u32 v99, 0xfffe0000, v99
  v_add_u32 v100, 0xfffe0000, v100
  v_add_u32 v101, 0xfffe0000, v101
  v_add_u32 v102, 0xfffe0000, v102
  v_add_u32 v103, 0xfffe0000, v103
  ds_read_b64_tr_b16 a[220:221], v96 offset:0
  v_mfma_f32_16x16x32_bf16 v[212:215], a[196:199], a[84:87], v[212:215]
  ds_read_b64_tr_b16 a[222:223], v96 offset:1024
  v_mfma_f32_16x16x32_bf16 v[216:219], a[196:199], a[88:91], v[216:219]
  v_mfma_f32_16x16x32_bf16 v[220:223], a[196:199], a[92:95], v[220:223]
  s_waitcnt lgkmcnt(8)
  v_mfma_f32_16x16x32_bf16 v[224:227], a[200:203], a[80:83], v[224:227]
  ds_read_b64_tr_b16 a[224:225], v97 offset:0
  v_mfma_f32_16x16x32_bf16 v[228:231], a[200:203], a[84:87], v[228:231]
  ds_read_b64_tr_b16 a[226:227], v97 offset:1024
  v_mfma_f32_16x16x32_bf16 v[232:235], a[200:203], a[88:91], v[232:235]
  v_mfma_f32_16x16x32_bf16 v[236:239], a[200:203], a[92:95], v[236:239]
  v_mfma_f32_16x16x32_bf16 v[240:243], a[204:207], a[80:83], v[240:243]
  ds_read_b64_tr_b16 a[228:229], v98 offset:0
  v_mfma_f32_16x16x32_bf16 v[244:247], a[204:207], a[84:87], v[244:247]
  ds_read_b64_tr_b16 a[230:231], v98 offset:1024
  v_mfma_f32_16x16x32_bf16 v[248:251], a[204:207], a[88:91], v[248:251]
  v_mfma_f32_16x16x32_bf16 v[252:255], a[204:207], a[92:95], v[252:255]
  s_waitcnt lgkmcnt(8)
  v_mfma_f32_16x16x32_bf16 v[32:35], a[208:211], a[0:3], v[32:35]
  ds_read_b64_tr_b16 a[232:233], v99 offset:0
  v_mfma_f32_16x16x32_bf16 v[36:39], a[208:211], a[4:7], v[36:39]
  ds_read_b64_tr_b16 a[234:235], v99 offset:1024
  v_mfma_f32_16x16x32_bf16 v[40:43], a[208:211], a[8:11], v[40:43]
  v_mfma_f32_16x16x32_bf16 v[44:47], a[208:211], a[12:15], v[44:47]
  v_mfma_f32_16x16x32_bf16 v[80:83], a[208:211], v[116:119], v[80:83]
  v_mfma_f32_16x16x32_bf16 v[48:51], a[212:215], a[0:3], v[48:51]
  ds_read_b64_tr_b16 a[236:237], v100 offset:0
  v_mfma_f32_16x16x32_bf16 v[52:55], a[212:215], a[4:7], v[52:55]
  ds_read_b64_tr_b16 a[238:239], v100 offset:1024
  v_mfma_f32_16x16x32_bf16 v[56:59], a[212:215], a[8:11], v[56:59]
  v_mfma_f32_16x16x32_bf16 v[60:63], a[212:215], a[12:15], v[60:63]
  v_mfma_f32_16x16x32_bf16 v[84:87], a[212:215], v[116:119], v[84:87]
  s_waitcnt lgkmcnt(8)
  v_mfma_f32_16x16x32_bf16 v[64:67], a[216:219], a[0:3], v[64:67]
  ds_read_b64_tr_b16 a[240:241], v101 offset:0
  v_mfma_f32_16x16x32_bf16 v[68:71], a[216:219], a[4:7], v[68:71]
  ds_read_b64_tr_b16 a[242:243], v101 offset:1024
  v_mfma_f32_16x16x32_bf16 v[72:75], a[216:219], a[8:11], v[72:75]
  v_mfma_f32_16x16x32_bf16 v[76:79], a[216:219], a[12:15], v[76:79]
  v_mfma_f32_16x16x32_bf16 v[88:91], a[216:219], v[116:119], v[88:91]
  v_mfma_f32_16x16x32_bf16 v[128:131], a[220:223], a[0:3], v[128:131]
  ds_read_b64_tr_b16 a[244:245], v102 offset:0
  v_mfma_f32_16x16x32_bf16 v[132:135], a[220:223], a[4:7], v[132:135]
  ds_read_b64_tr_b16 a[246:247], v102 offset:1024
  v_mfma_f32_16x16x32_bf16 v[136:139], a[220:223], a[8:11], v[136:139]
  v_mfma_f32_16x16x32_bf16 v[140:143], a[220:223], a[12:15], v[140:143]
  s_waitcnt lgkmcnt(8)
  v_mfma_f32_16x16x32_bf16 v[144:147], a[224:227], a[0:3], v[144:147]
  ds_read_b64_tr_b16 a[248:249], v103 offset:0
  v_mfma_f32_16x16x32_bf16 v[148:151], a[224:227], a[4:7], v[148:151]
  ds_read_b64_tr_b16 a[250:251], v103 offset:1024
  v_mfma_f32_16x16x32_bf16 v[152:155], a[224:227], a[8:11], v[152:155]
  v_mfma_f32_16x16x32_bf16 v[156:159], a[224:227], a[12:15], v[156:159]
  v_mfma_f32_16x16x32_bf16 v[160:163], a[228:231], a[0:3], v[160:163]
  ds_read_b64_tr_b16 a[252:253], v104 offset:20480
  v_mfma_f32_16x16x32_bf16 v[164:167], a[228:231], a[4:7], v[164:167]
  ds_read_b64_tr_b16 a[254:255], v104 offset:20992
  v_mfma_f32_16x16x32_bf16 v[168:171], a[228:231], a[8:11], v[168:171]
  v_mfma_f32_16x16x32_bf16 v[172:175], a[228:231], a[12:15], v[172:175]
  s_waitcnt lgkmcnt(8)
  v_mfma_f32_16x16x32_bf16 v[176:179], a[232:235], a[0:3], v[176:179]
  ds_read_b64_tr_b16 a[192:193], v105 offset:20480
  v_mfma_f32_16x16x32_bf16 v[180:183], a[232:235], a[4:7], v[180:183]
  ds_read_b64_tr_b16 a[194:195], v105 offset:20992
  v_mfma_f32_16x16x32_bf16 v[184:187], a[232:235], a[8:11], v[184:187]
  v_mfma_f32_16x16x32_bf16 v[188:191], a[232:235], a[12:15], v[188:191]
  v_mfma_f32_16x16x32_bf16 v[192:195], a[236:239], a[0:3], v[192:195]
  ds_read_b64_tr_b16 a[196:197], v106 offset:20480
  v_mfma_f32_16x16x32_bf16 v[196:199], a[236:239], a[4:7], v[196:199]
  ds_read_b64_tr_b16 a[198:199], v106 offset:20992
  v_mfma_f32_16x16x32_bf16 v[200:203], a[236:239], a[8:11], v[200:203]
  v_mfma_f32_16x16x32_bf16 v[204:207], a[236:239], a[12:15], v[204:207]
  s_waitcnt lgkmcnt(8)
  v_mfma_f32_16x16x32_bf16 v[208:211], a[240:243], a[0:3], v[208:211]
  ds_read_b64_tr_b16 a[200:201], v96 offset:8192
  v_mfma_f32_16x16x32_bf16 v[212:215], a[240:243], a[4:7], v[212:215]
  ds_read_b64_tr_b16 a[202:203], v96 offset:9216
  v_mfma_f32_16x16x32_bf16 v[216:219], a[240:243], a[8:11], v[216:219]
  v_mfma_f32_16x16x32_bf16 v[220:223], a[240:243], a[12:15], v[220:223]
  v_mfma_f32_16x16x32_bf16 v[224:227], a[244:247], a[0:3], v[224:227]
  ds_read_b64_tr_b16 a[204:205], v97 offset:8192
  v_mfma_f32_16x16x32_bf16 v[228:231], a[244:247], a[4:7], v[228:231]
  ds_read_b64_tr_b16 a[206:207], v97 offset:9216
  v_mfma_f32_16x16x32_bf16 v[232:235], a[244:247], a[8:11], v[232:235]
  v_mfma_f32_16x16x32_bf16 v[236:239], a[244:247], a[12:15], v[236:239]
  s_waitcnt lgkmcnt(8)
  v_mfma_f32_16x16x32_bf16 v[240:243], a[248:251], a[0:3], v[240:243]
  ds_read_b64_tr_b16 a[208:209], v98 offset:8192
  v_mfma_f32_16x16x32_bf16 v[244:247], a[248:251], a[4:7], v[244:247]
  ds_read_b64_tr_b16 a[210:211], v98 offset:9216
  v_mfma_f32_16x16x32_bf16 v[248:251], a[248:251], a[8:11], v[248:251]
  v_mfma_f32_16x16x32_bf16 v[252:255], a[248:251], a[12:15], v[252:255]
  v_mfma_f32_16x16x32_bf16 v[32:35], a[252:255], a[16:19], v[32:35]
  ds_read_b64_tr_b16 a[212:213], v99 offset:8192
  v_mfma_f32_16x16x32_bf16 v[36:39], a[252:255], a[20:23], v[36:39]
  ds_read_b64_tr_b16 a[214:215], v99 offset:9216
  v_mfma_f32_16x16x32_bf16 v[40:43], a[252:255], a[24:27], v[40:43]
  v_mfma_f32_16x16x32_bf16 v[44:47], a[252:255], a[28:31], v[44:47]
  v_mfma_f32_16x16x32_bf16 v[80:83], a[252:255], v[116:119], v[80:83]
  s_waitcnt lgkmcnt(8)
  v_mfma_f32_16x16x32_bf16 v[48:51], a[192:195], a[16:19], v[48:51]
  ds_read_b64_tr_b16 a[216:217], v100 offset:8192
  v_mfma_f32_16x16x32_bf16 v[52:55], a[192:195], a[20:23], v[52:55]
  ds_read_b64_tr_b16 a[218:219], v100 offset:9216
  v_mfma_f32_16x16x32_bf16 v[56:59], a[192:195], a[24:27], v[56:59]
  v_mfma_f32_16x16x32_bf16 v[60:63], a[192:195], a[28:31], v[60:63]
  v_mfma_f32_16x16x32_bf16 v[84:87], a[192:195], v[116:119], v[84:87]
  v_mfma_f32_16x16x32_bf16 v[64:67], a[196:199], a[16:19], v[64:67]
  ds_read_b64_tr_b16 a[220:221], v101 offset:8192
  v_mfma_f32_16x16x32_bf16 v[68:71], a[196:199], a[20:23], v[68:71]
  ds_read_b64_tr_b16 a[222:223], v101 offset:9216
  v_mfma_f32_16x16x32_bf16 v[72:75], a[196:199], a[24:27], v[72:75]
  v_mfma_f32_16x16x32_bf16 v[76:79], a[196:199], a[28:31], v[76:79]
  v_mfma_f32_16x16x32_bf16 v[88:91], a[196:199], v[116:119], v[88:91]
  s_waitcnt lgkmcnt(8)
  v_mfma_f32_16x16x32_bf16 v[128:131], a[200:203], a[16:19], v[128:131]
  ds_read_b64_tr_b16 a[224:225], v102 offset:8192
  v_mfma_f32_16x16x32_bf16 v[132:135], a[200:203], a[20:23], v[132:135]
  ds_read_b64_tr_b16 a[226:227], v102 offset:9216
  v_mfma_f32_16x16x32_bf16 v[136:139], a[200:203], a[24:27], v[136:139]
  v_mfma_f32_16x16x32_bf16 v[140:143], a[200:203], a[28:31], v[140:143]
  v_mfma_f32_16x16x32_bf16 v[144:147], a[204:207], a[16:19], v[144:147]
  ds_read_b64_tr_b16 a[228:229], v103 offset:8192
  v_mfma_f32_16x16x32_bf16 v[148:151], a[204:207], a[20:23], v[148:151]
  ds_read_b64_tr_b16 a[230:231], v103 offset:9216
  v_mfma_f32_16x16x32_bf16 v[152:155], a[204:207], a[24:27], v[152:155]
  v_mfma_f32_16x16x32_bf16 v[156:159], a[204:207], a[28:31], v[156:159]
  s_waitcnt lgkmcnt(8)
  v_mfma_f32_16x16x32_bf16 v[160:163], a[208:211], a[16:19], v[160:163]
  s_waitcnt vmcnt(4)
  s_barrier
  s_lshl_b32 s55, s33, 7
  s_add_u32 s55, s55, 61939712
  v_lshlrev_b32 v18, 2, v24
  buffer_load_dword v19, v18, s[8:11], s55 offen sc1
  ds_read_b64_tr_b16 a[232:233], v104 offset:24576
  v_mfma_f32_16x16x32_bf16 v[164:167], a[208:211], a[20:23], v[164:167]
  ds_read_b64_tr_b16 a[234:235], v104 offset:25088
  v_mfma_f32_16x16x32_bf16 v[168:171], a[208:211], a[24:27], v[168:171]
  v_mfma_f32_16x16x32_bf16 v[172:175], a[208:211], a[28:31], v[172:175]
  v_mfma_f32_16x16x32_bf16 v[176:179], a[212:215], a[16:19], v[176:179]
  ds_read_b64_tr_b16 a[236:237], v105 offset:24576
  v_mfma_f32_16x16x32_bf16 v[180:183], a[212:215], a[20:23], v[180:183]
  ds_read_b64_tr_b16 a[238:239], v105 offset:25088
  v_mfma_f32_16x16x32_bf16 v[184:187], a[212:215], a[24:27], v[184:187]
  v_mfma_f32_16x16x32_bf16 v[188:191], a[212:215], a[28:31], v[188:191]
  s_waitcnt lgkmcnt(8)
  v_mfma_f32_16x16x32_bf16 v[192:195], a[216:219], a[16:19], v[192:195]
  ds_read_b64_tr_b16 a[240:241], v106 offset:24576
  v_mfma_f32_16x16x32_bf16 v[196:199], a[216:219], a[20:23], v[196:199]
  ds_read_b64_tr_b16 a[242:243], v106 offset:25088
  v_mfma_f32_16x16x32_bf16 v[200:203], a[216:219], a[24:27], v[200:203]
  v_mfma_f32_16x16x32_bf16 v[204:207], a[216:219], a[28:31], v[204:207]
  v_mfma_f32_16x16x32_bf16 v[208:211], a[220:223], a[16:19], v[208:211]
  ds_read_b64_tr_b16 a[244:245], v96 offset:16384
  v_mfma_f32_16x16x32_bf16 v[212:215], a[220:223], a[20:23], v[212:215]
  ds_read_b64_tr_b16 a[246:247], v96 offset:17408
  v_mfma_f32_16x16x32_bf16 v[216:219], a[220:223], a[24:27], v[216:219]
  v_mfma_f32_16x16x32_bf16 v[220:223], a[220:223], a[28:31], v[220:223]
  s_waitcnt lgkmcnt(8)
  v_mfma_f32_16x16x32_bf16 v[224:227], a[224:227], a[16:19], v[224:227]
  ds_read_b64_tr_b16 a[248:249], v97 offset:16384
  v_mfma_f32_16x16x32_bf16 v[228:231], a[224:227], a[20:23], v[228:231]
  ds_read_b64_tr_b16 a[250:251], v97 offset:17408
  v_mfma_f32_16x16x32_bf16 v[232:235], a[224:227], a[24:27], v[232:235]
  v_mfma_f32_16x16x32_bf16 v[236:239], a[224:227], a[28:31], v[236:239]
  v_mfma_f32_16x16x32_bf16 v[240:243], a[228:231], a[16:19], v[240:243]
  ds_read_b64_tr_b16 a[252:253], v98 offset:16384
  v_mfma_f32_16x16x32_bf16 v[244:247], a[228:231], a[20:23], v[244:247]
  ds_read_b64_tr_b16 a[254:255], v98 offset:17408
  v_mfma_f32_16x16x32_bf16 v[248:251], a[228:231], a[24:27], v[248:251]
  v_mfma_f32_16x16x32_bf16 v[252:255], a[228:231], a[28:31], v[252:255]
  s_waitcnt lgkmcnt(8)
  v_mfma_f32_16x16x32_bf16 v[32:35], a[232:235], a[32:35], v[32:35]
  ds_read_b64_tr_b16 a[192:193], v99 offset:16384
  v_mfma_f32_16x16x32_bf16 v[36:39], a[232:235], a[36:39], v[36:39]
  ds_read_b64_tr_b16 a[194:195], v99 offset:17408
  v_mfma_f32_16x16x32_bf16 v[40:43], a[232:235], a[40:43], v[40:43]
  v_mfma_f32_16x16x32_bf16 v[44:47], a[232:235], a[44:47], v[44:47]
  v_mfma_f32_16x16x32_bf16 v[80:83], a[232:235], v[116:119], v[80:83]
  v_mfma_f32_16x16x32_bf16 v[48:51], a[236:239], a[32:35], v[48:51]
  ds_read_b64_tr_b16 a[196:197], v100 offset:16384
  v_mfma_f32_16x16x32_bf16 v[52:55], a[236:239], a[36:39], v[52:55]
  ds_read_b64_tr_b16 a[198:199], v100 offset:17408
  v_mfma_f32_16x16x32_bf16 v[56:59], a[236:239], a[40:43], v[56:59]
  v_mfma_f32_16x16x32_bf16 v[60:63], a[236:239], a[44:47], v[60:63]
  v_mfma_f32_16x16x32_bf16 v[84:87], a[236:239], v[116:119], v[84:87]
  s_waitcnt lgkmcnt(8)
  v_mfma_f32_16x16x32_bf16 v[64:67], a[240:243], a[32:35], v[64:67]
  ds_read_b64_tr_b16 a[200:201], v101 offset:16384
  v_mfma_f32_16x16x32_bf16 v[68:71], a[240:243], a[36:39], v[68:71]
  ds_read_b64_tr_b16 a[202:203], v101 offset:17408
  v_mfma_f32_16x16x32_bf16 v[72:75], a[240:243], a[40:43], v[72:75]
  v_mfma_f32_16x16x32_bf16 v[76:79], a[240:243], a[44:47], v[76:79]
  v_mfma_f32_16x16x32_bf16 v[88:91], a[240:243], v[116:119], v[88:91]
  v_mfma_f32_16x16x32_bf16 v[128:131], a[244:247], a[32:35], v[128:131]
  ds_read_b64_tr_b16 a[204:205], v102 offset:16384
  v_mfma_f32_16x16x32_bf16 v[132:135], a[244:247], a[36:39], v[132:135]
  ds_read_b64_tr_b16 a[206:207], v102 offset:17408
  v_mfma_f32_16x16x32_bf16 v[136:139], a[244:247], a[40:43], v[136:139]
  v_mfma_f32_16x16x32_bf16 v[140:143], a[244:247], a[44:47], v[140:143]
  s_waitcnt lgkmcnt(8)
  v_mfma_f32_16x16x32_bf16 v[144:147], a[248:251], a[32:35], v[144:147]
  ds_read_b64_tr_b16 a[208:209], v103 offset:16384
  v_mfma_f32_16x16x32_bf16 v[148:151], a[248:251], a[36:39], v[148:151]
  ds_read_b64_tr_b16 a[210:211], v103 offset:17408
  v_mfma_f32_16x16x32_bf16 v[152:155], a[248:251], a[40:43], v[152:155]
  v_mfma_f32_16x16x32_bf16 v[156:159], a[248:251], a[44:47], v[156:159]
  v_mfma_f32_16x16x32_bf16 v[160:163], a[252:255], a[32:35], v[160:163]
  ds_read_b64_tr_b16 a[212:213], v104 offset:28672
  v_mfma_f32_16x16x32_bf16 v[164:167], a[252:255], a[36:39], v[164:167]
  ds_read_b64_tr_b16 a[214:215], v104 offset:29184
  v_mfma_f32_16x16x32_bf16 v[168:171], a[252:255], a[40:43], v[168:171]
  v_mfma_f32_16x16x32_bf16 v[172:175], a[252:255], a[44:47], v[172:175]
  s_waitcnt lgkmcnt(8)
  v_mfma_f32_16x16x32_bf16 v[176:179], a[192:195], a[32:35], v[176:179]
  ds_read_b64_tr_b16 a[216:217], v105 offset:28672
  v_mfma_f32_16x16x32_bf16 v[180:183], a[192:195], a[36:39], v[180:183]
  ds_read_b64_tr_b16 a[218:219], v105 offset:29184
  v_mfma_f32_16x16x32_bf16 v[184:187], a[192:195], a[40:43], v[184:187]
  v_mfma_f32_16x16x32_bf16 v[188:191], a[192:195], a[44:47], v[188:191]
  v_mfma_f32_16x16x32_bf16 v[192:195], a[196:199], a[32:35], v[192:195]
  ds_read_b64_tr_b16 a[220:221], v106 offset:28672
  v_mfma_f32_16x16x32_bf16 v[196:199], a[196:199], a[36:39], v[196:199]
  ds_read_b64_tr_b16 a[222:223], v106 offset:29184
  v_mfma_f32_16x16x32_bf16 v[200:203], a[196:199], a[40:43], v[200:203]
  v_mfma_f32_16x16x32_bf16 v[204:207], a[196:199], a[44:47], v[204:207]
  s_waitcnt lgkmcnt(8)
  v_mfma_f32_16x16x32_bf16 v[208:211], a[200:203], a[32:35], v[208:211]
  ds_read_b64_tr_b16 a[224:225], v96 offset:24576
  v_mfma_f32_16x16x32_bf16 v[212:215], a[200:203], a[36:39], v[212:215]
  ds_read_b64_tr_b16 a[226:227], v96 offset:25600
  v_mfma_f32_16x16x32_bf16 v[216:219], a[200:203], a[40:43], v[216:219]
  v_mfma_f32_16x16x32_bf16 v[220:223], a[200:203], a[44:47], v[220:223]
  v_mfma_f32_16x16x32_bf16 v[224:227], a[204:207], a[32:35], v[224:227]
  ds_read_b64_tr_b16 a[228:229], v97 offset:24576
  v_mfma_f32_16x16x32_bf16 v[228:231], a[204:207], a[36:39], v[228:231]
  ds_read_b64_tr_b16 a[230:231], v97 offset:25600
  v_mfma_f32_16x16x32_bf16 v[232:235], a[204:207], a[40:43], v[232:235]
  v_mfma_f32_16x16x32_bf16 v[236:239], a[204:207], a[44:47], v[236:239]
  s_waitcnt lgkmcnt(8)
  v_mfma_f32_16x16x32_bf16 v[240:243], a[208:211], a[32:35], v[240:243]
  ds_read_b64_tr_b16 a[232:233], v98 offset:24576
  v_mfma_f32_16x16x32_bf16 v[244:247], a[208:211], a[36:39], v[244:247]
  ds_read_b64_tr_b16 a[234:235], v98 offset:25600
  v_mfma_f32_16x16x32_bf16 v[248:251], a[208:211], a[40:43], v[248:251]
  v_mfma_f32_16x16x32_bf16 v[252:255], a[208:211], a[44:47], v[252:255]
  s_waitcnt vmcnt(1)
  v_mfma_f32_16x16x32_bf16 v[32:35], a[212:215], a[48:51], v[32:35]
  ds_read_b64_tr_b16 a[236:237], v99 offset:24576
  v_mfma_f32_16x16x32_bf16 v[36:39], a[212:215], a[52:55], v[36:39]
  ds_read_b64_tr_b16 a[238:239], v99 offset:25600
  v_mfma_f32_16x16x32_bf16 v[40:43], a[212:215], a[56:59], v[40:43]
  v_mfma_f32_16x16x32_bf16 v[44:47], a[212:215], a[60:63], v[44:47]
  v_mfma_f32_16x16x32_bf16 v[80:83], a[212:215], v[116:119], v[80:83]
  s_waitcnt lgkmcnt(8)
  v_mfma_f32_16x16x32_bf16 v[48:51], a[216:219], a[48:51], v[48:51]
  ds_read_b64_tr_b16 a[240:241], v100 offset:24576
  v_mfma_f32_16x16x32_bf16 v[52:55], a[216:219], a[52:55], v[52:55]
  ds_read_b64_tr_b16 a[242:243], v100 offset:25600
  v_mfma_f32_16x16x32_bf16 v[56:59], a[216:219], a[56:59], v[56:59]
  v_mfma_f32_16x16x32_bf16 v[60:63], a[216:219], a[60:63], v[60:63]
  v_mfma_f32_16x16x32_bf16 v[84:87], a[216:219], v[116:119], v[84:87]
  v_mfma_f32_16x16x32_bf16 v[64:67], a[220:223], a[48:51], v[64:67]
  ds_read_b64_tr_b16 a[244:245], v101 offset:24576
  v_mfma_f32_16x16x32_bf16 v[68:71], a[220:223], a[52:55], v[68:71]
  ds_read_b64_tr_b16 a[246:247], v101 offset:25600
  v_mfma_f32_16x16x32_bf16 v[72:75], a[220:223], a[56:59], v[72:75]
  v_mfma_f32_16x16x32_bf16 v[76:79], a[220:223], a[60:63], v[76:79]
  v_mfma_f32_16x16x32_bf16 v[88:91], a[220:223], v[116:119], v[88:91]
  s_waitcnt lgkmcnt(8)
  v_mfma_f32_16x16x32_bf16 v[128:131], a[224:227], a[48:51], v[128:131]
  ds_read_b64_tr_b16 a[248:249], v102 offset:24576
  v_mfma_f32_16x16x32_bf16 v[132:135], a[224:227], a[52:55], v[132:135]
  ds_read_b64_tr_b16 a[250:251], v102 offset:25600
  v_mfma_f32_16x16x32_bf16 v[136:139], a[224:227], a[56:59], v[136:139]
  v_mfma_f32_16x16x32_bf16 v[140:143], a[224:227], a[60:63], v[140:143]
  v_mfma_f32_16x16x32_bf16 v[144:147], a[228:231], a[48:51], v[144:147]
  ds_read_b64_tr_b16 a[252:253], v103 offset:24576
  v_mfma_f32_16x16x32_bf16 v[148:151], a[228:231], a[52:55], v[148:151]
  ds_read_b64_tr_b16 a[254:255], v103 offset:25600
  v_mfma_f32_16x16x32_bf16 v[152:155], a[228:231], a[56:59], v[152:155]
  v_mfma_f32_16x16x32_bf16 v[156:159], a[228:231], a[60:63], v[156:159]
  s_waitcnt lgkmcnt(8)
  v_mfma_f32_16x16x32_bf16 v[160:163], a[232:235], a[48:51], v[160:163]
  v_mfma_f32_16x16x32_bf16 v[164:167], a[232:235], a[52:55], v[164:167]
  v_mfma_f32_16x16x32_bf16 v[168:171], a[232:235], a[56:59], v[168:171]
  v_mfma_f32_16x16x32_bf16 v[172:175], a[232:235], a[60:63], v[172:175]
  v_mfma_f32_16x16x32_bf16 v[176:179], a[236:239], a[48:51], v[176:179]
  v_mfma_f32_16x16x32_bf16 v[180:183], a[236:239], a[52:55], v[180:183]
  v_mfma_f32_16x16x32_bf16 v[184:187], a[236:239], a[56:59], v[184:187]
  v_mfma_f32_16x16x32_bf16 v[188:191], a[236:239], a[60:63], v[188:191]
  s_waitcnt lgkmcnt(4)
  v_mfma_f32_16x16x32_bf16 v[192:195], a[240:243], a[48:51], v[192:195]
  v_mfma_f32_16x16x32_bf16 v[196:199], a[240:243], a[52:55], v[196:199]
  v_mfma_f32_16x16x32_bf16 v[200:203], a[240:243], a[56:59], v[200:203]
  v_mfma_f32_16x16x32_bf16 v[204:207], a[240:243], a[60:63], v[204:207]
  v_mfma_f32_16x16x32_bf16 v[208:211], a[244:247], a[48:51], v[208:211]
  v_mfma_f32_16x16x32_bf16 v[212:215], a[244:247], a[52:55], v[212:215]
  v_mfma_f32_16x16x32_bf16 v[216:219], a[244:247], a[56:59], v[216:219]
  v_mfma_f32_16x16x32_bf16 v[220:223], a[244:247], a[60:63], v[220:223]
  s_waitcnt lgkmcnt(0)
  v_mfma_f32_16x16x32_bf16 v[224:227], a[248:251], a[48:51], v[224:227]
  v_mfma_f32_16x16x32_bf16 v[228:231], a[248:251], a[52:55], v[228:231]
  v_mfma_f32_16x16x32_bf16 v[232:235], a[248:251], a[56:59], v[232:235]
  v_mfma_f32_16x16x32_bf16 v[236:239], a[248:251], a[60:63], v[236:239]
  v_mfma_f32_16x16x32_bf16 v[240:243], a[252:255], a[48:51], v[240:243]
  v_mfma_f32_16x16x32_bf16 v[244:247], a[252:255], a[52:55], v[244:247]
  v_mfma_f32_16x16x32_bf16 v[248:251], a[252:255], a[56:59], v[248:251]
  v_mfma_f32_16x16x32_bf16 v[252:255], a[252:255], a[60:63], v[252:255]
  s_waitcnt vmcnt(0)
  s_mov_b32 s39, 0
k2_sp_again:
  v_cmp_ne_u32 vcc, 1, v19
  s_cmp_gt_u32 s39, 400000
  s_cbranch_scc1 k2_sp_done
  s_cbranch_vccz k2_sp_done
  s_sleep 4
  buffer_load_dword v19, v18, s[8:11], s55 offen sc1
  s_add_u32 s39, s39, 1
  s_waitcnt vmcnt(0)
  s_branch k2_sp_again
k2_sp_done:
  s_barrier
  s_add_u32 m0, s48, 32768
  s_mov_b32 s41, 0
  buffer_load_dwordx4 v4, s[20:23], s41 offen offset:0 sc1 lds
  buffer_load_dwordx4 v4, s[20:23], s41 offen offset:1024 sc1 lds
  buffer_load_dwordx4 v4, s[20:23], s41 offen offset:2048 sc1 lds
  buffer_load_dwordx4 v4, s[20:23], s41 offen offset:3072 sc1 lds
  s_add_u32 m0, s48, 65536
  s_mov_b32 s41, 16384
  buffer_load_dwordx4 v4, s[20:23], s41 offen offset:0 sc1 lds
  buffer_load_dwordx4 v4, s[20:23], s41 offen offset:1024 sc1 lds
  buffer_load_dwordx4 v4, s[20:23], s41 offen offset:2048 sc1 lds
  buffer_load_dwordx4 v4, s[20:23], s41 offen offset:3072 sc1 lds
  s_add_u32 m0, s48, 81920
  s_mov_b32 s41, 16384
  buffer_load_dwordx4 v4, s[24:27], s41 offen offset:0 sc1 lds
  buffer_load_dwordx4 v4, s[24:27], s41 offen offset:1024 sc1 lds
  buffer_load_dwordx4 v4, s[24:27], s41 offen offset:2048 sc1 lds
  buffer_load_dwordx4 v4, s[24:27], s41 offen offset:3072 sc1 lds
  s_add_u32 m0, s48, 98304
  s_mov_b32 s41, 32768
  buffer_load_dwordx4 v4, s[20:23], s41 offen offset:0 sc1 lds
  buffer_load_dwordx4 v4, s[20:23], s41 offen offset:1024 sc1 lds
  buffer_load_dwordx4 v4, s[20:23], s41 offen offset:2048 sc1 lds
  buffer_load_dwordx4 v4, s[20:23], s41 offen offset:3072 sc1 lds
  v_mul_u32_u24 v15, 44032, v28
  v_lshrrev_b32 v16, 5, v1
  v_lshl_add_u32 v15, v16, 8, v15
  v_lshl_add_u32 v15, v23, 4, v15
  v_mov_b32 v16, 0xc0135761
  v_mov_b32 v17, 0xbdd2d3e8
  v_mov_b32 v18, 1.0
  v_mov_b32 v19, 1.0
  v_lshlrev_b32 v96, 16, v92
  v_and_b32 v97, 0xffff0000, v92
  v_lshlrev_b32 v98, 16, v93
  v_and_b32 v99, 0xffff0000, v93
  s_mul_i32 s39, s33, 3
  s_add_u32 s39, s39, 0
  s_lshl_b32 s40, s39, 9
  s_add_u32 s40, s40, 54525952
  s_cmp_ge_u32 s39, 86
  s_cbranch_scc1 k2_kernel_skiph2
  v_pk_fma_f32 v[32:33], v[80:81], v[120:121], v[32:33] op_sel_hi:[1,0,1] neg_lo:[1,0,0] neg_hi:[1,0,0]
  v_pk_fma_f32 v[34:35], v[82:83], v[120:121], v[34:35] op_sel_hi:[1,0,1] neg_lo:[1,0,0] neg_hi:[1,0,0]
  v_pk_fma_f32 v[36:37], v[80:81], v[122:123], v[36:37] op_sel_hi:[1,0,1] neg_lo:[1,0,0] neg_hi:[1,0,0]
  v_pk_fma_f32 v[38:39], v[82:83], v[122:123], v[38:39] op_sel_hi:[1,0,1] neg_lo:[1,0,0] neg_hi:[1,0,0]
  v_pk_fma_f32 v[32:33], v[32:33], v[120:121], v[96:97] op_sel:[0,1,0]
  v_pk_fma_f32 v[34:35], v[34:35], v[120:121], v[98:99] op_sel:[0,1,0]
  v_pk_fma_f32 v[36:37], v[36:37], v[122:123], v[96:97] op_sel:[0,1,0]
  v_pk_fma_f32 v[38:39], v[38:39], v[122:123], v[98:99] op_sel:[0,1,0]
  v_pk_mul_f32 v[100:101], v[32:33], v[32:33]
  v_pk_mul_f32 v[102:103], v[34:35], v[34:35]
  v_pk_mul_f32 v[104:105], v[36:37], v[36:37]
  v_pk_mul_f32 v[106:107], v[38:39], v[38:39]
  v_pk_fma_f32 v[100:101], v[100:101], v[16:17], v[16:17] op_sel:[0,1,0] op_sel_hi:[1,1,0]
  v_pk_fma_f32 v[102:103], v[102:103], v[16:17], v[16:17] op_sel:[0,1,0] op_sel_hi:[1,1,0]
  v_pk_fma_f32 v[104:105], v[104:105], v[16:17], v[16:17] op_sel:[0,1,0] op_sel_hi:[1,1,0]
  v_pk_fma_f32 v[106:107], v[106:107], v[16:17], v[16:17] op_sel:[0,1,0] op_sel_hi:[1,1,0]
  v_pk_mul_f32 v[100:101], v[100:101], v[32:33]
  v_pk_mul_f32 v[102:103], v[102:103], v[34:35]
  v_pk_mul_f32 v[104:105], v[104:105], v[36:37]
  v_pk_mul_f32 v[106:107], v[106:107], v[38:39]
  v_exp_f32 v100, v100
  v_exp_f32 v101, v101
  v_exp_f32 v102, v102
  v_exp_f32 v103, v103
  v_exp_f32 v104, v104
  v_exp_f32 v105, v105
  v_exp_f32 v106, v106
  v_exp_f32 v107, v107
  v_pk_add_f32 v[100:101], v[100:101], v[18:19]
  v_pk_add_f32 v[102:103], v[102:103], v[18:19]
  v_pk_add_f32 v[104:105], v[104:105], v[18:19]
  v_pk_add_f32 v[106:107], v[106:107], v[18:19]
  v_rcp_f32 v100, v100
  v_rcp_f32 v101, v101
  v_rcp_f32 v102, v102
  v_rcp_f32 v103, v103
  v_rcp_f32 v104, v104
  v_rcp_f32 v105, v105
  v_rcp_f32 v106, v106
  v_rcp_f32 v107, v107
  v_pk_mul_f32 v[32:33], v[32:33], v[100:101]
  v_pk_mul_f32 v[34:35], v[34:35], v[102:103]
  v_pk_mul_f32 v[36:37], v[36:37], v[104:105]
  v_pk_mul_f32 v[38:39], v[38:39], v[106:107]
  v_cvt_pk_bf16_f32 v32, v32, v33
  v_cvt_pk_bf16_f32 v33, v34, v35
  v_cvt_pk_bf16_f32 v34, v36, v37
  v_cvt_pk_bf16_f32 v35, v38, v39
  s_add_u32 s38, s56, s40
  s_nop 0
  v_permlane16_swap_b32 v32, v34
  v_permlane16_swap_b32 v33, v35
  buffer_store_dwordx4 v[32:35], v15, s[8:11], s38 offen sc1
  v_pk_fma_f32 v[40:41], v[80:81], v[124:125], v[40:41] op_sel_hi:[1,0,1] neg_lo:[1,0,0] neg_hi:[1,0,0]
  v_pk_fma_f32 v[42:43], v[82:83], v[124:125], v[42:43] op_sel_hi:[1,0,1] neg_lo:[1,0,0] neg_hi:[1,0,0]
  v_pk_fma_f32 v[44:45], v[80:81], v[126:127], v[44:45] op_sel_hi:[1,0,1] neg_lo:[1,0,0] neg_hi:[1,0,0]
  v_pk_fma_f32 v[46:47], v[82:83], v[126:127], v[46:47] op_sel_hi:[1,0,1] neg_lo:[1,0,0] neg_hi:[1,0,0]
  v_pk_fma_f32 v[40:41], v[40:41], v[124:125], v[96:97] op_sel:[0,1,0]
  v_pk_fma_f32 v[42:43], v[42:43], v[124:125], v[98:99] op_sel:[0,1,0]
  v_pk_fma_f32 v[44:45], v[44:45], v[126:127], v[96:97] op_sel:[0,1,0]
  v_pk_fma_f32 v[46:47], v[46:47], v[126:127], v[98:99] op_sel:[0,1,0]
  v_pk_mul_f32 v[100:101], v[40:41], v[40:41]
  v_pk_mul_f32 v[102:103], v[42:43], v[42:43]
  v_pk_mul_f32 v[104:105], v[44:45], v[44:45]
  v_pk_mul_f32 v[106:107], v[46:47], v[46:47]
  v_pk_fma_f32 v[100:101], v[100:101], v[16:17], v[16:17] op_sel:[0,1,0] op_sel_hi:[1,1,0]
  v_pk_fma_f32 v[102:103], v[102:103], v[16:17], v[16:17] op_sel:[0,1,0] op_sel_hi:[1,1,0]
  v_pk_fma_f32 v[104:105], v[104:105], v[16:17], v[16:17] op_sel:[0,1,0] op_sel_hi:[1,1,0]
  v_pk_fma_f32 v[106:107], v[106:107], v[16:17], v[16:17] op_sel:[0,1,0] op_sel_hi:[1,1,0]
  v_pk_mul_f32 v[100:101], v[100:101], v[40:41]
  v_pk_mul_f32 v[102:103], v[102:103], v[42:43]
  v_pk_mul_f32 v[104:105], v[104:105], v[44:45]
  v_pk_mul_f32 v[106:107], v[106:107], v[46:47]
  v_exp_f32 v100, v100
  v_exp_f32 v101, v101
  v_exp_f32 v102, v102
  v_exp_f32 v103, v103
  v_exp_f32 v104, v104
  v_exp_f32 v105, v105
  v_exp_f32 v106, v106
  v_exp_f32 v107, v107
  v_pk_add_f32 v[100:101], v[100:101], v[18:19]
  v_pk_add_f32 v[102:103], v[102:103], v[18:19]
  v_pk_add_f32 v[104:105], v[104:105], v[18:19]
  v_pk_add_f32 v[106:107], v[106:107], v[18:19]
  v_rcp_f32 v100, v100
  v_rcp_f32 v101, v101
  v_rcp_f32 v102, v102
  v_rcp_f32 v103, v103
  v_rcp_f32 v104, v104
  v_rcp_f32 v105, v105
  v_rcp_f32 v106, v106
  v_rcp_f32 v107, v107
  v_pk_mul_f32 v[40:41], v[40:41], v[100:101]
  v_pk_mul_f32 v[42:43], v[42:43], v[102:103]
  v_pk_mul_f32 v[44:45], v[44:45], v[104:105]
  v_pk_mul_f32 v[46:47], v[46:47], v[106:107]
  v_cvt_pk_bf16_f32 v40, v40, v41
  v_cvt_pk_bf16_f32 v41, v42, v43
  v_cvt_pk_bf16_f32 v42, v44, v45
  v_cvt_pk_bf16_f32 v43, v46, v47
  s_add_u32 s38, s58, s40
  s_nop 0
  v_permlane16_swap_b32 v40, v42
  v_permlane16_swap_b32 v41, v43
  buffer_store_dwordx4 v[40:43], v15, s[8:11], s38 offen sc1
k2_kernel_skiph2:
  v_lshlrev_b32 v96, 16, v94
  v_and_b32 v97, 0xffff0000, v94
  v_lshlrev_b32 v98, 16, v95
  v_and_b32 v99, 0xffff0000, v95
  s_mul_i32 s39, s33, 3
  s_add_u32 s39, s39, 1
  s_lshl_b32 s40, s39, 9
  s_add_u32 s40, s40, 54525952
  s_cmp_ge_u32 s39, 86
  s_cbranch_scc1 k2_kernel_skiph3
  v_pk_fma_f32 v[48:49], v[84:85], v[120:121], v[48:49] op_sel_hi:[1,0,1] neg_lo:[1,0,0] neg_hi:[1,0,0]
  v_pk_fma_f32 v[50:51], v[86:87], v[120:121], v[50:51] op_sel_hi:[1,0,1] neg_lo:[1,0,0] neg_hi:[1,0,0]
  v_pk_fma_f32 v[52:53], v[84:85], v[122:123], v[52:53] op_sel_hi:[1,0,1] neg_lo:[1,0,0] neg_hi:[1,0,0]
  v_pk_fma_f32 v[54:55], v[86:87], v[122:123], v[54:55] op_sel_hi:[1,0,1] neg_lo:[1,0,0] neg_hi:[1,0,0]
  v_pk_fma_f32 v[48:49], v[48:49], v[120:121], v[96:97] op_sel:[0,1,0]
  v_pk_fma_f32 v[50:51], v[50:51], v[120:121], v[98:99] op_sel:[0,1,0]
  v_pk_fma_f32 v[52:53], v[52:53], v[122:123], v[96:97] op_sel:[0,1,0]
  v_pk_fma_f32 v[54:55], v[54:55], v[122:123], v[98:99] op_sel:[0,1,0]
  v_pk_mul_f32 v[100:101], v[48:49], v[48:49]
  v_pk_mul_f32 v[102:103], v[50:51], v[50:51]
  v_pk_mul_f32 v[104:105], v[52:53], v[52:53]
  v_pk_mul_f32 v[106:107], v[54:55], v[54:55]
  v_pk_fma_f32 v[100:101], v[100:101], v[16:17], v[16:17] op_sel:[0,1,0] op_sel_hi:[1,1,0]
  v_pk_fma_f32 v[102:103], v[102:103], v[16:17], v[16:17] op_sel:[0,1,0] op_sel_hi:[1,1,0]
  v_pk_fma_f32 v[104:105], v[104:105], v[16:17], v[16:17] op_sel:[0,1,0] op_sel_hi:[1,1,0]
  v_pk_fma_f32 v[106:107], v[106:107], v[16:17], v[16:17] op_sel:[0,1,0] op_sel_hi:[1,1,0]
  v_pk_mul_f32 v[100:101], v[100:101], v[48:49]
  v_pk_mul_f32 v[102:103], v[102:103], v[50:51]
  v_pk_mul_f32 v[104:105], v[104:105], v[52:53]
  v_pk_mul_f32 v[106:107], v[106:107], v[54:55]
  v_exp_f32 v100, v100
  v_exp_f32 v101, v101
  v_exp_f32 v102, v102
  v_exp_f32 v103, v103
  v_exp_f32 v104, v104
  v_exp_f32 v105, v105
  v_exp_f32 v106, v106
  v_exp_f32 v107, v107
  v_pk_add_f32 v[100:101], v[100:101], v[18:19]
  v_pk_add_f32 v[102:103], v[102:103], v[18:19]
  v_pk_add_f32 v[104:105], v[104:105], v[18:19]
  v_pk_add_f32 v[106:107], v[106:107], v[18:19]
  v_rcp_f32 v100, v100
  v_rcp_f32 v101, v101
  v_rcp_f32 v102, v102
  v_rcp_f32 v103, v103
  v_rcp_f32 v104, v104
  v_rcp_f32 v105, v105
  v_rcp_f32 v106, v106
  v_rcp_f32 v107, v107
  v_pk_mul_f32 v[48:49], v[48:49], v[100:101]
  v_pk_mul_f32 v[50:51], v[50:51], v[102:103]
  v_pk_mul_f32 v[52:53], v[52:53], v[104:105]
  v_pk_mul_f32 v[54:55], v[54:55], v[106:107]
  v_cvt_pk_bf16_f32 v48, v48, v49
  v_cvt_pk_bf16_f32 v49, v50, v51
  v_cvt_pk_bf16_f32 v50, v52, v53
  v_cvt_pk_bf16_f32 v51, v54, v55
  s_add_u32 s38, s56, s40
  s_nop 0
  v_permlane16_swap_b32 v48, v50
  v_permlane16_swap_b32 v49, v51
  buffer_store_dwordx4 v[48:51], v15, s[8:11], s38 offen sc1
  v_pk_fma_f32 v[56:57], v[84:85], v[124:125], v[56:57] op_sel_hi:[1,0,1] neg_lo:[1,0,0] neg_hi:[1,0,0]
  v_pk_fma_f32 v[58:59], v[86:87], v[124:125], v[58:59] op_sel_hi:[1,0,1] neg_lo:[1,0,0] neg_hi:[1,0,0]
  v_pk_fma_f32 v[60:61], v[84:85], v[126:127], v[60:61] op_sel_hi:[1,0,1] neg_lo:[1,0,0] neg_hi:[1,0,0]
  v_pk_fma_f32 v[62:63], v[86:87], v[126:127], v[62:63] op_sel_hi:[1,0,1] neg_lo:[1,0,0] neg_hi:[1,0,0]
  v_pk_fma_f32 v[56:57], v[56:57], v[124:125], v[96:97] op_sel:[0,1,0]
  v_pk_fma_f32 v[58:59], v[58:59], v[124:125], v[98:99] op_sel:[0,1,0]
  v_pk_fma_f32 v[60:61], v[60:61], v[126:127], v[96:97] op_sel:[0,1,0]
  v_pk_fma_f32 v[62:63], v[62:63], v[126:127], v[98:99] op_sel:[0,1,0]
  v_pk_mul_f32 v[100:101], v[56:57], v[56:57]
  v_pk_mul_f32 v[102:103], v[58:59], v[58:59]
  v_pk_mul_f32 v[104:105], v[60:61], v[60:61]
  v_pk_mul_f32 v[106:107], v[62:63], v[62:63]
  v_pk_fma_f32 v[100:101], v[100:101], v[16:17], v[16:17] op_sel:[0,1,0] op_sel_hi:[1,1,0]
  v_pk_fma_f32 v[102:103], v[102:103], v[16:17], v[16:17] op_sel:[0,1,0] op_sel_hi:[1,1,0]
  v_pk_fma_f32 v[104:105], v[104:105], v[16:17], v[16:17] op_sel:[0,1,0] op_sel_hi:[1,1,0]
  v_pk_fma_f32 v[106:107], v[106:107], v[16:17], v[16:17] op_sel:[0,1,0] op_sel_hi:[1,1,0]
  v_pk_mul_f32 v[100:101], v[100:101], v[56:57]
  v_pk_mul_f32 v[102:103], v[102:103], v[58:59]
  v_pk_mul_f32 v[104:105], v[104:105], v[60:61]
  v_pk_mul_f32 v[106:107], v[106:107], v[62:63]
  v_exp_f32 v100, v100
  v_exp_f32 v101, v101
  v_exp_f32 v102, v102
  v_exp_f32 v103, v103
  v_exp_f32 v104, v104
  v_exp_f32 v105, v105
  v_exp_f32 v106, v106
  v_exp_f32 v107, v107
  v_pk_add_f32 v[100:101], v[100:101], v[18:19]
  v_pk_add_f32 v[102:103], v[102:103], v[18:19]
  v_pk_add_f32 v[104:105], v[104:105], v[18:19]
  v_pk_add_f32 v[106:107], v[106:107], v[18:19]
  v_rcp_f32 v100, v100
  v_rcp_f32 v101, v101
  v_rcp_f32 v102, v102
  v_rcp_f32 v103, v103
  v_rcp_f32 v104, v104
  v_rcp_f32 v105, v105
  v_rcp_f32 v106, v106
  v_rcp_f32 v107, v107
  v_pk_mul_f32 v[56:57], v[56:57], v[100:101]
  v_pk_mul_f32 v[58:59], v[58:59], v[102:103]
  v_pk_mul_f32 v[60:61], v[60:61], v[104:105]
  v_pk_mul_f32 v[62:63], v[62:63], v[106:107]
  v_cvt_pk_bf16_f32 v56, v56, v57
  v_cvt_pk_bf16_f32 v57, v58, v59
  v_cvt_pk_bf16_f32 v58, v60, v61
  v_cvt_pk_bf16_f32 v59, v62, v63
  s_add_u32 s38, s58, s40
  s_nop 0
  v_permlane16_swap_b32 v56, v58
  v_permlane16_swap_b32 v57, v59
  buffer_store_dwordx4 v[56:59], v15, s[8:11], s38 offen sc1
k2_kernel_skiph3:
  v_lshlrev_b32 v96, 16, v30
  v_and_b32 v97, 0xffff0000, v30
  v_lshlrev_b32 v98, 16, v31
  v_and_b32 v99, 0xffff0000, v31
  s_mul_i32 s39, s33, 3
  s_add_u32 s39, s39, 2
  s_lshl_b32 s40, s39, 9
  s_add_u32 s40, s40, 54525952
  s_cmp_ge_u32 s39, 86
  s_cbranch_scc1 k2_kernel_skiph4
  v_pk_fma_f32 v[64:65], v[88:89], v[120:121], v[64:65] op_sel_hi:[1,0,1] neg_lo:[1,0,0] neg_hi:[1,0,0]
  v_pk_fma_f32 v[66:67], v[90:91], v[120:121], v[66:67] op_sel_hi:[1,0,1] neg_lo:[1,0,0] neg_hi:[1,0,0]
  v_pk_fma_f32 v[68:69], v[88:89], v[122:123], v[68:69] op_sel_hi:[1,0,1] neg_lo:[1,0,0] neg_hi:[1,0,0]
  v_pk_fma_f32 v[70:71], v[90:91], v[122:123], v[70:71] op_sel_hi:[1,0,1] neg_lo:[1,0,0] neg_hi:[1,0,0]
  v_pk_fma_f32 v[64:65], v[64:65], v[120:121], v[96:97] op_sel:[0,1,0]
  v_pk_fma_f32 v[66:67], v[66:67], v[120:121], v[98:99] op_sel:[0,1,0]
  v_pk_fma_f32 v[68:69], v[68:69], v[122:123], v[96:97] op_sel:[0,1,0]
  v_pk_fma_f32 v[70:71], v[70:71], v[122:123], v[98:99] op_sel:[0,1,0]
  v_pk_mul_f32 v[100:101], v[64:65], v[64:65]
  v_pk_mul_f32 v[102:103], v[66:67], v[66:67]
  v_pk_mul_f32 v[104:105], v[68:69], v[68:69]
  v_pk_mul_f32 v[106:107], v[70:71], v[70:71]
  v_pk_fma_f32 v[100:101], v[100:101], v[16:17], v[16:17] op_sel:[0,1,0] op_sel_hi:[1,1,0]
  v_pk_fma_f32 v[102:103], v[102:103], v[16:17], v[16:17] op_sel:[0,1,0] op_sel_hi:[1,1,0]
  v_pk_fma_f32 v[104:105], v[104:105], v[16:17], v[16:17] op_sel:[0,1,0] op_sel_hi:[1,1,0]
  v_pk_fma_f32 v[106:107], v[106:107], v[16:17], v[16:17] op_sel:[0,1,0] op_sel_hi:[1,1,0]
  v_pk_mul_f32 v[100:101], v[100:101], v[64:65]
  v_pk_mul_f32 v[102:103], v[102:103], v[66:67]
  v_pk_mul_f32 v[104:105], v[104:105], v[68:69]
  v_pk_mul_f32 v[106:107], v[106:107], v[70:71]
  v_exp_f32 v100, v100
  v_exp_f32 v101, v101
  v_exp_f32 v102, v102
  v_exp_f32 v103, v103
  v_exp_f32 v104, v104
  v_exp_f32 v105, v105
  v_exp_f32 v106, v106
  v_exp_f32 v107, v107
  v_pk_add_f32 v[100:101], v[100:101], v[18:19]
  v_pk_add_f32 v[102:103], v[102:103], v[18:19]
  v_pk_add_f32 v[104:105], v[104:105], v[18:19]
  v_pk_add_f32 v[106:107], v[106:107], v[18:19]
  v_rcp_f32 v100, v100
  v_rcp_f32 v101, v101
  v_rcp_f32 v102, v102
  v_rcp_f32 v103, v103
  v_rcp_f32 v104, v104
  v_rcp_f32 v105, v105
  v_rcp_f32 v106, v106
  v_rcp_f32 v107, v107
  v_pk_mul_f32 v[64:65], v[64:65], v[100:101]
  v_pk_mul_f32 v[66:67], v[66:67], v[102:103]
  v_pk_mul_f32 v[68:69], v[68:69], v[104:105]
  v_pk_mul_f32 v[70:71], v[70:71], v[106:107]
  v_cvt_pk_bf16_f32 v64, v64, v65
  v_cvt_pk_bf16_f32 v65, v66, v67
  v_cvt_pk_bf16_f32 v66, v68, v69
  v_cvt_pk_bf16_f32 v67, v70, v71
  s_add_u32 s38, s56, s40
  s_nop 0
  v_permlane16_swap_b32 v64, v66
  v_permlane16_swap_b32 v65, v67
  buffer_store_dwordx4 v[64:67], v15, s[8:11], s38 offen sc1
  v_pk_fma_f32 v[72:73], v[88:89], v[124:125], v[72:73] op_sel_hi:[1,0,1] neg_lo:[1,0,0] neg_hi:[1,0,0]
  v_pk_fma_f32 v[74:75], v[90:91], v[124:125], v[74:75] op_sel_hi:[1,0,1] neg_lo:[1,0,0] neg_hi:[1,0,0]
  v_pk_fma_f32 v[76:77], v[88:89], v[126:127], v[76:77] op_sel_hi:[1,0,1] neg_lo:[1,0,0] neg_hi:[1,0,0]
  v_pk_fma_f32 v[78:79], v[90:91], v[126:127], v[78:79] op_sel_hi:[1,0,1] neg_lo:[1,0,0] neg_hi:[1,0,0]
  v_pk_fma_f32 v[72:73], v[72:73], v[124:125], v[96:97] op_sel:[0,1,0]
  v_pk_fma_f32 v[74:75], v[74:75], v[124:125], v[98:99] op_sel:[0,1,0]
  v_pk_fma_f32 v[76:77], v[76:77], v[126:127], v[96:97] op_sel:[0,1,0]
  v_pk_fma_f32 v[78:79], v[78:79], v[126:127], v[98:99] op_sel:[0,1,0]
  v_pk_mul_f32 v[100:101], v[72:73], v[72:73]
  v_pk_mul_f32 v[102:103], v[74:75], v[74:75]
  v_pk_mul_f32 v[104:105], v[76:77], v[76:77]
  v_pk_mul_f32 v[106:107], v[78:79], v[78:79]
  v_pk_fma_f32 v[100:101], v[100:101], v[16:17], v[16:17] op_sel:[0,1,0] op_sel_hi:[1,1,0]
  v_pk_fma_f32 v[102:103], v[102:103], v[16:17], v[16:17] op_sel:[0,1,0] op_sel_hi:[1,1,0]
  v_pk_fma_f32 v[104:105], v[104:105], v[16:17], v[16:17] op_sel:[0,1,0] op_sel_hi:[1,1,0]
  v_pk_fma_f32 v[106:107], v[106:107], v[16:17], v[16:17] op_sel:[0,1,0] op_sel_hi:[1,1,0]
  v_pk_mul_f32 v[100:101], v[100:101], v[72:73]
  v_pk_mul_f32 v[102:103], v[102:103], v[74:75]
  v_pk_mul_f32 v[104:105], v[104:105], v[76:77]
  v_pk_mul_f32 v[106:107], v[106:107], v[78:79]
  v_exp_f32 v100, v100
  v_exp_f32 v101, v101
  v_exp_f32 v102, v102
  v_exp_f32 v103, v103
  v_exp_f32 v104, v104
  v_exp_f32 v105, v105
  v_exp_f32 v106, v106
  v_exp_f32 v107, v107
  v_pk_add_f32 v[100:101], v[100:101], v[18:19]
  v_pk_add_f32 v[102:103], v[102:103], v[18:19]
  v_pk_add_f32 v[104:105], v[104:105], v[18:19]
  v_pk_add_f32 v[106:107], v[106:107], v[18:19]
  v_rcp_f32 v100, v100
  v_rcp_f32 v101, v101
  v_rcp_f32 v102, v102
  v_rcp_f32 v103, v103
  v_rcp_f32 v104, v104
  v_rcp_f32 v105, v105
  v_rcp_f32 v106, v106
  v_rcp_f32 v107, v107
  v_pk_mul_f32 v[72:73], v[72:73], v[100:101]
  v_pk_mul_f32 v[74:75], v[74:75], v[102:103]
  v_pk_mul_f32 v[76:77], v[76:77], v[104:105]
  v_pk_mul_f32 v[78:79], v[78:79], v[106:107]
  v_cvt_pk_bf16_f32 v72, v72, v73
  v_cvt_pk_bf16_f32 v73, v74, v75
  v_cvt_pk_bf16_f32 v74, v76, v77
  v_cvt_pk_bf16_f32 v75, v78, v79
  s_add_u32 s38, s58, s40
  s_nop 0
  v_permlane16_swap_b32 v72, v74
  v_permlane16_swap_b32 v73, v75
  buffer_store_dwordx4 v[72:75], v15, s[8:11], s38 offen sc1
k2_kernel_skiph4:
  s_add_u32 m0, s48, 114688
  s_mov_b32 s41, 32768
  buffer_load_dwordx4 v4, s[24:27], s41 offen offset:0 sc1 lds
  buffer_load_dwordx4 v4, s[24:27], s41 offen offset:1024 sc1 lds
  buffer_load_dwordx4 v4, s[24:27], s41 offen offset:2048 sc1 lds
  buffer_load_dwordx4 v4, s[24:27], s41 offen offset:3072 sc1 lds
  s_add_u32 m0, s48, 131072
  s_mov_b32 s41, 49152
  buffer_load_dwordx4 v4, s[20:23], s41 offen offset:0 sc1 lds
  buffer_load_dwordx4 v4, s[20:23], s41 offen offset:1024 sc1 lds
  buffer_load_dwordx4 v4, s[20:23], s41 offen offset:2048 sc1 lds
  buffer_load_dwordx4 v4, s[20:23], s41 offen offset:3072 sc1 lds
  s_add_u32 m0, s48, 147456
  s_mov_b32 s41, 49152
  buffer_load_dwordx4 v4, s[24:27], s41 offen offset:0 sc1 lds
  buffer_load_dwordx4 v4, s[24:27], s41 offen offset:1024 sc1 lds
  buffer_load_dwordx4 v4, s[24:27], s41 offen offset:2048 sc1 lds
  buffer_load_dwordx4 v4, s[24:27], s41 offen offset:3072 sc1 lds
  v_mov_b32 v16, 0x3e0293ee
  v_mov_b32 v17, 0x3e0293ee
  v_pk_mul_f32 v[128:129], v[128:129], v[16:17]
  v_pk_mul_f32 v[130:131], v[130:131], v[16:17]
  v_cvt_pk_bf16_f32 v32, v128, v129
  v_cvt_pk_bf16_f32 v33, v130, v131
  v_pk_mul_f32 v[144:145], v[144:145], v[16:17]
  v_pk_mul_f32 v[146:147], v[146:147], v[16:17]
  v_cvt_pk_bf16_f32 v34, v144, v145
  v_cvt_pk_bf16_f32 v35, v146, v147
  v_pk_mul_f32 v[160:161], v[160:161], v[16:17]
  v_pk_mul_f32 v[162:163], v[162:163], v[16:17]
  v_cvt_pk_bf16_f32 v36, v160, v161
  v_cvt_pk_bf16_f32 v37, v162, v163
  v_pk_mul_f32 v[176:177], v[176:177], v[16:17]
  v_pk_mul_f32 v[178:179], v[178:179], v[16:17]
  v_cvt_pk_bf16_f32 v38, v176, v177
  v_cvt_pk_bf16_f32 v39, v178, v179
  v_pk_mul_f32 v[192:193], v[192:193], v[16:17]
  v_pk_mul_f32 v[194:195], v[194:195], v[16:17]
  v_cvt_pk_bf16_f32 v40, v192, v193
  v_cvt_pk_bf16_f32 v41, v194, v195
  v_pk_mul_f32 v[208:209], v[208:209], v[16:17]
  v_pk_mul_f32 v[210:211], v[210:211], v[16:17]
  v_cvt_pk_bf16_f32 v42, v208, v209
  v_cvt_pk_bf16_f32 v43, v210, v211
  v_pk_mul_f32 v[224:225], v[224:225], v[16:17]
  v_pk_mul_f32 v[226:227], v[226:227], v[16:17]
  v_cvt_pk_bf16_f32 v44, v224, v225
  v_cvt_pk_bf16_f32 v45, v226, v227
  v_pk_mul_f32 v[240:241], v[240:241], v[16:17]
  v_pk_mul_f32 v[242:243], v[242:243], v[16:17]
  v_cvt_pk_bf16_f32 v46, v240, v241
  v_cvt_pk_bf16_f32 v47, v242, v243
  v_pk_mul_f32 v[132:133], v[132:133], v[16:17]
  v_pk_mul_f32 v[134:135], v[134:135], v[16:17]
  v_cvt_pk_bf16_f32 v48, v132, v133
  v_cvt_pk_bf16_f32 v49, v134, v135
  v_pk_mul_f32 v[148:149], v[148:149], v[16:17]
  v_pk_mul_f32 v[150:151], v[150:151], v[16:17]
  v_cvt_pk_bf16_f32 v50, v148, v149
  v_cvt_pk_bf16_f32 v51, v150, v151
  v_pk_mul_f32 v[164:165], v[164:165], v[16:17]
  v_pk_mul_f32 v[166:167], v[166:167], v[16:17]
  v_cvt_pk_bf16_f32 v52, v164, v165
  v_cvt_pk_bf16_f32 v53, v166, v167
  v_pk_mul_f32 v[180:181], v[180:181], v[16:17]
  v_pk_mul_f32 v[182:183], v[182:183], v[16:17]
  v_cvt_pk_bf16_f32 v54, v180, v181
  v_cvt_pk_bf16_f32 v55, v182, v183
  v_pk_mul_f32 v[196:197], v[196:197], v[16:17]
  v_pk_mul_f32 v[198:199], v[198:199], v[16:17]
  v_cvt_pk_bf16_f32 v56, v196, v197
  v_cvt_pk_bf16_f32 v57, v198, v199
  v_pk_mul_f32 v[212:213], v[212:213], v[16:17]
  v_pk_mul_f32 v[214:215], v[214:215], v[16:17]
  v_cvt_pk_bf16_f32 v58, v212, v213
  v_cvt_pk_bf16_f32 v59, v214, v215
  v_pk_mul_f32 v[228:229], v[228:229], v[16:17]
  v_pk_mul_f32 v[230:231], v[230:231], v[16:17]
  v_cvt_pk_bf16_f32 v60, v228, v229
  v_cvt_pk_bf16_f32 v61, v230, v231
  v_pk_mul_f32 v[244:245], v[244:245], v[16:17]
  v_pk_mul_f32 v[246:247], v[246:247], v[16:17]
  v_cvt_pk_bf16_f32 v62, v244, v245
  v_cvt_pk_bf16_f32 v63, v246, v247
  v_pk_mul_f32 v[136:137], v[136:137], v[16:17]
  v_pk_mul_f32 v[138:139], v[138:139], v[16:17]
  v_cvt_pk_bf16_f32 v64, v136, v137
  v_cvt_pk_bf16_f32 v65, v138, v139
  v_pk_mul_f32 v[152:153], v[152:153], v[16:17]
  v_pk_mul_f32 v[154:155], v[154:155], v[16:17]
  v_cvt_pk_bf16_f32 v66, v152, v153
  v_cvt_pk_bf16_f32 v67, v154, v155
  v_pk_mul_f32 v[168:169], v[168:169], v[16:17]
  v_pk_mul_f32 v[170:171], v[170:171], v[16:17]
  v_cvt_pk_bf16_f32 v68, v168, v169
  v_cvt_pk_bf16_f32 v69, v170, v171
  v_pk_mul_f32 v[184:185], v[184:185], v[16:17]
  v_pk_mul_f32 v[186:187], v[186:187], v[16:17]
  v_cvt_pk_bf16_f32 v70, v184, v185
  v_cvt_pk_bf16_f32 v71, v186, v187
  v_pk_mul_f32 v[200:201], v[200:201], v[16:17]
  v_pk_mul_f32 v[202:203], v[202:203], v[16:17]
  v_cvt_pk_bf16_f32 v72, v200, v201
  v_cvt_pk_bf16_f32 v73, v202, v203
  v_pk_mul_f32 v[216:217], v[216:217], v[16:17]
  v_pk_mul_f32 v[218:219], v[218:219], v[16:17]
  v_cvt_pk_bf16_f32 v74, v216, v217
  v_cvt_pk_bf16_f32 v75, v218, v219
  v_pk_mul_f32 v[232:233], v[232:233], v[16:17]
  v_pk_mul_f32 v[234:235], v[234:235], v[16:17]
  v_cvt_pk_bf16_f32 v76, v232, v233
  v_cvt_pk_bf16_f32 v77, v234, v235
  v_pk_mul_f32 v[248:249], v[248:249], v[16:17]
  v_pk_mul_f32 v[250:251], v[250:251], v[16:17]
  v_cvt_pk_bf16_f32 v78, v248, v249
  v_cvt_pk_bf16_f32 v79, v250, v251
  v_pk_mul_f32 v[140:141], v[140:141], v[16:17]
  v_pk_mul_f32 v[142:143], v[142:143], v[16:17]
  v_cvt_pk_bf16_f32 v80, v140, v141
  v_cvt_pk_bf16_f32 v81, v142, v143
  v_pk_mul_f32 v[156:157], v[156:157], v[16:17]
  v_pk_mul_f32 v[158:159], v[158:159], v[16:17]
  v_cvt_pk_bf16_f32 v82, v156, v157
  v_cvt_pk_bf16_f32 v83, v158, v159
  v_pk_mul_f32 v[172:173], v[172:173], v[16:17]
  v_pk_mul_f32 v[174:175], v[174:175], v[16:17]
  v_cvt_pk_bf16_f32 v84, v172, v173
  v_cvt_pk_bf16_f32 v85, v174, v175
  v_pk_mul_f32 v[188:189], v[188:189], v[16:17]
  v_pk_mul_f32 v[190:191], v[190:191], v[16:17]
  v_cvt_pk_bf16_f32 v86, v188, v189
  v_cvt_pk_bf16_f32 v87, v190, v191
  v_pk_mul_f32 v[204:205], v[204:205], v[16:17]
  v_pk_mul_f32 v[206:207], v[206:207], v[16:17]
  v_cvt_pk_bf16_f32 v88, v204, v205
  v_cvt_pk_bf16_f32 v89, v206, v207
  v_pk_mul_f32 v[220:221], v[220:221], v[16:17]
  v_pk_mul_f32 v[222:223], v[222:223], v[16:17]
  v_cvt_pk_bf16_f32 v90, v220, v221
  v_cvt_pk_bf16_f32 v91, v222, v223
  v_pk_mul_f32 v[236:237], v[236:237], v[16:17]
  v_pk_mul_f32 v[238:239], v[238:239], v[16:17]
  v_cvt_pk_bf16_f32 v92, v236, v237
  v_cvt_pk_bf16_f32 v93, v238, v239
  v_pk_mul_f32 v[252:253], v[252:253], v[16:17]
  v_pk_mul_f32 v[254:255], v[254:255], v[16:17]
  v_cvt_pk_bf16_f32 v94, v252, v253
  v_cvt_pk_bf16_f32 v95, v254, v255
  s_and_b32 s38, s32, 1
  s_lshl_b32 s38, s38, 5
  v_add_u32 v5, s38, v23
  v_lshlrev_b32 v15, 2, v22
  v_sub_u32 v5, v5, v15
  v_mov_b32 v6, 0xf149f2ca
  v_mov_b32 v24, 0x3f803f80
  v_mov_b32 v25, 0x3f803f80
  v_mov_b32 v26, 0x3f803f80
  v_mov_b32 v27, 0x3f803f80
  v_mov_b32 v112, 0
  v_mov_b32 v113, 0
  v_mov_b32 v114, 0
  v_mov_b32 v115, 0
  v_mov_b32 v116, 0
  v_mov_b32 v117, 0
  v_mov_b32 v118, 0
  v_mov_b32 v119, 0
  v_mov_b32 v120, 0
  v_mov_b32 v121, 0
  v_mov_b32 v122, 0
  v_mov_b32 v123, 0
  v_mov_b32 v124, 0
  v_mov_b32 v125, 0
  v_mov_b32 v126, 0
  v_mov_b32 v127, 0
  s_mov_b32 s49, 0x67800000
  s_mov_b32 s42, 0
  s_mov_b32 s45, 98304
  s_mov_b32 s46, 65536
  s_mov_b32 s37, 2
  v_mov_b32 v21, s49
  v_add_u32 v13, 32768, v2
  s_waitcnt vmcnt(24)
  s_barrier
  ds_read_b128 a[0:3], v13 offset:0
  ds_read_b128 a[4:7], v13 offset:1024
  ds_read_b128 a[8:11], v13 offset:2048
  ds_read_b128 a[12:15], v13 offset:3072
  ds_read_b128 a[16:19], v13 offset:4096
  ds_read_b128 a[20:23], v13 offset:5120
  ds_read_b128 a[24:27], v13 offset:6144
  ds_read_b128 a[28:31], v13 offset:7168
  ds_read_b128 a[32:35], v13 offset:8192
  ds_read_b128 a[36:39], v13 offset:9216
  ds_read_b128 a[40:43], v13 offset:10240
  ds_read_b128 a[44:47], v13 offset:11264
  ds_read_b128 a[48:51], v13 offset:12288
  ds_read_b128 a[52:55], v13 offset:13312
  ds_read_b128 a[56:59], v13 offset:14336
  ds_read_b128 a[60:63], v13 offset:15360
  s_waitcnt lgkmcnt(15)
  v_mfma_f32_16x16x32_bf16 v[128:131], a[0:3], v[32:35], 0
  v_accvgpr_write_b32 a64, 0
  v_accvgpr_write_b32 a65, 0
  v_mfma_f32_16x16x32_bf16 v[144:147], a[0:3], v[48:51], 0
  v_accvgpr_write_b32 a66, 0
  v_accvgpr_write_b32 a67, 0
  v_mfma_f32_16x16x32_bf16 v[192:195], a[0:3], v[64:67], 0
  v_accvgpr_write_b32 a68, 0
  v_accvgpr_write_b32 a69, 0
  v_mfma_f32_16x16x32_bf16 v[208:211], a[0:3], v[80:83], 0
  v_accvgpr_write_b32 a70, 0
  v_accvgpr_write_b32 a71, 0
  s_waitcnt lgkmcnt(14)
  v_mfma_f32_16x16x32_bf16 v[128:131], a[4:7], v[36:39], v[128:131]
  v_accvgpr_write_b32 a72, 0
  v_accvgpr_write_b32 a73, 0
  v_mfma_f32_16x16x32_bf16 v[144:147], a[4:7], v[52:55], v[144:147]
  v_accvgpr_write_b32 a74, 0
  v_accvgpr_write_b32 a75, 0
  v_mfma_f32_16x16x32_bf16 v[192:195], a[4:7], v[68:71], v[192:195]
  v_accvgpr_write_b32 a76, 0
  v_accvgpr_write_b32 a77, 0
  v_mfma_f32_16x16x32_bf16 v[208:211], a[4:7], v[84:87], v[208:211]
  v_accvgpr_write_b32 a78, 0
  v_accvgpr_write_b32 a79, 0
  s_waitcnt lgkmcnt(13)
  v_mfma_f32_16x16x32_bf16 v[128:131], a[8:11], v[40:43], v[128:131]
  v_accvgpr_write_b32 a80, 0
  v_accvgpr_write_b32 a81, 0
  v_mfma_f32_16x16x32_bf16 v[144:147], a[8:11], v[56:59], v[144:147]
  v_accvgpr_write_b32 a82, 0
  v_accvgpr_write_b32 a83, 0
  v_mfma_f32_16x16x32_bf16 v[192:195], a[8:11], v[72:75], v[192:195]
  v_accvgpr_write_b32 a84, 0
  v_accvgpr_write_b32 a85, 0
  v_mfma_f32_16x16x32_bf16 v[208:211], a[8:11], v[88:91], v[208:211]
  v_accvgpr_write_b32 a86, 0
  v_accvgpr_write_b32 a87, 0
  s_waitcnt lgkmcnt(12)
  v_mfma_f32_16x16x32_bf16 v[128:131], a[12:15], v[44:47], v[128:131]
  v_accvgpr_write_b32 a88, 0
  v_accvgpr_write_b32 a89, 0
  v_mfma_f32_16x16x32_bf16 v[144:147], a[12:15], v[60:63], v[144:147]
  v_accvgpr_write_b32 a90, 0
  v_accvgpr_write_b32 a91, 0
  v_mfma_f32_16x16x32_bf16 v[192:195], a[12:15], v[76:79], v[192:195]
  v_accvgpr_write_b32 a92, 0
  v_accvgpr_write_b32 a93, 0
  v_mfma_f32_16x16x32_bf16 v[208:211], a[12:15], v[92:95], v[208:211]
  v_accvgpr_write_b32 a94, 0
  v_accvgpr_write_b32 a95, 0
  s_waitcnt lgkmcnt(11)
  v_mfma_f32_16x16x32_bf16 v[132:135], a[16:19], v[32:35], 0
  v_accvgpr_write_b32 a96, 0
  v_accvgpr_write_b32 a97, 0
  v_mfma_f32_16x16x32_bf16 v[148:151], a[16:19], v[48:51], 0
  v_accvgpr_write_b32 a98, 0
  v_accvgpr_write_b32 a99, 0
  v_mfma_f32_16x16x32_bf16 v[196:199], a[16:19], v[64:67], 0
  v_accvgpr_write_b32 a100, 0
  v_accvgpr_write_b32 a101, 0
  v_mfma_f32_16x16x32_bf16 v[212:215], a[16:19], v[80:83], 0
  v_accvgpr_write_b32 a102, 0
  v_accvgpr_write_b32 a103, 0
  s_waitcnt lgkmcnt(10)
  v_mfma_f32_16x16x32_bf16 v[132:135], a[20:23], v[36:39], v[132:135]
  v_accvgpr_write_b32 a104, 0
  v_accvgpr_write_b32 a105, 0
  v_mfma_f32_16x16x32_bf16 v[148:151], a[20:23], v[52:55], v[148:151]
  v_accvgpr_write_b32 a106, 0
  v_accvgpr_write_b32 a107, 0
  v_mfma_f32_16x16x32_bf16 v[196:199], a[20:23], v[68:71], v[196:199]
  v_accvgpr_write_b32 a108, 0
  v_accvgpr_write_b32 a109, 0
  v_mfma_f32_16x16x32_bf16 v[212:215], a[20:23], v[84:87], v[212:215]
  v_accvgpr_write_b32 a110, 0
  v_accvgpr_write_b32 a111, 0
  s_waitcnt lgkmcnt(9)
  v_mfma_f32_16x16x32_bf16 v[132:135], a[24:27], v[40:43], v[132:135]
  v_accvgpr_write_b32 a112, 0
  v_accvgpr_write_b32 a113, 0
  v_mfma_f32_16x16x32_bf16 v[148:151], a[24:27], v[56:59], v[148:151]
  v_accvgpr_write_b32 a114, 0
  v_accvgpr_write_b32 a115, 0
  v_mfma_f32_16x16x32_bf16 v[196:199], a[24:27], v[72:75], v[196:199]
  v_accvgpr_write_b32 a116, 0
  v_accvgpr_write_b32 a117, 0
  v_mfma_f32_16x16x32_bf16 v[212:215], a[24:27], v[88:91], v[212:215]
  v_accvgpr_write_b32 a118, 0
  v_accvgpr_write_b32 a119, 0
  s_waitcnt lgkmcnt(8)
  v_mfma_f32_16x16x32_bf16 v[132:135], a[28:31], v[44:47], v[132:135]
  v_accvgpr_write_b32 a120, 0
  v_accvgpr_write_b32 a121, 0
  v_mfma_f32_16x16x32_bf16 v[148:151], a[28:31], v[60:63], v[148:151]
  v_accvgpr_write_b32 a122, 0
  v_accvgpr_write_b32 a123, 0
  v_mfma_f32_16x16x32_bf16 v[196:199], a[28:31], v[76:79], v[196:199]
  v_accvgpr_write_b32 a124, 0
  v_accvgpr_write_b32 a125, 0
  v_mfma_f32_16x16x32_bf16 v[212:215], a[28:31], v[92:95], v[212:215]
  v_accvgpr_write_b32 a126, 0
  v_accvgpr_write_b32 a127, 0
  s_waitcnt lgkmcnt(7)
  v_mfma_f32_16x16x32_bf16 v[136:139], a[32:35], v[32:35], 0
  v_accvgpr_write_b32 a128, 0
  v_accvgpr_write_b32 a129, 0
  v_mfma_f32_16x16x32_bf16 v[152:155], a[32:35], v[48:51], 0
  v_accvgpr_write_b32 a130, 0
  v_accvgpr_write_b32 a131, 0
  v_mfma_f32_16x16x32_bf16 v[200:203], a[32:35], v[64:67], 0
  v_accvgpr_write_b32 a132, 0
  v_accvgpr_write_b32 a133, 0
  v_mfma_f32_16x16x32_bf16 v[216:219], a[32:35], v[80:83], 0
  v_accvgpr_write_b32 a134, 0
  v_accvgpr_write_b32 a135, 0
  s_waitcnt lgkmcnt(6)
  v_mfma_f32_16x16x32_bf16 v[136:139], a[36:39], v[36:39], v[136:139]
  v_accvgpr_write_b32 a136, 0
  v_accvgpr_write_b32 a137, 0
  v_mfma_f32_16x16x32_bf16 v[152:155], a[36:39], v[52:55], v[152:155]
  v_accvgpr_write_b32 a138, 0
  v_accvgpr_write_b32 a139, 0
  v_mfma_f32_16x16x32_bf16 v[200:203], a[36:39], v[68:71], v[200:203]
  v_accvgpr_write_b32 a140, 0
  v_accvgpr_write_b32 a141, 0
  v_mfma_f32_16x16x32_bf16 v[216:219], a[36:39], v[84:87], v[216:219]
  v_accvgpr_write_b32 a142, 0
  v_accvgpr_write_b32 a143, 0
  s_waitcnt lgkmcnt(5)
  v_mfma_f32_16x16x32_bf16 v[136:139], a[40:43], v[40:43], v[136:139]
  v_accvgpr_write_b32 a144, 0
  v_accvgpr_write_b32 a145, 0
  v_mfma_f32_16x16x32_bf16 v[152:155], a[40:43], v[56:59], v[152:155]
  v_accvgpr_write_b32 a146, 0
  v_accvgpr_write_b32 a147, 0
  v_mfma_f32_16x16x32_bf16 v[200:203], a[40:43], v[72:75], v[200:203]
  v_accvgpr_write_b32 a148, 0
  v_accvgpr_write_b32 a149, 0
  v_mfma_f32_16x16x32_bf16 v[216:219], a[40:43], v[88:91], v[216:219]
  v_accvgpr_write_b32 a150, 0
  v_accvgpr_write_b32 a151, 0
  s_waitcnt lgkmcnt(4)
  v_mfma_f32_16x16x32_bf16 v[136:139], a[44:47], v[44:47], v[136:139]
  v_accvgpr_write_b32 a152, 0
  v_accvgpr_write_b32 a153, 0
  v_mfma_f32_16x16x32_bf16 v[152:155], a[44:47], v[60:63], v[152:155]
  v_accvgpr_write_b32 a154, 0
  v_accvgpr_write_b32 a155, 0
  v_mfma_f32_16x16x32_bf16 v[200:203], a[44:47], v[76:79], v[200:203]
  v_accvgpr_write_b32 a156, 0
  v_accvgpr_write_b32 a157, 0
  v_mfma_f32_16x16x32_bf16 v[216:219], a[44:47], v[92:95], v[216:219]
  v_accvgpr_write_b32 a158, 0
  v_accvgpr_write_b32 a159, 0
  s_waitcnt lgkmcnt(3)
  v_mfma_f32_16x16x32_bf16 v[140:143], a[48:51], v[32:35], 0
  v_accvgpr_write_b32 a160, 0
  v_accvgpr_write_b32 a161, 0
  v_mfma_f32_16x16x32_bf16 v[156:159], a[48:51], v[48:51], 0
  v_accvgpr_write_b32 a162, 0
  v_accvgpr_write_b32 a163, 0
  v_mfma_f32_16x16x32_bf16 v[204:207], a[48:51], v[64:67], 0
  v_accvgpr_write_b32 a164, 0
  v_accvgpr_write_b32 a165, 0
  v_mfma_f32_16x16x32_bf16 v[220:223], a[48:51], v[80:83], 0
  v_accvgpr_write_b32 a166, 0
  v_accvgpr_write_b32 a167, 0
  s_waitcnt lgkmcnt(2)
  v_mfma_f32_16x16x32_bf16 v[140:143], a[52:55], v[36:39], v[140:143]
  v_accvgpr_write_b32 a168, 0
  v_accvgpr_write_b32 a169, 0
  v_mfma_f32_16x16x32_bf16 v[156:159], a[52:55], v[52:55], v[156:159]
  v_accvgpr_write_b32 a170, 0
  v_accvgpr_write_b32 a171, 0
  v_mfma_f32_16x16x32_bf16 v[204:207], a[52:55], v[68:71], v[204:207]
  v_accvgpr_write_b32 a172, 0
  v_accvgpr_write_b32 a173, 0
  v_mfma_f32_16x16x32_bf16 v[220:223], a[52:55], v[84:87], v[220:223]
  v_accvgpr_write_b32 a174, 0
  v_accvgpr_write_b32 a175, 0
  s_waitcnt lgkmcnt(1)
  v_mfma_f32_16x16x32_bf16 v[140:143], a[56:59], v[40:43], v[140:143]
  v_accvgpr_write_b32 a176, 0
  v_accvgpr_write_b32 a177, 0
  v_mfma_f32_16x16x32_bf16 v[156:159], a[56:59], v[56:59], v[156:159]
  v_accvgpr_write_b32 a178, 0
  v_accvgpr_write_b32 a179, 0
  v_mfma_f32_16x16x32_bf16 v[204:207], a[56:59], v[72:75], v[204:207]
  v_accvgpr_write_b32 a180, 0
  v_accvgpr_write_b32 a181, 0
  v_mfma_f32_16x16x32_bf16 v[220:223], a[56:59], v[88:91], v[220:223]
  v_accvgpr_write_b32 a182, 0
  v_accvgpr_write_b32 a183, 0
  s_waitcnt lgkmcnt(0)
  v_mfma_f32_16x16x32_bf16 v[140:143], a[60:63], v[44:47], v[140:143]
  v_accvgpr_write_b32 a184, 0
  v_accvgpr_write_b32 a185, 0
  v_mfma_f32_16x16x32_bf16 v[156:159], a[60:63], v[60:63], v[156:159]
  v_accvgpr_write_b32 a186, 0
  v_accvgpr_write_b32 a187, 0
  v_mfma_f32_16x16x32_bf16 v[204:207], a[60:63], v[76:79], v[204:207]
  v_accvgpr_write_b32 a188, 0
  v_accvgpr_write_b32 a189, 0
  v_mfma_f32_16x16x32_bf16 v[220:223], a[60:63], v[92:95], v[220:223]
  v_accvgpr_write_b32 a190, 0
  v_accvgpr_write_b32 a191, 0
  s_waitcnt vmcnt(0)
  s_barrier
  s_lshl_b32 s38, s34, 8
  s_lshl_b32 s39, s33, 2
  s_add_u32 s38, s38, s39
  s_add_u32 s38, s38, 61931648
  v_mov_b32 v17, 0
  v_mov_b32 v18, 1
  s_cmp_lg_u32 s32, 0
  s_cbranch_scc1 k2_kernel_skip15
  s_mov_b64 exec, 1
  buffer_store_dword v18, v17, s[8:11], s38 offen sc1
  s_mov_b64 exec, -1
k2_kernel_skip15:
  s_add_u32 m0, s42, s48
  v_add_u32 v3, 65536, v2
  buffer_load_dwordx4 v4, s[20:23], s46 offen offset:0 sc1 lds
  buffer_load_dwordx4 v4, s[20:23], s46 offen offset:1024 sc1 lds
  ds_read_b128 a[192:195], v3 offset:0
  ds_read_b128 a[196:199], v3 offset:1024
  ds_read_b128 a[200:203], v3 offset:2048
  ds_read_b128 a[204:207], v3 offset:3072
  ds_read_b128 a[208:211], v3 offset:4096
  ds_read_b128 a[212:215], v3 offset:5120
  ds_read_b128 a[216:219], v3 offset:6144
  ds_read_b128 a[220:223], v3 offset:7168
  s_cmp_lg_u32 s35, 1
  s_cbranch_scc1 k2_kernel_nomask06
  v_cmp_gt_i32 s[56:57], 0, v5
  v_cmp_gt_i32 s[58:59], 1, v5
  s_nop 0
  v_cndmask_b32 v128, v128, v6, s[56:57]
  v_cndmask_b32 v129, v129, v6, s[58:59]
  v_cmp_gt_i32 s[56:57], 2, v5
  v_cmp_gt_i32 s[58:59], 3, v5
  s_nop 0
  v_cndmask_b32 v130, v130, v6, s[56:57]
  v_cndmask_b32 v131, v131, v6, s[58:59]
  v_cmp_gt_i32 s[56:57], 16, v5
  v_cmp_gt_i32 s[58:59], 17, v5
  s_nop 0
  v_cndmask_b32 v132, v132, v6, s[56:57]
  v_cndmask_b32 v133, v133, v6, s[58:59]
  v_cmp_gt_i32 s[56:57], 18, v5
  v_cmp_gt_i32 s[58:59], 19, v5
  s_nop 0
  v_cndmask_b32 v134, v134, v6, s[56:57]
  v_cndmask_b32 v135, v135, v6, s[58:59]
  v_cmp_gt_i32 s[56:57], 32, v5
  v_cmp_gt_i32 s[58:59], 33, v5
  s_nop 0
  v_cndmask_b32 v136, v136, v6, s[56:57]
  v_cndmask_b32 v137, v137, v6, s[58:59]
  v_cmp_gt_i32 s[56:57], 34, v5
  v_cmp_gt_i32 s[58:59], 35, v5
  s_nop 0
  v_cndmask_b32 v138, v138, v6, s[56:57]
  v_cndmask_b32 v139, v139, v6, s[58:59]
  v_cmp_gt_i32 s[56:57], 48, v5
  v_cmp_gt_i32 s[58:59], 49, v5
  s_nop 0
  v_cndmask_b32 v140, v140, v6, s[56:57]
  v_cndmask_b32 v141, v141, v6, s[58:59]
  v_cmp_gt_i32 s[56:57], 50, v5
  v_cmp_gt_i32 s[58:59], 51, v5
  s_nop 0
  v_cndmask_b32 v142, v142, v6, s[56:57]
  v_cndmask_b32 v143, v143, v6, s[58:59]
  v_cmp_gt_i32 s[56:57], -16, v5
  v_cmp_gt_i32 s[58:59], -15, v5
  s_nop 0
  v_cndmask_b32 v144, v144, v6, s[56:57]
  v_cndmask_b32 v145, v145, v6, s[58:59]
  v_cmp_gt_i32 s[56:57], -14, v5
  v_cmp_gt_i32 s[58:59], -13, v5
  s_nop 0
  v_cndmask_b32 v146, v146, v6, s[56:57]
  v_cndmask_b32 v147, v147, v6, s[58:59]
  v_cmp_gt_i32 s[56:57], 0, v5
  v_cmp_gt_i32 s[58:59], 1, v5
  s_nop 0
  v_cndmask_b32 v148, v148, v6, s[56:57]
  v_cndmask_b32 v149, v149, v6, s[58:59]
  v_cmp_gt_i32 s[56:57], 2, v5
  v_cmp_gt_i32 s[58:59], 3, v5
  s_nop 0
  v_cndmask_b32 v150, v150, v6, s[56:57]
  v_cndmask_b32 v151, v151, v6, s[58:59]
  v_cmp_gt_i32 s[56:57], 16, v5
  v_cmp_gt_i32 s[58:59], 17, v5
  s_nop 0
  v_cndmask_b32 v152, v152, v6, s[56:57]
  v_cndmask_b32 v153, v153, v6, s[58:59]
  v_cmp_gt_i32 s[56:57], 18, v5
  v_cmp_gt_i32 s[58:59], 19, v5
  s_nop 0
  v_cndmask_b32 v154, v154, v6, s[56:57]
  v_cndmask_b32 v155, v155, v6, s[58:59]
  v_cmp_gt_i32 s[56:57], 32, v5
  v_cmp_gt_i32 s[58:59], 33, v5
  s_nop 0
  v_cndmask_b32 v156, v156, v6, s[56:57]
  v_cndmask_b32 v157, v157, v6, s[58:59]
  v_cmp_gt_i32 s[56:57], 34, v5
  v_cmp_gt_i32 s[58:59], 35, v5
  s_nop 0
  v_cndmask_b32 v158, v158, v6, s[56:57]
  v_cndmask_b32 v159, v159, v6, s[58:59]
k2_kernel_nomask06:
  v_max3_f32 v15, v128, v129, v130
  v_max3_f32 v15, v15, v131, v132
  v_max3_f32 v15, v15, v133, v134
  v_max3_f32 v15, v15, v135, v136
  v_max3_f32 v15, v15, v137, v138
  v_max3_f32 v15, v15, v139, v140
  v_max3_f32 v15, v15, v141, v142
  v_max_f32 v15, v15, v143
  v_mov_b32 v14, v15
  s_nop 1
  v_permlane16_swap_b32 v15, v14
  v_max_f32 v15, v15, v14
  v_mov_b32 v14, v15
  s_nop 1
  v_permlane32_swap_b32 v15, v14
  v_max_f32 v15, v15, v14
  v_sub_f32 v96, 0, v15
  v_sub_f32 v97, 0, v15
  v_sub_f32 v98, 0, v15
  v_sub_f32 v99, 0, v15
  v_pk_add_f32 v[128:129], v[128:129], v[96:97]
  v_pk_add_f32 v[130:131], v[130:131], v[96:97]
  v_pk_add_f32 v[132:133], v[132:133], v[96:97]
  v_pk_add_f32 v[134:135], v[134:135], v[96:97]
  v_pk_add_f32 v[136:137], v[136:137], v[96:97]
  v_pk_add_f32 v[138:139], v[138:139], v[96:97]
  v_pk_add_f32 v[140:141], v[140:141], v[96:97]
  v_pk_add_f32 v[142:143], v[142:143], v[96:97]
  v_max3_f32 v15, v144, v145, v146
  v_max3_f32 v15, v15, v147, v148
  v_max3_f32 v15, v15, v149, v150
  v_max3_f32 v15, v15, v151, v152
  v_max3_f32 v15, v15, v153, v154
  v_max3_f32 v15, v15, v155, v156
  v_max3_f32 v15, v15, v157, v158
  v_max_f32 v15, v15, v159
  v_mov_b32 v14, v15
  s_nop 1
  v_permlane16_swap_b32 v15, v14
  v_max_f32 v15, v15, v14
  v_mov_b32 v14, v15
  s_nop 1
  v_permlane32_swap_b32 v15, v14
  v_max_f32 v15, v15, v14
  v_sub_f32 v100, 0, v15
  v_sub_f32 v101, 0, v15
  v_sub_f32 v102, 0, v15
  v_sub_f32 v103, 0, v15
  v_pk_add_f32 v[144:145], v[144:145], v[100:101]
  v_pk_add_f32 v[146:147], v[146:147], v[100:101]
  v_pk_add_f32 v[148:149], v[148:149], v[100:101]
  v_pk_add_f32 v[150:151], v[150:151], v[100:101]
  v_pk_add_f32 v[152:153], v[152:153], v[100:101]
  v_pk_add_f32 v[154:155], v[154:155], v[100:101]
  v_pk_add_f32 v[156:157], v[156:157], v[100:101]
  v_pk_add_f32 v[158:159], v[158:159], v[100:101]
  v_max3_f32 v15, v192, v193, v194
  v_max3_f32 v15, v15, v195, v196
  v_max3_f32 v15, v15, v197, v198
  v_max3_f32 v15, v15, v199, v200
  v_max3_f32 v15, v15, v201, v202
  v_max3_f32 v15, v15, v203, v204
  v_max3_f32 v15, v15, v205, v206
  v_max_f32 v15, v15, v207
  v_mov_b32 v14, v15
  s_nop 1
  v_permlane16_swap_b32 v15, v14
  v_max_f32 v15, v15, v14
  v_mov_b32 v14, v15
  s_nop 1
  v_permlane32_swap_b32 v15, v14
  v_max_f32 v15, v15, v14
  v_sub_f32 v104, 0, v15
  v_sub_f32 v105, 0, v15
  v_sub_f32 v106, 0, v15
  v_sub_f32 v107, 0, v15
  v_pk_add_f32 v[192:193], v[192:193], v[104:105]
  v_pk_add_f32 v[194:195], v[194:195], v[104:105]
  v_pk_add_f32 v[196:197], v[196:197], v[104:105]
  v_pk_add_f32 v[198:199], v[198:199], v[104:105]
  v_pk_add_f32 v[200:201], v[200:201], v[104:105]
  v_pk_add_f32 v[202:203], v[202:203], v[104:105]
  v_pk_add_f32 v[204:205], v[204:205], v[104:105]
  v_pk_add_f32 v[206:207], v[206:207], v[104:105]
  v_max3_f32 v15, v208, v209, v210
  v_max3_f32 v15, v15, v211, v212
  v_max3_f32 v15, v15, v213, v214
  v_max3_f32 v15, v15, v215, v216
  v_max3_f32 v15, v15, v217, v218
  v_max3_f32 v15, v15, v219, v220
  v_max3_f32 v15, v15, v221, v222
  v_max_f32 v15, v15, v223
  v_mov_b32 v14, v15
  s_nop 1
  v_permlane16_swap_b32 v15, v14
  v_max_f32 v15, v15, v14
  v_mov_b32 v14, v15
  s_nop 1
  v_permlane32_swap_b32 v15, v14
  v_max_f32 v15, v15, v14
  v_sub_f32 v108, 0, v15
  v_sub_f32 v109, 0, v15
  v_sub_f32 v110, 0, v15
  v_sub_f32 v111, 0, v15
  v_pk_add_f32 v[208:209], v[208:209], v[108:109]
  v_pk_add_f32 v[210:211], v[210:211], v[108:109]
  v_pk_add_f32 v[212:213], v[212:213], v[108:109]
  v_pk_add_f32 v[214:215], v[214:215], v[108:109]
  v_pk_add_f32 v[216:217], v[216:217], v[108:109]
  v_pk_add_f32 v[218:219], v[218:219], v[108:109]
  v_pk_add_f32 v[220:221], v[220:221], v[108:109]
  v_pk_add_f32 v[222:223], v[222:223], v[108:109]
  v_exp_f32 v128, v128
  v_exp_f32 v192, v192
  v_exp_f32 v129, v129
  v_exp_f32 v193, v193
  v_exp_f32 v130, v130
  v_exp_f32 v194, v194
  v_cvt_pk_bf16_f32 v128, v128, v129
  v_cvt_pk_bf16_f32 v192, v192, v193
  v_exp_f32 v131, v131
  v_exp_f32 v195, v195
  v_exp_f32 v132, v132
  v_exp_f32 v196, v196
  v_cvt_pk_bf16_f32 v129, v130, v131
  v_cvt_pk_bf16_f32 v193, v194, v195
  v_exp_f32 v133, v133
  v_exp_f32 v197, v197
  v_exp_f32 v134, v134
  v_exp_f32 v198, v198
  v_cvt_pk_bf16_f32 v130, v132, v133
  v_cvt_pk_bf16_f32 v194, v196, v197
  v_exp_f32 v135, v135
  v_exp_f32 v199, v199
  v_exp_f32 v144, v144
  v_exp_f32 v208, v208
  v_cvt_pk_bf16_f32 v131, v134, v135
  v_cvt_pk_bf16_f32 v195, v198, v199
  v_exp_f32 v145, v145
  v_exp_f32 v209, v209
  v_exp_f32 v146, v146
  v_exp_f32 v210, v210
  v_cvt_pk_bf16_f32 v144, v144, v145
  v_cvt_pk_bf16_f32 v208, v208, v209
  v_exp_f32 v147, v147
  v_exp_f32 v211, v211
  v_exp_f32 v148, v148
  v_exp_f32 v212, v212
  v_cvt_pk_bf16_f32 v145, v146, v147
  v_cvt_pk_bf16_f32 v209, v210, v211
  v_exp_f32 v149, v149
  v_exp_f32 v213, v213
  v_exp_f32 v150, v150
  v_exp_f32 v214, v214
  v_cvt_pk_bf16_f32 v146, v148, v149
  v_cvt_pk_bf16_f32 v210, v212, v213
  v_exp_f32 v151, v151
  v_exp_f32 v215, v215
  s_cmp_lt_u32 1, s35
  s_cbranch_scc0 k2_DL0
k2_DD0:
  s_waitcnt lgkmcnt(4)
  v_mfma_f32_16x16x32_bf16 v[160:163], a[192:195], v[32:35], v[96:99]
  v_exp_f32 v136, v136
  v_mfma_f32_16x16x32_bf16 v[176:179], a[192:195], v[48:51], v[100:103]
  ds_read_b128 a[224:227], v3 offset:8192
  v_cvt_pk_bf16_f32 v147, v150, v151
  v_mfma_f32_16x16x32_bf16 v[224:227], a[192:195], v[64:67], v[104:107]
  v_exp_f32 v200, v200
  v_mfma_f32_16x16x32_bf16 v[240:243], a[192:195], v[80:83], v[108:111]
  v_cvt_pk_bf16_f32 v211, v214, v215
  v_mfma_f32_16x16x32_bf16 v[160:163], a[196:199], v[36:39], v[160:163]
  v_exp_f32 v137, v137
  v_mfma_f32_16x16x32_bf16 v[176:179], a[196:199], v[52:55], v[176:179]
  ds_read_b128 a[228:231], v3 offset:9216
  v_mfma_f32_16x16x32_bf16 v[224:227], a[196:199], v[68:71], v[224:227]
  v_exp_f32 v201, v201
  v_mfma_f32_16x16x32_bf16 v[240:243], a[196:199], v[84:87], v[240:243]
  buffer_load_dwordx4 v4, s[20:23], s46 offen offset:2048 sc1 lds
  v_mfma_f32_16x16x32_bf16 v[160:163], a[200:203], v[40:43], v[160:163]
  v_exp_f32 v138, v138
  v_mfma_f32_16x16x32_bf16 v[176:179], a[200:203], v[56:59], v[176:179]
  ds_read_b128 a[232:235], v3 offset:10240
  v_cvt_pk_bf16_f32 v136, v136, v137
  v_mfma_f32_16x16x32_bf16 v[224:227], a[200:203], v[72:75], v[224:227]
  v_exp_f32 v202, v202
  v_mfma_f32_16x16x32_bf16 v[240:243], a[200:203], v[88:91], v[240:243]
  v_cvt_pk_bf16_f32 v200, v200, v201
  v_mfma_f32_16x16x32_bf16 v[160:163], a[204:207], v[44:47], v[160:163]
  v_exp_f32 v139, v139
  v_mfma_f32_16x16x32_bf16 v[176:179], a[204:207], v[60:63], v[176:179]
  ds_read_b128 a[236:239], v3 offset:11264
  v_mfma_f32_16x16x32_bf16 v[224:227], a[204:207], v[76:79], v[224:227]
  v_exp_f32 v203, v203
  v_mfma_f32_16x16x32_bf16 v[240:243], a[204:207], v[92:95], v[240:243]
  s_waitcnt lgkmcnt(4)
  v_mfma_f32_16x16x32_bf16 v[164:167], a[208:211], v[32:35], v[96:99]
  v_exp_f32 v140, v140
  v_mfma_f32_16x16x32_bf16 v[180:183], a[208:211], v[48:51], v[100:103]
  ds_read_b128 a[240:243], v3 offset:12288
  v_cvt_pk_bf16_f32 v137, v138, v139
  v_mfma_f32_16x16x32_bf16 v[228:231], a[208:211], v[64:67], v[104:107]
  v_exp_f32 v204, v204
  v_mfma_f32_16x16x32_bf16 v[244:247], a[208:211], v[80:83], v[108:111]
  v_cvt_pk_bf16_f32 v201, v202, v203
  v_mfma_f32_16x16x32_bf16 v[164:167], a[212:215], v[36:39], v[164:167]
  v_exp_f32 v141, v141
  v_mfma_f32_16x16x32_bf16 v[180:183], a[212:215], v[52:55], v[180:183]
  ds_read_b128 a[244:247], v3 offset:13312
  v_mfma_f32_16x16x32_bf16 v[228:231], a[212:215], v[68:71], v[228:231]
  v_exp_f32 v205, v205
  v_mfma_f32_16x16x32_bf16 v[244:247], a[212:215], v[84:87], v[244:247]
  buffer_load_dwordx4 v4, s[20:23], s46 offen offset:3072 sc1 lds
  v_mfma_f32_16x16x32_bf16 v[164:167], a[216:219], v[40:43], v[164:167]
  v_exp_f32 v142, v142
  v_mfma_f32_16x16x32_bf16 v[180:183], a[216:219], v[56:59], v[180:183]
  ds_read_b128 a[248:251], v3 offset:14336
  v_cvt_pk_bf16_f32 v138, v140, v141
  v_mfma_f32_16x16x32_bf16 v[228:231], a[216:219], v[72:75], v[228:231]
  v_exp_f32 v206, v206
  v_mfma_f32_16x16x32_bf16 v[244:247], a[216:219], v[88:91], v[244:247]
  v_cvt_pk_bf16_f32 v202, v204, v205
  v_mfma_f32_16x16x32_bf16 v[164:167], a[220:223], v[44:47], v[164:167]
  v_exp_f32 v143, v143
  v_mfma_f32_16x16x32_bf16 v[180:183], a[220:223], v[60:63], v[180:183]
  ds_read_b128 a[252:255], v3 offset:15360
  v_mfma_f32_16x16x32_bf16 v[228:231], a[220:223], v[76:79], v[228:231]
  v_exp_f32 v207, v207
  v_mfma_f32_16x16x32_bf16 v[244:247], a[220:223], v[92:95], v[244:247]
  s_add_u32 m0, m0, 16384
  s_waitcnt lgkmcnt(4)
  v_mfma_f32_16x16x32_bf16 v[168:171], a[224:227], v[32:35], v[96:99]
  v_exp_f32 v152, v152
  v_mfma_f32_16x16x32_bf16 v[184:187], a[224:227], v[48:51], v[100:103]
  ds_read_b128 a[192:195], v3 offset:16384
  v_cvt_pk_bf16_f32 v139, v142, v143
  v_mfma_f32_16x16x32_bf16 v[232:235], a[224:227], v[64:67], v[104:107]
  v_exp_f32 v216, v216
  v_mfma_f32_16x16x32_bf16 v[248:251], a[224:227], v[80:83], v[108:111]
  v_cvt_pk_bf16_f32 v203, v206, v207
  v_mfma_f32_16x16x32_bf16 v[168:171], a[228:231], v[36:39], v[168:171]
  v_exp_f32 v153, v153
  v_mfma_f32_16x16x32_bf16 v[184:187], a[228:231], v[52:55], v[184:187]
  ds_read_b128 a[196:199], v3 offset:17408
  v_mfma_f32_16x16x32_bf16 v[232:235], a[228:231], v[68:71], v[232:235]
  v_exp_f32 v217, v217
  v_mfma_f32_16x16x32_bf16 v[248:251], a[228:231], v[84:87], v[248:251]
  buffer_load_dwordx4 v4, s[24:27], s46 offen offset:0 sc1 lds
  v_mfma_f32_16x16x32_bf16 v[168:171], a[232:235], v[40:43], v[168:171]
  v_exp_f32 v154, v154
  v_mfma_f32_16x16x32_bf16 v[184:187], a[232:235], v[56:59], v[184:187]
  ds_read_b128 a[200:203], v3 offset:18432
  v_cvt_pk_bf16_f32 v152, v152, v153
  v_mfma_f32_16x16x32_bf16 v[232:235], a[232:235], v[72:75], v[232:235]
  v_exp_f32 v218, v218
  v_mfma_f32_16x16x32_bf16 v[248:251], a[232:235], v[88:91], v[248:251]
  v_cvt_pk_bf16_f32 v216, v216, v217
  v_mfma_f32_16x16x32_bf16 v[168:171], a[236:239], v[44:47], v[168:171]
  v_exp_f32 v155, v155
  v_mfma_f32_16x16x32_bf16 v[184:187], a[236:239], v[60:63], v[184:187]
  ds_read_b128 a[204:207], v3 offset:19456
  v_mfma_f32_16x16x32_bf16 v[232:235], a[236:239], v[76:79], v[232:235]
  v_exp_f32 v219, v219
  v_mfma_f32_16x16x32_bf16 v[248:251], a[236:239], v[92:95], v[248:251]
  s_waitcnt lgkmcnt(4)
  v_mfma_f32_16x16x32_bf16 v[172:175], a[240:243], v[32:35], v[96:99]
  v_exp_f32 v156, v156
  v_mfma_f32_16x16x32_bf16 v[188:191], a[240:243], v[48:51], v[100:103]
  ds_read_b128 a[208:211], v3 offset:20480
  v_cvt_pk_bf16_f32 v153, v154, v155
  v_mfma_f32_16x16x32_bf16 v[236:239], a[240:243], v[64:67], v[104:107]
  v_exp_f32 v220, v220
  v_mfma_f32_16x16x32_bf16 v[252:255], a[240:243], v[80:83], v[108:111]
  v_cvt_pk_bf16_f32 v217, v218, v219
  v_mfma_f32_16x16x32_bf16 v[172:175], a[244:247], v[36:39], v[172:175]
  v_exp_f32 v157, v157
  v_mfma_f32_16x16x32_bf16 v[188:191], a[244:247], v[52:55], v[188:191]
  ds_read_b128 a[212:215], v3 offset:21504
  v_mfma_f32_16x16x32_bf16 v[236:239], a[244:247], v[68:71], v[236:239]
  v_exp_f32 v221, v221
  v_mfma_f32_16x16x32_bf16 v[252:255], a[244:247], v[84:87], v[252:255]
  buffer_load_dwordx4 v4, s[24:27], s46 offen offset:1024 sc1 lds
  v_mfma_f32_16x16x32_bf16 v[172:175], a[248:251], v[40:43], v[172:175]
  v_exp_f32 v158, v158
  v_mfma_f32_16x16x32_bf16 v[188:191], a[248:251], v[56:59], v[188:191]
  ds_read_b128 a[216:219], v3 offset:22528
  v_cvt_pk_bf16_f32 v154, v156, v157
  v_mfma_f32_16x16x32_bf16 v[236:239], a[248:251], v[72:75], v[236:239]
  v_exp_f32 v222, v222
  v_mfma_f32_16x16x32_bf16 v[252:255], a[248:251], v[88:91], v[252:255]
  v_cvt_pk_bf16_f32 v218, v220, v221
  v_mfma_f32_16x16x32_bf16 v[172:175], a[252:255], v[44:47], v[172:175]
  v_exp_f32 v159, v159
  v_mfma_f32_16x16x32_bf16 v[188:191], a[252:255], v[60:63], v[188:191]
  ds_read_b128 a[220:223], v3 offset:23552
  v_mfma_f32_16x16x32_bf16 v[236:239], a[252:255], v[76:79], v[236:239]
  v_exp_f32 v223, v223
  v_mfma_f32_16x16x32_bf16 v[252:255], a[252:255], v[92:95], v[252:255]
  s_cmp_eq_u32 s37, s35
  s_cbranch_scc1 k2_kernel_domask8
k2_kernel_nomask7:
  s_waitcnt lgkmcnt(4)
  v_mfma_f32_16x16x32_bf16 a[64:67], a[192:195], v[128:131], a[64:67]
  v_exp_f32 v160, v160
  v_mfma_f32_16x16x32_bf16 a[68:71], a[192:195], v[144:147], a[68:71]
  ds_read_b128 a[224:227], v3 offset:24576
  v_cvt_pk_bf16_f32 v155, v158, v159
  v_mfma_f32_16x16x32_bf16 a[128:131], a[192:195], v[192:195], a[128:131]
  v_exp_f32 v224, v224
  v_mfma_f32_16x16x32_bf16 a[132:135], a[192:195], v[208:211], a[132:135]
  v_cvt_pk_bf16_f32 v219, v222, v223
  v_mfma_f32_16x16x32_bf16 a[72:75], a[196:199], v[128:131], a[72:75]
  v_exp_f32 v161, v161
  v_mfma_f32_16x16x32_bf16 a[76:79], a[196:199], v[144:147], a[76:79]
  ds_read_b128 a[228:231], v3 offset:25600
  v_mfma_f32_16x16x32_bf16 a[136:139], a[196:199], v[192:195], a[136:139]
  v_exp_f32 v225, v225
  v_mfma_f32_16x16x32_bf16 a[140:143], a[196:199], v[208:211], a[140:143]
  buffer_load_dwordx4 v4, s[24:27], s46 offen offset:2048 sc1 lds
  v_mfma_f32_16x16x32_bf16 a[80:83], a[200:203], v[128:131], a[80:83]
  v_exp_f32 v162, v162
  v_mfma_f32_16x16x32_bf16 a[84:87], a[200:203], v[144:147], a[84:87]
  ds_read_b128 a[232:235], v3 offset:26624
  v_cvt_pk_bf16_f32 v160, v160, v161
  v_mfma_f32_16x16x32_bf16 a[144:147], a[200:203], v[192:195], a[144:147]
  v_exp_f32 v226, v226
  v_mfma_f32_16x16x32_bf16 a[148:151], a[200:203], v[208:211], a[148:151]
  v_cvt_pk_bf16_f32 v224, v224, v225
  v_mfma_f32_16x16x32_bf16 a[88:91], a[204:207], v[128:131], a[88:91]
  v_exp_f32 v163, v163
  v_mfma_f32_16x16x32_bf16 a[92:95], a[204:207], v[144:147], a[92:95]
  ds_read_b128 a[236:239], v3 offset:27648
  v_mfma_f32_16x16x32_bf16 v[112:115], v[24:27], v[128:131], v[112:115]
  v_mfma_f32_16x16x32_bf16 a[152:155], a[204:207], v[192:195], a[152:155]
  v_exp_f32 v227, v227
  v_mfma_f32_16x16x32_bf16 a[156:159], a[204:207], v[208:211], a[156:159]
  v_mfma_f32_16x16x32_bf16 v[120:123], v[24:27], v[192:195], v[120:123]
  s_add_u32 s37, s37, 1
  s_waitcnt lgkmcnt(4)
  v_mfma_f32_16x16x32_bf16 a[96:99], a[208:211], v[128:131], a[96:99]
  v_exp_f32 v164, v164
  v_mfma_f32_16x16x32_bf16 a[100:103], a[208:211], v[144:147], a[100:103]
  ds_read_b128 a[240:243], v3 offset:28672
  v_cvt_pk_bf16_f32 v161, v162, v163
  v_mfma_f32_16x16x32_bf16 a[160:163], a[208:211], v[192:195], a[160:163]
  v_exp_f32 v228, v228
  v_mfma_f32_16x16x32_bf16 a[164:167], a[208:211], v[208:211], a[164:167]
  v_cvt_pk_bf16_f32 v225, v226, v227
  v_mfma_f32_16x16x32_bf16 a[104:107], a[212:215], v[128:131], a[104:107]
  v_exp_f32 v165, v165
  v_mfma_f32_16x16x32_bf16 a[108:111], a[212:215], v[144:147], a[108:111]
  ds_read_b128 a[244:247], v3 offset:29696
  v_mfma_f32_16x16x32_bf16 a[168:171], a[212:215], v[192:195], a[168:171]
  v_exp_f32 v229, v229
  v_mfma_f32_16x16x32_bf16 a[172:175], a[212:215], v[208:211], a[172:175]
  buffer_load_dwordx4 v4, s[24:27], s46 offen offset:3072 sc1 lds
  v_mfma_f32_16x16x32_bf16 a[112:115], a[216:219], v[128:131], a[112:115]
  v_exp_f32 v166, v166
  v_mfma_f32_16x16x32_bf16 a[116:119], a[216:219], v[144:147], a[116:119]
  ds_read_b128 a[248:251], v3 offset:30720
  v_cvt_pk_bf16_f32 v162, v164, v165
  v_mfma_f32_16x16x32_bf16 a[176:179], a[216:219], v[192:195], a[176:179]
  v_exp_f32 v230, v230
  v_mfma_f32_16x16x32_bf16 a[180:183], a[216:219], v[208:211], a[180:183]
  v_cvt_pk_bf16_f32 v226, v228, v229
  v_mfma_f32_16x16x32_bf16 a[120:123], a[220:223], v[128:131], a[120:123]
  v_exp_f32 v167, v167
  v_mfma_f32_16x16x32_bf16 a[124:127], a[220:223], v[144:147], a[124:127]
  ds_read_b128 a[252:255], v3 offset:31744
  v_mfma_f32_16x16x32_bf16 v[116:119], v[24:27], v[144:147], v[116:119]
  v_mfma_f32_16x16x32_bf16 a[184:187], a[220:223], v[192:195], a[184:187]
  v_exp_f32 v231, v231
  v_mfma_f32_16x16x32_bf16 a[188:191], a[220:223], v[208:211], a[188:191]
  v_mfma_f32_16x16x32_bf16 v[124:127], v[24:27], v[208:211], v[124:127]
  s_add_u32 s46, s46, 16384
  s_add_u32 s42, s42, 32768
  s_waitcnt lgkmcnt(4)
  v_mfma_f32_16x16x32_bf16 a[64:67], a[224:227], v[136:139], a[64:67]
  v_exp_f32 v176, v176
  v_mfma_f32_16x16x32_bf16 a[68:71], a[224:227], v[152:155], a[68:71]
  s_waitcnt vmcnt(16)
  s_barrier
  v_add_u32 v3, s45, v2
  ds_read_b128 a[192:195], v3 offset:0
  v_cvt_pk_bf16_f32 v163, v166, v167
  v_mfma_f32_16x16x32_bf16 a[128:131], a[224:227], v[200:203], a[128:131]
  v_exp_f32 v240, v240
  v_mfma_f32_16x16x32_bf16 a[132:135], a[224:227], v[216:219], a[132:135]
  v_cvt_pk_bf16_f32 v227, v230, v231
  v_mfma_f32_16x16x32_bf16 a[72:75], a[228:231], v[136:139], a[72:75]
  v_exp_f32 v177, v177
  v_mfma_f32_16x16x32_bf16 a[76:79], a[228:231], v[152:155], a[76:79]
  ds_read_b128 a[196:199], v3 offset:1024
  v_mfma_f32_16x16x32_bf16 a[136:139], a[228:231], v[200:203], a[136:139]
  v_exp_f32 v241, v241
  v_mfma_f32_16x16x32_bf16 a[140:143], a[228:231], v[216:219], a[140:143]
  s_cmp_eq_u32 s42, 163840
  s_cselect_b32 s42, 0, s42
  s_add_u32 m0, s42, s48
  v_mfma_f32_16x16x32_bf16 a[80:83], a[232:235], v[136:139], a[80:83]
  v_exp_f32 v178, v178
  v_mfma_f32_16x16x32_bf16 a[84:87], a[232:235], v[152:155], a[84:87]
  ds_read_b128 a[200:203], v3 offset:2048
  v_cvt_pk_bf16_f32 v176, v176, v177
  v_mfma_f32_16x16x32_bf16 a[144:147], a[232:235], v[200:203], a[144:147]
  v_exp_f32 v242, v242
  v_mfma_f32_16x16x32_bf16 a[148:151], a[232:235], v[216:219], a[148:151]
  v_cvt_pk_bf16_f32 v240, v240, v241
  v_mfma_f32_16x16x32_bf16 a[88:91], a[236:239], v[136:139], a[88:91]
  v_exp_f32 v179, v179
  v_mfma_f32_16x16x32_bf16 a[92:95], a[236:239], v[152:155], a[92:95]
  ds_read_b128 a[204:207], v3 offset:3072
  v_mfma_f32_16x16x32_bf16 v[112:115], v[24:27], v[136:139], v[112:115]
  v_mfma_f32_16x16x32_bf16 a[152:155], a[236:239], v[200:203], a[152:155]
  v_exp_f32 v243, v243
  v_mfma_f32_16x16x32_bf16 a[156:159], a[236:239], v[216:219], a[156:159]
  v_mfma_f32_16x16x32_bf16 v[120:123], v[24:27], v[200:203], v[120:123]
  buffer_load_dwordx4 v4, s[20:23], s46 offen offset:0 sc1 lds
  s_waitcnt lgkmcnt(4)
  v_mfma_f32_16x16x32_bf16 a[96:99], a[240:243], v[136:139], a[96:99]
  v_exp_f32 v180, v180
  v_mfma_f32_16x16x32_bf16 a[100:103], a[240:243], v[152:155], a[100:103]
  ds_read_b128 a[208:211], v3 offset:4096
  v_cvt_pk_bf16_f32 v177, v178, v179
  v_mfma_f32_16x16x32_bf16 a[160:163], a[240:243], v[200:203], a[160:163]
  v_exp_f32 v244, v244
  v_mfma_f32_16x16x32_bf16 a[164:167], a[240:243], v[216:219], a[164:167]
  v_cvt_pk_bf16_f32 v241, v242, v243
  v_mfma_f32_16x16x32_bf16 a[104:107], a[244:247], v[136:139], a[104:107]
  v_exp_f32 v181, v181
  v_mfma_f32_16x16x32_bf16 a[108:111], a[244:247], v[152:155], a[108:111]
  ds_read_b128 a[212:215], v3 offset:5120
  v_mfma_f32_16x16x32_bf16 a[168:171], a[244:247], v[200:203], a[168:171]
  v_exp_f32 v245, v245
  v_mfma_f32_16x16x32_bf16 a[172:175], a[244:247], v[216:219], a[172:175]
  s_add_u32 s45, s45, 32768
  v_mfma_f32_16x16x32_bf16 a[112:115], a[248:251], v[136:139], a[112:115]
  v_exp_f32 v182, v182
  v_mfma_f32_16x16x32_bf16 a[116:119], a[248:251], v[152:155], a[116:119]
  ds_read_b128 a[216:219], v3 offset:6144
  v_cvt_pk_bf16_f32 v178, v180, v181
  v_mfma_f32_16x16x32_bf16 a[176:179], a[248:251], v[200:203], a[176:179]
  v_exp_f32 v246, v246
  v_mfma_f32_16x16x32_bf16 a[180:183], a[248:251], v[216:219], a[180:183]
  v_cvt_pk_bf16_f32 v242, v244, v245
  s_cmp_eq_u32 s45, 163840
  s_cselect_b32 s45, 0, s45
  v_mfma_f32_16x16x32_bf16 a[120:123], a[252:255], v[136:139], a[120:123]
  v_exp_f32 v183, v183
  v_mfma_f32_16x16x32_bf16 a[124:127], a[252:255], v[152:155], a[124:127]
  ds_read_b128 a[220:223], v3 offset:7168
  v_mfma_f32_16x16x32_bf16 v[116:119], v[24:27], v[152:155], v[116:119]
  v_mfma_f32_16x16x32_bf16 a[184:187], a[252:255], v[200:203], a[184:187]
  v_exp_f32 v247, v247
  v_mfma_f32_16x16x32_bf16 a[188:191], a[252:255], v[216:219], a[188:191]
  v_mfma_f32_16x16x32_bf16 v[124:127], v[24:27], v[216:219], v[124:127]
  buffer_load_dwordx4 v4, s[20:23], s46 offen offset:1024 sc1 lds
  s_cmp_le_u32 s37, s35
  s_cbranch_scc0 k2_DL1
k2_DD1:
  s_waitcnt lgkmcnt(4)
  v_mfma_f32_16x16x32_bf16 v[128:131], a[192:195], v[32:35], v[96:99]
  v_exp_f32 v168, v168
  v_mfma_f32_16x16x32_bf16 v[144:147], a[192:195], v[48:51], v[100:103]
  ds_read_b128 a[224:227], v3 offset:8192
  v_cvt_pk_bf16_f32 v179, v182, v183
  v_mfma_f32_16x16x32_bf16 v[192:195], a[192:195], v[64:67], v[104:107]
  v_exp_f32 v232, v232
  v_mfma_f32_16x16x32_bf16 v[208:211], a[192:195], v[80:83], v[108:111]
  v_cvt_pk_bf16_f32 v243, v246, v247
  v_mfma_f32_16x16x32_bf16 v[128:131], a[196:199], v[36:39], v[128:131]
  v_exp_f32 v169, v169
  v_mfma_f32_16x16x32_bf16 v[144:147], a[196:199], v[52:55], v[144:147]
  ds_read_b128 a[228:231], v3 offset:9216
  v_mfma_f32_16x16x32_bf16 v[192:195], a[196:199], v[68:71], v[192:195]
  v_exp_f32 v233, v233
  v_mfma_f32_16x16x32_bf16 v[208:211], a[196:199], v[84:87], v[208:211]
  buffer_load_dwordx4 v4, s[20:23], s46 offen offset:2048 sc1 lds
  v_mfma_f32_16x16x32_bf16 v[128:131], a[200:203], v[40:43], v[128:131]
  v_exp_f32 v170, v170
  v_mfma_f32_16x16x32_bf16 v[144:147], a[200:203], v[56:59], v[144:147]
  ds_read_b128 a[232:235], v3 offset:10240
  v_cvt_pk_bf16_f32 v168, v168, v169
  v_mfma_f32_16x16x32_bf16 v[192:195], a[200:203], v[72:75], v[192:195]
  v_exp_f32 v234, v234
  v_mfma_f32_16x16x32_bf16 v[208:211], a[200:203], v[88:91], v[208:211]
  v_cvt_pk_bf16_f32 v232, v232, v233
  v_mfma_f32_16x16x32_bf16 v[128:131], a[204:207], v[44:47], v[128:131]
  v_exp_f32 v171, v171
  v_mfma_f32_16x16x32_bf16 v[144:147], a[204:207], v[60:63], v[144:147]
  ds_read_b128 a[236:239], v3 offset:11264
  v_mfma_f32_16x16x32_bf16 v[192:195], a[204:207], v[76:79], v[192:195]
  v_exp_f32 v235, v235
  v_mfma_f32_16x16x32_bf16 v[208:211], a[204:207], v[92:95], v[208:211]
  s_waitcnt lgkmcnt(4)
  v_mfma_f32_16x16x32_bf16 v[132:135], a[208:211], v[32:35], v[96:99]
  v_exp_f32 v172, v172
  v_mfma_f32_16x16x32_bf16 v[148:151], a[208:211], v[48:51], v[100:103]
  ds_read_b128 a[240:243], v3 offset:12288
  v_cvt_pk_bf16_f32 v169, v170, v171
  v_mfma_f32_16x16x32_bf16 v[196:199], a[208:211], v[64:67], v[104:107]
  v_exp_f32 v236, v236
  v_mfma_f32_16x16x32_bf16 v[212:215], a[208:211], v[80:83], v[108:111]
  v_cvt_pk_bf16_f32 v233, v234, v235
  v_mfma_f32_16x16x32_bf16 v[132:135], a[212:215], v[36:39], v[132:135]
  v_exp_f32 v173, v173
  v_mfma_f32_16x16x32_bf16 v[148:151], a[212:215], v[52:55], v[148:151]
  ds_read_b128 a[244:247], v3 offset:13312
  v_mfma_f32_16x16x32_bf16 v[196:199], a[212:215], v[68:71], v[196:199]
  v_exp_f32 v237, v237
  v_mfma_f32_16x16x32_bf16 v[212:215], a[212:215], v[84:87], v[212:215]
  buffer_load_dwordx4 v4, s[20:23], s46 offen offset:3072 sc1 lds
  v_mfma_f32_16x16x32_bf16 v[132:135], a[216:219], v[40:43], v[132:135]
  v_exp_f32 v174, v174
  v_mfma_f32_16x16x32_bf16 v[148:151], a[216:219], v[56:59], v[148:151]
  ds_read_b128 a[248:251], v3 offset:14336
  v_cvt_pk_bf16_f32 v170, v172, v173
  v_mfma_f32_16x16x32_bf16 v[196:199], a[216:219], v[72:75], v[196:199]
  v_exp_f32 v238, v238
  v_mfma_f32_16x16x32_bf16 v[212:215], a[216:219], v[88:91], v[212:215]
  v_cvt_pk_bf16_f32 v234, v236, v237
  v_mfma_f32_16x16x32_bf16 v[132:135], a[220:223], v[44:47], v[132:135]
  v_exp_f32 v175, v175
  v_mfma_f32_16x16x32_bf16 v[148:151], a[220:223], v[60:63], v[148:151]
  ds_read_b128 a[252:255], v3 offset:15360
  v_mfma_f32_16x16x32_bf16 v[196:199], a[220:223], v[76:79], v[196:199]
  v_exp_f32 v239, v239
  v_mfma_f32_16x16x32_bf16 v[212:215], a[220:223], v[92:95], v[212:215]
  s_add_u32 m0, m0, 16384
  s_waitcnt lgkmcnt(4)
  v_mfma_f32_16x16x32_bf16 v[136:139], a[224:227], v[32:35], v[96:99]
  v_exp_f32 v184, v184
  v_mfma_f32_16x16x32_bf16 v[152:155], a[224:227], v[48:51], v[100:103]
  ds_read_b128 a[192:195], v3 offset:16384
  v_cvt_pk_bf16_f32 v171, v174, v175
  v_mfma_f32_16x16x32_bf16 v[200:203], a[224:227], v[64:67], v[104:107]
  v_exp_f32 v248, v248
  v_mfma_f32_16x16x32_bf16 v[216:219], a[224:227], v[80:83], v[108:111]
  v_cvt_pk_bf16_f32 v235, v238, v239
  v_mfma_f32_16x16x32_bf16 v[136:139], a[228:231], v[36:39], v[136:139]
  v_exp_f32 v185, v185
  v_mfma_f32_16x16x32_bf16 v[152:155], a[228:231], v[52:55], v[152:155]
  ds_read_b128 a[196:199], v3 offset:17408
  v_mfma_f32_16x16x32_bf16 v[200:203], a[228:231], v[68:71], v[200:203]
  v_exp_f32 v249, v249
  v_mfma_f32_16x16x32_bf16 v[216:219], a[228:231], v[84:87], v[216:219]
  buffer_load_dwordx4 v4, s[24:27], s46 offen offset:0 sc1 lds
  v_mfma_f32_16x16x32_bf16 v[136:139], a[232:235], v[40:43], v[136:139]
  v_exp_f32 v186, v186
  v_mfma_f32_16x16x32_bf16 v[152:155], a[232:235], v[56:59], v[152:155]
  ds_read_b128 a[200:203], v3 offset:18432
  v_cvt_pk_bf16_f32 v184, v184, v185
  v_mfma_f32_16x16x32_bf16 v[200:203], a[232:235], v[72:75], v[200:203]
  v_exp_f32 v250, v250
  v_mfma_f32_16x16x32_bf16 v[216:219], a[232:235], v[88:91], v[216:219]
  v_cvt_pk_bf16_f32 v248, v248, v249
  v_mfma_f32_16x16x32_bf16 v[136:139], a[236:239], v[44:47], v[136:139]
  v_exp_f32 v187, v187
  v_mfma_f32_16x16x32_bf16 v[152:155], a[236:239], v[60:63], v[152:155]
  ds_read_b128 a[204:207], v3 offset:19456
  v_mfma_f32_16x16x32_bf16 v[200:203], a[236:239], v[76:79], v[200:203]
  v_exp_f32 v251, v251
  v_mfma_f32_16x16x32_bf16 v[216:219], a[236:239], v[92:95], v[216:219]
  s_waitcnt lgkmcnt(4)
  v_mfma_f32_16x16x32_bf16 v[140:143], a[240:243], v[32:35], v[96:99]
  v_exp_f32 v188, v188
  v_mfma_f32_16x16x32_bf16 v[156:159], a[240:243], v[48:51], v[100:103]
  ds_read_b128 a[208:211], v3 offset:20480
  v_cvt_pk_bf16_f32 v185, v186, v187
  v_mfma_f32_16x16x32_bf16 v[204:207], a[240:243], v[64:67], v[104:107]
  v_exp_f32 v252, v252
  v_mfma_f32_16x16x32_bf16 v[220:223], a[240:243], v[80:83], v[108:111]
  v_cvt_pk_bf16_f32 v249, v250, v251
  v_mfma_f32_16x16x32_bf16 v[140:143], a[244:247], v[36:39], v[140:143]
  v_exp_f32 v189, v189
  v_mfma_f32_16x16x32_bf16 v[156:159], a[244:247], v[52:55], v[156:159]
  ds_read_b128 a[212:215], v3 offset:21504
  v_mfma_f32_16x16x32_bf16 v[204:207], a[244:247], v[68:71], v[204:207]
  v_exp_f32 v253, v253
  v_mfma_f32_16x16x32_bf16 v[220:223], a[244:247], v[84:87], v[220:223]
  buffer_load_dwordx4 v4, s[24:27], s46 offen offset:1024 sc1 lds
  v_mfma_f32_16x16x32_bf16 v[140:143], a[248:251], v[40:43], v[140:143]
  v_exp_f32 v190, v190
  v_mfma_f32_16x16x32_bf16 v[156:159], a[248:251], v[56:59], v[156:159]
  ds_read_b128 a[216:219], v3 offset:22528
  v_cvt_pk_bf16_f32 v186, v188, v189
  v_mfma_f32_16x16x32_bf16 v[204:207], a[248:251], v[72:75], v[204:207]
  v_exp_f32 v254, v254
  v_mfma_f32_16x16x32_bf16 v[220:223], a[248:251], v[88:91], v[220:223]
  v_cvt_pk_bf16_f32 v250, v252, v253
  v_mfma_f32_16x16x32_bf16 v[140:143], a[252:255], v[44:47], v[140:143]
  v_exp_f32 v191, v191
  v_mfma_f32_16x16x32_bf16 v[156:159], a[252:255], v[60:63], v[156:159]
  ds_read_b128 a[220:223], v3 offset:23552
  v_mfma_f32_16x16x32_bf16 v[204:207], a[252:255], v[76:79], v[204:207]
  v_exp_f32 v255, v255
  v_mfma_f32_16x16x32_bf16 v[220:223], a[252:255], v[92:95], v[220:223]
  s_cmp_eq_u32 s37, s35
  s_cbranch_scc1 k2_kernel_domask10
k2_kernel_nomask9:
  s_waitcnt lgkmcnt(4)
  v_mfma_f32_16x16x32_bf16 a[64:67], a[192:195], v[160:163], a[64:67]
  v_exp_f32 v128, v128
  v_mfma_f32_16x16x32_bf16 a[68:71], a[192:195], v[176:179], a[68:71]
  ds_read_b128 a[224:227], v3 offset:24576
  v_cvt_pk_bf16_f32 v187, v190, v191
  v_mfma_f32_16x16x32_bf16 a[128:131], a[192:195], v[224:227], a[128:131]
  v_exp_f32 v192, v192
  v_mfma_f32_16x16x32_bf16 a[132:135], a[192:195], v[240:243], a[132:135]
  v_cvt_pk_bf16_f32 v251, v254, v255
  v_mfma_f32_16x16x32_bf16 a[72:75], a[196:199], v[160:163], a[72:75]
  v_exp_f32 v129, v129
  v_mfma_f32_16x16x32_bf16 a[76:79], a[196:199], v[176:179], a[76:79]
  ds_read_b128 a[228:231], v3 offset:25600
  v_mfma_f32_16x16x32_bf16 a[136:139], a[196:199], v[224:227], a[136:139]
  v_exp_f32 v193, v193
  v_mfma_f32_16x16x32_bf16 a[140:143], a[196:199], v[240:243], a[140:143]
  buffer_load_dwordx4 v4, s[24:27], s46 offen offset:2048 sc1 lds
  v_mfma_f32_16x16x32_bf16 a[80:83], a[200:203], v[160:163], a[80:83]
  v_exp_f32 v130, v130
  v_mfma_f32_16x16x32_bf16 a[84:87], a[200:203], v[176:179], a[84:87]
  ds_read_b128 a[232:235], v3 offset:26624
  v_cvt_pk_bf16_f32 v128, v128, v129
  v_mfma_f32_16x16x32_bf16 a[144:147], a[200:203], v[224:227], a[144:147]
  v_exp_f32 v194, v194
  v_mfma_f32_16x16x32_bf16 a[148:151], a[200:203], v[240:243], a[148:151]
  v_cvt_pk_bf16_f32 v192, v192, v193
  v_mfma_f32_16x16x32_bf16 a[88:91], a[204:207], v[160:163], a[88:91]
  v_exp_f32 v131, v131
  v_mfma_f32_16x16x32_bf16 a[92:95], a[204:207], v[176:179], a[92:95]
  ds_read_b128 a[236:239], v3 offset:27648
  v_mfma_f32_16x16x32_bf16 v[112:115], v[24:27], v[160:163], v[112:115]
  v_mfma_f32_16x16x32_bf16 a[152:155], a[204:207], v[224:227], a[152:155]
  v_exp_f32 v195, v195
  v_mfma_f32_16x16x32_bf16 a[156:159], a[204:207], v[240:243], a[156:159]
  v_mfma_f32_16x16x32_bf16 v[120:123], v[24:27], v[224:227], v[120:123]
  s_add_u32 s37, s37, 1
  s_waitcnt lgkmcnt(4)
  v_mfma_f32_16x16x32_bf16 a[96:99], a[208:211], v[160:163], a[96:99]
  v_exp_f32 v132, v132
  v_mfma_f32_16x16x32_bf16 a[100:103], a[208:211], v[176:179], a[100:103]
  ds_read_b128 a[240:243], v3 offset:28672
  v_cvt_pk_bf16_f32 v129, v130, v131
  v_mfma_f32_16x16x32_bf16 a[160:163], a[208:211], v[224:227], a[160:163]
  v_exp_f32 v196, v196
  v_mfma_f32_16x16x32_bf16 a[164:167], a[208:211], v[240:243], a[164:167]
  v_cvt_pk_bf16_f32 v193, v194, v195
  v_mfma_f32_16x16x32_bf16 a[104:107], a[212:215], v[160:163], a[104:107]
  v_exp_f32 v133, v133
  v_mfma_f32_16x16x32_bf16 a[108:111], a[212:215], v[176:179], a[108:111]
  ds_read_b128 a[244:247], v3 offset:29696
  v_mfma_f32_16x16x32_bf16 a[168:171], a[212:215], v[224:227], a[168:171]
  v_exp_f32 v197, v197
  v_mfma_f32_16x16x32_bf16 a[172:175], a[212:215], v[240:243], a[172:175]
  buffer_load_dwordx4 v4, s[24:27], s46 offen offset:3072 sc1 lds
  v_mfma_f32_16x16x32_bf16 a[112:115], a[216:219], v[160:163], a[112:115]
  v_exp_f32 v134, v134
  v_mfma_f32_16x16x32_bf16 a[116:119], a[216:219], v[176:179], a[116:119]
  ds_read_b128 a[248:251], v3 offset:30720
  v_cvt_pk_bf16_f32 v130, v132, v133
  v_mfma_f32_16x16x32_bf16 a[176:179], a[216:219], v[224:227], a[176:179]
  v_exp_f32 v198, v198
  v_mfma_f32_16x16x32_bf16 a[180:183], a[216:219], v[240:243], a[180:183]
  v_cvt_pk_bf16_f32 v194, v196, v197
  v_mfma_f32_16x16x32_bf16 a[120:123], a[220:223], v[160:163], a[120:123]
  v_exp_f32 v135, v135
  v_mfma_f32_16x16x32_bf16 a[124:127], a[220:223], v[176:179], a[124:127]
  ds_read_b128 a[252:255], v3 offset:31744
  v_mfma_f32_16x16x32_bf16 v[116:119], v[24:27], v[176:179], v[116:119]
  v_mfma_f32_16x16x32_bf16 a[184:187], a[220:223], v[224:227], a[184:187]
  v_exp_f32 v199, v199
  v_mfma_f32_16x16x32_bf16 a[188:191], a[220:223], v[240:243], a[188:191]
  v_mfma_f32_16x16x32_bf16 v[124:127], v[24:27], v[240:243], v[124:127]
  s_add_u32 s46, s46, 16384
  s_add_u32 s42, s42, 32768
  s_waitcnt lgkmcnt(4)
  v_mfma_f32_16x16x32_bf16 a[64:67], a[224:227], v[168:171], a[64:67]
  v_exp_f32 v144, v144
  v_mfma_f32_16x16x32_bf16 a[68:71], a[224:227], v[184:187], a[68:71]
  s_waitcnt vmcnt(16)
  s_barrier
  v_add_u32 v3, s45, v2
  ds_read_b128 a[192:195], v3 offset:0
  v_cvt_pk_bf16_f32 v131, v134, v135
  v_mfma_f32_16x16x32_bf16 a[128:131], a[224:227], v[232:235], a[128:131]
  v_exp_f32 v208, v208
  v_mfma_f32_16x16x32_bf16 a[132:135], a[224:227], v[248:251], a[132:135]
  v_cvt_pk_bf16_f32 v195, v198, v199
  v_mfma_f32_16x16x32_bf16 a[72:75], a[228:231], v[168:171], a[72:75]
  v_exp_f32 v145, v145
  v_mfma_f32_16x16x32_bf16 a[76:79], a[228:231], v[184:187], a[76:79]
  ds_read_b128 a[196:199], v3 offset:1024
  v_mfma_f32_16x16x32_bf16 a[136:139], a[228:231], v[232:235], a[136:139]
  v_exp_f32 v209, v209
  v_mfma_f32_16x16x32_bf16 a[140:143], a[228:231], v[248:251], a[140:143]
  s_cmp_eq_u32 s42, 163840
  s_cselect_b32 s42, 0, s42
  s_add_u32 m0, s42, s48
  v_mfma_f32_16x16x32_bf16 a[80:83], a[232:235], v[168:171], a[80:83]
  v_exp_f32 v146, v146
  v_mfma_f32_16x16x32_bf16 a[84:87], a[232:235], v[184:187], a[84:87]
  ds_read_b128 a[200:203], v3 offset:2048
  v_cvt_pk_bf16_f32 v144, v144, v145
  v_mfma_f32_16x16x32_bf16 a[144:147], a[232:235], v[232:235], a[144:147]
  v_exp_f32 v210, v210
  v_mfma_f32_16x16x32_bf16 a[148:151], a[232:235], v[248:251], a[148:151]
  v_cvt_pk_bf16_f32 v208, v208, v209
  v_mfma_f32_16x16x32_bf16 a[88:91], a[236:239], v[168:171], a[88:91]
  v_exp_f32 v147, v147
  v_mfma_f32_16x16x32_bf16 a[92:95], a[236:239], v[184:187], a[92:95]
  ds_read_b128 a[204:207], v3 offset:3072
  v_mfma_f32_16x16x32_bf16 v[112:115], v[24:27], v[168:171], v[112:115]
  v_mfma_f32_16x16x32_bf16 a[152:155], a[236:239], v[232:235], a[152:155]
  v_exp_f32 v211, v211
  v_mfma_f32_16x16x32_bf16 a[156:159], a[236:239], v[248:251], a[156:159]
  v_mfma_f32_16x16x32_bf16 v[120:123], v[24:27], v[232:235], v[120:123]
  buffer_load_dwordx4 v4, s[20:23], s46 offen offset:0 sc1 lds
  s_waitcnt lgkmcnt(4)
  v_mfma_f32_16x16x32_bf16 a[96:99], a[240:243], v[168:171], a[96:99]
  v_exp_f32 v148, v148
  v_mfma_f32_16x16x32_bf16 a[100:103], a[240:243], v[184:187], a[100:103]
  ds_read_b128 a[208:211], v3 offset:4096
  v_cvt_pk_bf16_f32 v145, v146, v147
  v_mfma_f32_16x16x32_bf16 a[160:163], a[240:243], v[232:235], a[160:163]
  v_exp_f32 v212, v212
  v_mfma_f32_16x16x32_bf16 a[164:167], a[240:243], v[248:251], a[164:167]
  v_cvt_pk_bf16_f32 v209, v210, v211
  v_mfma_f32_16x16x32_bf16 a[104:107], a[244:247], v[168:171], a[104:107]
  v_exp_f32 v149, v149
  v_mfma_f32_16x16x32_bf16 a[108:111], a[244:247], v[184:187], a[108:111]
  ds_read_b128 a[212:215], v3 offset:5120
  v_mfma_f32_16x16x32_bf16 a[168:171], a[244:247], v[232:235], a[168:171]
  v_exp_f32 v213, v213
  v_mfma_f32_16x16x32_bf16 a[172:175], a[244:247], v[248:251], a[172:175]
  s_add_u32 s45, s45, 32768
  v_mfma_f32_16x16x32_bf16 a[112:115], a[248:251], v[168:171], a[112:115]
  v_exp_f32 v150, v150
  v_mfma_f32_16x16x32_bf16 a[116:119], a[248:251], v[184:187], a[116:119]
  ds_read_b128 a[216:219], v3 offset:6144
  v_cvt_pk_bf16_f32 v146, v148, v149
  v_mfma_f32_16x16x32_bf16 a[176:179], a[248:251], v[232:235], a[176:179]
  v_exp_f32 v214, v214
  v_mfma_f32_16x16x32_bf16 a[180:183], a[248:251], v[248:251], a[180:183]
  v_cvt_pk_bf16_f32 v210, v212, v213
  s_cmp_eq_u32 s45, 163840
  s_cselect_b32 s45, 0, s45
  v_mfma_f32_16x16x32_bf16 a[120:123], a[252:255], v[168:171], a[120:123]
  v_exp_f32 v151, v151
  v_mfma_f32_16x16x32_bf16 a[124:127], a[252:255], v[184:187], a[124:127]
  ds_read_b128 a[220:223], v3 offset:7168
  v_mfma_f32_16x16x32_bf16 v[116:119], v[24:27], v[184:187], v[116:119]
  v_mfma_f32_16x16x32_bf16 a[184:187], a[252:255], v[232:235], a[184:187]
  v_exp_f32 v215, v215
  v_mfma_f32_16x16x32_bf16 a[188:191], a[252:255], v[248:251], a[188:191]
  v_mfma_f32_16x16x32_bf16 v[124:127], v[24:27], v[248:251], v[124:127]
  buffer_load_dwordx4 v4, s[20:23], s46 offen offset:1024 sc1 lds
  s_cmp_le_u32 s37, s35
  s_cbranch_scc0 k2_DL0
  s_branch k2_DD0
k2_DL0:
  s_waitcnt lgkmcnt(4)
  v_mfma_f32_16x16x32_bf16 v[224:227], a[192:195], v[64:67], v[104:107]
  v_exp_f32 v136, v136
  v_exp_f32 v200, v200
  v_mfma_f32_16x16x32_bf16 v[240:243], a[192:195], v[80:83], v[108:111]
  ds_read_b128 a[224:227], v3 offset:8192
  v_cvt_pk_bf16_f32 v147, v150, v151
  v_cvt_pk_bf16_f32 v211, v214, v215
  v_mfma_f32_16x16x32_bf16 v[224:227], a[196:199], v[68:71], v[224:227]
  v_exp_f32 v137, v137
  v_exp_f32 v201, v201
  v_mfma_f32_16x16x32_bf16 v[240:243], a[196:199], v[84:87], v[240:243]
  ds_read_b128 a[228:231], v3 offset:9216
  buffer_load_dwordx4 v4, s[20:23], s46 offen offset:2048 sc1 lds
  v_mfma_f32_16x16x32_bf16 v[224:227], a[200:203], v[72:75], v[224:227]
  v_exp_f32 v138, v138
  v_exp_f32 v202, v202
  v_mfma_f32_16x16x32_bf16 v[240:243], a[200:203], v[88:91], v[240:243]
  ds_read_b128 a[232:235], v3 offset:10240
  v_cvt_pk_bf16_f32 v136, v136, v137
  v_cvt_pk_bf16_f32 v200, v200, v201
  v_mfma_f32_16x16x32_bf16 v[224:227], a[204:207], v[76:79], v[224:227]
  v_exp_f32 v139, v139
  v_exp_f32 v203, v203
  v_mfma_f32_16x16x32_bf16 v[240:243], a[204:207], v[92:95], v[240:243]
  ds_read_b128 a[236:239], v3 offset:11264
  s_waitcnt lgkmcnt(4)
  v_mfma_f32_16x16x32_bf16 v[228:231], a[208:211], v[64:67], v[104:107]
  v_exp_f32 v140, v140
  v_exp_f32 v204, v204
  v_mfma_f32_16x16x32_bf16 v[244:247], a[208:211], v[80:83], v[108:111]
  ds_read_b128 a[240:243], v3 offset:12288
  v_cvt_pk_bf16_f32 v137, v138, v139
  v_cvt_pk_bf16_f32 v201, v202, v203
  v_mfma_f32_16x16x32_bf16 v[228:231], a[212:215], v[68:71], v[228:231]
  v_exp_f32 v141, v141
  v_exp_f32 v205, v205
  v_mfma_f32_16x16x32_bf16 v[244:247], a[212:215], v[84:87], v[244:247]
  ds_read_b128 a[244:247], v3 offset:13312
  buffer_load_dwordx4 v4, s[20:23], s46 offen offset:3072 sc1 lds
  v_mfma_f32_16x16x32_bf16 v[228:231], a[216:219], v[72:75], v[228:231]
  v_exp_f32 v142, v142
  v_exp_f32 v206, v206
  v_mfma_f32_16x16x32_bf16 v[244:247], a[216:219], v[88:91], v[244:247]
  ds_read_b128 a[248:251], v3 offset:14336
  v_cvt_pk_bf16_f32 v138, v140, v141
  v_cvt_pk_bf16_f32 v202, v204, v205
  v_mfma_f32_16x16x32_bf16 v[228:231], a[220:223], v[76:79], v[228:231]
  v_exp_f32 v143, v143
  v_exp_f32 v207, v207
  v_mfma_f32_16x16x32_bf16 v[244:247], a[220:223], v[92:95], v[244:247]
  ds_read_b128 a[252:255], v3 offset:15360
  s_add_u32 m0, m0, 16384
  s_waitcnt lgkmcnt(4)
  v_mfma_f32_16x16x32_bf16 v[232:235], a[224:227], v[64:67], v[104:107]
  v_exp_f32 v152, v152
  v_exp_f32 v216, v216
  v_mfma_f32_16x16x32_bf16 v[248:251], a[224:227], v[80:83], v[108:111]
  ds_read_b128 a[192:195], v3 offset:16384
  v_cvt_pk_bf16_f32 v139, v142, v143
  v_cvt_pk_bf16_f32 v203, v206, v207
  v_mfma_f32_16x16x32_bf16 v[232:235], a[228:231], v[68:71], v[232:235]
  v_exp_f32 v153, v153
  v_exp_f32 v217, v217
  v_mfma_f32_16x16x32_bf16 v[248:251], a[228:231], v[84:87], v[248:251]
  ds_read_b128 a[196:199], v3 offset:17408
  buffer_load_dwordx4 v4, s[24:27], s46 offen offset:0 sc1 lds
  v_mfma_f32_16x16x32_bf16 v[232:235], a[232:235], v[72:75], v[232:235]
  v_exp_f32 v154, v154
  v_exp_f32 v218, v218
  v_mfma_f32_16x16x32_bf16 v[248:251], a[232:235], v[88:91], v[248:251]
  ds_read_b128 a[200:203], v3 offset:18432
  v_cvt_pk_bf16_f32 v152, v152, v153
  v_cvt_pk_bf16_f32 v216, v216, v217
  v_mfma_f32_16x16x32_bf16 v[232:235], a[236:239], v[76:79], v[232:235]
  v_exp_f32 v155, v155
  v_exp_f32 v219, v219
  v_mfma_f32_16x16x32_bf16 v[248:251], a[236:239], v[92:95], v[248:251]
  ds_read_b128 a[204:207], v3 offset:19456
  s_waitcnt lgkmcnt(4)
  v_mfma_f32_16x16x32_bf16 v[236:239], a[240:243], v[64:67], v[104:107]
  v_exp_f32 v156, v156
  v_exp_f32 v220, v220
  v_mfma_f32_16x16x32_bf16 v[252:255], a[240:243], v[80:83], v[108:111]
  ds_read_b128 a[208:211], v3 offset:20480
  v_cvt_pk_bf16_f32 v153, v154, v155
  v_cvt_pk_bf16_f32 v217, v218, v219
  v_mfma_f32_16x16x32_bf16 v[236:239], a[244:247], v[68:71], v[236:239]
  v_exp_f32 v157, v157
  v_exp_f32 v221, v221
  v_mfma_f32_16x16x32_bf16 v[252:255], a[244:247], v[84:87], v[252:255]
  ds_read_b128 a[212:215], v3 offset:21504
  buffer_load_dwordx4 v4, s[24:27], s46 offen offset:1024 sc1 lds
  v_mfma_f32_16x16x32_bf16 v[236:239], a[248:251], v[72:75], v[236:239]
  v_exp_f32 v158, v158
  v_exp_f32 v222, v222
  v_mfma_f32_16x16x32_bf16 v[252:255], a[248:251], v[88:91], v[252:255]
  ds_read_b128 a[216:219], v3 offset:22528
  v_cvt_pk_bf16_f32 v154, v156, v157
  v_cvt_pk_bf16_f32 v218, v220, v221
  v_mfma_f32_16x16x32_bf16 v[236:239], a[252:255], v[76:79], v[236:239]
  v_exp_f32 v159, v159
  v_exp_f32 v223, v223
  v_mfma_f32_16x16x32_bf16 v[252:255], a[252:255], v[92:95], v[252:255]
  ds_read_b128 a[220:223], v3 offset:23552
  s_waitcnt lgkmcnt(4)
  v_mfma_f32_16x16x32_bf16 a[64:67], a[192:195], v[128:131], a[64:67]
  v_mfma_f32_16x16x32_bf16 a[68:71], a[192:195], v[144:147], a[68:71]
  ds_read_b128 a[224:227], v3 offset:24576
  v_cvt_pk_bf16_f32 v155, v158, v159
  v_mfma_f32_16x16x32_bf16 a[128:131], a[192:195], v[192:195], a[128:131]
  v_exp_f32 v224, v224
  v_mfma_f32_16x16x32_bf16 a[132:135], a[192:195], v[208:211], a[132:135]
  v_cvt_pk_bf16_f32 v219, v222, v223
  v_mfma_f32_16x16x32_bf16 a[72:75], a[196:199], v[128:131], a[72:75]
  v_mfma_f32_16x16x32_bf16 a[76:79], a[196:199], v[144:147], a[76:79]
  ds_read_b128 a[228:231], v3 offset:25600
  v_mfma_f32_16x16x32_bf16 a[136:139], a[196:199], v[192:195], a[136:139]
  v_exp_f32 v225, v225
  v_mfma_f32_16x16x32_bf16 a[140:143], a[196:199], v[208:211], a[140:143]
  buffer_load_dwordx4 v4, s[24:27], s46 offen offset:2048 sc1 lds
  v_mfma_f32_16x16x32_bf16 a[80:83], a[200:203], v[128:131], a[80:83]
  v_mfma_f32_16x16x32_bf16 a[84:87], a[200:203], v[144:147], a[84:87]
  ds_read_b128 a[232:235], v3 offset:26624
  v_mfma_f32_16x16x32_bf16 a[144:147], a[200:203], v[192:195], a[144:147]
  v_exp_f32 v226, v226
  v_mfma_f32_16x16x32_bf16 a[148:151], a[200:203], v[208:211], a[148:151]
  v_cvt_pk_bf16_f32 v224, v224, v225
  v_mfma_f32_16x16x32_bf16 a[88:91], a[204:207], v[128:131], a[88:91]
  v_mfma_f32_16x16x32_bf16 a[92:95], a[204:207], v[144:147], a[92:95]
  ds_read_b128 a[236:239], v3 offset:27648
  v_mfma_f32_16x16x32_bf16 v[112:115], v[24:27], v[128:131], v[112:115]
  v_mfma_f32_16x16x32_bf16 a[152:155], a[204:207], v[192:195], a[152:155]
  v_exp_f32 v227, v227
  v_mfma_f32_16x16x32_bf16 a[156:159], a[204:207], v[208:211], a[156:159]
  v_mfma_f32_16x16x32_bf16 v[120:123], v[24:27], v[192:195], v[120:123]
  s_add_u32 s37, s37, 1
  s_waitcnt lgkmcnt(4)
  v_mfma_f32_16x16x32_bf16 a[96:99], a[208:211], v[128:131], a[96:99]
  v_mfma_f32_16x16x32_bf16 a[100:103], a[208:211], v[144:147], a[100:103]
  ds_read_b128 a[240:243], v3 offset:28672
  v_mfma_f32_16x16x32_bf16 a[160:163], a[208:211], v[192:195], a[160:163]
  v_exp_f32 v228, v228
  v_mfma_f32_16x16x32_bf16 a[164:167], a[208:211], v[208:211], a[164:167]
  v_cvt_pk_bf16_f32 v225, v226, v227
  v_mfma_f32_16x16x32_bf16 a[104:107], a[212:215], v[128:131], a[104:107]
  v_mfma_f32_16x16x32_bf16 a[108:111], a[212:215], v[144:147], a[108:111]
  ds_read_b128 a[244:247], v3 offset:29696
  v_mfma_f32_16x16x32_bf16 a[168:171], a[212:215], v[192:195], a[168:171]
  v_exp_f32 v229, v229
  v_mfma_f32_16x16x32_bf16 a[172:175], a[212:215], v[208:211], a[172:175]
  buffer_load_dwordx4 v4, s[24:27], s46 offen offset:3072 sc1 lds
  v_mfma_f32_16x16x32_bf16 a[112:115], a[216:219], v[128:131], a[112:115]
  v_mfma_f32_16x16x32_bf16 a[116:119], a[216:219], v[144:147], a[116:119]
  ds_read_b128 a[248:251], v3 offset:30720
  v_mfma_f32_16x16x32_bf16 a[176:179], a[216:219], v[192:195], a[176:179]
  v_exp_f32 v230, v230
  v_mfma_f32_16x16x32_bf16 a[180:183], a[216:219], v[208:211], a[180:183]
  v_cvt_pk_bf16_f32 v226, v228, v229
  v_mfma_f32_16x16x32_bf16 a[120:123], a[220:223], v[128:131], a[120:123]
  v_mfma_f32_16x16x32_bf16 a[124:127], a[220:223], v[144:147], a[124:127]
  ds_read_b128 a[252:255], v3 offset:31744
  v_mfma_f32_16x16x32_bf16 v[116:119], v[24:27], v[144:147], v[116:119]
  v_mfma_f32_16x16x32_bf16 a[184:187], a[220:223], v[192:195], a[184:187]
  v_exp_f32 v231, v231
  v_mfma_f32_16x16x32_bf16 a[188:191], a[220:223], v[208:211], a[188:191]
  v_mfma_f32_16x16x32_bf16 v[124:127], v[24:27], v[208:211], v[124:127]
  s_add_u32 s46, s46, 16384
  s_add_u32 s42, s42, 32768
  s_waitcnt lgkmcnt(4)
  v_mfma_f32_16x16x32_bf16 a[64:67], a[224:227], v[136:139], a[64:67]
  v_mfma_f32_16x16x32_bf16 a[68:71], a[224:227], v[152:155], a[68:71]
  s_waitcnt vmcnt(16)
  s_barrier
  v_add_u32 v3, s45, v2
  ds_read_b128 a[192:195], v3 offset:0
  v_mfma_f32_16x16x32_bf16 a[128:131], a[224:227], v[200:203], a[128:131]
  v_exp_f32 v240, v240
  v_mfma_f32_16x16x32_bf16 a[132:135], a[224:227], v[216:219], a[132:135]
  v_cvt_pk_bf16_f32 v227, v230, v231
  v_mfma_f32_16x16x32_bf16 a[72:75], a[228:231], v[136:139], a[72:75]
  v_mfma_f32_16x16x32_bf16 a[76:79], a[228:231], v[152:155], a[76:79]
  ds_read_b128 a[196:199], v3 offset:1024
  v_mfma_f32_16x16x32_bf16 a[136:139], a[228:231], v[200:203], a[136:139]
  v_exp_f32 v241, v241
  v_mfma_f32_16x16x32_bf16 a[140:143], a[228:231], v[216:219], a[140:143]
  s_cmp_eq_u32 s42, 163840
  s_cselect_b32 s42, 0, s42
  s_add_u32 m0, s42, s48
  v_mfma_f32_16x16x32_bf16 a[80:83], a[232:235], v[136:139], a[80:83]
  v_mfma_f32_16x16x32_bf16 a[84:87], a[232:235], v[152:155], a[84:87]
  ds_read_b128 a[200:203], v3 offset:2048
  v_mfma_f32_16x16x32_bf16 a[144:147], a[232:235], v[200:203], a[144:147]
  v_exp_f32 v242, v242
  v_mfma_f32_16x16x32_bf16 a[148:151], a[232:235], v[216:219], a[148:151]
  v_cvt_pk_bf16_f32 v240, v240, v241
  v_mfma_f32_16x16x32_bf16 a[88:91], a[236:239], v[136:139], a[88:91]
  v_mfma_f32_16x16x32_bf16 a[92:95], a[236:239], v[152:155], a[92:95]
  ds_read_b128 a[204:207], v3 offset:3072
  v_mfma_f32_16x16x32_bf16 v[112:115], v[24:27], v[136:139], v[112:115]
  v_mfma_f32_16x16x32_bf16 a[152:155], a[236:239], v[200:203], a[152:155]
  v_exp_f32 v243, v243
  v_mfma_f32_16x16x32_bf16 a[156:159], a[236:239], v[216:219], a[156:159]
  v_mfma_f32_16x16x32_bf16 v[120:123], v[24:27], v[200:203], v[120:123]
  buffer_load_dwordx4 v4, s[20:23], s46 offen offset:0 sc1 lds
  s_waitcnt lgkmcnt(4)
  v_mfma_f32_16x16x32_bf16 a[96:99], a[240:243], v[136:139], a[96:99]
  v_mfma_f32_16x16x32_bf16 a[100:103], a[240:243], v[152:155], a[100:103]
  ds_read_b128 a[208:211], v3 offset:4096
  v_mfma_f32_16x16x32_bf16 a[160:163], a[240:243], v[200:203], a[160:163]
  v_exp_f32 v244, v244
  v_mfma_f32_16x16x32_bf16 a[164:167], a[240:243], v[216:219], a[164:167]
  v_cvt_pk_bf16_f32 v241, v242, v243
  v_mfma_f32_16x16x32_bf16 a[104:107], a[244:247], v[136:139], a[104:107]
  v_mfma_f32_16x16x32_bf16 a[108:111], a[244:247], v[152:155], a[108:111]
  ds_read_b128 a[212:215], v3 offset:5120
  v_mfma_f32_16x16x32_bf16 a[168:171], a[244:247], v[200:203], a[168:171]
  v_exp_f32 v245, v245
  v_mfma_f32_16x16x32_bf16 a[172:175], a[244:247], v[216:219], a[172:175]
  s_add_u32 s45, s45, 32768
  v_mfma_f32_16x16x32_bf16 a[112:115], a[248:251], v[136:139], a[112:115]
  v_mfma_f32_16x16x32_bf16 a[116:119], a[248:251], v[152:155], a[116:119]
  ds_read_b128 a[216:219], v3 offset:6144
  v_mfma_f32_16x16x32_bf16 a[176:179], a[248:251], v[200:203], a[176:179]
  v_exp_f32 v246, v246
  v_mfma_f32_16x16x32_bf16 a[180:183], a[248:251], v[216:219], a[180:183]
  v_cvt_pk_bf16_f32 v242, v244, v245
  s_cmp_eq_u32 s45, 163840
  s_cselect_b32 s45, 0, s45
  v_mfma_f32_16x16x32_bf16 a[120:123], a[252:255], v[136:139], a[120:123]
  v_mfma_f32_16x16x32_bf16 a[124:127], a[252:255], v[152:155], a[124:127]
  ds_read_b128 a[220:223], v3 offset:7168
  v_mfma_f32_16x16x32_bf16 v[116:119], v[24:27], v[152:155], v[116:119]
  v_mfma_f32_16x16x32_bf16 a[184:187], a[252:255], v[200:203], a[184:187]
  v_exp_f32 v247, v247
  v_mfma_f32_16x16x32_bf16 a[188:191], a[252:255], v[216:219], a[188:191]
  v_mfma_f32_16x16x32_bf16 v[124:127], v[24:27], v[216:219], v[124:127]
  buffer_load_dwordx4 v4, s[20:23], s46 offen offset:1024 sc1 lds
  s_nop 7
  v_max_f32 v13, v112, v116
  v_add_f32 v14, v112, v116
  v_cmp_nle_f32 vcc, v14, v21
  s_mov_b32 s50, 0
  s_cbranch_vccnz k2_slow_0
k2_ret_0_0:
  v_rcp_f32 v16, v112
  v_rcp_f32 v17, v116
  v_accvgpr_read_b32 v128, a64
  v_accvgpr_read_b32 v129, a65
  v_accvgpr_read_b32 v130, a66
  v_accvgpr_read_b32 v131, a67
  v_accvgpr_read_b32 v132, a72
  v_accvgpr_read_b32 v133, a73
  v_accvgpr_read_b32 v134, a74
  v_accvgpr_read_b32 v135, a75
  v_pk_mul_f32 v[128:129], v[128:129], v[16:17] op_sel_hi:[1,0]
  v_pk_mul_f32 v[130:131], v[130:131], v[16:17] op_sel_hi:[1,0]
  v_pk_mul_f32 v[132:133], v[132:133], v[16:17] op_sel_hi:[1,0]
  v_pk_mul_f32 v[134:135], v[134:135], v[16:17] op_sel_hi:[1,0]
  v_cvt_pk_bf16_f32 v128, v128, v129
  v_cvt_pk_bf16_f32 v129, v130, v131
  v_cvt_pk_bf16_f32 v130, v132, v133
  v_cvt_pk_bf16_f32 v131, v134, v135
  buffer_store_dwordx4 v[128:131], v2, s[8:11], s53 offen offset:0 sc1
  v_accvgpr_read_b32 v136, a80
  v_accvgpr_read_b32 v137, a81
  v_accvgpr_read_b32 v138, a82
  v_accvgpr_read_b32 v139, a83
  v_accvgpr_read_b32 v140, a88
  v_accvgpr_read_b32 v141, a89
  v_accvgpr_read_b32 v142, a90
  v_accvgpr_read_b32 v143, a91
  v_pk_mul_f32 v[136:137], v[136:137], v[16:17] op_sel_hi:[1,0]
  v_pk_mul_f32 v[138:139], v[138:139], v[16:17] op_sel_hi:[1,0]
  v_pk_mul_f32 v[140:141], v[140:141], v[16:17] op_sel_hi:[1,0]
  v_pk_mul_f32 v[142:143], v[142:143], v[16:17] op_sel_hi:[1,0]
  v_cvt_pk_bf16_f32 v136, v136, v137
  v_cvt_pk_bf16_f32 v137, v138, v139
  v_cvt_pk_bf16_f32 v138, v140, v141
  v_cvt_pk_bf16_f32 v139, v142, v143
  buffer_store_dwordx4 v[136:139], v2, s[8:11], s53 offen offset:1024 sc1
  v_accvgpr_read_b32 v144, a96
  v_accvgpr_read_b32 v145, a97
  v_accvgpr_read_b32 v146, a98
  v_accvgpr_read_b32 v147, a99
  v_accvgpr_read_b32 v148, a104
  v_accvgpr_read_b32 v149, a105
  v_accvgpr_read_b32 v150, a106
  v_accvgpr_read_b32 v151, a107
  v_pk_mul_f32 v[144:145], v[144:145], v[16:17] op_sel_hi:[1,0]
  v_pk_mul_f32 v[146:147], v[146:147], v[16:17] op_sel_hi:[1,0]
  v_pk_mul_f32 v[148:149], v[148:149], v[16:17] op_sel_hi:[1,0]
  v_pk_mul_f32 v[150:151], v[150:151], v[16:17] op_sel_hi:[1,0]
  v_cvt_pk_bf16_f32 v144, v144, v145
  v_cvt_pk_bf16_f32 v145, v146, v147
  v_cvt_pk_bf16_f32 v146, v148, v149
  v_cvt_pk_bf16_f32 v147, v150, v151
  buffer_store_dwordx4 v[144:147], v2, s[8:11], s53 offen offset:2048 sc1
  v_accvgpr_read_b32 v152, a112
  v_accvgpr_read_b32 v153, a113
  v_accvgpr_read_b32 v154, a114
  v_accvgpr_read_b32 v155, a115
  v_accvgpr_read_b32 v156, a120
  v_accvgpr_read_b32 v157, a121
  v_accvgpr_read_b32 v158, a122
  v_accvgpr_read_b32 v159, a123
  v_pk_mul_f32 v[152:153], v[152:153], v[16:17] op_sel_hi:[1,0]
  v_pk_mul_f32 v[154:155], v[154:155], v[16:17] op_sel_hi:[1,0]
  v_pk_mul_f32 v[156:157], v[156:157], v[16:17] op_sel_hi:[1,0]
  v_pk_mul_f32 v[158:159], v[158:159], v[16:17] op_sel_hi:[1,0]
  v_cvt_pk_bf16_f32 v152, v152, v153
  v_cvt_pk_bf16_f32 v153, v154, v155
  v_cvt_pk_bf16_f32 v154, v156, v157
  v_cvt_pk_bf16_f32 v155, v158, v159
  buffer_store_dwordx4 v[152:155], v2, s[8:11], s53 offen offset:3072 sc1
  s_add_u32 s38, s53, 131072
  v_accvgpr_read_b32 v160, a68
  v_accvgpr_read_b32 v161, a69
  v_accvgpr_read_b32 v162, a70
  v_accvgpr_read_b32 v163, a71
  v_accvgpr_read_b32 v164, a76
  v_accvgpr_read_b32 v165, a77
  v_accvgpr_read_b32 v166, a78
  v_accvgpr_read_b32 v167, a79
  v_pk_mul_f32 v[160:161], v[160:161], v[16:17] op_sel:[0,1]
  v_pk_mul_f32 v[162:163], v[162:163], v[16:17] op_sel:[0,1]
  v_pk_mul_f32 v[164:165], v[164:165], v[16:17] op_sel:[0,1]
  v_pk_mul_f32 v[166:167], v[166:167], v[16:17] op_sel:[0,1]
  v_cvt_pk_bf16_f32 v160, v160, v161
  v_cvt_pk_bf16_f32 v161, v162, v163
  v_cvt_pk_bf16_f32 v162, v164, v165
  v_cvt_pk_bf16_f32 v163, v166, v167
  buffer_store_dwordx4 v[160:163], v2, s[8:11], s38 offen offset:0 sc1
  v_accvgpr_read_b32 v168, a84
  v_accvgpr_read_b32 v169, a85
  v_accvgpr_read_b32 v170, a86
  v_accvgpr_read_b32 v171, a87
  v_accvgpr_read_b32 v172, a92
  v_accvgpr_read_b32 v173, a93
  v_accvgpr_read_b32 v174, a94
  v_accvgpr_read_b32 v175, a95
  v_pk_mul_f32 v[168:169], v[168:169], v[16:17] op_sel:[0,1]
  v_pk_mul_f32 v[170:171], v[170:171], v[16:17] op_sel:[0,1]
  v_pk_mul_f32 v[172:173], v[172:173], v[16:17] op_sel:[0,1]
  v_pk_mul_f32 v[174:175], v[174:175], v[16:17] op_sel:[0,1]
  v_cvt_pk_bf16_f32 v168, v168, v169
  v_cvt_pk_bf16_f32 v169, v170, v171
  v_cvt_pk_bf16_f32 v170, v172, v173
  v_cvt_pk_bf16_f32 v171, v174, v175
  buffer_store_dwordx4 v[168:171], v2, s[8:11], s38 offen offset:1024 sc1
  v_accvgpr_read_b32 v176, a100
  v_accvgpr_read_b32 v177, a101
  v_accvgpr_read_b32 v178, a102
  v_accvgpr_read_b32 v179, a103
  v_accvgpr_read_b32 v180, a108
  v_accvgpr_read_b32 v181, a109
  v_accvgpr_read_b32 v182, a110
  v_accvgpr_read_b32 v183, a111
  v_pk_mul_f32 v[176:177], v[176:177], v[16:17] op_sel:[0,1]
  v_pk_mul_f32 v[178:179], v[178:179], v[16:17] op_sel:[0,1]
  v_pk_mul_f32 v[180:181], v[180:181], v[16:17] op_sel:[0,1]
  v_pk_mul_f32 v[182:183], v[182:183], v[16:17] op_sel:[0,1]
  v_cvt_pk_bf16_f32 v176, v176, v177
  v_cvt_pk_bf16_f32 v177, v178, v179
  v_cvt_pk_bf16_f32 v178, v180, v181
  v_cvt_pk_bf16_f32 v179, v182, v183
  buffer_store_dwordx4 v[176:179], v2, s[8:11], s38 offen offset:2048 sc1
  v_accvgpr_read_b32 v184, a116
  v_accvgpr_read_b32 v185, a117
  v_accvgpr_read_b32 v186, a118
  v_accvgpr_read_b32 v187, a119
  v_accvgpr_read_b32 v188, a124
  v_accvgpr_read_b32 v189, a125
  v_accvgpr_read_b32 v190, a126
  v_accvgpr_read_b32 v191, a127
  v_pk_mul_f32 v[184:185], v[184:185], v[16:17] op_sel:[0,1]
  v_pk_mul_f32 v[186:187], v[186:187], v[16:17] op_sel:[0,1]
  v_pk_mul_f32 v[188:189], v[188:189], v[16:17] op_sel:[0,1]
  v_pk_mul_f32 v[190:191], v[190:191], v[16:17] op_sel:[0,1]
  v_cvt_pk_bf16_f32 v184, v184, v185
  v_cvt_pk_bf16_f32 v185, v186, v187
  v_cvt_pk_bf16_f32 v186, v188, v189
  v_cvt_pk_bf16_f32 v187, v190, v191
  buffer_store_dwordx4 v[184:187], v2, s[8:11], s38 offen offset:3072 sc1
  s_branch k2_SS1
k2_DL1:
  s_waitcnt lgkmcnt(4)
  v_mfma_f32_16x16x32_bf16 v[192:195], a[192:195], v[64:67], v[104:107]
  v_exp_f32 v168, v168
  v_exp_f32 v232, v232
  v_mfma_f32_16x16x32_bf16 v[208:211], a[192:195], v[80:83], v[108:111]
  ds_read_b128 a[224:227], v3 offset:8192
  v_cvt_pk_bf16_f32 v179, v182, v183
  v_cvt_pk_bf16_f32 v243, v246, v247
  v_mfma_f32_16x16x32_bf16 v[192:195], a[196:199], v[68:71], v[192:195]
  v_exp_f32 v169, v169
  v_exp_f32 v233, v233
  v_mfma_f32_16x16x32_bf16 v[208:211], a[196:199], v[84:87], v[208:211]
  ds_read_b128 a[228:231], v3 offset:9216
  buffer_load_dwordx4 v4, s[20:23], s46 offen offset:2048 sc1 lds
  v_mfma_f32_16x16x32_bf16 v[192:195], a[200:203], v[72:75], v[192:195]
  v_exp_f32 v170, v170
  v_exp_f32 v234, v234
  v_mfma_f32_16x16x32_bf16 v[208:211], a[200:203], v[88:91], v[208:211]
  ds_read_b128 a[232:235], v3 offset:10240
  v_cvt_pk_bf16_f32 v168, v168, v169
  v_cvt_pk_bf16_f32 v232, v232, v233
  v_mfma_f32_16x16x32_bf16 v[192:195], a[204:207], v[76:79], v[192:195]
  v_exp_f32 v171, v171
  v_exp_f32 v235, v235
  v_mfma_f32_16x16x32_bf16 v[208:211], a[204:207], v[92:95], v[208:211]
  ds_read_b128 a[236:239], v3 offset:11264
  s_waitcnt lgkmcnt(4)
  v_mfma_f32_16x16x32_bf16 v[196:199], a[208:211], v[64:67], v[104:107]
  v_exp_f32 v172, v172
  v_exp_f32 v236, v236
  v_mfma_f32_16x16x32_bf16 v[212:215], a[208:211], v[80:83], v[108:111]
  ds_read_b128 a[240:243], v3 offset:12288
  v_cvt_pk_bf16_f32 v169, v170, v171
  v_cvt_pk_bf16_f32 v233, v234, v235
  v_mfma_f32_16x16x32_bf16 v[196:199], a[212:215], v[68:71], v[196:199]
  v_exp_f32 v173, v173
  v_exp_f32 v237, v237
  v_mfma_f32_16x16x32_bf16 v[212:215], a[212:215], v[84:87], v[212:215]
  ds_read_b128 a[244:247], v3 offset:13312
  buffer_load_dwordx4 v4, s[20:23], s46 offen offset:3072 sc1 lds
  v_mfma_f32_16x16x32_bf16 v[196:199], a[216:219], v[72:75], v[196:199]
  v_exp_f32 v174, v174
  v_exp_f32 v238, v238
  v_mfma_f32_16x16x32_bf16 v[212:215], a[216:219], v[88:91], v[212:215]
  ds_read_b128 a[248:251], v3 offset:14336
  v_cvt_pk_bf16_f32 v170, v172, v173
  v_cvt_pk_bf16_f32 v234, v236, v237
  v_mfma_f32_16x16x32_bf16 v[196:199], a[220:223], v[76:79], v[196:199]
  v_exp_f32 v175, v175
  v_exp_f32 v239, v239
  v_mfma_f32_16x16x32_bf16 v[212:215], a[220:223], v[92:95], v[212:215]
  ds_read_b128 a[252:255], v3 offset:15360
  s_add_u32 m0, m0, 16384
  s_waitcnt lgkmcnt(4)
  v_mfma_f32_16x16x32_bf16 v[200:203], a[224:227], v[64:67], v[104:107]
  v_exp_f32 v184, v184
  v_exp_f32 v248, v248
  v_mfma_f32_16x16x32_bf16 v[216:219], a[224:227], v[80:83], v[108:111]
  ds_read_b128 a[192:195], v3 offset:16384
  v_cvt_pk_bf16_f32 v171, v174, v175
  v_cvt_pk_bf16_f32 v235, v238, v239
  v_mfma_f32_16x16x32_bf16 v[200:203], a[228:231], v[68:71], v[200:203]
  v_exp_f32 v185, v185
  v_exp_f32 v249, v249
  v_mfma_f32_16x16x32_bf16 v[216:219], a[228:231], v[84:87], v[216:219]
  ds_read_b128 a[196:199], v3 offset:17408
  buffer_load_dwordx4 v4, s[24:27], s46 offen offset:0 sc1 lds
  v_mfma_f32_16x16x32_bf16 v[200:203], a[232:235], v[72:75], v[200:203]
  v_exp_f32 v186, v186
  v_exp_f32 v250, v250
  v_mfma_f32_16x16x32_bf16 v[216:219], a[232:235], v[88:91], v[216:219]
  ds_read_b128 a[200:203], v3 offset:18432
  v_cvt_pk_bf16_f32 v184, v184, v185
  v_cvt_pk_bf16_f32 v248, v248, v249
  v_mfma_f32_16x16x32_bf16 v[200:203], a[236:239], v[76:79], v[200:203]
  v_exp_f32 v187, v187
  v_exp_f32 v251, v251
  v_mfma_f32_16x16x32_bf16 v[216:219], a[236:239], v[92:95], v[216:219]
  ds_read_b128 a[204:207], v3 offset:19456
  s_waitcnt lgkmcnt(4)
  v_mfma_f32_16x16x32_bf16 v[204:207], a[240:243], v[64:67], v[104:107]
  v_exp_f32 v188, v188
  v_exp_f32 v252, v252
  v_mfma_f32_16x16x32_bf16 v[220:223], a[240:243], v[80:83], v[108:111]
  ds_read_b128 a[208:211], v3 offset:20480
  v_cvt_pk_bf16_f32 v185, v186, v187
  v_cvt_pk_bf16_f32 v249, v250, v251
  v_mfma_f32_16x16x32_bf16 v[204:207], a[244:247], v[68:71], v[204:207]
  v_exp_f32 v189, v189
  v_exp_f32 v253, v253
  v_mfma_f32_16x16x32_bf16 v[220:223], a[244:247], v[84:87], v[220:223]
  ds_read_b128 a[212:215], v3 offset:21504
  buffer_load_dwordx4 v4, s[24:27], s46 offen offset:1024 sc1 lds
  v_mfma_f32_16x16x32_bf16 v[204:207], a[248:251], v[72:75], v[204:207]
  v_exp_f32 v190, v190
  v_exp_f32 v254, v254
  v_mfma_f32_16x16x32_bf16 v[220:223], a[248:251], v[88:91], v[220:223]
  ds_read_b128 a[216:219], v3 offset:22528
  v_cvt_pk_bf16_f32 v186, v188, v189
  v_cvt_pk_bf16_f32 v250, v252, v253
  v_mfma_f32_16x16x32_bf16 v[204:207], a[252:255], v[76:79], v[204:207]
  v_exp_f32 v191, v191
  v_exp_f32 v255, v255
  v_mfma_f32_16x16x32_bf16 v[220:223], a[252:255], v[92:95], v[220:223]
  ds_read_b128 a[220:223], v3 offset:23552
  s_waitcnt lgkmcnt(4)
  v_mfma_f32_16x16x32_bf16 a[64:67], a[192:195], v[160:163], a[64:67]
  v_mfma_f32_16x16x32_bf16 a[68:71], a[192:195], v[176:179], a[68:71]
  ds_read_b128 a[224:227], v3 offset:24576
  v_cvt_pk_bf16_f32 v187, v190, v191
  v_mfma_f32_16x16x32_bf16 a[128:131], a[192:195], v[224:227], a[128:131]
  v_exp_f32 v192, v192
  v_mfma_f32_16x16x32_bf16 a[132:135], a[192:195], v[240:243], a[132:135]
  v_cvt_pk_bf16_f32 v251, v254, v255
  v_mfma_f32_16x16x32_bf16 a[72:75], a[196:199], v[160:163], a[72:75]
  v_mfma_f32_16x16x32_bf16 a[76:79], a[196:199], v[176:179], a[76:79]
  ds_read_b128 a[228:231], v3 offset:25600
  v_mfma_f32_16x16x32_bf16 a[136:139], a[196:199], v[224:227], a[136:139]
  v_exp_f32 v193, v193
  v_mfma_f32_16x16x32_bf16 a[140:143], a[196:199], v[240:243], a[140:143]
  buffer_load_dwordx4 v4, s[24:27], s46 offen offset:2048 sc1 lds
  v_mfma_f32_16x16x32_bf16 a[80:83], a[200:203], v[160:163], a[80:83]
  v_mfma_f32_16x16x32_bf16 a[84:87], a[200:203], v[176:179], a[84:87]
  ds_read_b128 a[232:235], v3 offset:26624
  v_mfma_f32_16x16x32_bf16 a[144:147], a[200:203], v[224:227], a[144:147]
  v_exp_f32 v194, v194
  v_mfma_f32_16x16x32_bf16 a[148:151], a[200:203], v[240:243], a[148:151]
  v_cvt_pk_bf16_f32 v192, v192, v193
  v_mfma_f32_16x16x32_bf16 a[88:91], a[204:207], v[160:163], a[88:91]
  v_mfma_f32_16x16x32_bf16 a[92:95], a[204:207], v[176:179], a[92:95]
  ds_read_b128 a[236:239], v3 offset:27648
  v_mfma_f32_16x16x32_bf16 v[112:115], v[24:27], v[160:163], v[112:115]
  v_mfma_f32_16x16x32_bf16 a[152:155], a[204:207], v[224:227], a[152:155]
  v_exp_f32 v195, v195
  v_mfma_f32_16x16x32_bf16 a[156:159], a[204:207], v[240:243], a[156:159]
  v_mfma_f32_16x16x32_bf16 v[120:123], v[24:27], v[224:227], v[120:123]
  s_add_u32 s37, s37, 1
  s_waitcnt lgkmcnt(4)
  v_mfma_f32_16x16x32_bf16 a[96:99], a[208:211], v[160:163], a[96:99]
  v_mfma_f32_16x16x32_bf16 a[100:103], a[208:211], v[176:179], a[100:103]
  ds_read_b128 a[240:243], v3 offset:28672
  v_mfma_f32_16x16x32_bf16 a[160:163], a[208:211], v[224:227], a[160:163]
  v_exp_f32 v196, v196
  v_mfma_f32_16x16x32_bf16 a[164:167], a[208:211], v[240:243], a[164:167]
  v_cvt_pk_bf16_f32 v193, v194, v195
  v_mfma_f32_16x16x32_bf16 a[104:107], a[212:215], v[160:163], a[104:107]
  v_mfma_f32_16x16x32_bf16 a[108:111], a[212:215], v[176:179], a[108:111]
  ds_read_b128 a[244:247], v3 offset:29696
  v_mfma_f32_16x16x32_bf16 a[168:171], a[212:215], v[224:227], a[168:171]
  v_exp_f32 v197, v197
  v_mfma_f32_16x16x32_bf16 a[172:175], a[212:215], v[240:243], a[172:175]
  buffer_load_dwordx4 v4, s[24:27], s46 offen offset:3072 sc1 lds
  v_mfma_f32_16x16x32_bf16 a[112:115], a[216:219], v[160:163], a[112:115]
  v_mfma_f32_16x16x32_bf16 a[116:119], a[216:219], v[176:179], a[116:119]
  ds_read_b128 a[248:251], v3 offset:30720
  v_mfma_f32_16x16x32_bf16 a[176:179], a[216:219], v[224:227], a[176:179]
  v_exp_f32 v198, v198
  v_mfma_f32_16x16x32_bf16 a[180:183], a[216:219], v[240:243], a[180:183]
  v_cvt_pk_bf16_f32 v194, v196, v197
  v_mfma_f32_16x16x32_bf16 a[120:123], a[220:223], v[160:163], a[120:123]
  v_mfma_f32_16x16x32_bf16 a[124:127], a[220:223], v[176:179], a[124:127]
  ds_read_b128 a[252:255], v3 offset:31744
  v_mfma_f32_16x16x32_bf16 v[116:119], v[24:27], v[176:179], v[116:119]
  v_mfma_f32_16x16x32_bf16 a[184:187], a[220:223], v[224:227], a[184:187]
  v_exp_f32 v199, v199
  v_mfma_f32_16x16x32_bf16 a[188:191], a[220:223], v[240:243], a[188:191]
  v_mfma_f32_16x16x32_bf16 v[124:127], v[24:27], v[240:243], v[124:127]
  s_add_u32 s46, s46, 16384
  s_add_u32 s42, s42, 32768
  s_waitcnt lgkmcnt(4)
  v_mfma_f32_16x16x32_bf16 a[64:67], a[224:227], v[168:171], a[64:67]
  v_mfma_f32_16x16x32_bf16 a[68:71], a[224:227], v[184:187], a[68:71]
  s_waitcnt vmcnt(16)
  s_barrier
  v_add_u32 v3, s45, v2
  ds_read_b128 a[192:195], v3 offset:0
  v_mfma_f32_16x16x32_bf16 a[128:131], a[224:227], v[232:235], a[128:131]
  v_exp_f32 v208, v208
  v_mfma_f32_16x16x32_bf16 a[132:135], a[224:227], v[248:251], a[132:135]
  v_cvt_pk_bf16_f32 v195, v198, v199
  v_mfma_f32_16x16x32_bf16 a[72:75], a[228:231], v[168:171], a[72:75]
  v_mfma_f32_16x16x32_bf16 a[76:79], a[228:231], v[184:187], a[76:79]
  ds_read_b128 a[196:199], v3 offset:1024
  v_mfma_f32_16x16x32_bf16 a[136:139], a[228:231], v[232:235], a[136:139]
  v_exp_f32 v209, v209
  v_mfma_f32_16x16x32_bf16 a[140:143], a[228:231], v[248:251], a[140:143]
  s_cmp_eq_u32 s42, 163840
  s_cselect_b32 s42, 0, s42
  s_add_u32 m0, s42, s48
  v_mfma_f32_16x16x32_bf16 a[80:83], a[232:235], v[168:171], a[80:83]
  v_mfma_f32_16x16x32_bf16 a[84:87], a[232:235], v[184:187], a[84:87]
  ds_read_b128 a[200:203], v3 offset:2048
  v_mfma_f32_16x16x32_bf16 a[144:147], a[232:235], v[232:235], a[144:147]
  v_exp_f32 v210, v210
  v_mfma_f32_16x16x32_bf16 a[148:151], a[232:235], v[248:251], a[148:151]
  v_cvt_pk_bf16_f32 v208, v208, v209
  v_mfma_f32_16x16x32_bf16 a[88:91], a[236:239], v[168:171], a[88:91]
  v_mfma_f32_16x16x32_bf16 a[92:95], a[236:239], v[184:187], a[92:95]
  ds_read_b128 a[204:207], v3 offset:3072
  v_mfma_f32_16x16x32_bf16 v[112:115], v[24:27], v[168:171], v[112:115]
  v_mfma_f32_16x16x32_bf16 a[152:155], a[236:239], v[232:235], a[152:155]
  v_exp_f32 v211, v211
  v_mfma_f32_16x16x32_bf16 a[156:159], a[236:239], v[248:251], a[156:159]
  v_mfma_f32_16x16x32_bf16 v[120:123], v[24:27], v[232:235], v[120:123]
  buffer_load_dwordx4 v4, s[20:23], s46 offen offset:0 sc1 lds
  s_waitcnt lgkmcnt(4)
  v_mfma_f32_16x16x32_bf16 a[96:99], a[240:243], v[168:171], a[96:99]
  v_mfma_f32_16x16x32_bf16 a[100:103], a[240:243], v[184:187], a[100:103]
  ds_read_b128 a[208:211], v3 offset:4096
  v_mfma_f32_16x16x32_bf16 a[160:163], a[240:243], v[232:235], a[160:163]
  v_exp_f32 v212, v212
  v_mfma_f32_16x16x32_bf16 a[164:167], a[240:243], v[248:251], a[164:167]
  v_cvt_pk_bf16_f32 v209, v210, v211
  v_mfma_f32_16x16x32_bf16 a[104:107], a[244:247], v[168:171], a[104:107]
  v_mfma_f32_16x16x32_bf16 a[108:111], a[244:247], v[184:187], a[108:111]
  ds_read_b128 a[212:215], v3 offset:5120
  v_mfma_f32_16x16x32_bf16 a[168:171], a[244:247], v[232:235], a[168:171]
  v_exp_f32 v213, v213
  v_mfma_f32_16x16x32_bf16 a[172:175], a[244:247], v[248:251], a[172:175]
  s_add_u32 s45, s45, 32768
  v_mfma_f32_16x16x32_bf16 a[112:115], a[248:251], v[168:171], a[112:115]
  v_mfma_f32_16x16x32_bf16 a[116:119], a[248:251], v[184:187], a[116:119]
  ds_read_b128 a[216:219], v3 offset:6144
  v_mfma_f32_16x16x32_bf16 a[176:179], a[248:251], v[232:235], a[176:179]
  v_exp_f32 v214, v214
  v_mfma_f32_16x16x32_bf16 a[180:183], a[248:251], v[248:251], a[180:183]
  v_cvt_pk_bf16_f32 v210, v212, v213
  s_cmp_eq_u32 s45, 163840
  s_cselect_b32 s45, 0, s45
  v_mfma_f32_16x16x32_bf16 a[120:123], a[252:255], v[168:171], a[120:123]
  v_mfma_f32_16x16x32_bf16 a[124:127], a[252:255], v[184:187], a[124:127]
  ds_read_b128 a[220:223], v3 offset:7168
  v_mfma_f32_16x16x32_bf16 v[116:119], v[24:27], v[184:187], v[116:119]
  v_mfma_f32_16x16x32_bf16 a[184:187], a[252:255], v[232:235], a[184:187]
  v_exp_f32 v215, v215
  v_mfma_f32_16x16x32_bf16 a[188:191], a[252:255], v[248:251], a[188:191]
  v_mfma_f32_16x16x32_bf16 v[124:127], v[24:27], v[248:251], v[124:127]
  buffer_load_dwordx4 v4, s[20:23], s46 offen offset:1024 sc1 lds
  s_nop 7
  v_max_f32 v13, v112, v116
  v_add_f32 v14, v112, v116
  v_cmp_nle_f32 vcc, v14, v21
  s_mov_b32 s50, 1
  s_cbranch_vccnz k2_slow_0
k2_ret_0_1:
  v_rcp_f32 v16, v112
  v_rcp_f32 v17, v116
  v_accvgpr_read_b32 v128, a64
  v_accvgpr_read_b32 v129, a65
  v_accvgpr_read_b32 v130, a66
  v_accvgpr_read_b32 v131, a67
  v_accvgpr_read_b32 v132, a72
  v_accvgpr_read_b32 v133, a73
  v_accvgpr_read_b32 v134, a74
  v_accvgpr_read_b32 v135, a75
  v_pk_mul_f32 v[128:129], v[128:129], v[16:17] op_sel_hi:[1,0]
  v_pk_mul_f32 v[130:131], v[130:131], v[16:17] op_sel_hi:[1,0]
  v_pk_mul_f32 v[132:133], v[132:133], v[16:17] op_sel_hi:[1,0]
  v_pk_mul_f32 v[134:135], v[134:135], v[16:17] op_sel_hi:[1,0]
  v_cvt_pk_bf16_f32 v128, v128, v129
  v_cvt_pk_bf16_f32 v129, v130, v131
  v_cvt_pk_bf16_f32 v130, v132, v133
  v_cvt_pk_bf16_f32 v131, v134, v135
  buffer_store_dwordx4 v[128:131], v2, s[8:11], s53 offen offset:0 sc1
  v_accvgpr_read_b32 v136, a80
  v_accvgpr_read_b32 v137, a81
  v_accvgpr_read_b32 v138, a82
  v_accvgpr_read_b32 v139, a83
  v_accvgpr_read_b32 v140, a88
  v_accvgpr_read_b32 v141, a89
  v_accvgpr_read_b32 v142, a90
  v_accvgpr_read_b32 v143, a91
  v_pk_mul_f32 v[136:137], v[136:137], v[16:17] op_sel_hi:[1,0]
  v_pk_mul_f32 v[138:139], v[138:139], v[16:17] op_sel_hi:[1,0]
  v_pk_mul_f32 v[140:141], v[140:141], v[16:17] op_sel_hi:[1,0]
  v_pk_mul_f32 v[142:143], v[142:143], v[16:17] op_sel_hi:[1,0]
  v_cvt_pk_bf16_f32 v136, v136, v137
  v_cvt_pk_bf16_f32 v137, v138, v139
  v_cvt_pk_bf16_f32 v138, v140, v141
  v_cvt_pk_bf16_f32 v139, v142, v143
  buffer_store_dwordx4 v[136:139], v2, s[8:11], s53 offen offset:1024 sc1
  v_accvgpr_read_b32 v144, a96
  v_accvgpr_read_b32 v145, a97
  v_accvgpr_read_b32 v146, a98
  v_accvgpr_read_b32 v147, a99
  v_accvgpr_read_b32 v148, a104
  v_accvgpr_read_b32 v149, a105
  v_accvgpr_read_b32 v150, a106
  v_accvgpr_read_b32 v151, a107
  v_pk_mul_f32 v[144:145], v[144:145], v[16:17] op_sel_hi:[1,0]
  v_pk_mul_f32 v[146:147], v[146:147], v[16:17] op_sel_hi:[1,0]
  v_pk_mul_f32 v[148:149], v[148:149], v[16:17] op_sel_hi:[1,0]
  v_pk_mul_f32 v[150:151], v[150:151], v[16:17] op_sel_hi:[1,0]
  v_cvt_pk_bf16_f32 v144, v144, v145
  v_cvt_pk_bf16_f32 v145, v146, v147
  v_cvt_pk_bf16_f32 v146, v148, v149
  v_cvt_pk_bf16_f32 v147, v150, v151
  buffer_store_dwordx4 v[144:147], v2, s[8:11], s53 offen offset:2048 sc1
  v_accvgpr_read_b32 v152, a112
  v_accvgpr_read_b32 v153, a113
  v_accvgpr_read_b32 v154, a114
  v_accvgpr_read_b32 v155, a115
  v_accvgpr_read_b32 v156, a120
  v_accvgpr_read_b32 v157, a121
  v_accvgpr_read_b32 v158, a122
  v_accvgpr_read_b32 v159, a123
  v_pk_mul_f32 v[152:153], v[152:153], v[16:17] op_sel_hi:[1,0]
  v_pk_mul_f32 v[154:155], v[154:155], v[16:17] op_sel_hi:[1,0]
  v_pk_mul_f32 v[156:157], v[156:157], v[16:17] op_sel_hi:[1,0]
  v_pk_mul_f32 v[158:159], v[158:159], v[16:17] op_sel_hi:[1,0]
  v_cvt_pk_bf16_f32 v152, v152, v153
  v_cvt_pk_bf16_f32 v153, v154, v155
  v_cvt_pk_bf16_f32 v154, v156, v157
  v_cvt_pk_bf16_f32 v155, v158, v159
  buffer_store_dwordx4 v[152:155], v2, s[8:11], s53 offen offset:3072 sc1
  s_add_u32 s38, s53, 131072
  v_accvgpr_read_b32 v160, a68
  v_accvgpr_read_b32 v161, a69
  v_accvgpr_read_b32 v162, a70
  v_accvgpr_read_b32 v163, a71
  v_accvgpr_read_b32 v164, a76
  v_accvgpr_read_b32 v165, a77
  v_accvgpr_read_b32 v166, a78
  v_accvgpr_read_b32 v167, a79
  v_pk_mul_f32 v[160:161], v[160:161], v[16:17] op_sel:[0,1]
  v_pk_mul_f32 v[162:163], v[162:163], v[16:17] op_sel:[0,1]
  v_pk_mul_f32 v[164:165], v[164:165], v[16:17] op_sel:[0,1]
  v_pk_mul_f32 v[166:167], v[166:167], v[16:17] op_sel:[0,1]
  v_cvt_pk_bf16_f32 v160, v160, v161
  v_cvt_pk_bf16_f32 v161, v162, v163
  v_cvt_pk_bf16_f32 v162, v164, v165
  v_cvt_pk_bf16_f32 v163, v166, v167
  buffer_store_dwordx4 v[160:163], v2, s[8:11], s38 offen offset:0 sc1
  v_accvgpr_read_b32 v168, a84
  v_accvgpr_read_b32 v169, a85
  v_accvgpr_read_b32 v170, a86
  v_accvgpr_read_b32 v171, a87
  v_accvgpr_read_b32 v172, a92
  v_accvgpr_read_b32 v173, a93
  v_accvgpr_read_b32 v174, a94
  v_accvgpr_read_b32 v175, a95
  v_pk_mul_f32 v[168:169], v[168:169], v[16:17] op_sel:[0,1]
  v_pk_mul_f32 v[170:171], v[170:171], v[16:17] op_sel:[0,1]
  v_pk_mul_f32 v[172:173], v[172:173], v[16:17] op_sel:[0,1]
  v_pk_mul_f32 v[174:175], v[174:175], v[16:17] op_sel:[0,1]
  v_cvt_pk_bf16_f32 v168, v168, v169
  v_cvt_pk_bf16_f32 v169, v170, v171
  v_cvt_pk_bf16_f32 v170, v172, v173
  v_cvt_pk_bf16_f32 v171, v174, v175
  buffer_store_dwordx4 v[168:171], v2, s[8:11], s38 offen offset:1024 sc1
  v_accvgpr_read_b32 v176, a100
  v_accvgpr_read_b32 v177, a101
  v_accvgpr_read_b32 v178, a102
  v_accvgpr_read_b32 v179, a103
  v_accvgpr_read_b32 v180, a108
  v_accvgpr_read_b32 v181, a109
  v_accvgpr_read_b32 v182, a110
  v_accvgpr_read_b32 v183, a111
  v_pk_mul_f32 v[176:177], v[176:177], v[16:17] op_sel:[0,1]
  v_pk_mul_f32 v[178:179], v[178:179], v[16:17] op_sel:[0,1]
  v_pk_mul_f32 v[180:181], v[180:181], v[16:17] op_sel:[0,1]
  v_pk_mul_f32 v[182:183], v[182:183], v[16:17] op_sel:[0,1]
  v_cvt_pk_bf16_f32 v176, v176, v177
  v_cvt_pk_bf16_f32 v177, v178, v179
  v_cvt_pk_bf16_f32 v178, v180, v181
  v_cvt_pk_bf16_f32 v179, v182, v183
  buffer_store_dwordx4 v[176:179], v2, s[8:11], s38 offen offset:2048 sc1
  v_accvgpr_read_b32 v184, a116
  v_accvgpr_read_b32 v185, a117
  v_accvgpr_read_b32 v186, a118
  v_accvgpr_read_b32 v187, a119
  v_accvgpr_read_b32 v188, a124
  v_accvgpr_read_b32 v189, a125
  v_accvgpr_read_b32 v190, a126
  v_accvgpr_read_b32 v191, a127
  v_pk_mul_f32 v[184:185], v[184:185], v[16:17] op_sel:[0,1]
  v_pk_mul_f32 v[186:187], v[186:187], v[16:17] op_sel:[0,1]
  v_pk_mul_f32 v[188:189], v[188:189], v[16:17] op_sel:[0,1]
  v_pk_mul_f32 v[190:191], v[190:191], v[16:17] op_sel:[0,1]
  v_cvt_pk_bf16_f32 v184, v184, v185
  v_cvt_pk_bf16_f32 v185, v186, v187
  v_cvt_pk_bf16_f32 v186, v188, v189
  v_cvt_pk_bf16_f32 v187, v190, v191
  buffer_store_dwordx4 v[184:187], v2, s[8:11], s38 offen offset:3072 sc1
  s_branch k2_SS0
k2_SS0:
  s_waitcnt lgkmcnt(4)
  v_mfma_f32_16x16x32_bf16 v[224:227], a[192:195], v[64:67], v[104:107]
  v_exp_f32 v200, v200
  v_mfma_f32_16x16x32_bf16 v[240:243], a[192:195], v[80:83], v[108:111]
  ds_read_b128 a[224:227], v3 offset:8192
  v_cvt_pk_bf16_f32 v211, v214, v215
  v_mfma_f32_16x16x32_bf16 v[224:227], a[196:199], v[68:71], v[224:227]
  v_exp_f32 v201, v201
  v_mfma_f32_16x16x32_bf16 v[240:243], a[196:199], v[84:87], v[240:243]
  ds_read_b128 a[228:231], v3 offset:9216
  buffer_load_dwordx4 v4, s[20:23], s46 offen offset:2048 sc1 lds
  v_mfma_f32_16x16x32_bf16 v[224:227], a[200:203], v[72:75], v[224:227]
  v_exp_f32 v202, v202
  v_mfma_f32_16x16x32_bf16 v[240:243], a[200:203], v[88:91], v[240:243]
  ds_read_b128 a[232:235], v3 offset:10240
  v_cvt_pk_bf16_f32 v200, v200, v201
  v_mfma_f32_16x16x32_bf16 v[224:227], a[204:207], v[76:79], v[224:227]
  v_exp_f32 v203, v203
  v_mfma_f32_16x16x32_bf16 v[240:243], a[204:207], v[92:95], v[240:243]
  ds_read_b128 a[236:239], v3 offset:11264
  s_waitcnt lgkmcnt(4)
  v_mfma_f32_16x16x32_bf16 v[228:231], a[208:211], v[64:67], v[104:107]
  v_exp_f32 v204, v204
  v_mfma_f32_16x16x32_bf16 v[244:247], a[208:211], v[80:83], v[108:111]
  ds_read_b128 a[240:243], v3 offset:12288
  v_cvt_pk_bf16_f32 v201, v202, v203
  v_mfma_f32_16x16x32_bf16 v[228:231], a[212:215], v[68:71], v[228:231]
  v_exp_f32 v205, v205
  v_mfma_f32_16x16x32_bf16 v[244:247], a[212:215], v[84:87], v[244:247]
  ds_read_b128 a[244:247], v3 offset:13312
  buffer_load_dwordx4 v4, s[20:23], s46 offen offset:3072 sc1 lds
  v_mfma_f32_16x16x32_bf16 v[228:231], a[216:219], v[72:75], v[228:231]
  v_exp_f32 v206, v206
  v_mfma_f32_16x16x32_bf16 v[244:247], a[216:219], v[88:91], v[244:247]
  ds_read_b128 a[248:251], v3 offset:14336
  v_cvt_pk_bf16_f32 v202, v204, v205
  v_mfma_f32_16x16x32_bf16 v[228:231], a[220:223], v[76:79], v[228:231]
  v_exp_f32 v207, v207
  v_mfma_f32_16x16x32_bf16 v[244:247], a[220:223], v[92:95], v[244:247]
  ds_read_b128 a[252:255], v3 offset:15360
  s_add_u32 m0, m0, 16384
  s_waitcnt lgkmcnt(4)
  v_mfma_f32_16x16x32_bf16 v[232:235], a[224:227], v[64:67], v[104:107]
  v_exp_f32 v216, v216
  v_mfma_f32_16x16x32_bf16 v[248:251], a[224:227], v[80:83], v[108:111]
  ds_read_b128 a[192:195], v3 offset:16384
  v_cvt_pk_bf16_f32 v203, v206, v207
  v_mfma_f32_16x16x32_bf16 v[232:235], a[228:231], v[68:71], v[232:235]
  v_exp_f32 v217, v217
  v_mfma_f32_16x16x32_bf16 v[248:251], a[228:231], v[84:87], v[248:251]
  ds_read_b128 a[196:199], v3 offset:17408
  buffer_load_dwordx4 v4, s[24:27], s46 offen offset:0 sc1 lds
  v_mfma_f32_16x16x32_bf16 v[232:235], a[232:235], v[72:75], v[232:235]
  v_exp_f32 v218, v218
  v_mfma_f32_16x16x32_bf16 v[248:251], a[232:235], v[88:91], v[248:251]
  ds_read_b128 a[200:203], v3 offset:18432
  v_cvt_pk_bf16_f32 v216, v216, v217
  v_mfma_f32_16x16x32_bf16 v[232:235], a[236:239], v[76:79], v[232:235]
  v_exp_f32 v219, v219
  v_mfma_f32_16x16x32_bf16 v[248:251], a[236:239], v[92:95], v[248:251]
  ds_read_b128 a[204:207], v3 offset:19456
  s_waitcnt lgkmcnt(4)
  v_mfma_f32_16x16x32_bf16 v[236:239], a[240:243], v[64:67], v[104:107]
  v_exp_f32 v220, v220
  v_mfma_f32_16x16x32_bf16 v[252:255], a[240:243], v[80:83], v[108:111]
  ds_read_b128 a[208:211], v3 offset:20480
  v_cvt_pk_bf16_f32 v217, v218, v219
  v_mfma_f32_16x16x32_bf16 v[236:239], a[244:247], v[68:71], v[236:239]
  v_exp_f32 v221, v221
  v_mfma_f32_16x16x32_bf16 v[252:255], a[244:247], v[84:87], v[252:255]
  ds_read_b128 a[212:215], v3 offset:21504
  buffer_load_dwordx4 v4, s[24:27], s46 offen offset:1024 sc1 lds
  v_mfma_f32_16x16x32_bf16 v[236:239], a[248:251], v[72:75], v[236:239]
  v_exp_f32 v222, v222
  v_mfma_f32_16x16x32_bf16 v[252:255], a[248:251], v[88:91], v[252:255]
  ds_read_b128 a[216:219], v3 offset:22528
  v_cvt_pk_bf16_f32 v218, v220, v221
  v_mfma_f32_16x16x32_bf16 v[236:239], a[252:255], v[76:79], v[236:239]
  v_exp_f32 v223, v223
  v_mfma_f32_16x16x32_bf16 v[252:255], a[252:255], v[92:95], v[252:255]
  ds_read_b128 a[220:223], v3 offset:23552
  s_cmp_eq_u32 s37, s36
  s_cbranch_scc1 k2_kernel_domask12
k2_kernel_nomask11:
  s_waitcnt lgkmcnt(4)
  v_mfma_f32_16x16x32_bf16 a[128:131], a[192:195], v[192:195], a[128:131]
  v_exp_f32 v224, v224
  v_mfma_f32_16x16x32_bf16 a[132:135], a[192:195], v[208:211], a[132:135]
  ds_read_b128 a[224:227], v3 offset:24576
  v_cvt_pk_bf16_f32 v219, v222, v223
  v_mfma_f32_16x16x32_bf16 a[136:139], a[196:199], v[192:195], a[136:139]
  v_exp_f32 v225, v225
  v_mfma_f32_16x16x32_bf16 a[140:143], a[196:199], v[208:211], a[140:143]
  ds_read_b128 a[228:231], v3 offset:25600
  buffer_load_dwordx4 v4, s[24:27], s46 offen offset:2048 sc1 lds
  v_mfma_f32_16x16x32_bf16 a[144:147], a[200:203], v[192:195], a[144:147]
  v_exp_f32 v226, v226
  v_mfma_f32_16x16x32_bf16 a[148:151], a[200:203], v[208:211], a[148:151]
  ds_read_b128 a[232:235], v3 offset:26624
  v_cvt_pk_bf16_f32 v224, v224, v225
  v_mfma_f32_16x16x32_bf16 a[152:155], a[204:207], v[192:195], a[152:155]
  v_exp_f32 v227, v227
  v_mfma_f32_16x16x32_bf16 a[156:159], a[204:207], v[208:211], a[156:159]
  ds_read_b128 a[236:239], v3 offset:27648
  v_mfma_f32_16x16x32_bf16 v[120:123], v[24:27], v[192:195], v[120:123]
  s_add_u32 s37, s37, 1
  s_waitcnt lgkmcnt(4)
  v_mfma_f32_16x16x32_bf16 a[160:163], a[208:211], v[192:195], a[160:163]
  v_exp_f32 v228, v228
  v_mfma_f32_16x16x32_bf16 a[164:167], a[208:211], v[208:211], a[164:167]
  ds_read_b128 a[240:243], v3 offset:28672
  v_cvt_pk_bf16_f32 v225, v226, v227
  v_mfma_f32_16x16x32_bf16 a[168:171], a[212:215], v[192:195], a[168:171]
  v_exp_f32 v229, v229
  v_mfma_f32_16x16x32_bf16 a[172:175], a[212:215], v[208:211], a[172:175]
  ds_read_b128 a[244:247], v3 offset:29696
  buffer_load_dwordx4 v4, s[24:27], s46 offen offset:3072 sc1 lds
  v_mfma_f32_16x16x32_bf16 a[176:179], a[216:219], v[192:195], a[176:179]
  v_exp_f32 v230, v230
  v_mfma_f32_16x16x32_bf16 a[180:183], a[216:219], v[208:211], a[180:183]
  ds_read_b128 a[248:251], v3 offset:30720
  v_cvt_pk_bf16_f32 v226, v228, v229
  v_mfma_f32_16x16x32_bf16 a[184:187], a[220:223], v[192:195], a[184:187]
  v_exp_f32 v231, v231
  v_mfma_f32_16x16x32_bf16 a[188:191], a[220:223], v[208:211], a[188:191]
  ds_read_b128 a[252:255], v3 offset:31744
  v_mfma_f32_16x16x32_bf16 v[124:127], v[24:27], v[208:211], v[124:127]
  s_add_u32 s46, s46, 16384
  s_add_u32 s42, s42, 32768
  s_waitcnt lgkmcnt(4)
  v_mfma_f32_16x16x32_bf16 a[128:131], a[224:227], v[200:203], a[128:131]
  v_exp_f32 v240, v240
  v_mfma_f32_16x16x32_bf16 a[132:135], a[224:227], v[216:219], a[132:135]
  s_waitcnt vmcnt(16)
  s_barrier
  v_add_u32 v3, s45, v2
  ds_read_b128 a[192:195], v3 offset:0
  v_cvt_pk_bf16_f32 v227, v230, v231
  v_mfma_f32_16x16x32_bf16 a[136:139], a[228:231], v[200:203], a[136:139]
  v_exp_f32 v241, v241
  v_mfma_f32_16x16x32_bf16 a[140:143], a[228:231], v[216:219], a[140:143]
  ds_read_b128 a[196:199], v3 offset:1024
  s_cmp_eq_u32 s42, 163840
  s_cselect_b32 s42, 0, s42
  s_add_u32 m0, s42, s48
  v_mfma_f32_16x16x32_bf16 a[144:147], a[232:235], v[200:203], a[144:147]
  v_exp_f32 v242, v242
  v_mfma_f32_16x16x32_bf16 a[148:151], a[232:235], v[216:219], a[148:151]
  ds_read_b128 a[200:203], v3 offset:2048
  v_cvt_pk_bf16_f32 v240, v240, v241
  v_mfma_f32_16x16x32_bf16 a[152:155], a[236:239], v[200:203], a[152:155]
  v_exp_f32 v243, v243
  v_mfma_f32_16x16x32_bf16 a[156:159], a[236:239], v[216:219], a[156:159]
  ds_read_b128 a[204:207], v3 offset:3072
  v_mfma_f32_16x16x32_bf16 v[120:123], v[24:27], v[200:203], v[120:123]
  buffer_load_dwordx4 v4, s[20:23], s46 offen offset:0 sc1 lds
  s_waitcnt lgkmcnt(4)
  v_mfma_f32_16x16x32_bf16 a[160:163], a[240:243], v[200:203], a[160:163]
  v_exp_f32 v244, v244
  v_mfma_f32_16x16x32_bf16 a[164:167], a[240:243], v[216:219], a[164:167]
  ds_read_b128 a[208:211], v3 offset:4096
  v_cvt_pk_bf16_f32 v241, v242, v243
  v_mfma_f32_16x16x32_bf16 a[168:171], a[244:247], v[200:203], a[168:171]
  v_exp_f32 v245, v245
  v_mfma_f32_16x16x32_bf16 a[172:175], a[244:247], v[216:219], a[172:175]
  ds_read_b128 a[212:215], v3 offset:5120
  s_add_u32 s45, s45, 32768
  v_mfma_f32_16x16x32_bf16 a[176:179], a[248:251], v[200:203], a[176:179]
  v_exp_f32 v246, v246
  v_mfma_f32_16x16x32_bf16 a[180:183], a[248:251], v[216:219], a[180:183]
  ds_read_b128 a[216:219], v3 offset:6144
  v_cvt_pk_bf16_f32 v242, v244, v245
  s_cmp_eq_u32 s45, 163840
  s_cselect_b32 s45, 0, s45
  v_mfma_f32_16x16x32_bf16 a[184:187], a[252:255], v[200:203], a[184:187]
  v_exp_f32 v247, v247
  v_mfma_f32_16x16x32_bf16 a[188:191], a[252:255], v[216:219], a[188:191]
  ds_read_b128 a[220:223], v3 offset:7168
  v_mfma_f32_16x16x32_bf16 v[124:127], v[24:27], v[216:219], v[124:127]
  buffer_load_dwordx4 v4, s[20:23], s46 offen offset:1024 sc1 lds
  s_cmp_le_u32 s37, s36
  s_cbranch_scc0 k2_SL1
k2_SS1:
  s_waitcnt lgkmcnt(4)
  v_mfma_f32_16x16x32_bf16 v[192:195], a[192:195], v[64:67], v[104:107]
  v_exp_f32 v232, v232
  v_mfma_f32_16x16x32_bf16 v[208:211], a[192:195], v[80:83], v[108:111]
  ds_read_b128 a[224:227], v3 offset:8192
  v_cvt_pk_bf16_f32 v243, v246, v247
  v_mfma_f32_16x16x32_bf16 v[192:195], a[196:199], v[68:71], v[192:195]
  v_exp_f32 v233, v233
  v_mfma_f32_16x16x32_bf16 v[208:211], a[196:199], v[84:87], v[208:211]
  ds_read_b128 a[228:231], v3 offset:9216
  buffer_load_dwordx4 v4, s[20:23], s46 offen offset:2048 sc1 lds
  v_mfma_f32_16x16x32_bf16 v[192:195], a[200:203], v[72:75], v[192:195]
  v_exp_f32 v234, v234
  v_mfma_f32_16x16x32_bf16 v[208:211], a[200:203], v[88:91], v[208:211]
  ds_read_b128 a[232:235], v3 offset:10240
  v_cvt_pk_bf16_f32 v232, v232, v233
  v_mfma_f32_16x16x32_bf16 v[192:195], a[204:207], v[76:79], v[192:195]
  v_exp_f32 v235, v235
  v_mfma_f32_16x16x32_bf16 v[208:211], a[204:207], v[92:95], v[208:211]
  ds_read_b128 a[236:239], v3 offset:11264
  s_waitcnt lgkmcnt(4)
  v_mfma_f32_16x16x32_bf16 v[196:199], a[208:211], v[64:67], v[104:107]
  v_exp_f32 v236, v236
  v_mfma_f32_16x16x32_bf16 v[212:215], a[208:211], v[80:83], v[108:111]
  ds_read_b128 a[240:243], v3 offset:12288
  v_cvt_pk_bf16_f32 v233, v234, v235
  v_mfma_f32_16x16x32_bf16 v[196:199], a[212:215], v[68:71], v[196:199]
  v_exp_f32 v237, v237
  v_mfma_f32_16x16x32_bf16 v[212:215], a[212:215], v[84:87], v[212:215]
  ds_read_b128 a[244:247], v3 offset:13312
  buffer_load_dwordx4 v4, s[20:23], s46 offen offset:3072 sc1 lds
  v_mfma_f32_16x16x32_bf16 v[196:199], a[216:219], v[72:75], v[196:199]
  v_exp_f32 v238, v238
  v_mfma_f32_16x16x32_bf16 v[212:215], a[216:219], v[88:91], v[212:215]
  ds_read_b128 a[248:251], v3 offset:14336
  v_cvt_pk_bf16_f32 v234, v236, v237
  v_mfma_f32_16x16x32_bf16 v[196:199], a[220:223], v[76:79], v[196:199]
  v_exp_f32 v239, v239
  v_mfma_f32_16x16x32_bf16 v[212:215], a[220:223], v[92:95], v[212:215]
  ds_read_b128 a[252:255], v3 offset:15360
  s_add_u32 m0, m0, 16384
  s_waitcnt lgkmcnt(4)
  v_mfma_f32_16x16x32_bf16 v[200:203], a[224:227], v[64:67], v[104:107]
  v_exp_f32 v248, v248
  v_mfma_f32_16x16x32_bf16 v[216:219], a[224:227], v[80:83], v[108:111]
  ds_read_b128 a[192:195], v3 offset:16384
  v_cvt_pk_bf16_f32 v235, v238, v239
  v_mfma_f32_16x16x32_bf16 v[200:203], a[228:231], v[68:71], v[200:203]
  v_exp_f32 v249, v249
  v_mfma_f32_16x16x32_bf16 v[216:219], a[228:231], v[84:87], v[216:219]
  ds_read_b128 a[196:199], v3 offset:17408
  buffer_load_dwordx4 v4, s[24:27], s46 offen offset:0 sc1 lds
  v_mfma_f32_16x16x32_bf16 v[200:203], a[232:235], v[72:75], v[200:203]
  v_exp_f32 v250, v250
  v_mfma_f32_16x16x32_bf16 v[216:219], a[232:235], v[88:91], v[216:219]
  ds_read_b128 a[200:203], v3 offset:18432
  v_cvt_pk_bf16_f32 v248, v248, v249
  v_mfma_f32_16x16x32_bf16 v[200:203], a[236:239], v[76:79], v[200:203]
  v_exp_f32 v251, v251
  v_mfma_f32_16x16x32_bf16 v[216:219], a[236:239], v[92:95], v[216:219]
  ds_read_b128 a[204:207], v3 offset:19456
  s_waitcnt lgkmcnt(4)
  v_mfma_f32_16x16x32_bf16 v[204:207], a[240:243], v[64:67], v[104:107]
  v_exp_f32 v252, v252
  v_mfma_f32_16x16x32_bf16 v[220:223], a[240:243], v[80:83], v[108:111]
  ds_read_b128 a[208:211], v3 offset:20480
  v_cvt_pk_bf16_f32 v249, v250, v251
  v_mfma_f32_16x16x32_bf16 v[204:207], a[244:247], v[68:71], v[204:207]
  v_exp_f32 v253, v253
  v_mfma_f32_16x16x32_bf16 v[220:223], a[244:247], v[84:87], v[220:223]
  ds_read_b128 a[212:215], v3 offset:21504
  buffer_load_dwordx4 v4, s[24:27], s46 offen offset:1024 sc1 lds
  v_mfma_f32_16x16x32_bf16 v[204:207], a[248:251], v[72:75], v[204:207]
  v_exp_f32 v254, v254
  v_mfma_f32_16x16x32_bf16 v[220:223], a[248:251], v[88:91], v[220:223]
  ds_read_b128 a[216:219], v3 offset:22528
  v_cvt_pk_bf16_f32 v250, v252, v253
  v_mfma_f32_16x16x32_bf16 v[204:207], a[252:255], v[76:79], v[204:207]
  v_exp_f32 v255, v255
  v_mfma_f32_16x16x32_bf16 v[220:223], a[252:255], v[92:95], v[220:223]
  ds_read_b128 a[220:223], v3 offset:23552
  s_cmp_eq_u32 s37, s36
  s_cbranch_scc1 k2_kernel_domask14
k2_kernel_nomask13:
  s_waitcnt lgkmcnt(4)
  v_mfma_f32_16x16x32_bf16 a[128:131], a[192:195], v[224:227], a[128:131]
  v_exp_f32 v192, v192
  v_mfma_f32_16x16x32_bf16 a[132:135], a[192:195], v[240:243], a[132:135]
  ds_read_b128 a[224:227], v3 offset:24576
  v_cvt_pk_bf16_f32 v251, v254, v255
  v_mfma_f32_16x16x32_bf16 a[136:139], a[196:199], v[224:227], a[136:139]
  v_exp_f32 v193, v193
  v_mfma_f32_16x16x32_bf16 a[140:143], a[196:199], v[240:243], a[140:143]
  ds_read_b128 a[228:231], v3 offset:25600
  buffer_load_dwordx4 v4, s[24:27], s46 offen offset:2048 sc1 lds
  v_mfma_f32_16x16x32_bf16 a[144:147], a[200:203], v[224:227], a[144:147]
  v_exp_f32 v194, v194
  v_mfma_f32_16x16x32_bf16 a[148:151], a[200:203], v[240:243], a[148:151]
  ds_read_b128 a[232:235], v3 offset:26624
  v_cvt_pk_bf16_f32 v192, v192, v193
  v_mfma_f32_16x16x32_bf16 a[152:155], a[204:207], v[224:227], a[152:155]
  v_exp_f32 v195, v195
  v_mfma_f32_16x16x32_bf16 a[156:159], a[204:207], v[240:243], a[156:159]
  ds_read_b128 a[236:239], v3 offset:27648
  v_mfma_f32_16x16x32_bf16 v[120:123], v[24:27], v[224:227], v[120:123]
  s_add_u32 s37, s37, 1
  s_waitcnt lgkmcnt(4)
  v_mfma_f32_16x16x32_bf16 a[160:163], a[208:211], v[224:227], a[160:163]
  v_exp_f32 v196, v196
  v_mfma_f32_16x16x32_bf16 a[164:167], a[208:211], v[240:243], a[164:167]
  ds_read_b128 a[240:243], v3 offset:28672
  v_cvt_pk_bf16_f32 v193, v194, v195
  v_mfma_f32_16x16x32_bf16 a[168:171], a[212:215], v[224:227], a[168:171]
  v_exp_f32 v197, v197
  v_mfma_f32_16x16x32_bf16 a[172:175], a[212:215], v[240:243], a[172:175]
  ds_read_b128 a[244:247], v3 offset:29696
  buffer_load_dwordx4 v4, s[24:27], s46 offen offset:3072 sc1 lds
  v_mfma_f32_16x16x32_bf16 a[176:179], a[216:219], v[224:227], a[176:179]
  v_exp_f32 v198, v198
  v_mfma_f32_16x16x32_bf16 a[180:183], a[216:219], v[240:243], a[180:183]
  ds_read_b128 a[248:251], v3 offset:30720
  v_cvt_pk_bf16_f32 v194, v196, v197
  v_mfma_f32_16x16x32_bf16 a[184:187], a[220:223], v[224:227], a[184:187]
  v_exp_f32 v199, v199
  v_mfma_f32_16x16x32_bf16 a[188:191], a[220:223], v[240:243], a[188:191]
  ds_read_b128 a[252:255], v3 offset:31744
  v_mfma_f32_16x16x32_bf16 v[124:127], v[24:27], v[240:243], v[124:127]
  s_add_u32 s46, s46, 16384
  s_add_u32 s42, s42, 32768
  s_waitcnt lgkmcnt(4)
  v_mfma_f32_16x16x32_bf16 a[128:131], a[224:227], v[232:235], a[128:131]
  v_exp_f32 v208, v208
  v_mfma_f32_16x16x32_bf16 a[132:135], a[224:227], v[248:251], a[132:135]
  s_waitcnt vmcnt(16)
  s_barrier
  v_add_u32 v3, s45, v2
  ds_read_b128 a[192:195], v3 offset:0
  v_cvt_pk_bf16_f32 v195, v198, v199
  v_mfma_f32_16x16x32_bf16 a[136:139], a[228:231], v[232:235], a[136:139]
  v_exp_f32 v209, v209
  v_mfma_f32_16x16x32_bf16 a[140:143], a[228:231], v[248:251], a[140:143]
  ds_read_b128 a[196:199], v3 offset:1024
  s_cmp_eq_u32 s42, 163840
  s_cselect_b32 s42, 0, s42
  s_add_u32 m0, s42, s48
  v_mfma_f32_16x16x32_bf16 a[144:147], a[232:235], v[232:235], a[144:147]
  v_exp_f32 v210, v210
  v_mfma_f32_16x16x32_bf16 a[148:151], a[232:235], v[248:251], a[148:151]
  ds_read_b128 a[200:203], v3 offset:2048
  v_cvt_pk_bf16_f32 v208, v208, v209
  v_mfma_f32_16x16x32_bf16 a[152:155], a[236:239], v[232:235], a[152:155]
  v_exp_f32 v211, v211
  v_mfma_f32_16x16x32_bf16 a[156:159], a[236:239], v[248:251], a[156:159]
  ds_read_b128 a[204:207], v3 offset:3072
  v_mfma_f32_16x16x32_bf16 v[120:123], v[24:27], v[232:235], v[120:123]
  buffer_load_dwordx4 v4, s[20:23], s46 offen offset:0 sc1 lds
  s_waitcnt lgkmcnt(4)
  v_mfma_f32_16x16x32_bf16 a[160:163], a[240:243], v[232:235], a[160:163]
  v_exp_f32 v212, v212
  v_mfma_f32_16x16x32_bf16 a[164:167], a[240:243], v[248:251], a[164:167]
  ds_read_b128 a[208:211], v3 offset:4096
  v_cvt_pk_bf16_f32 v209, v210, v211
  v_mfma_f32_16x16x32_bf16 a[168:171], a[244:247], v[232:235], a[168:171]
  v_exp_f32 v213, v213
  v_mfma_f32_16x16x32_bf16 a[172:175], a[244:247], v[248:251], a[172:175]
  ds_read_b128 a[212:215], v3 offset:5120
  s_add_u32 s45, s45, 32768
  v_mfma_f32_16x16x32_bf16 a[176:179], a[248:251], v[232:235], a[176:179]
  v_exp_f32 v214, v214
  v_mfma_f32_16x16x32_bf16 a[180:183], a[248:251], v[248:251], a[180:183]
  ds_read_b128 a[216:219], v3 offset:6144
  v_cvt_pk_bf16_f32 v210, v212, v213
  s_cmp_eq_u32 s45, 163840
  s_cselect_b32 s45, 0, s45
  v_mfma_f32_16x16x32_bf16 a[184:187], a[252:255], v[232:235], a[184:187]
  v_exp_f32 v215, v215
  v_mfma_f32_16x16x32_bf16 a[188:191], a[252:255], v[248:251], a[188:191]
  ds_read_b128 a[220:223], v3 offset:7168
  v_mfma_f32_16x16x32_bf16 v[124:127], v[24:27], v[248:251], v[124:127]
  buffer_load_dwordx4 v4, s[20:23], s46 offen offset:1024 sc1 lds
  s_cmp_le_u32 s37, s36
  s_cbranch_scc0 k2_SL0
  s_branch k2_SS0
k2_SL0:
  s_waitcnt lgkmcnt(0)
  ds_read_b128 a[192:195], v3 offset:16384
  ds_read_b128 a[196:199], v3 offset:17408
  ds_read_b128 a[200:203], v3 offset:18432
  ds_read_b128 a[204:207], v3 offset:19456
  ds_read_b128 a[208:211], v3 offset:20480
  ds_read_b128 a[212:215], v3 offset:21504
  ds_read_b128 a[216:219], v3 offset:22528
  ds_read_b128 a[220:223], v3 offset:23552
  v_exp_f32 v200, v200
  v_cvt_pk_bf16_f32 v211, v214, v215
  v_exp_f32 v201, v201
  v_exp_f32 v202, v202
  v_cvt_pk_bf16_f32 v200, v200, v201
  v_exp_f32 v203, v203
  v_exp_f32 v204, v204
  v_cvt_pk_bf16_f32 v201, v202, v203
  v_exp_f32 v205, v205
  v_exp_f32 v206, v206
  v_cvt_pk_bf16_f32 v202, v204, v205
  v_exp_f32 v207, v207
  v_exp_f32 v216, v216
  v_cvt_pk_bf16_f32 v203, v206, v207
  v_exp_f32 v217, v217
  v_exp_f32 v218, v218
  v_cvt_pk_bf16_f32 v216, v216, v217
  v_exp_f32 v219, v219
  v_exp_f32 v220, v220
  v_cvt_pk_bf16_f32 v217, v218, v219
  v_exp_f32 v221, v221
  v_exp_f32 v222, v222
  v_cvt_pk_bf16_f32 v218, v220, v221
  v_exp_f32 v223, v223
  s_nop 1
  s_waitcnt lgkmcnt(4)
  v_mfma_f32_16x16x32_bf16 a[128:131], a[192:195], v[192:195], a[128:131]
  v_mfma_f32_16x16x32_bf16 a[132:135], a[192:195], v[208:211], a[132:135]
  ds_read_b128 a[224:227], v3 offset:24576
  v_cvt_pk_bf16_f32 v219, v222, v223
  v_mfma_f32_16x16x32_bf16 a[136:139], a[196:199], v[192:195], a[136:139]
  v_mfma_f32_16x16x32_bf16 a[140:143], a[196:199], v[208:211], a[140:143]
  ds_read_b128 a[228:231], v3 offset:25600
  v_mfma_f32_16x16x32_bf16 a[144:147], a[200:203], v[192:195], a[144:147]
  v_mfma_f32_16x16x32_bf16 a[148:151], a[200:203], v[208:211], a[148:151]
  ds_read_b128 a[232:235], v3 offset:26624
  v_mfma_f32_16x16x32_bf16 a[152:155], a[204:207], v[192:195], a[152:155]
  v_mfma_f32_16x16x32_bf16 a[156:159], a[204:207], v[208:211], a[156:159]
  ds_read_b128 a[236:239], v3 offset:27648
  v_mfma_f32_16x16x32_bf16 v[120:123], v[24:27], v[192:195], v[120:123]
  s_waitcnt lgkmcnt(4)
  v_mfma_f32_16x16x32_bf16 a[160:163], a[208:211], v[192:195], a[160:163]
  v_mfma_f32_16x16x32_bf16 a[164:167], a[208:211], v[208:211], a[164:167]
  ds_read_b128 a[240:243], v3 offset:28672
  v_mfma_f32_16x16x32_bf16 a[168:171], a[212:215], v[192:195], a[168:171]
  v_mfma_f32_16x16x32_bf16 a[172:175], a[212:215], v[208:211], a[172:175]
  ds_read_b128 a[244:247], v3 offset:29696
  v_mfma_f32_16x16x32_bf16 a[176:179], a[216:219], v[192:195], a[176:179]
  v_mfma_f32_16x16x32_bf16 a[180:183], a[216:219], v[208:211], a[180:183]
  ds_read_b128 a[248:251], v3 offset:30720
  v_mfma_f32_16x16x32_bf16 a[184:187], a[220:223], v[192:195], a[184:187]
  v_mfma_f32_16x16x32_bf16 a[188:191], a[220:223], v[208:211], a[188:191]
  ds_read_b128 a[252:255], v3 offset:31744
  v_mfma_f32_16x16x32_bf16 v[124:127], v[24:27], v[208:211], v[124:127]
  s_waitcnt lgkmcnt(4)
  v_mfma_f32_16x16x32_bf16 a[128:131], a[224:227], v[200:203], a[128:131]
  v_mfma_f32_16x16x32_bf16 a[132:135], a[224:227], v[216:219], a[132:135]
  s_cmp_ge_u32 s32, 2
  s_cbranch_scc1 k2_kernel_nobar15
  s_waitcnt vmcnt(8)
  s_barrier
k2_kernel_nobar15:
  v_add_u32 v3, s45, v2
  v_mfma_f32_16x16x32_bf16 a[136:139], a[228:231], v[200:203], a[136:139]
  v_mfma_f32_16x16x32_bf16 a[140:143], a[228:231], v[216:219], a[140:143]
  v_mfma_f32_16x16x32_bf16 a[144:147], a[232:235], v[200:203], a[144:147]
  v_mfma_f32_16x16x32_bf16 a[148:151], a[232:235], v[216:219], a[148:151]
  v_mfma_f32_16x16x32_bf16 a[152:155], a[236:239], v[200:203], a[152:155]
  v_mfma_f32_16x16x32_bf16 a[156:159], a[236:239], v[216:219], a[156:159]
  v_mfma_f32_16x16x32_bf16 v[120:123], v[24:27], v[200:203], v[120:123]
  s_waitcnt lgkmcnt(0)
  v_mfma_f32_16x16x32_bf16 a[160:163], a[240:243], v[200:203], a[160:163]
  v_mfma_f32_16x16x32_bf16 a[164:167], a[240:243], v[216:219], a[164:167]
  v_mfma_f32_16x16x32_bf16 a[168:171], a[244:247], v[200:203], a[168:171]
  v_mfma_f32_16x16x32_bf16 a[172:175], a[244:247], v[216:219], a[172:175]
  v_mfma_f32_16x16x32_bf16 a[176:179], a[248:251], v[200:203], a[176:179]
  v_mfma_f32_16x16x32_bf16 a[180:183], a[248:251], v[216:219], a[180:183]
  v_mfma_f32_16x16x32_bf16 a[184:187], a[252:255], v[200:203], a[184:187]
  v_mfma_f32_16x16x32_bf16 a[188:191], a[252:255], v[216:219], a[188:191]
  v_mfma_f32_16x16x32_bf16 v[124:127], v[24:27], v[216:219], v[124:127]
  s_branch k2_fin
k2_SL1:
  s_waitcnt lgkmcnt(0)
  ds_read_b128 a[192:195], v3 offset:16384
  ds_read_b128 a[196:199], v3 offset:17408
  ds_read_b128 a[200:203], v3 offset:18432
  ds_read_b128 a[204:207], v3 offset:19456
  ds_read_b128 a[208:211], v3 offset:20480
  ds_read_b128 a[212:215], v3 offset:21504
  ds_read_b128 a[216:219], v3 offset:22528
  ds_read_b128 a[220:223], v3 offset:23552
  v_exp_f32 v232, v232
  v_cvt_pk_bf16_f32 v243, v246, v247
  v_exp_f32 v233, v233
  v_exp_f32 v234, v234
  v_cvt_pk_bf16_f32 v232, v232, v233
  v_exp_f32 v235, v235
  v_exp_f32 v236, v236
  v_cvt_pk_bf16_f32 v233, v234, v235
  v_exp_f32 v237, v237
  v_exp_f32 v238, v238
  v_cvt_pk_bf16_f32 v234, v236, v237
  v_exp_f32 v239, v239
  v_exp_f32 v248, v248
  v_cvt_pk_bf16_f32 v235, v238, v239
  v_exp_f32 v249, v249
  v_exp_f32 v250, v250
  v_cvt_pk_bf16_f32 v248, v248, v249
  v_exp_f32 v251, v251
  v_exp_f32 v252, v252
  v_cvt_pk_bf16_f32 v249, v250, v251
  v_exp_f32 v253, v253
  v_exp_f32 v254, v254
  v_cvt_pk_bf16_f32 v250, v252, v253
  v_exp_f32 v255, v255
  s_nop 1
  s_waitcnt lgkmcnt(4)
  v_mfma_f32_16x16x32_bf16 a[128:131], a[192:195], v[224:227], a[128:131]
  v_mfma_f32_16x16x32_bf16 a[132:135], a[192:195], v[240:243], a[132:135]
  ds_read_b128 a[224:227], v3 offset:24576
  v_cvt_pk_bf16_f32 v251, v254, v255
  v_mfma_f32_16x16x32_bf16 a[136:139], a[196:199], v[224:227], a[136:139]
  v_mfma_f32_16x16x32_bf16 a[140:143], a[196:199], v[240:243], a[140:143]
  ds_read_b128 a[228:231], v3 offset:25600
  v_mfma_f32_16x16x32_bf16 a[144:147], a[200:203], v[224:227], a[144:147]
  v_mfma_f32_16x16x32_bf16 a[148:151], a[200:203], v[240:243], a[148:151]
  ds_read_b128 a[232:235], v3 offset:26624
  v_mfma_f32_16x16x32_bf16 a[152:155], a[204:207], v[224:227], a[152:155]
  v_mfma_f32_16x16x32_bf16 a[156:159], a[204:207], v[240:243], a[156:159]
  ds_read_b128 a[236:239], v3 offset:27648
  v_mfma_f32_16x16x32_bf16 v[120:123], v[24:27], v[224:227], v[120:123]
  s_waitcnt lgkmcnt(4)
  v_mfma_f32_16x16x32_bf16 a[160:163], a[208:211], v[224:227], a[160:163]
  v_mfma_f32_16x16x32_bf16 a[164:167], a[208:211], v[240:243], a[164:167]
  ds_read_b128 a[240:243], v3 offset:28672
  v_mfma_f32_16x16x32_bf16 a[168:171], a[212:215], v[224:227], a[168:171]
  v_mfma_f32_16x16x32_bf16 a[172:175], a[212:215], v[240:243], a[172:175]
  ds_read_b128 a[244:247], v3 offset:29696
  v_mfma_f32_16x16x32_bf16 a[176:179], a[216:219], v[224:227], a[176:179]
  v_mfma_f32_16x16x32_bf16 a[180:183], a[216:219], v[240:243], a[180:183]
  ds_read_b128 a[248:251], v3 offset:30720
  v_mfma_f32_16x16x32_bf16 a[184:187], a[220:223], v[224:227], a[184:187]
  v_mfma_f32_16x16x32_bf16 a[188:191], a[220:223], v[240:243], a[188:191]
  ds_read_b128 a[252:255], v3 offset:31744
  v_mfma_f32_16x16x32_bf16 v[124:127], v[24:27], v[240:243], v[124:127]
  s_waitcnt lgkmcnt(4)
  v_mfma_f32_16x16x32_bf16 a[128:131], a[224:227], v[232:235], a[128:131]
  v_mfma_f32_16x16x32_bf16 a[132:135], a[224:227], v[248:251], a[132:135]
  s_cmp_ge_u32 s32, 2
  s_cbranch_scc1 k2_kernel_nobar16
  s_waitcnt vmcnt(8)
  s_barrier
k2_kernel_nobar16:
  v_add_u32 v3, s45, v2
  v_mfma_f32_16x16x32_bf16 a[136:139], a[228:231], v[232:235], a[136:139]
  v_mfma_f32_16x16x32_bf16 a[140:143], a[228:231], v[248:251], a[140:143]
  v_mfma_f32_16x16x32_bf16 a[144:147], a[232:235], v[232:235], a[144:147]
  v_mfma_f32_16x16x32_bf16 a[148:151], a[232:235], v[248:251], a[148:151]
  v_mfma_f32_16x16x32_bf16 a[152:155], a[236:239], v[232:235], a[152:155]
  v_mfma_f32_16x16x32_bf16 a[156:159], a[236:239], v[248:251], a[156:159]
  v_mfma_f32_16x16x32_bf16 v[120:123], v[24:27], v[232:235], v[120:123]
  s_waitcnt lgkmcnt(0)
  v_mfma_f32_16x16x32_bf16 a[160:163], a[240:243], v[232:235], a[160:163]
  v_mfma_f32_16x16x32_bf16 a[164:167], a[240:243], v[248:251], a[164:167]
  v_mfma_f32_16x16x32_bf16 a[168:171], a[244:247], v[232:235], a[168:171]
  v_mfma_f32_16x16x32_bf16 a[172:175], a[244:247], v[248:251], a[172:175]
  v_mfma_f32_16x16x32_bf16 a[176:179], a[248:251], v[232:235], a[176:179]
  v_mfma_f32_16x16x32_bf16 a[180:183], a[248:251], v[248:251], a[180:183]
  v_mfma_f32_16x16x32_bf16 a[184:187], a[252:255], v[232:235], a[184:187]
  v_mfma_f32_16x16x32_bf16 a[188:191], a[252:255], v[248:251], a[188:191]
  v_mfma_f32_16x16x32_bf16 v[124:127], v[24:27], v[248:251], v[124:127]
k2_fin:
  s_nop 7
  v_max_f32 v13, v120, v124
  v_add_f32 v14, v120, v124
  v_cmp_nle_f32 vcc, v14, v21
  s_mov_b32 s50, 0
  s_cbranch_vccnz k2_slow_1
k2_ret_1_0:
  v_rcp_f32 v16, v120
  v_rcp_f32 v17, v124
  v_accvgpr_read_b32 v192, a128
  v_accvgpr_read_b32 v193, a129
  v_accvgpr_read_b32 v194, a130
  v_accvgpr_read_b32 v195, a131
  v_accvgpr_read_b32 v196, a136
  v_accvgpr_read_b32 v197, a137
  v_accvgpr_read_b32 v198, a138
  v_accvgpr_read_b32 v199, a139
  v_pk_mul_f32 v[192:193], v[192:193], v[16:17] op_sel_hi:[1,0]
  v_pk_mul_f32 v[194:195], v[194:195], v[16:17] op_sel_hi:[1,0]
  v_pk_mul_f32 v[196:197], v[196:197], v[16:17] op_sel_hi:[1,0]
  v_pk_mul_f32 v[198:199], v[198:199], v[16:17] op_sel_hi:[1,0]
  v_cvt_pk_bf16_f32 v192, v192, v193
  v_cvt_pk_bf16_f32 v193, v194, v195
  v_cvt_pk_bf16_f32 v194, v196, v197
  v_cvt_pk_bf16_f32 v195, v198, v199
  buffer_store_dwordx4 v[192:195], v2, s[8:11], s54 offen offset:0 sc1
  v_accvgpr_read_b32 v200, a144
  v_accvgpr_read_b32 v201, a145
  v_accvgpr_read_b32 v202, a146
  v_accvgpr_read_b32 v203, a147
  v_accvgpr_read_b32 v204, a152
  v_accvgpr_read_b32 v205, a153
  v_accvgpr_read_b32 v206, a154
  v_accvgpr_read_b32 v207, a155
  v_pk_mul_f32 v[200:201], v[200:201], v[16:17] op_sel_hi:[1,0]
  v_pk_mul_f32 v[202:203], v[202:203], v[16:17] op_sel_hi:[1,0]
  v_pk_mul_f32 v[204:205], v[204:205], v[16:17] op_sel_hi:[1,0]
  v_pk_mul_f32 v[206:207], v[206:207], v[16:17] op_sel_hi:[1,0]
  v_cvt_pk_bf16_f32 v200, v200, v201
  v_cvt_pk_bf16_f32 v201, v202, v203
  v_cvt_pk_bf16_f32 v202, v204, v205
  v_cvt_pk_bf16_f32 v203, v206, v207
  buffer_store_dwordx4 v[200:203], v2, s[8:11], s54 offen offset:1024 sc1
  v_accvgpr_read_b32 v208, a160
  v_accvgpr_read_b32 v209, a161
  v_accvgpr_read_b32 v210, a162
  v_accvgpr_read_b32 v211, a163
  v_accvgpr_read_b32 v212, a168
  v_accvgpr_read_b32 v213, a169
  v_accvgpr_read_b32 v214, a170
  v_accvgpr_read_b32 v215, a171
  v_pk_mul_f32 v[208:209], v[208:209], v[16:17] op_sel_hi:[1,0]
  v_pk_mul_f32 v[210:211], v[210:211], v[16:17] op_sel_hi:[1,0]
  v_pk_mul_f32 v[212:213], v[212:213], v[16:17] op_sel_hi:[1,0]
  v_pk_mul_f32 v[214:215], v[214:215], v[16:17] op_sel_hi:[1,0]
  v_cvt_pk_bf16_f32 v208, v208, v209
  v_cvt_pk_bf16_f32 v209, v210, v211
  v_cvt_pk_bf16_f32 v210, v212, v213
  v_cvt_pk_bf16_f32 v211, v214, v215
  buffer_store_dwordx4 v[208:211], v2, s[8:11], s54 offen offset:2048 sc1
  v_accvgpr_read_b32 v216, a176
  v_accvgpr_read_b32 v217, a177
  v_accvgpr_read_b32 v218, a178
  v_accvgpr_read_b32 v219, a179
  v_accvgpr_read_b32 v220, a184
  v_accvgpr_read_b32 v221, a185
  v_accvgpr_read_b32 v222, a186
  v_accvgpr_read_b32 v223, a187
  v_pk_mul_f32 v[216:217], v[216:217], v[16:17] op_sel_hi:[1,0]
  v_pk_mul_f32 v[218:219], v[218:219], v[16:17] op_sel_hi:[1,0]
  v_pk_mul_f32 v[220:221], v[220:221], v[16:17] op_sel_hi:[1,0]
  v_pk_mul_f32 v[222:223], v[222:223], v[16:17] op_sel_hi:[1,0]
  v_cvt_pk_bf16_f32 v216, v216, v217
  v_cvt_pk_bf16_f32 v217, v218, v219
  v_cvt_pk_bf16_f32 v218, v220, v221
  v_cvt_pk_bf16_f32 v219, v222, v223
  buffer_store_dwordx4 v[216:219], v2, s[8:11], s54 offen offset:3072 sc1
  s_add_u32 s38, s54, 131072
  v_accvgpr_read_b32 v224, a132
  v_accvgpr_read_b32 v225, a133
  v_accvgpr_read_b32 v226, a134
  v_accvgpr_read_b32 v227, a135
  v_accvgpr_read_b32 v228, a140
  v_accvgpr_read_b32 v229, a141
  v_accvgpr_read_b32 v230, a142
  v_accvgpr_read_b32 v231, a143
  v_pk_mul_f32 v[224:225], v[224:225], v[16:17] op_sel:[0,1]
  v_pk_mul_f32 v[226:227], v[226:227], v[16:17] op_sel:[0,1]
  v_pk_mul_f32 v[228:229], v[228:229], v[16:17] op_sel:[0,1]
  v_pk_mul_f32 v[230:231], v[230:231], v[16:17] op_sel:[0,1]
  v_cvt_pk_bf16_f32 v224, v224, v225
  v_cvt_pk_bf16_f32 v225, v226, v227
  v_cvt_pk_bf16_f32 v226, v228, v229
  v_cvt_pk_bf16_f32 v227, v230, v231
  buffer_store_dwordx4 v[224:227], v2, s[8:11], s38 offen offset:0 sc1
  v_accvgpr_read_b32 v232, a148
  v_accvgpr_read_b32 v233, a149
  v_accvgpr_read_b32 v234, a150
  v_accvgpr_read_b32 v235, a151
  v_accvgpr_read_b32 v236, a156
  v_accvgpr_read_b32 v237, a157
  v_accvgpr_read_b32 v238, a158
  v_accvgpr_read_b32 v239, a159
  v_pk_mul_f32 v[232:233], v[232:233], v[16:17] op_sel:[0,1]
  v_pk_mul_f32 v[234:235], v[234:235], v[16:17] op_sel:[0,1]
  v_pk_mul_f32 v[236:237], v[236:237], v[16:17] op_sel:[0,1]
  v_pk_mul_f32 v[238:239], v[238:239], v[16:17] op_sel:[0,1]
  v_cvt_pk_bf16_f32 v232, v232, v233
  v_cvt_pk_bf16_f32 v233, v234, v235
  v_cvt_pk_bf16_f32 v234, v236, v237
  v_cvt_pk_bf16_f32 v235, v238, v239
  buffer_store_dwordx4 v[232:235], v2, s[8:11], s38 offen offset:1024 sc1
  v_accvgpr_read_b32 v240, a164
  v_accvgpr_read_b32 v241, a165
  v_accvgpr_read_b32 v242, a166
  v_accvgpr_read_b32 v243, a167
  v_accvgpr_read_b32 v244, a172
  v_accvgpr_read_b32 v245, a173
  v_accvgpr_read_b32 v246, a174
  v_accvgpr_read_b32 v247, a175
  v_pk_mul_f32 v[240:241], v[240:241], v[16:17] op_sel:[0,1]
  v_pk_mul_f32 v[242:243], v[242:243], v[16:17] op_sel:[0,1]
  v_pk_mul_f32 v[244:245], v[244:245], v[16:17] op_sel:[0,1]
  v_pk_mul_f32 v[246:247], v[246:247], v[16:17] op_sel:[0,1]
  v_cvt_pk_bf16_f32 v240, v240, v241
  v_cvt_pk_bf16_f32 v241, v242, v243
  v_cvt_pk_bf16_f32 v242, v244, v245
  v_cvt_pk_bf16_f32 v243, v246, v247
  buffer_store_dwordx4 v[240:243], v2, s[8:11], s38 offen offset:2048 sc1
  v_accvgpr_read_b32 v248, a180
  v_accvgpr_read_b32 v249, a181
  v_accvgpr_read_b32 v250, a182
  v_accvgpr_read_b32 v251, a183
  v_accvgpr_read_b32 v252, a188
  v_accvgpr_read_b32 v253, a189
  v_accvgpr_read_b32 v254, a190
  v_accvgpr_read_b32 v255, a191
  v_pk_mul_f32 v[248:249], v[248:249], v[16:17] op_sel:[0,1]
  v_pk_mul_f32 v[250:251], v[250:251], v[16:17] op_sel:[0,1]
  v_pk_mul_f32 v[252:253], v[252:253], v[16:17] op_sel:[0,1]
  v_pk_mul_f32 v[254:255], v[254:255], v[16:17] op_sel:[0,1]
  v_cvt_pk_bf16_f32 v248, v248, v249
  v_cvt_pk_bf16_f32 v249, v250, v251
  v_cvt_pk_bf16_f32 v250, v252, v253
  v_cvt_pk_bf16_f32 v251, v254, v255
  buffer_store_dwordx4 v[248:251], v2, s[8:11], s38 offen offset:3072 sc1
  s_lshl_b32 s38, s34, 8
  s_lshl_b32 s39, s33, 2
  s_add_u32 s38, s38, s39
  s_add_u32 s96, s38, 61931520
  s_waitcnt lgkmcnt(0)
  s_branch k3_kernel
  s_endpgm
k2_kernel_domask8:
  s_nop 7
  v_cmp_gt_i32 s[56:57], 0, v5
  v_cmp_gt_i32 s[58:59], 1, v5
  s_nop 0
  v_cndmask_b32 v160, v160, v6, s[56:57]
  v_cndmask_b32 v161, v161, v6, s[58:59]
  v_cmp_gt_i32 s[56:57], 2, v5
  v_cmp_gt_i32 s[58:59], 3, v5
  s_nop 0
  v_cndmask_b32 v162, v162, v6, s[56:57]
  v_cndmask_b32 v163, v163, v6, s[58:59]
  v_cmp_gt_i32 s[56:57], 16, v5
  v_cmp_gt_i32 s[58:59], 17, v5
  s_nop 0
  v_cndmask_b32 v164, v164, v6, s[56:57]
  v_cndmask_b32 v165, v165, v6, s[58:59]
  v_cmp_gt_i32 s[56:57], 18, v5
  v_cmp_gt_i32 s[58:59], 19, v5
  s_nop 0
  v_cndmask_b32 v166, v166, v6, s[56:57]
  v_cndmask_b32 v167, v167, v6, s[58:59]
  v_cmp_gt_i32 s[56:57], 32, v5
  v_cmp_gt_i32 s[58:59], 33, v5
  s_nop 0
  v_cndmask_b32 v168, v168, v6, s[56:57]
  v_cndmask_b32 v169, v169, v6, s[58:59]
  v_cmp_gt_i32 s[56:57], 34, v5
  v_cmp_gt_i32 s[58:59], 35, v5
  s_nop 0
  v_cndmask_b32 v170, v170, v6, s[56:57]
  v_cndmask_b32 v171, v171, v6, s[58:59]
  v_cmp_gt_i32 s[56:57], 48, v5
  v_cmp_gt_i32 s[58:59], 49, v5
  s_nop 0
  v_cndmask_b32 v172, v172, v6, s[56:57]
  v_cndmask_b32 v173, v173, v6, s[58:59]
  v_cmp_gt_i32 s[56:57], 50, v5
  v_cmp_gt_i32 s[58:59], 51, v5
  s_nop 0
  v_cndmask_b32 v174, v174, v6, s[56:57]
  v_cndmask_b32 v175, v175, v6, s[58:59]
  v_cmp_gt_i32 s[56:57], -16, v5
  v_cmp_gt_i32 s[58:59], -15, v5
  s_nop 0
  v_cndmask_b32 v176, v176, v6, s[56:57]
  v_cndmask_b32 v177, v177, v6, s[58:59]
  v_cmp_gt_i32 s[56:57], -14, v5
  v_cmp_gt_i32 s[58:59], -13, v5
  s_nop 0
  v_cndmask_b32 v178, v178, v6, s[56:57]
  v_cndmask_b32 v179, v179, v6, s[58:59]
  v_cmp_gt_i32 s[56:57], 0, v5
  v_cmp_gt_i32 s[58:59], 1, v5
  s_nop 0
  v_cndmask_b32 v180, v180, v6, s[56:57]
  v_cndmask_b32 v181, v181, v6, s[58:59]
  v_cmp_gt_i32 s[56:57], 2, v5
  v_cmp_gt_i32 s[58:59], 3, v5
  s_nop 0
  v_cndmask_b32 v182, v182, v6, s[56:57]
  v_cndmask_b32 v183, v183, v6, s[58:59]
  v_cmp_gt_i32 s[56:57], 16, v5
  v_cmp_gt_i32 s[58:59], 17, v5
  s_nop 0
  v_cndmask_b32 v184, v184, v6, s[56:57]
  v_cndmask_b32 v185, v185, v6, s[58:59]
  v_cmp_gt_i32 s[56:57], 18, v5
  v_cmp_gt_i32 s[58:59], 19, v5
  s_nop 0
  v_cndmask_b32 v186, v186, v6, s[56:57]
  v_cndmask_b32 v187, v187, v6, s[58:59]
  v_cmp_gt_i32 s[56:57], 32, v5
  v_cmp_gt_i32 s[58:59], 33, v5
  s_nop 0
  v_cndmask_b32 v188, v188, v6, s[56:57]
  v_cndmask_b32 v189, v189, v6, s[58:59]
  v_cmp_gt_i32 s[56:57], 34, v5
  v_cmp_gt_i32 s[58:59], 35, v5
  s_nop 0
  v_cndmask_b32 v190, v190, v6, s[56:57]
  v_cndmask_b32 v191, v191, v6, s[58:59]
  s_branch k2_kernel_nomask7
k2_kernel_domask10:
  s_nop 7
  v_cmp_gt_i32 s[56:57], 0, v5
  v_cmp_gt_i32 s[58:59], 1, v5
  s_nop 0
  v_cndmask_b32 v128, v128, v6, s[56:57]
  v_cndmask_b32 v129, v129, v6, s[58:59]
  v_cmp_gt_i32 s[56:57], 2, v5
  v_cmp_gt_i32 s[58:59], 3, v5
  s_nop 0
  v_cndmask_b32 v130, v130, v6, s[56:57]
  v_cndmask_b32 v131, v131, v6, s[58:59]
  v_cmp_gt_i32 s[56:57], 16, v5
  v_cmp_gt_i32 s[58:59], 17, v5
  s_nop 0
  v_cndmask_b32 v132, v132, v6, s[56:57]
  v_cndmask_b32 v133, v133, v6, s[58:59]
  v_cmp_gt_i32 s[56:57], 18, v5
  v_cmp_gt_i32 s[58:59], 19, v5
  s_nop 0
  v_cndmask_b32 v134, v134, v6, s[56:57]
  v_cndmask_b32 v135, v135, v6, s[58:59]
  v_cmp_gt_i32 s[56:57], 32, v5
  v_cmp_gt_i32 s[58:59], 33, v5
  s_nop 0
  v_cndmask_b32 v136, v136, v6, s[56:57]
  v_cndmask_b32 v137, v137, v6, s[58:59]
  v_cmp_gt_i32 s[56:57], 34, v5
  v_cmp_gt_i32 s[58:59], 35, v5
  s_nop 0
  v_cndmask_b32 v138, v138, v6, s[56:57]
  v_cndmask_b32 v139, v139, v6, s[58:59]
  v_cmp_gt_i32 s[56:57], 48, v5
  v_cmp_gt_i32 s[58:59], 49, v5
  s_nop 0
  v_cndmask_b32 v140, v140, v6, s[56:57]
  v_cndmask_b32 v141, v141, v6, s[58:59]
  v_cmp_gt_i32 s[56:57], 50, v5
  v_cmp_gt_i32 s[58:59], 51, v5
  s_nop 0
  v_cndmask_b32 v142, v142, v6, s[56:57]
  v_cndmask_b32 v143, v143, v6, s[58:59]
  v_cmp_gt_i32 s[56:57], -16, v5
  v_cmp_gt_i32 s[58:59], -15, v5
  s_nop 0
  v_cndmask_b32 v144, v144, v6, s[56:57]
  v_cndmask_b32 v145, v145, v6, s[58:59]
  v_cmp_gt_i32 s[56:57], -14, v5
  v_cmp_gt_i32 s[58:59], -13, v5
  s_nop 0
  v_cndmask_b32 v146, v146, v6, s[56:57]
  v_cndmask_b32 v147, v147, v6, s[58:59]
  v_cmp_gt_i32 s[56:57], 0, v5
  v_cmp_gt_i32 s[58:59], 1, v5
  s_nop 0
  v_cndmask_b32 v148, v148, v6, s[56:57]
  v_cndmask_b32 v149, v149, v6, s[58:59]
  v_cmp_gt_i32 s[56:57], 2, v5
  v_cmp_gt_i32 s[58:59], 3, v5
  s_nop 0
  v_cndmask_b32 v150, v150, v6, s[56:57]
  v_cndmask_b32 v151, v151, v6, s[58:59]
  v_cmp_gt_i32 s[56:57], 16, v5
  v_cmp_gt_i32 s[58:59], 17, v5
  s_nop 0
  v_cndmask_b32 v152, v152, v6, s[56:57]
  v_cndmask_b32 v153, v153, v6, s[58:59]
  v_cmp_gt_i32 s[56:57], 18, v5
  v_cmp_gt_i32 s[58:59], 19, v5
  s_nop 0
  v_cndmask_b32 v154, v154, v6, s[56:57]
  v_cndmask_b32 v155, v155, v6, s[58:59]
  v_cmp_gt_i32 s[56:57], 32, v5
  v_cmp_gt_i32 s[58:59], 33, v5
  s_nop 0
  v_cndmask_b32 v156, v156, v6, s[56:57]
  v_cndmask_b32 v157, v157, v6, s[58:59]
  v_cmp_gt_i32 s[56:57], 34, v5
  v_cmp_gt_i32 s[58:59], 35, v5
  s_nop 0
  v_cndmask_b32 v158, v158, v6, s[56:57]
  v_cndmask_b32 v159, v159, v6, s[58:59]
  s_branch k2_kernel_nomask9
k2_kernel_domask12:
  s_nop 7
  v_cmp_gt_i32 s[56:57], 0, v5
  v_cmp_gt_i32 s[58:59], 1, v5
  s_nop 0
  v_cndmask_b32 v224, v224, v6, s[56:57]
  v_cndmask_b32 v225, v225, v6, s[58:59]
  v_cmp_gt_i32 s[56:57], 2, v5
  v_cmp_gt_i32 s[58:59], 3, v5
  s_nop 0
  v_cndmask_b32 v226, v226, v6, s[56:57]
  v_cndmask_b32 v227, v227, v6, s[58:59]
  v_cmp_gt_i32 s[56:57], 16, v5
  v_cmp_gt_i32 s[58:59], 17, v5
  s_nop 0
  v_cndmask_b32 v228, v228, v6, s[56:57]
  v_cndmask_b32 v229, v229, v6, s[58:59]
  v_cmp_gt_i32 s[56:57], 18, v5
  v_cmp_gt_i32 s[58:59], 19, v5
  s_nop 0
  v_cndmask_b32 v230, v230, v6, s[56:57]
  v_cndmask_b32 v231, v231, v6, s[58:59]
  v_cmp_gt_i32 s[56:57], 32, v5
  v_cmp_gt_i32 s[58:59], 33, v5
  s_nop 0
  v_cndmask_b32 v232, v232, v6, s[56:57]
  v_cndmask_b32 v233, v233, v6, s[58:59]
  v_cmp_gt_i32 s[56:57], 34, v5
  v_cmp_gt_i32 s[58:59], 35, v5
  s_nop 0
  v_cndmask_b32 v234, v234, v6, s[56:57]
  v_cndmask_b32 v235, v235, v6, s[58:59]
  v_cmp_gt_i32 s[56:57], 48, v5
  v_cmp_gt_i32 s[58:59], 49, v5
  s_nop 0
  v_cndmask_b32 v236, v236, v6, s[56:57]
  v_cndmask_b32 v237, v237, v6, s[58:59]
  v_cmp_gt_i32 s[56:57], 50, v5
  v_cmp_gt_i32 s[58:59], 51, v5
  s_nop 0
  v_cndmask_b32 v238, v238, v6, s[56:57]
  v_cndmask_b32 v239, v239, v6, s[58:59]
  v_cmp_gt_i32 s[56:57], -16, v5
  v_cmp_gt_i32 s[58:59], -15, v5
  s_nop 0
  v_cndmask_b32 v240, v240, v6, s[56:57]
  v_cndmask_b32 v241, v241, v6, s[58:59]
  v_cmp_gt_i32 s[56:57], -14, v5
  v_cmp_gt_i32 s[58:59], -13, v5
  s_nop 0
  v_cndmask_b32 v242, v242, v6, s[56:57]
  v_cndmask_b32 v243, v243, v6, s[58:59]
  v_cmp_gt_i32 s[56:57], 0, v5
  v_cmp_gt_i32 s[58:59], 1, v5
  s_nop 0
  v_cndmask_b32 v244, v244, v6, s[56:57]
  v_cndmask_b32 v245, v245, v6, s[58:59]
  v_cmp_gt_i32 s[56:57], 2, v5
  v_cmp_gt_i32 s[58:59], 3, v5
  s_nop 0
  v_cndmask_b32 v246, v246, v6, s[56:57]
  v_cndmask_b32 v247, v247, v6, s[58:59]
  v_cmp_gt_i32 s[56:57], 16, v5
  v_cmp_gt_i32 s[58:59], 17, v5
  s_nop 0
  v_cndmask_b32 v248, v248, v6, s[56:57]
  v_cndmask_b32 v249, v249, v6, s[58:59]
  v_cmp_gt_i32 s[56:57], 18, v5
  v_cmp_gt_i32 s[58:59], 19, v5
  s_nop 0
  v_cndmask_b32 v250, v250, v6, s[56:57]
  v_cndmask_b32 v251, v251, v6, s[58:59]
  v_cmp_gt_i32 s[56:57], 32, v5
  v_cmp_gt_i32 s[58:59], 33, v5
  s_nop 0
  v_cndmask_b32 v252, v252, v6, s[56:57]
  v_cndmask_b32 v253, v253, v6, s[58:59]
  v_cmp_gt_i32 s[56:57], 34, v5
  v_cmp_gt_i32 s[58:59], 35, v5
  s_nop 0
  v_cndmask_b32 v254, v254, v6, s[56:57]
  v_cndmask_b32 v255, v255, v6, s[58:59]
  s_branch k2_kernel_nomask11
k2_kernel_domask14:
  s_nop 7
  v_cmp_gt_i32 s[56:57], 0, v5
  v_cmp_gt_i32 s[58:59], 1, v5
  s_nop 0
  v_cndmask_b32 v192, v192, v6, s[56:57]
  v_cndmask_b32 v193, v193, v6, s[58:59]
  v_cmp_gt_i32 s[56:57], 2, v5
  v_cmp_gt_i32 s[58:59], 3, v5
  s_nop 0
  v_cndmask_b32 v194, v194, v6, s[56:57]
  v_cndmask_b32 v195, v195, v6, s[58:59]
  v_cmp_gt_i32 s[56:57], 16, v5
  v_cmp_gt_i32 s[58:59], 17, v5
  s_nop 0
  v_cndmask_b32 v196, v196, v6, s[56:57]
  v_cndmask_b32 v197, v197, v6, s[58:59]
  v_cmp_gt_i32 s[56:57], 18, v5
  v_cmp_gt_i32 s[58:59], 19, v5
  s_nop 0
  v_cndmask_b32 v198, v198, v6, s[56:57]
  v_cndmask_b32 v199, v199, v6, s[58:59]
  v_cmp_gt_i32 s[56:57], 32, v5
  v_cmp_gt_i32 s[58:59], 33, v5
  s_nop 0
  v_cndmask_b32 v200, v200, v6, s[56:57]
  v_cndmask_b32 v201, v201, v6, s[58:59]
  v_cmp_gt_i32 s[56:57], 34, v5
  v_cmp_gt_i32 s[58:59], 35, v5
  s_nop 0
  v_cndmask_b32 v202, v202, v6, s[56:57]
  v_cndmask_b32 v203, v203, v6, s[58:59]
  v_cmp_gt_i32 s[56:57], 48, v5
  v_cmp_gt_i32 s[58:59], 49, v5
  s_nop 0
  v_cndmask_b32 v204, v204, v6, s[56:57]
  v_cndmask_b32 v205, v205, v6, s[58:59]
  v_cmp_gt_i32 s[56:57], 50, v5
  v_cmp_gt_i32 s[58:59], 51, v5
  s_nop 0
  v_cndmask_b32 v206, v206, v6, s[56:57]
  v_cndmask_b32 v207, v207, v6, s[58:59]
  v_cmp_gt_i32 s[56:57], -16, v5
  v_cmp_gt_i32 s[58:59], -15, v5
  s_nop 0
  v_cndmask_b32 v208, v208, v6, s[56:57]
  v_cndmask_b32 v209, v209, v6, s[58:59]
  v_cmp_gt_i32 s[56:57], -14, v5
  v_cmp_gt_i32 s[58:59], -13, v5
  s_nop 0
  v_cndmask_b32 v210, v210, v6, s[56:57]
  v_cndmask_b32 v211, v211, v6, s[58:59]
  v_cmp_gt_i32 s[56:57], 0, v5
  v_cmp_gt_i32 s[58:59], 1, v5
  s_nop 0
  v_cndmask_b32 v212, v212, v6, s[56:57]
  v_cndmask_b32 v213, v213, v6, s[58:59]
  v_cmp_gt_i32 s[56:57], 2, v5
  v_cmp_gt_i32 s[58:59], 3, v5
  s_nop 0
  v_cndmask_b32 v214, v214, v6, s[56:57]
  v_cndmask_b32 v215, v215, v6, s[58:59]
  v_cmp_gt_i32 s[56:57], 16, v5
  v_cmp_gt_i32 s[58:59], 17, v5
  s_nop 0
  v_cndmask_b32 v216, v216, v6, s[56:57]
  v_cndmask_b32 v217, v217, v6, s[58:59]
  v_cmp_gt_i32 s[56:57], 18, v5
  v_cmp_gt_i32 s[58:59], 19, v5
  s_nop 0
  v_cndmask_b32 v218, v218, v6, s[56:57]
  v_cndmask_b32 v219, v219, v6, s[58:59]
  v_cmp_gt_i32 s[56:57], 32, v5
  v_cmp_gt_i32 s[58:59], 33, v5
  s_nop 0
  v_cndmask_b32 v220, v220, v6, s[56:57]
  v_cndmask_b32 v221, v221, v6, s[58:59]
  v_cmp_gt_i32 s[56:57], 34, v5
  v_cmp_gt_i32 s[58:59], 35, v5
  s_nop 0
  v_cndmask_b32 v222, v222, v6, s[56:57]
  v_cndmask_b32 v223, v223, v6, s[58:59]
  s_branch k2_kernel_nomask13
k2_slow_0:
  s_nop 7
  v_accvgpr_write_b32 a64, 0
  v_accvgpr_write_b32 a65, 0
  v_accvgpr_write_b32 a66, 0
  v_accvgpr_write_b32 a67, 0
  v_accvgpr_write_b32 a68, 0
  v_accvgpr_write_b32 a69, 0
  v_accvgpr_write_b32 a70, 0
  v_accvgpr_write_b32 a71, 0
  v_accvgpr_write_b32 a72, 0
  v_accvgpr_write_b32 a73, 0
  v_accvgpr_write_b32 a74, 0
  v_accvgpr_write_b32 a75, 0
  v_accvgpr_write_b32 a76, 0
  v_accvgpr_write_b32 a77, 0
  v_accvgpr_write_b32 a78, 0
  v_accvgpr_write_b32 a79, 0
  v_accvgpr_write_b32 a80, 0
  v_accvgpr_write_b32 a81, 0
  v_accvgpr_write_b32 a82, 0
  v_accvgpr_write_b32 a83, 0
  v_accvgpr_write_b32 a84, 0
  v_accvgpr_write_b32 a85, 0
  v_accvgpr_write_b32 a86, 0
  v_accvgpr_write_b32 a87, 0
  v_accvgpr_write_b32 a88, 0
  v_accvgpr_write_b32 a89, 0
  v_accvgpr_write_b32 a90, 0
  v_accvgpr_write_b32 a91, 0
  v_accvgpr_write_b32 a92, 0
  v_accvgpr_write_b32 a93, 0
  v_accvgpr_write_b32 a94, 0
  v_accvgpr_write_b32 a95, 0
  v_accvgpr_write_b32 a96, 0
  v_accvgpr_write_b32 a97, 0
  v_accvgpr_write_b32 a98, 0
  v_accvgpr_write_b32 a99, 0
  v_accvgpr_write_b32 a100, 0
  v_accvgpr_write_b32 a101, 0
  v_accvgpr_write_b32 a102, 0
  v_accvgpr_write_b32 a103, 0
  v_accvgpr_write_b32 a104, 0
  v_accvgpr_write_b32 a105, 0
  v_accvgpr_write_b32 a106, 0
  v_accvgpr_write_b32 a107, 0
  v_accvgpr_write_b32 a108, 0
  v_accvgpr_write_b32 a109, 0
  v_accvgpr_write_b32 a110, 0
  v_accvgpr_write_b32 a111, 0
  v_accvgpr_write_b32 a112, 0
  v_accvgpr_write_b32 a113, 0
  v_accvgpr_write_b32 a114, 0
  v_accvgpr_write_b32 a115, 0
  v_accvgpr_write_b32 a116, 0
  v_accvgpr_write_b32 a117, 0
  v_accvgpr_write_b32 a118, 0
  v_accvgpr_write_b32 a119, 0
  v_accvgpr_write_b32 a120, 0
  v_accvgpr_write_b32 a121, 0
  v_accvgpr_write_b32 a122, 0
  v_accvgpr_write_b32 a123, 0
  v_accvgpr_write_b32 a124, 0
  v_accvgpr_write_b32 a125, 0
  v_accvgpr_write_b32 a126, 0
  v_accvgpr_write_b32 a127, 0
  v_mov_b32 v96, 0xf149f2ca
  v_mov_b32 v112, 0
  v_mov_b32 v113, 0
  v_mov_b32 v114, 0
  v_mov_b32 v115, 0
  v_mov_b32 v100, 0xf149f2ca
  v_mov_b32 v116, 0
  v_mov_b32 v117, 0
  v_mov_b32 v118, 0
  v_mov_b32 v119, 0
  s_mov_b32 s60, 1
  s_mov_b32 s61, 0
k2_slowloop_0:
  s_add_u32 s98, s61, 0
  buffer_load_dwordx4 a[0:3], v2, s[20:23], s98 offen offset:0 sc1
  buffer_load_dwordx4 a[4:7], v2, s[20:23], s98 offen offset:1024 sc1
  buffer_load_dwordx4 a[8:11], v2, s[20:23], s98 offen offset:2048 sc1
  buffer_load_dwordx4 a[12:15], v2, s[20:23], s98 offen offset:3072 sc1
  s_add_u32 s98, s61, 4096
  buffer_load_dwordx4 a[16:19], v2, s[20:23], s98 offen offset:0 sc1
  buffer_load_dwordx4 a[20:23], v2, s[20:23], s98 offen offset:1024 sc1
  buffer_load_dwordx4 a[24:27], v2, s[20:23], s98 offen offset:2048 sc1
  buffer_load_dwordx4 a[28:31], v2, s[20:23], s98 offen offset:3072 sc1
  s_add_u32 s98, s61, 8192
  buffer_load_dwordx4 a[32:35], v2, s[20:23], s98 offen offset:0 sc1
  buffer_load_dwordx4 a[36:39], v2, s[20:23], s98 offen offset:1024 sc1
  buffer_load_dwordx4 a[40:43], v2, s[20:23], s98 offen offset:2048 sc1
  buffer_load_dwordx4 a[44:47], v2, s[20:23], s98 offen offset:3072 sc1
  s_add_u32 s98, s61, 12288
  buffer_load_dwordx4 a[48:51], v2, s[20:23], s98 offen offset:0 sc1
  buffer_load_dwordx4 a[52:55], v2, s[20:23], s98 offen offset:1024 sc1
  buffer_load_dwordx4 a[56:59], v2, s[20:23], s98 offen offset:2048 sc1
  buffer_load_dwordx4 a[60:63], v2, s[20:23], s98 offen offset:3072 sc1
  s_waitcnt vmcnt(0)
  v_mfma_f32_16x16x32_bf16 v[128:131], a[0:3], v[32:35], 0
  v_mfma_f32_16x16x32_bf16 v[144:147], a[0:3], v[48:51], 0
  v_mfma_f32_16x16x32_bf16 v[128:131], a[4:7], v[36:39], v[128:131]
  v_mfma_f32_16x16x32_bf16 v[144:147], a[4:7], v[52:55], v[144:147]
  v_mfma_f32_16x16x32_bf16 v[128:131], a[8:11], v[40:43], v[128:131]
  v_mfma_f32_16x16x32_bf16 v[144:147], a[8:11], v[56:59], v[144:147]
  v_mfma_f32_16x16x32_bf16 v[128:131], a[12:15], v[44:47], v[128:131]
  v_mfma_f32_16x16x32_bf16 v[144:147], a[12:15], v[60:63], v[144:147]
  v_mfma_f32_16x16x32_bf16 v[132:135], a[16:19], v[32:35], 0
  v_mfma_f32_16x16x32_bf16 v[148:151], a[16:19], v[48:51], 0
  v_mfma_f32_16x16x32_bf16 v[132:135], a[20:23], v[36:39], v[132:135]
  v_mfma_f32_16x16x32_bf16 v[148:151], a[20:23], v[52:55], v[148:151]
  v_mfma_f32_16x16x32_bf16 v[132:135], a[24:27], v[40:43], v[132:135]
  v_mfma_f32_16x16x32_bf16 v[148:151], a[24:27], v[56:59], v[148:151]
  v_mfma_f32_16x16x32_bf16 v[132:135], a[28:31], v[44:47], v[132:135]
  v_mfma_f32_16x16x32_bf16 v[148:151], a[28:31], v[60:63], v[148:151]
  v_mfma_f32_16x16x32_bf16 v[136:139], a[32:35], v[32:35], 0
  v_mfma_f32_16x16x32_bf16 v[152:155], a[32:35], v[48:51], 0
  v_mfma_f32_16x16x32_bf16 v[136:139], a[36:39], v[36:39], v[136:139]
  v_mfma_f32_16x16x32_bf16 v[152:155], a[36:39], v[52:55], v[152:155]
  v_mfma_f32_16x16x32_bf16 v[136:139], a[40:43], v[40:43], v[136:139]
  v_mfma_f32_16x16x32_bf16 v[152:155], a[40:43], v[56:59], v[152:155]
  v_mfma_f32_16x16x32_bf16 v[136:139], a[44:47], v[44:47], v[136:139]
  v_mfma_f32_16x16x32_bf16 v[152:155], a[44:47], v[60:63], v[152:155]
  v_mfma_f32_16x16x32_bf16 v[140:143], a[48:51], v[32:35], 0
  v_mfma_f32_16x16x32_bf16 v[156:159], a[48:51], v[48:51], 0
  v_mfma_f32_16x16x32_bf16 v[140:143], a[52:55], v[36:39], v[140:143]
  v_mfma_f32_16x16x32_bf16 v[156:159], a[52:55], v[52:55], v[156:159]
  v_mfma_f32_16x16x32_bf16 v[140:143], a[56:59], v[40:43], v[140:143]
  v_mfma_f32_16x16x32_bf16 v[156:159], a[56:59], v[56:59], v[156:159]
  v_mfma_f32_16x16x32_bf16 v[140:143], a[60:63], v[44:47], v[140:143]
  v_mfma_f32_16x16x32_bf16 v[156:159], a[60:63], v[60:63], v[156:159]
  s_add_u32 s98, s61, 16384
  buffer_load_dwordx4 a[0:3], v2, s[24:27], s98 offen offset:0 sc1
  buffer_load_dwordx4 a[4:7], v2, s[24:27], s98 offen offset:1024 sc1
  buffer_load_dwordx4 a[8:11], v2, s[24:27], s98 offen offset:2048 sc1
  buffer_load_dwordx4 a[12:15], v2, s[24:27], s98 offen offset:3072 sc1
  s_add_u32 s98, s61, 20480
  buffer_load_dwordx4 a[16:19], v2, s[24:27], s98 offen offset:0 sc1
  buffer_load_dwordx4 a[20:23], v2, s[24:27], s98 offen offset:1024 sc1
  buffer_load_dwordx4 a[24:27], v2, s[24:27], s98 offen offset:2048 sc1
  buffer_load_dwordx4 a[28:31], v2, s[24:27], s98 offen offset:3072 sc1
  s_add_u32 s98, s61, 24576
  buffer_load_dwordx4 a[32:35], v2, s[24:27], s98 offen offset:0 sc1
  buffer_load_dwordx4 a[36:39], v2, s[24:27], s98 offen offset:1024 sc1
  buffer_load_dwordx4 a[40:43], v2, s[24:27], s98 offen offset:2048 sc1
  buffer_load_dwordx4 a[44:47], v2, s[24:27], s98 offen offset:3072 sc1
  s_add_u32 s98, s61, 28672
  buffer_load_dwordx4 a[48:51], v2, s[24:27], s98 offen offset:0 sc1
  buffer_load_dwordx4 a[52:55], v2, s[24:27], s98 offen offset:1024 sc1
  buffer_load_dwordx4 a[56:59], v2, s[24:27], s98 offen offset:2048 sc1
  buffer_load_dwordx4 a[60:63], v2, s[24:27], s98 offen offset:3072 sc1
  s_cmp_lg_u32 s60, s35
  s_cbranch_scc1 k2_kernel_snomask17
  v_cmp_gt_i32 s[56:57], 0, v5
  v_cmp_gt_i32 s[58:59], 1, v5
  s_nop 0
  v_cndmask_b32 v128, v128, v6, s[56:57]
  v_cndmask_b32 v129, v129, v6, s[58:59]
  v_cmp_gt_i32 s[56:57], 2, v5
  v_cmp_gt_i32 s[58:59], 3, v5
  s_nop 0
  v_cndmask_b32 v130, v130, v6, s[56:57]
  v_cndmask_b32 v131, v131, v6, s[58:59]
  v_cmp_gt_i32 s[56:57], 16, v5
  v_cmp_gt_i32 s[58:59], 17, v5
  s_nop 0
  v_cndmask_b32 v132, v132, v6, s[56:57]
  v_cndmask_b32 v133, v133, v6, s[58:59]
  v_cmp_gt_i32 s[56:57], 18, v5
  v_cmp_gt_i32 s[58:59], 19, v5
  s_nop 0
  v_cndmask_b32 v134, v134, v6, s[56:57]
  v_cndmask_b32 v135, v135, v6, s[58:59]
  v_cmp_gt_i32 s[56:57], 32, v5
  v_cmp_gt_i32 s[58:59], 33, v5
  s_nop 0
  v_cndmask_b32 v136, v136, v6, s[56:57]
  v_cndmask_b32 v137, v137, v6, s[58:59]
  v_cmp_gt_i32 s[56:57], 34, v5
  v_cmp_gt_i32 s[58:59], 35, v5
  s_nop 0
  v_cndmask_b32 v138, v138, v6, s[56:57]
  v_cndmask_b32 v139, v139, v6, s[58:59]
  v_cmp_gt_i32 s[56:57], 48, v5
  v_cmp_gt_i32 s[58:59], 49, v5
  s_nop 0
  v_cndmask_b32 v140, v140, v6, s[56:57]
  v_cndmask_b32 v141, v141, v6, s[58:59]
  v_cmp_gt_i32 s[56:57], 50, v5
  v_cmp_gt_i32 s[58:59], 51, v5
  s_nop 0
  v_cndmask_b32 v142, v142, v6, s[56:57]
  v_cndmask_b32 v143, v143, v6, s[58:59]
  v_cmp_gt_i32 s[56:57], -16, v5
  v_cmp_gt_i32 s[58:59], -15, v5
  s_nop 0
  v_cndmask_b32 v144, v144, v6, s[56:57]
  v_cndmask_b32 v145, v145, v6, s[58:59]
  v_cmp_gt_i32 s[56:57], -14, v5
  v_cmp_gt_i32 s[58:59], -13, v5
  s_nop 0
  v_cndmask_b32 v146, v146, v6, s[56:57]
  v_cndmask_b32 v147, v147, v6, s[58:59]
  v_cmp_gt_i32 s[56:57], 0, v5
  v_cmp_gt_i32 s[58:59], 1, v5
  s_nop 0
  v_cndmask_b32 v148, v148, v6, s[56:57]
  v_cndmask_b32 v149, v149, v6, s[58:59]
  v_cmp_gt_i32 s[56:57], 2, v5
  v_cmp_gt_i32 s[58:59], 3, v5
  s_nop 0
  v_cndmask_b32 v150, v150, v6, s[56:57]
  v_cndmask_b32 v151, v151, v6, s[58:59]
  v_cmp_gt_i32 s[56:57], 16, v5
  v_cmp_gt_i32 s[58:59], 17, v5
  s_nop 0
  v_cndmask_b32 v152, v152, v6, s[56:57]
  v_cndmask_b32 v153, v153, v6, s[58:59]
  v_cmp_gt_i32 s[56:57], 18, v5
  v_cmp_gt_i32 s[58:59], 19, v5
  s_nop 0
  v_cndmask_b32 v154, v154, v6, s[56:57]
  v_cndmask_b32 v155, v155, v6, s[58:59]
  v_cmp_gt_i32 s[56:57], 32, v5
  v_cmp_gt_i32 s[58:59], 33, v5
  s_nop 0
  v_cndmask_b32 v156, v156, v6, s[56:57]
  v_cndmask_b32 v157, v157, v6, s[58:59]
  v_cmp_gt_i32 s[56:57], 34, v5
  v_cmp_gt_i32 s[58:59], 35, v5
  s_nop 0
  v_cndmask_b32 v158, v158, v6, s[56:57]
  v_cndmask_b32 v159, v159, v6, s[58:59]
k2_kernel_snomask17:
  v_max3_f32 v16, v128, v129, v130
  v_max3_f32 v16, v16, v131, v132
  v_max3_f32 v16, v16, v133, v134
  v_max3_f32 v16, v16, v135, v136
  v_max3_f32 v16, v16, v137, v138
  v_max3_f32 v16, v16, v139, v140
  v_max3_f32 v16, v16, v141, v142
  v_max_f32 v16, v16, v143
  v_mov_b32 v14, v16
  s_nop 1
  v_permlane16_swap_b32 v16, v14
  v_max_f32 v16, v16, v14
  v_mov_b32 v14, v16
  s_nop 1
  v_permlane32_swap_b32 v16, v14
  v_max_f32 v16, v16, v14
  v_max_f32 v16, v16, v96
  v_sub_f32 v97, v96, v16
  v_mov_b32 v96, v16
  v_exp_f32 v97, v97
  v_sub_f32 v128, v128, v96
  v_sub_f32 v129, v129, v96
  v_sub_f32 v130, v130, v96
  v_sub_f32 v131, v131, v96
  v_sub_f32 v132, v132, v96
  v_sub_f32 v133, v133, v96
  v_sub_f32 v134, v134, v96
  v_sub_f32 v135, v135, v96
  v_sub_f32 v136, v136, v96
  v_sub_f32 v137, v137, v96
  v_sub_f32 v138, v138, v96
  v_sub_f32 v139, v139, v96
  v_sub_f32 v140, v140, v96
  v_sub_f32 v141, v141, v96
  v_sub_f32 v142, v142, v96
  v_sub_f32 v143, v143, v96
  v_mul_f32 v112, v112, v97
  v_mul_f32 v113, v113, v97
  v_mul_f32 v114, v114, v97
  v_mul_f32 v115, v115, v97
  v_accvgpr_read_b32 v13, a64
  v_mul_f32 v13, v13, v97
  v_accvgpr_write_b32 a64, v13
  v_accvgpr_read_b32 v14, a65
  v_mul_f32 v14, v14, v97
  v_accvgpr_write_b32 a65, v14
  v_accvgpr_read_b32 v13, a66
  v_mul_f32 v13, v13, v97
  v_accvgpr_write_b32 a66, v13
  v_accvgpr_read_b32 v14, a67
  v_mul_f32 v14, v14, v97
  v_accvgpr_write_b32 a67, v14
  v_accvgpr_read_b32 v13, a72
  v_mul_f32 v13, v13, v97
  v_accvgpr_write_b32 a72, v13
  v_accvgpr_read_b32 v14, a73
  v_mul_f32 v14, v14, v97
  v_accvgpr_write_b32 a73, v14
  v_accvgpr_read_b32 v13, a74
  v_mul_f32 v13, v13, v97
  v_accvgpr_write_b32 a74, v13
  v_accvgpr_read_b32 v14, a75
  v_mul_f32 v14, v14, v97
  v_accvgpr_write_b32 a75, v14
  v_accvgpr_read_b32 v13, a80
  v_mul_f32 v13, v13, v97
  v_accvgpr_write_b32 a80, v13
  v_accvgpr_read_b32 v14, a81
  v_mul_f32 v14, v14, v97
  v_accvgpr_write_b32 a81, v14
  v_accvgpr_read_b32 v13, a82
  v_mul_f32 v13, v13, v97
  v_accvgpr_write_b32 a82, v13
  v_accvgpr_read_b32 v14, a83
  v_mul_f32 v14, v14, v97
  v_accvgpr_write_b32 a83, v14
  v_accvgpr_read_b32 v13, a88
  v_mul_f32 v13, v13, v97
  v_accvgpr_write_b32 a88, v13
  v_accvgpr_read_b32 v14, a89
  v_mul_f32 v14, v14, v97
  v_accvgpr_write_b32 a89, v14
  v_accvgpr_read_b32 v13, a90
  v_mul_f32 v13, v13, v97
  v_accvgpr_write_b32 a90, v13
  v_accvgpr_read_b32 v14, a91
  v_mul_f32 v14, v14, v97
  v_accvgpr_write_b32 a91, v14
  v_accvgpr_read_b32 v13, a96
  v_mul_f32 v13, v13, v97
  v_accvgpr_write_b32 a96, v13
  v_accvgpr_read_b32 v14, a97
  v_mul_f32 v14, v14, v97
  v_accvgpr_write_b32 a97, v14
  v_accvgpr_read_b32 v13, a98
  v_mul_f32 v13, v13, v97
  v_accvgpr_write_b32 a98, v13
  v_accvgpr_read_b32 v14, a99
  v_mul_f32 v14, v14, v97
  v_accvgpr_write_b32 a99, v14
  v_accvgpr_read_b32 v13, a104
  v_mul_f32 v13, v13, v97
  v_accvgpr_write_b32 a104, v13
  v_accvgpr_read_b32 v14, a105
  v_mul_f32 v14, v14, v97
  v_accvgpr_write_b32 a105, v14
  v_accvgpr_read_b32 v13, a106
  v_mul_f32 v13, v13, v97
  v_accvgpr_write_b32 a106, v13
  v_accvgpr_read_b32 v14, a107
  v_mul_f32 v14, v14, v97
  v_accvgpr_write_b32 a107, v14
  v_accvgpr_read_b32 v13, a112
  v_mul_f32 v13, v13, v97
  v_accvgpr_write_b32 a112, v13
  v_accvgpr_read_b32 v14, a113
  v_mul_f32 v14, v14, v97
  v_accvgpr_write_b32 a113, v14
  v_accvgpr_read_b32 v13, a114
  v_mul_f32 v13, v13, v97
  v_accvgpr_write_b32 a114, v13
  v_accvgpr_read_b32 v14, a115
  v_mul_f32 v14, v14, v97
  v_accvgpr_write_b32 a115, v14
  v_accvgpr_read_b32 v13, a120
  v_mul_f32 v13, v13, v97
  v_accvgpr_write_b32 a120, v13
  v_accvgpr_read_b32 v14, a121
  v_mul_f32 v14, v14, v97
  v_accvgpr_write_b32 a121, v14
  v_accvgpr_read_b32 v13, a122
  v_mul_f32 v13, v13, v97
  v_accvgpr_write_b32 a122, v13
  v_accvgpr_read_b32 v14, a123
  v_mul_f32 v14, v14, v97
  v_accvgpr_write_b32 a123, v14
  v_max3_f32 v16, v144, v145, v146
  v_max3_f32 v16, v16, v147, v148
  v_max3_f32 v16, v16, v149, v150
  v_max3_f32 v16, v16, v151, v152
  v_max3_f32 v16, v16, v153, v154
  v_max3_f32 v16, v16, v155, v156
  v_max3_f32 v16, v16, v157, v158
  v_max_f32 v16, v16, v159
  v_mov_b32 v14, v16
  s_nop 1
  v_permlane16_swap_b32 v16, v14
  v_max_f32 v16, v16, v14
  v_mov_b32 v14, v16
  s_nop 1
  v_permlane32_swap_b32 v16, v14
  v_max_f32 v16, v16, v14
  v_max_f32 v16, v16, v100
  v_sub_f32 v101, v100, v16
  v_mov_b32 v100, v16
  v_exp_f32 v101, v101
  v_sub_f32 v144, v144, v100
  v_sub_f32 v145, v145, v100
  v_sub_f32 v146, v146, v100
  v_sub_f32 v147, v147, v100
  v_sub_f32 v148, v148, v100
  v_sub_f32 v149, v149, v100
  v_sub_f32 v150, v150, v100
  v_sub_f32 v151, v151, v100
  v_sub_f32 v152, v152, v100
  v_sub_f32 v153, v153, v100
  v_sub_f32 v154, v154, v100
  v_sub_f32 v155, v155, v100
  v_sub_f32 v156, v156, v100
  v_sub_f32 v157, v157, v100
  v_sub_f32 v158, v158, v100
  v_sub_f32 v159, v159, v100
  v_mul_f32 v116, v116, v101
  v_mul_f32 v117, v117, v101
  v_mul_f32 v118, v118, v101
  v_mul_f32 v119, v119, v101
  v_accvgpr_read_b32 v13, a68
  v_mul_f32 v13, v13, v101
  v_accvgpr_write_b32 a68, v13
  v_accvgpr_read_b32 v14, a69
  v_mul_f32 v14, v14, v101
  v_accvgpr_write_b32 a69, v14
  v_accvgpr_read_b32 v13, a70
  v_mul_f32 v13, v13, v101
  v_accvgpr_write_b32 a70, v13
  v_accvgpr_read_b32 v14, a71
  v_mul_f32 v14, v14, v101
  v_accvgpr_write_b32 a71, v14
  v_accvgpr_read_b32 v13, a76
  v_mul_f32 v13, v13, v101
  v_accvgpr_write_b32 a76, v13
  v_accvgpr_read_b32 v14, a77
  v_mul_f32 v14, v14, v101
  v_accvgpr_write_b32 a77, v14
  v_accvgpr_read_b32 v13, a78
  v_mul_f32 v13, v13, v101
  v_accvgpr_write_b32 a78, v13
  v_accvgpr_read_b32 v14, a79
  v_mul_f32 v14, v14, v101
  v_accvgpr_write_b32 a79, v14
  v_accvgpr_read_b32 v13, a84
  v_mul_f32 v13, v13, v101
  v_accvgpr_write_b32 a84, v13
  v_accvgpr_read_b32 v14, a85
  v_mul_f32 v14, v14, v101
  v_accvgpr_write_b32 a85, v14
  v_accvgpr_read_b32 v13, a86
  v_mul_f32 v13, v13, v101
  v_accvgpr_write_b32 a86, v13
  v_accvgpr_read_b32 v14, a87
  v_mul_f32 v14, v14, v101
  v_accvgpr_write_b32 a87, v14
  v_accvgpr_read_b32 v13, a92
  v_mul_f32 v13, v13, v101
  v_accvgpr_write_b32 a92, v13
  v_accvgpr_read_b32 v14, a93
  v_mul_f32 v14, v14, v101
  v_accvgpr_write_b32 a93, v14
  v_accvgpr_read_b32 v13, a94
  v_mul_f32 v13, v13, v101
  v_accvgpr_write_b32 a94, v13
  v_accvgpr_read_b32 v14, a95
  v_mul_f32 v14, v14, v101
  v_accvgpr_write_b32 a95, v14
  v_accvgpr_read_b32 v13, a100
  v_mul_f32 v13, v13, v101
  v_accvgpr_write_b32 a100, v13
  v_accvgpr_read_b32 v14, a101
  v_mul_f32 v14, v14, v101
  v_accvgpr_write_b32 a101, v14
  v_accvgpr_read_b32 v13, a102
  v_mul_f32 v13, v13, v101
  v_accvgpr_write_b32 a102, v13
  v_accvgpr_read_b32 v14, a103
  v_mul_f32 v14, v14, v101
  v_accvgpr_write_b32 a103, v14
  v_accvgpr_read_b32 v13, a108
  v_mul_f32 v13, v13, v101
  v_accvgpr_write_b32 a108, v13
  v_accvgpr_read_b32 v14, a109
  v_mul_f32 v14, v14, v101
  v_accvgpr_write_b32 a109, v14
  v_accvgpr_read_b32 v13, a110
  v_mul_f32 v13, v13, v101
  v_accvgpr_write_b32 a110, v13
  v_accvgpr_read_b32 v14, a111
  v_mul_f32 v14, v14, v101
  v_accvgpr_write_b32 a111, v14
  v_accvgpr_read_b32 v13, a116
  v_mul_f32 v13, v13, v101
  v_accvgpr_write_b32 a116, v13
  v_accvgpr_read_b32 v14, a117
  v_mul_f32 v14, v14, v101
  v_accvgpr_write_b32 a117, v14
  v_accvgpr_read_b32 v13, a118
  v_mul_f32 v13, v13, v101
  v_accvgpr_write_b32 a118, v13
  v_accvgpr_read_b32 v14, a119
  v_mul_f32 v14, v14, v101
  v_accvgpr_write_b32 a119, v14
  v_accvgpr_read_b32 v13, a124
  v_mul_f32 v13, v13, v101
  v_accvgpr_write_b32 a124, v13
  v_accvgpr_read_b32 v14, a125
  v_mul_f32 v14, v14, v101
  v_accvgpr_write_b32 a125, v14
  v_accvgpr_read_b32 v13, a126
  v_mul_f32 v13, v13, v101
  v_accvgpr_write_b32 a126, v13
  v_accvgpr_read_b32 v14, a127
  v_mul_f32 v14, v14, v101
  v_accvgpr_write_b32 a127, v14
  v_exp_f32 v128, v128
  v_exp_f32 v129, v129
  v_exp_f32 v130, v130
  v_cvt_pk_bf16_f32 v128, v128, v129
  v_exp_f32 v131, v131
  v_exp_f32 v132, v132
  v_cvt_pk_bf16_f32 v129, v130, v131
  v_exp_f32 v133, v133
  v_exp_f32 v134, v134
  v_cvt_pk_bf16_f32 v130, v132, v133
  v_exp_f32 v135, v135
  v_exp_f32 v144, v144
  v_cvt_pk_bf16_f32 v131, v134, v135
  v_exp_f32 v145, v145
  v_exp_f32 v146, v146
  v_cvt_pk_bf16_f32 v144, v144, v145
  v_exp_f32 v147, v147
  v_exp_f32 v148, v148
  v_cvt_pk_bf16_f32 v145, v146, v147
  v_exp_f32 v149, v149
  v_exp_f32 v150, v150
  v_cvt_pk_bf16_f32 v146, v148, v149
  v_exp_f32 v151, v151
  v_exp_f32 v136, v136
  v_cvt_pk_bf16_f32 v147, v150, v151
  v_exp_f32 v137, v137
  v_exp_f32 v138, v138
  v_cvt_pk_bf16_f32 v136, v136, v137
  v_exp_f32 v139, v139
  v_exp_f32 v140, v140
  v_cvt_pk_bf16_f32 v137, v138, v139
  v_exp_f32 v141, v141
  v_exp_f32 v142, v142
  v_cvt_pk_bf16_f32 v138, v140, v141
  v_exp_f32 v143, v143
  v_exp_f32 v152, v152
  v_cvt_pk_bf16_f32 v139, v142, v143
  v_exp_f32 v153, v153
  v_exp_f32 v154, v154
  v_cvt_pk_bf16_f32 v152, v152, v153
  v_exp_f32 v155, v155
  v_exp_f32 v156, v156
  v_cvt_pk_bf16_f32 v153, v154, v155
  v_exp_f32 v157, v157
  v_exp_f32 v158, v158
  v_cvt_pk_bf16_f32 v154, v156, v157
  v_exp_f32 v159, v159
  s_nop 0
  v_cvt_pk_bf16_f32 v155, v158, v159
  s_waitcnt vmcnt(0)
  s_nop 0
  v_mfma_f32_16x16x32_bf16 a[64:67], a[0:3], v[128:131], a[64:67]
  v_mfma_f32_16x16x32_bf16 a[68:71], a[0:3], v[144:147], a[68:71]
  v_mfma_f32_16x16x32_bf16 a[72:75], a[4:7], v[128:131], a[72:75]
  v_mfma_f32_16x16x32_bf16 a[76:79], a[4:7], v[144:147], a[76:79]
  v_mfma_f32_16x16x32_bf16 a[80:83], a[8:11], v[128:131], a[80:83]
  v_mfma_f32_16x16x32_bf16 a[84:87], a[8:11], v[144:147], a[84:87]
  v_mfma_f32_16x16x32_bf16 a[88:91], a[12:15], v[128:131], a[88:91]
  v_mfma_f32_16x16x32_bf16 a[92:95], a[12:15], v[144:147], a[92:95]
  v_mfma_f32_16x16x32_bf16 v[112:115], v[24:27], v[128:131], v[112:115]
  v_mfma_f32_16x16x32_bf16 a[96:99], a[16:19], v[128:131], a[96:99]
  v_mfma_f32_16x16x32_bf16 a[100:103], a[16:19], v[144:147], a[100:103]
  v_mfma_f32_16x16x32_bf16 a[104:107], a[20:23], v[128:131], a[104:107]
  v_mfma_f32_16x16x32_bf16 a[108:111], a[20:23], v[144:147], a[108:111]
  v_mfma_f32_16x16x32_bf16 a[112:115], a[24:27], v[128:131], a[112:115]
  v_mfma_f32_16x16x32_bf16 a[116:119], a[24:27], v[144:147], a[116:119]
  v_mfma_f32_16x16x32_bf16 a[120:123], a[28:31], v[128:131], a[120:123]
  v_mfma_f32_16x16x32_bf16 a[124:127], a[28:31], v[144:147], a[124:127]
  v_mfma_f32_16x16x32_bf16 v[116:119], v[24:27], v[144:147], v[116:119]
  v_mfma_f32_16x16x32_bf16 a[64:67], a[32:35], v[136:139], a[64:67]
  v_mfma_f32_16x16x32_bf16 a[68:71], a[32:35], v[152:155], a[68:71]
  v_mfma_f32_16x16x32_bf16 a[72:75], a[36:39], v[136:139], a[72:75]
  v_mfma_f32_16x16x32_bf16 a[76:79], a[36:39], v[152:155], a[76:79]
  v_mfma_f32_16x16x32_bf16 a[80:83], a[40:43], v[136:139], a[80:83]
  v_mfma_f32_16x16x32_bf16 a[84:87], a[40:43], v[152:155], a[84:87]
  v_mfma_f32_16x16x32_bf16 a[88:91], a[44:47], v[136:139], a[88:91]
  v_mfma_f32_16x16x32_bf16 a[92:95], a[44:47], v[152:155], a[92:95]
  v_mfma_f32_16x16x32_bf16 v[112:115], v[24:27], v[136:139], v[112:115]
  v_mfma_f32_16x16x32_bf16 a[96:99], a[48:51], v[136:139], a[96:99]
  v_mfma_f32_16x16x32_bf16 a[100:103], a[48:51], v[152:155], a[100:103]
  v_mfma_f32_16x16x32_bf16 a[104:107], a[52:55], v[136:139], a[104:107]
  v_mfma_f32_16x16x32_bf16 a[108:111], a[52:55], v[152:155], a[108:111]
  v_mfma_f32_16x16x32_bf16 a[112:115], a[56:59], v[136:139], a[112:115]
  v_mfma_f32_16x16x32_bf16 a[116:119], a[56:59], v[152:155], a[116:119]
  v_mfma_f32_16x16x32_bf16 a[120:123], a[60:63], v[136:139], a[120:123]
  v_mfma_f32_16x16x32_bf16 a[124:127], a[60:63], v[152:155], a[124:127]
  v_mfma_f32_16x16x32_bf16 v[116:119], v[24:27], v[152:155], v[116:119]
  s_add_u32 s61, s61, 16384
  s_add_u32 s60, s60, 1
  s_nop 7
  s_cmp_le_u32 s60, s35
  s_cbranch_scc1 k2_slowloop_0
  s_cmp_eq_u32 s50, 0
  s_cbranch_scc1 k2_ret_0_0
  s_branch k2_ret_0_1
k2_slow_1:
  s_nop 7
  v_accvgpr_write_b32 a128, 0
  v_accvgpr_write_b32 a129, 0
  v_accvgpr_write_b32 a130, 0
  v_accvgpr_write_b32 a131, 0
  v_accvgpr_write_b32 a132, 0
  v_accvgpr_write_b32 a133, 0
  v_accvgpr_write_b32 a134, 0
  v_accvgpr_write_b32 a135, 0
  v_accvgpr_write_b32 a136, 0
  v_accvgpr_write_b32 a137, 0
  v_accvgpr_write_b32 a138, 0
  v_accvgpr_write_b32 a139, 0
  v_accvgpr_write_b32 a140, 0
  v_accvgpr_write_b32 a141, 0
  v_accvgpr_write_b32 a142, 0
  v_accvgpr_write_b32 a143, 0
  v_accvgpr_write_b32 a144, 0
  v_accvgpr_write_b32 a145, 0
  v_accvgpr_write_b32 a146, 0
  v_accvgpr_write_b32 a147, 0
  v_accvgpr_write_b32 a148, 0
  v_accvgpr_write_b32 a149, 0
  v_accvgpr_write_b32 a150, 0
  v_accvgpr_write_b32 a151, 0
  v_accvgpr_write_b32 a152, 0
  v_accvgpr_write_b32 a153, 0
  v_accvgpr_write_b32 a154, 0
  v_accvgpr_write_b32 a155, 0
  v_accvgpr_write_b32 a156, 0
  v_accvgpr_write_b32 a157, 0
  v_accvgpr_write_b32 a158, 0
  v_accvgpr_write_b32 a159, 0
  v_accvgpr_write_b32 a160, 0
  v_accvgpr_write_b32 a161, 0
  v_accvgpr_write_b32 a162, 0
  v_accvgpr_write_b32 a163, 0
  v_accvgpr_write_b32 a164, 0
  v_accvgpr_write_b32 a165, 0
  v_accvgpr_write_b32 a166, 0
  v_accvgpr_write_b32 a167, 0
  v_accvgpr_write_b32 a168, 0
  v_accvgpr_write_b32 a169, 0
  v_accvgpr_write_b32 a170, 0
  v_accvgpr_write_b32 a171, 0
  v_accvgpr_write_b32 a172, 0
  v_accvgpr_write_b32 a173, 0
  v_accvgpr_write_b32 a174, 0
  v_accvgpr_write_b32 a175, 0
  v_accvgpr_write_b32 a176, 0
  v_accvgpr_write_b32 a177, 0
  v_accvgpr_write_b32 a178, 0
  v_accvgpr_write_b32 a179, 0
  v_accvgpr_write_b32 a180, 0
  v_accvgpr_write_b32 a181, 0
  v_accvgpr_write_b32 a182, 0
  v_accvgpr_write_b32 a183, 0
  v_accvgpr_write_b32 a184, 0
  v_accvgpr_write_b32 a185, 0
  v_accvgpr_write_b32 a186, 0
  v_accvgpr_write_b32 a187, 0
  v_accvgpr_write_b32 a188, 0
  v_accvgpr_write_b32 a189, 0
  v_accvgpr_write_b32 a190, 0
  v_accvgpr_write_b32 a191, 0
  v_mov_b32 v104, 0xf149f2ca
  v_mov_b32 v120, 0
  v_mov_b32 v121, 0
  v_mov_b32 v122, 0
  v_mov_b32 v123, 0
  v_mov_b32 v108, 0xf149f2ca
  v_mov_b32 v124, 0
  v_mov_b32 v125, 0
  v_mov_b32 v126, 0
  v_mov_b32 v127, 0
  s_mov_b32 s60, 1
  s_mov_b32 s61, 0
k2_slowloop_1:
  s_add_u32 s98, s61, 0
  buffer_load_dwordx4 a[0:3], v2, s[20:23], s98 offen offset:0 sc1
  buffer_load_dwordx4 a[4:7], v2, s[20:23], s98 offen offset:1024 sc1
  buffer_load_dwordx4 a[8:11], v2, s[20:23], s98 offen offset:2048 sc1
  buffer_load_dwordx4 a[12:15], v2, s[20:23], s98 offen offset:3072 sc1
  s_add_u32 s98, s61, 4096
  buffer_load_dwordx4 a[16:19], v2, s[20:23], s98 offen offset:0 sc1
  buffer_load_dwordx4 a[20:23], v2, s[20:23], s98 offen offset:1024 sc1
  buffer_load_dwordx4 a[24:27], v2, s[20:23], s98 offen offset:2048 sc1
  buffer_load_dwordx4 a[28:31], v2, s[20:23], s98 offen offset:3072 sc1
  s_add_u32 s98, s61, 8192
  buffer_load_dwordx4 a[32:35], v2, s[20:23], s98 offen offset:0 sc1
  buffer_load_dwordx4 a[36:39], v2, s[20:23], s98 offen offset:1024 sc1
  buffer_load_dwordx4 a[40:43], v2, s[20:23], s98 offen offset:2048 sc1
  buffer_load_dwordx4 a[44:47], v2, s[20:23], s98 offen offset:3072 sc1
  s_add_u32 s98, s61, 12288
  buffer_load_dwordx4 a[48:51], v2, s[20:23], s98 offen offset:0 sc1
  buffer_load_dwordx4 a[52:55], v2, s[20:23], s98 offen offset:1024 sc1
  buffer_load_dwordx4 a[56:59], v2, s[20:23], s98 offen offset:2048 sc1
  buffer_load_dwordx4 a[60:63], v2, s[20:23], s98 offen offset:3072 sc1
  s_waitcnt vmcnt(0)
  v_mfma_f32_16x16x32_bf16 v[192:195], a[0:3], v[64:67], 0
  v_mfma_f32_16x16x32_bf16 v[208:211], a[0:3], v[80:83], 0
  v_mfma_f32_16x16x32_bf16 v[192:195], a[4:7], v[68:71], v[192:195]
  v_mfma_f32_16x16x32_bf16 v[208:211], a[4:7], v[84:87], v[208:211]
  v_mfma_f32_16x16x32_bf16 v[192:195], a[8:11], v[72:75], v[192:195]
  v_mfma_f32_16x16x32_bf16 v[208:211], a[8:11], v[88:91], v[208:211]
  v_mfma_f32_16x16x32_bf16 v[192:195], a[12:15], v[76:79], v[192:195]
  v_mfma_f32_16x16x32_bf16 v[208:211], a[12:15], v[92:95], v[208:211]
  v_mfma_f32_16x16x32_bf16 v[196:199], a[16:19], v[64:67], 0
  v_mfma_f32_16x16x32_bf16 v[212:215], a[16:19], v[80:83], 0
  v_mfma_f32_16x16x32_bf16 v[196:199], a[20:23], v[68:71], v[196:199]
  v_mfma_f32_16x16x32_bf16 v[212:215], a[20:23], v[84:87], v[212:215]
  v_mfma_f32_16x16x32_bf16 v[196:199], a[24:27], v[72:75], v[196:199]
  v_mfma_f32_16x16x32_bf16 v[212:215], a[24:27], v[88:91], v[212:215]
  v_mfma_f32_16x16x32_bf16 v[196:199], a[28:31], v[76:79], v[196:199]
  v_mfma_f32_16x16x32_bf16 v[212:215], a[28:31], v[92:95], v[212:215]
  v_mfma_f32_16x16x32_bf16 v[200:203], a[32:35], v[64:67], 0
  v_mfma_f32_16x16x32_bf16 v[216:219], a[32:35], v[80:83], 0
  v_mfma_f32_16x16x32_bf16 v[200:203], a[36:39], v[68:71], v[200:203]
  v_mfma_f32_16x16x32_bf16 v[216:219], a[36:39], v[84:87], v[216:219]
  v_mfma_f32_16x16x32_bf16 v[200:203], a[40:43], v[72:75], v[200:203]
  v_mfma_f32_16x16x32_bf16 v[216:219], a[40:43], v[88:91], v[216:219]
  v_mfma_f32_16x16x32_bf16 v[200:203], a[44:47], v[76:79], v[200:203]
  v_mfma_f32_16x16x32_bf16 v[216:219], a[44:47], v[92:95], v[216:219]
  v_mfma_f32_16x16x32_bf16 v[204:207], a[48:51], v[64:67], 0
  v_mfma_f32_16x16x32_bf16 v[220:223], a[48:51], v[80:83], 0
  v_mfma_f32_16x16x32_bf16 v[204:207], a[52:55], v[68:71], v[204:207]
  v_mfma_f32_16x16x32_bf16 v[220:223], a[52:55], v[84:87], v[220:223]
  v_mfma_f32_16x16x32_bf16 v[204:207], a[56:59], v[72:75], v[204:207]
  v_mfma_f32_16x16x32_bf16 v[220:223], a[56:59], v[88:91], v[220:223]
  v_mfma_f32_16x16x32_bf16 v[204:207], a[60:63], v[76:79], v[204:207]
  v_mfma_f32_16x16x32_bf16 v[220:223], a[60:63], v[92:95], v[220:223]
  s_add_u32 s98, s61, 16384
  buffer_load_dwordx4 a[0:3], v2, s[24:27], s98 offen offset:0 sc1
  buffer_load_dwordx4 a[4:7], v2, s[24:27], s98 offen offset:1024 sc1
  buffer_load_dwordx4 a[8:11], v2, s[24:27], s98 offen offset:2048 sc1
  buffer_load_dwordx4 a[12:15], v2, s[24:27], s98 offen offset:3072 sc1
  s_add_u32 s98, s61, 20480
  buffer_load_dwordx4 a[16:19], v2, s[24:27], s98 offen offset:0 sc1
  buffer_load_dwordx4 a[20:23], v2, s[24:27], s98 offen offset:1024 sc1
  buffer_load_dwordx4 a[24:27], v2, s[24:27], s98 offen offset:2048 sc1
  buffer_load_dwordx4 a[28:31], v2, s[24:27], s98 offen offset:3072 sc1
  s_add_u32 s98, s61, 24576
  buffer_load_dwordx4 a[32:35], v2, s[24:27], s98 offen offset:0 sc1
  buffer_load_dwordx4 a[36:39], v2, s[24:27], s98 offen offset:1024 sc1
  buffer_load_dwordx4 a[40:43], v2, s[24:27], s98 offen offset:2048 sc1
  buffer_load_dwordx4 a[44:47], v2, s[24:27], s98 offen offset:3072 sc1
  s_add_u32 s98, s61, 28672
  buffer_load_dwordx4 a[48:51], v2, s[24:27], s98 offen offset:0 sc1
  buffer_load_dwordx4 a[52:55], v2, s[24:27], s98 offen offset:1024 sc1
  buffer_load_dwordx4 a[56:59], v2, s[24:27], s98 offen offset:2048 sc1
  buffer_load_dwordx4 a[60:63], v2, s[24:27], s98 offen offset:3072 sc1
  s_cmp_lg_u32 s60, s36
  s_cbranch_scc1 k2_kernel_snomask18
  v_cmp_gt_i32 s[56:57], 0, v5
  v_cmp_gt_i32 s[58:59], 1, v5
  s_nop 0
  v_cndmask_b32 v192, v192, v6, s[56:57]
  v_cndmask_b32 v193, v193, v6, s[58:59]
  v_cmp_gt_i32 s[56:57], 2, v5
  v_cmp_gt_i32 s[58:59], 3, v5
  s_nop 0
  v_cndmask_b32 v194, v194, v6, s[56:57]
  v_cndmask_b32 v195, v195, v6, s[58:59]
  v_cmp_gt_i32 s[56:57], 16, v5
  v_cmp_gt_i32 s[58:59], 17, v5
  s_nop 0
  v_cndmask_b32 v196, v196, v6, s[56:57]
  v_cndmask_b32 v197, v197, v6, s[58:59]
  v_cmp_gt_i32 s[56:57], 18, v5
  v_cmp_gt_i32 s[58:59], 19, v5
  s_nop 0
  v_cndmask_b32 v198, v198, v6, s[56:57]
  v_cndmask_b32 v199, v199, v6, s[58:59]
  v_cmp_gt_i32 s[56:57], 32, v5
  v_cmp_gt_i32 s[58:59], 33, v5
  s_nop 0
  v_cndmask_b32 v200, v200, v6, s[56:57]
  v_cndmask_b32 v201, v201, v6, s[58:59]
  v_cmp_gt_i32 s[56:57], 34, v5
  v_cmp_gt_i32 s[58:59], 35, v5
  s_nop 0
  v_cndmask_b32 v202, v202, v6, s[56:57]
  v_cndmask_b32 v203, v203, v6, s[58:59]
  v_cmp_gt_i32 s[56:57], 48, v5
  v_cmp_gt_i32 s[58:59], 49, v5
  s_nop 0
  v_cndmask_b32 v204, v204, v6, s[56:57]
  v_cndmask_b32 v205, v205, v6, s[58:59]
  v_cmp_gt_i32 s[56:57], 50, v5
  v_cmp_gt_i32 s[58:59], 51, v5
  s_nop 0
  v_cndmask_b32 v206, v206, v6, s[56:57]
  v_cndmask_b32 v207, v207, v6, s[58:59]
  v_cmp_gt_i32 s[56:57], -16, v5
  v_cmp_gt_i32 s[58:59], -15, v5
  s_nop 0
  v_cndmask_b32 v208, v208, v6, s[56:57]
  v_cndmask_b32 v209, v209, v6, s[58:59]
  v_cmp_gt_i32 s[56:57], -14, v5
  v_cmp_gt_i32 s[58:59], -13, v5
  s_nop 0
  v_cndmask_b32 v210, v210, v6, s[56:57]
  v_cndmask_b32 v211, v211, v6, s[58:59]
  v_cmp_gt_i32 s[56:57], 0, v5
  v_cmp_gt_i32 s[58:59], 1, v5
  s_nop 0
  v_cndmask_b32 v212, v212, v6, s[56:57]
  v_cndmask_b32 v213, v213, v6, s[58:59]
  v_cmp_gt_i32 s[56:57], 2, v5
  v_cmp_gt_i32 s[58:59], 3, v5
  s_nop 0
  v_cndmask_b32 v214, v214, v6, s[56:57]
  v_cndmask_b32 v215, v215, v6, s[58:59]
  v_cmp_gt_i32 s[56:57], 16, v5
  v_cmp_gt_i32 s[58:59], 17, v5
  s_nop 0
  v_cndmask_b32 v216, v216, v6, s[56:57]
  v_cndmask_b32 v217, v217, v6, s[58:59]
  v_cmp_gt_i32 s[56:57], 18, v5
  v_cmp_gt_i32 s[58:59], 19, v5
  s_nop 0
  v_cndmask_b32 v218, v218, v6, s[56:57]
  v_cndmask_b32 v219, v219, v6, s[58:59]
  v_cmp_gt_i32 s[56:57], 32, v5
  v_cmp_gt_i32 s[58:59], 33, v5
  s_nop 0
  v_cndmask_b32 v220, v220, v6, s[56:57]
  v_cndmask_b32 v221, v221, v6, s[58:59]
  v_cmp_gt_i32 s[56:57], 34, v5
  v_cmp_gt_i32 s[58:59], 35, v5
  s_nop 0
  v_cndmask_b32 v222, v222, v6, s[56:57]
  v_cndmask_b32 v223, v223, v6, s[58:59]
k2_kernel_snomask18:
  v_max3_f32 v16, v192, v193, v194
  v_max3_f32 v16, v16, v195, v196
  v_max3_f32 v16, v16, v197, v198
  v_max3_f32 v16, v16, v199, v200
  v_max3_f32 v16, v16, v201, v202
  v_max3_f32 v16, v16, v203, v204
  v_max3_f32 v16, v16, v205, v206
  v_max_f32 v16, v16, v207
  v_mov_b32 v14, v16
  s_nop 1
  v_permlane16_swap_b32 v16, v14
  v_max_f32 v16, v16, v14
  v_mov_b32 v14, v16
  s_nop 1
  v_permlane32_swap_b32 v16, v14
  v_max_f32 v16, v16, v14
  v_max_f32 v16, v16, v104
  v_sub_f32 v105, v104, v16
  v_mov_b32 v104, v16
  v_exp_f32 v105, v105
  v_sub_f32 v192, v192, v104
  v_sub_f32 v193, v193, v104
  v_sub_f32 v194, v194, v104
  v_sub_f32 v195, v195, v104
  v_sub_f32 v196, v196, v104
  v_sub_f32 v197, v197, v104
  v_sub_f32 v198, v198, v104
  v_sub_f32 v199, v199, v104
  v_sub_f32 v200, v200, v104
  v_sub_f32 v201, v201, v104
  v_sub_f32 v202, v202, v104
  v_sub_f32 v203, v203, v104
  v_sub_f32 v204, v204, v104
  v_sub_f32 v205, v205, v104
  v_sub_f32 v206, v206, v104
  v_sub_f32 v207, v207, v104
  v_mul_f32 v120, v120, v105
  v_mul_f32 v121, v121, v105
  v_mul_f32 v122, v122, v105
  v_mul_f32 v123, v123, v105
  v_accvgpr_read_b32 v13, a128
  v_mul_f32 v13, v13, v105
  v_accvgpr_write_b32 a128, v13
  v_accvgpr_read_b32 v14, a129
  v_mul_f32 v14, v14, v105
  v_accvgpr_write_b32 a129, v14
  v_accvgpr_read_b32 v13, a130
  v_mul_f32 v13, v13, v105
  v_accvgpr_write_b32 a130, v13
  v_accvgpr_read_b32 v14, a131
  v_mul_f32 v14, v14, v105
  v_accvgpr_write_b32 a131, v14
  v_accvgpr_read_b32 v13, a136
  v_mul_f32 v13, v13, v105
  v_accvgpr_write_b32 a136, v13
  v_accvgpr_read_b32 v14, a137
  v_mul_f32 v14, v14, v105
  v_accvgpr_write_b32 a137, v14
  v_accvgpr_read_b32 v13, a138
  v_mul_f32 v13, v13, v105
  v_accvgpr_write_b32 a138, v13
  v_accvgpr_read_b32 v14, a139
  v_mul_f32 v14, v14, v105
  v_accvgpr_write_b32 a139, v14
  v_accvgpr_read_b32 v13, a144
  v_mul_f32 v13, v13, v105
  v_accvgpr_write_b32 a144, v13
  v_accvgpr_read_b32 v14, a145
  v_mul_f32 v14, v14, v105
  v_accvgpr_write_b32 a145, v14
  v_accvgpr_read_b32 v13, a146
  v_mul_f32 v13, v13, v105
  v_accvgpr_write_b32 a146, v13
  v_accvgpr_read_b32 v14, a147
  v_mul_f32 v14, v14, v105
  v_accvgpr_write_b32 a147, v14
  v_accvgpr_read_b32 v13, a152
  v_mul_f32 v13, v13, v105
  v_accvgpr_write_b32 a152, v13
  v_accvgpr_read_b32 v14, a153
  v_mul_f32 v14, v14, v105
  v_accvgpr_write_b32 a153, v14
  v_accvgpr_read_b32 v13, a154
  v_mul_f32 v13, v13, v105
  v_accvgpr_write_b32 a154, v13
  v_accvgpr_read_b32 v14, a155
  v_mul_f32 v14, v14, v105
  v_accvgpr_write_b32 a155, v14
  v_accvgpr_read_b32 v13, a160
  v_mul_f32 v13, v13, v105
  v_accvgpr_write_b32 a160, v13
  v_accvgpr_read_b32 v14, a161
  v_mul_f32 v14, v14, v105
  v_accvgpr_write_b32 a161, v14
  v_accvgpr_read_b32 v13, a162
  v_mul_f32 v13, v13, v105
  v_accvgpr_write_b32 a162, v13
  v_accvgpr_read_b32 v14, a163
  v_mul_f32 v14, v14, v105
  v_accvgpr_write_b32 a163, v14
  v_accvgpr_read_b32 v13, a168
  v_mul_f32 v13, v13, v105
  v_accvgpr_write_b32 a168, v13
  v_accvgpr_read_b32 v14, a169
  v_mul_f32 v14, v14, v105
  v_accvgpr_write_b32 a169, v14
  v_accvgpr_read_b32 v13, a170
  v_mul_f32 v13, v13, v105
  v_accvgpr_write_b32 a170, v13
  v_accvgpr_read_b32 v14, a171
  v_mul_f32 v14, v14, v105
  v_accvgpr_write_b32 a171, v14
  v_accvgpr_read_b32 v13, a176
  v_mul_f32 v13, v13, v105
  v_accvgpr_write_b32 a176, v13
  v_accvgpr_read_b32 v14, a177
  v_mul_f32 v14, v14, v105
  v_accvgpr_write_b32 a177, v14
  v_accvgpr_read_b32 v13, a178
  v_mul_f32 v13, v13, v105
  v_accvgpr_write_b32 a178, v13
  v_accvgpr_read_b32 v14, a179
  v_mul_f32 v14, v14, v105
  v_accvgpr_write_b32 a179, v14
  v_accvgpr_read_b32 v13, a184
  v_mul_f32 v13, v13, v105
  v_accvgpr_write_b32 a184, v13
  v_accvgpr_read_b32 v14, a185
  v_mul_f32 v14, v14, v105
  v_accvgpr_write_b32 a185, v14
  v_accvgpr_read_b32 v13, a186
  v_mul_f32 v13, v13, v105
  v_accvgpr_write_b32 a186, v13
  v_accvgpr_read_b32 v14, a187
  v_mul_f32 v14, v14, v105
  v_accvgpr_write_b32 a187, v14
  v_max3_f32 v16, v208, v209, v210
  v_max3_f32 v16, v16, v211, v212
  v_max3_f32 v16, v16, v213, v214
  v_max3_f32 v16, v16, v215, v216
  v_max3_f32 v16, v16, v217, v218
  v_max3_f32 v16, v16, v219, v220
  v_max3_f32 v16, v16, v221, v222
  v_max_f32 v16, v16, v223
  v_mov_b32 v14, v16
  s_nop 1
  v_permlane16_swap_b32 v16, v14
  v_max_f32 v16, v16, v14
  v_mov_b32 v14, v16
  s_nop 1
  v_permlane32_swap_b32 v16, v14
  v_max_f32 v16, v16, v14
  v_max_f32 v16, v16, v108
  v_sub_f32 v109, v108, v16
  v_mov_b32 v108, v16
  v_exp_f32 v109, v109
  v_sub_f32 v208, v208, v108
  v_sub_f32 v209, v209, v108
  v_sub_f32 v210, v210, v108
  v_sub_f32 v211, v211, v108
  v_sub_f32 v212, v212, v108
  v_sub_f32 v213, v213, v108
  v_sub_f32 v214, v214, v108
  v_sub_f32 v215, v215, v108
  v_sub_f32 v216, v216, v108
  v_sub_f32 v217, v217, v108
  v_sub_f32 v218, v218, v108
  v_sub_f32 v219, v219, v108
  v_sub_f32 v220, v220, v108
  v_sub_f32 v221, v221, v108
  v_sub_f32 v222, v222, v108
  v_sub_f32 v223, v223, v108
  v_mul_f32 v124, v124, v109
  v_mul_f32 v125, v125, v109
  v_mul_f32 v126, v126, v109
  v_mul_f32 v127, v127, v109
  v_accvgpr_read_b32 v13, a132
  v_mul_f32 v13, v13, v109
  v_accvgpr_write_b32 a132, v13
  v_accvgpr_read_b32 v14, a133
  v_mul_f32 v14, v14, v109
  v_accvgpr_write_b32 a133, v14
  v_accvgpr_read_b32 v13, a134
  v_mul_f32 v13, v13, v109
  v_accvgpr_write_b32 a134, v13
  v_accvgpr_read_b32 v14, a135
  v_mul_f32 v14, v14, v109
  v_accvgpr_write_b32 a135, v14
  v_accvgpr_read_b32 v13, a140
  v_mul_f32 v13, v13, v109
  v_accvgpr_write_b32 a140, v13
  v_accvgpr_read_b32 v14, a141
  v_mul_f32 v14, v14, v109
  v_accvgpr_write_b32 a141, v14
  v_accvgpr_read_b32 v13, a142
  v_mul_f32 v13, v13, v109
  v_accvgpr_write_b32 a142, v13
  v_accvgpr_read_b32 v14, a143
  v_mul_f32 v14, v14, v109
  v_accvgpr_write_b32 a143, v14
  v_accvgpr_read_b32 v13, a148
  v_mul_f32 v13, v13, v109
  v_accvgpr_write_b32 a148, v13
  v_accvgpr_read_b32 v14, a149
  v_mul_f32 v14, v14, v109
  v_accvgpr_write_b32 a149, v14
  v_accvgpr_read_b32 v13, a150
  v_mul_f32 v13, v13, v109
  v_accvgpr_write_b32 a150, v13
  v_accvgpr_read_b32 v14, a151
  v_mul_f32 v14, v14, v109
  v_accvgpr_write_b32 a151, v14
  v_accvgpr_read_b32 v13, a156
  v_mul_f32 v13, v13, v109
  v_accvgpr_write_b32 a156, v13
  v_accvgpr_read_b32 v14, a157
  v_mul_f32 v14, v14, v109
  v_accvgpr_write_b32 a157, v14
  v_accvgpr_read_b32 v13, a158
  v_mul_f32 v13, v13, v109
  v_accvgpr_write_b32 a158, v13
  v_accvgpr_read_b32 v14, a159
  v_mul_f32 v14, v14, v109
  v_accvgpr_write_b32 a159, v14
  v_accvgpr_read_b32 v13, a164
  v_mul_f32 v13, v13, v109
  v_accvgpr_write_b32 a164, v13
  v_accvgpr_read_b32 v14, a165
  v_mul_f32 v14, v14, v109
  v_accvgpr_write_b32 a165, v14
  v_accvgpr_read_b32 v13, a166
  v_mul_f32 v13, v13, v109
  v_accvgpr_write_b32 a166, v13
  v_accvgpr_read_b32 v14, a167
  v_mul_f32 v14, v14, v109
  v_accvgpr_write_b32 a167, v14
  v_accvgpr_read_b32 v13, a172
  v_mul_f32 v13, v13, v109
  v_accvgpr_write_b32 a172, v13
  v_accvgpr_read_b32 v14, a173
  v_mul_f32 v14, v14, v109
  v_accvgpr_write_b32 a173, v14
  v_accvgpr_read_b32 v13, a174
  v_mul_f32 v13, v13, v109
  v_accvgpr_write_b32 a174, v13
  v_accvgpr_read_b32 v14, a175
  v_mul_f32 v14, v14, v109
  v_accvgpr_write_b32 a175, v14
  v_accvgpr_read_b32 v13, a180
  v_mul_f32 v13, v13, v109
  v_accvgpr_write_b32 a180, v13
  v_accvgpr_read_b32 v14, a181
  v_mul_f32 v14, v14, v109
  v_accvgpr_write_b32 a181, v14
  v_accvgpr_read_b32 v13, a182
  v_mul_f32 v13, v13, v109
  v_accvgpr_write_b32 a182, v13
  v_accvgpr_read_b32 v14, a183
  v_mul_f32 v14, v14, v109
  v_accvgpr_write_b32 a183, v14
  v_accvgpr_read_b32 v13, a188
  v_mul_f32 v13, v13, v109
  v_accvgpr_write_b32 a188, v13
  v_accvgpr_read_b32 v14, a189
  v_mul_f32 v14, v14, v109
  v_accvgpr_write_b32 a189, v14
  v_accvgpr_read_b32 v13, a190
  v_mul_f32 v13, v13, v109
  v_accvgpr_write_b32 a190, v13
  v_accvgpr_read_b32 v14, a191
  v_mul_f32 v14, v14, v109
  v_accvgpr_write_b32 a191, v14
  v_exp_f32 v192, v192
  v_exp_f32 v193, v193
  v_exp_f32 v194, v194
  v_cvt_pk_bf16_f32 v192, v192, v193
  v_exp_f32 v195, v195
  v_exp_f32 v196, v196
  v_cvt_pk_bf16_f32 v193, v194, v195
  v_exp_f32 v197, v197
  v_exp_f32 v198, v198
  v_cvt_pk_bf16_f32 v194, v196, v197
  v_exp_f32 v199, v199
  v_exp_f32 v208, v208
  v_cvt_pk_bf16_f32 v195, v198, v199
  v_exp_f32 v209, v209
  v_exp_f32 v210, v210
  v_cvt_pk_bf16_f32 v208, v208, v209
  v_exp_f32 v211, v211
  v_exp_f32 v212, v212
  v_cvt_pk_bf16_f32 v209, v210, v211
  v_exp_f32 v213, v213
  v_exp_f32 v214, v214
  v_cvt_pk_bf16_f32 v210, v212, v213
  v_exp_f32 v215, v215
  v_exp_f32 v200, v200
  v_cvt_pk_bf16_f32 v211, v214, v215
  v_exp_f32 v201, v201
  v_exp_f32 v202, v202
  v_cvt_pk_bf16_f32 v200, v200, v201
  v_exp_f32 v203, v203
  v_exp_f32 v204, v204
  v_cvt_pk_bf16_f32 v201, v202, v203
  v_exp_f32 v205, v205
  v_exp_f32 v206, v206
  v_cvt_pk_bf16_f32 v202, v204, v205
  v_exp_f32 v207, v207
  v_exp_f32 v216, v216
  v_cvt_pk_bf16_f32 v203, v206, v207
  v_exp_f32 v217, v217
  v_exp_f32 v218, v218
  v_cvt_pk_bf16_f32 v216, v216, v217
  v_exp_f32 v219, v219
  v_exp_f32 v220, v220
  v_cvt_pk_bf16_f32 v217, v218, v219
  v_exp_f32 v221, v221
  v_exp_f32 v222, v222
  v_cvt_pk_bf16_f32 v218, v220, v221
  v_exp_f32 v223, v223
  s_nop 0
  v_cvt_pk_bf16_f32 v219, v222, v223
  s_waitcnt vmcnt(0)
  s_nop 0
  v_mfma_f32_16x16x32_bf16 a[128:131], a[0:3], v[192:195], a[128:131]
  v_mfma_f32_16x16x32_bf16 a[132:135], a[0:3], v[208:211], a[132:135]
  v_mfma_f32_16x16x32_bf16 a[136:139], a[4:7], v[192:195], a[136:139]
  v_mfma_f32_16x16x32_bf16 a[140:143], a[4:7], v[208:211], a[140:143]
  v_mfma_f32_16x16x32_bf16 a[144:147], a[8:11], v[192:195], a[144:147]
  v_mfma_f32_16x16x32_bf16 a[148:151], a[8:11], v[208:211], a[148:151]
  v_mfma_f32_16x16x32_bf16 a[152:155], a[12:15], v[192:195], a[152:155]
  v_mfma_f32_16x16x32_bf16 a[156:159], a[12:15], v[208:211], a[156:159]
  v_mfma_f32_16x16x32_bf16 v[120:123], v[24:27], v[192:195], v[120:123]
  v_mfma_f32_16x16x32_bf16 a[160:163], a[16:19], v[192:195], a[160:163]
  v_mfma_f32_16x16x32_bf16 a[164:167], a[16:19], v[208:211], a[164:167]
  v_mfma_f32_16x16x32_bf16 a[168:171], a[20:23], v[192:195], a[168:171]
  v_mfma_f32_16x16x32_bf16 a[172:175], a[20:23], v[208:211], a[172:175]
  v_mfma_f32_16x16x32_bf16 a[176:179], a[24:27], v[192:195], a[176:179]
  v_mfma_f32_16x16x32_bf16 a[180:183], a[24:27], v[208:211], a[180:183]
  v_mfma_f32_16x16x32_bf16 a[184:187], a[28:31], v[192:195], a[184:187]
  v_mfma_f32_16x16x32_bf16 a[188:191], a[28:31], v[208:211], a[188:191]
  v_mfma_f32_16x16x32_bf16 v[124:127], v[24:27], v[208:211], v[124:127]
  v_mfma_f32_16x16x32_bf16 a[128:131], a[32:35], v[200:203], a[128:131]
  v_mfma_f32_16x16x32_bf16 a[132:135], a[32:35], v[216:219], a[132:135]
  v_mfma_f32_16x16x32_bf16 a[136:139], a[36:39], v[200:203], a[136:139]
  v_mfma_f32_16x16x32_bf16 a[140:143], a[36:39], v[216:219], a[140:143]
  v_mfma_f32_16x16x32_bf16 a[144:147], a[40:43], v[200:203], a[144:147]
  v_mfma_f32_16x16x32_bf16 a[148:151], a[40:43], v[216:219], a[148:151]
  v_mfma_f32_16x16x32_bf16 a[152:155], a[44:47], v[200:203], a[152:155]
  v_mfma_f32_16x16x32_bf16 a[156:159], a[44:47], v[216:219], a[156:159]
  v_mfma_f32_16x16x32_bf16 v[120:123], v[24:27], v[200:203], v[120:123]
  v_mfma_f32_16x16x32_bf16 a[160:163], a[48:51], v[200:203], a[160:163]
  v_mfma_f32_16x16x32_bf16 a[164:167], a[48:51], v[216:219], a[164:167]
  v_mfma_f32_16x16x32_bf16 a[168:171], a[52:55], v[200:203], a[168:171]
  v_mfma_f32_16x16x32_bf16 a[172:175], a[52:55], v[216:219], a[172:175]
  v_mfma_f32_16x16x32_bf16 a[176:179], a[56:59], v[200:203], a[176:179]
  v_mfma_f32_16x16x32_bf16 a[180:183], a[56:59], v[216:219], a[180:183]
  v_mfma_f32_16x16x32_bf16 a[184:187], a[60:63], v[200:203], a[184:187]
  v_mfma_f32_16x16x32_bf16 a[188:191], a[60:63], v[216:219], a[188:191]
  v_mfma_f32_16x16x32_bf16 v[124:127], v[24:27], v[216:219], v[124:127]
  s_add_u32 s61, s61, 16384
  s_add_u32 s60, s60, 1
  s_nop 7
  s_cmp_le_u32 s60, s36
  s_cbranch_scc1 k2_slowloop_1
  s_branch k2_ret_1_0
k2_end:
  s_endpgm
.p2align 6
k3_kernel:
  s_load_dwordx2 s[40:41], s[0:1], 0
  s_load_dwordx2 s[42:43], s[0:1], 40
  s_load_dwordx4 s[44:47], s[0:1], 72
  s_load_dwordx4 s[48:51], s[0:1], 88
  s_load_dwordx2 s[88:89], s[0:1], 104
  v_and_b32 v1, 63, v0
  v_lshrrev_b32 v31, 6, v0
  s_and_b32 s31, s2, 7
  v_readfirstlane_b32 s28, v31
  s_lshr_b32 s35, s31, 1
  s_and_b32 s31, s31, 1
  s_lshr_b32 s32, s2, 3
  s_and_b32 s33, s32, 7
  s_lshl_b32 s29, s31, 3
  s_add_u32 s29, s29, s33
  s_lshr_b32 s30, s32, 3
  s_add_u32 s52, s29, s30
  s_and_b32 s52, s52, 3
  s_lshl_b32 s58, s29, 2
  s_add_u32 s58, s58, s30
  v_lshlrev_b32 v2, 4, v1
  v_lshrrev_b32 v26, 4, v1
  v_and_b32 v27, 15, v1
  v_bfe_u32 v28, v1, 2, 2
  v_and_b32 v29, 3, v1
  v_and_b32 v30, 1, v26
  s_lshl_b32 s33, s29, 3
  s_lshl_b32 s32, s28, 1
  s_add_u32 s33, s33, s32
  s_lshl_b32 s34, s33, 17
  s_lshl_b32 s32, s35, 15
  s_add_u32 s34, s34, s32
  s_add_u32 s34, s34, 37748736
  s_mul_i32 s36, s33, 44032
  s_add_u32 s36, s36, 54525952
  v_mov_b32 v4, v2
  v_add_u32 v5, 130048, v2
  v_mov_b32 v6, v2
  v_add_u32 v7, 43008, v2
  v_lshlrev_b32 v31, 1, v26
  v_xor_b32 v31, v31, v27
  v_lshlrev_b32 v31, 4, v31
  v_lshl_add_u32 v31, v26, 10, v31
  s_lshl_b32 s32, s30, 8
  s_lshl_b32 s33, s28, 13
  s_add_u32 s32, s32, s33
  v_add_u32 v8, s32, v31
  v_xor_b32 v9, 128, v8
  v_add_u32 v9, 3072, v9
  s_and_b32 s32, s28, 1
  s_lshl_b32 s32, s32, 7
  v_xor_b32 v10, s32, v8
  v_add_u32 v11, 3072, v10
  s_lshl_b32 s38, s28, 11
  s_add_u32 s39, s38, 8192
  v_lshl_or_b32 v3, v30, 2, v28
  s_and_b32 s32, s28, 1
  s_lshl_b32 s32, s32, 2
  v_xor_b32 v3, s32, v3
  v_lshl_add_u32 v31, v26, 2, v28
  v_lshlrev_b32 v31, 8, v31
  v_lshl_add_u32 v31, v29, 3, v31
  v_add_u32 v31, 8192, v31
  v_xor_b32 v33, 0, v3
  v_lshl_add_u32 v180, v33, 5, v31
  v_add_u32 v181, 4096, v180
  v_xor_b32 v33, 1, v3
  v_lshl_add_u32 v182, v33, 5, v31
  v_add_u32 v183, 4096, v182
  v_xor_b32 v33, 2, v3
  v_lshl_add_u32 v184, v33, 5, v31
  v_add_u32 v185, 4096, v184
  v_xor_b32 v33, 3, v3
  v_lshl_add_u32 v186, v33, 5, v31
  v_add_u32 v187, 4096, v186
  v_add_u32 v188, 65536, v180
  v_add_u32 v196, 131072, v180
  v_add_u32 v189, 65536, v181
  v_add_u32 v197, 131072, v181
  v_add_u32 v190, 65536, v182
  v_add_u32 v198, 131072, v182
  v_add_u32 v191, 65536, v183
  v_add_u32 v199, 131072, v183
  v_add_u32 v192, 65536, v184
  v_add_u32 v200, 131072, v184
  v_add_u32 v193, 65536, v185
  v_add_u32 v201, 131072, v185
  v_add_u32 v194, 65536, v186
  v_add_u32 v202, 131072, v186
  v_add_u32 v195, 65536, v187
  v_add_u32 v203, 131072, v187
  v_lshl_add_u32 v31, v26, 3, v28
  v_lshlrev_b32 v31, 8, v31
  v_lshl_add_u32 v31, v29, 3, v31
  v_add_u32 v31, 8192, v31
  v_xor_b32 v33, 0, v3
  v_lshl_add_u32 v204, v33, 5, v31
  v_add_u32 v205, 1024, v204
  v_xor_b32 v33, 1, v3
  v_lshl_add_u32 v206, v33, 5, v31
  v_add_u32 v207, 1024, v206
  v_xor_b32 v33, 2, v3
  v_lshl_add_u32 v208, v33, 5, v31
  v_add_u32 v209, 1024, v208
  v_xor_b32 v33, 3, v3
  v_lshl_add_u32 v210, v33, 5, v31
  v_add_u32 v211, 1024, v210
  v_add_u32 v212, 65536, v204
  v_add_u32 v220, 131072, v204
  v_add_u32 v213, 65536, v205
  v_add_u32 v221, 131072, v205
  v_add_u32 v214, 65536, v206
  v_add_u32 v222, 131072, v206
  v_add_u32 v215, 65536, v207
  v_add_u32 v223, 131072, v207
  v_add_u32 v216, 65536, v208
  v_add_u32 v224, 131072, v208
  v_add_u32 v217, 65536, v209
  v_add_u32 v225, 131072, v209
  v_add_u32 v218, 65536, v210
  v_add_u32 v226, 131072, v210
  v_add_u32 v219, 65536, v211
  v_add_u32 v227, 131072, v211
  s_lshr_b32 s32, s28, 1
  s_lshl_b32 s32, s32, 12
  v_add_u32 v12, s32, v2
  v_add_u32 v13, 65536, v12
  v_add_u32 v14, 131072, v12
  s_lshl_b32 s31, s29, 17
  s_lshr_b32 s32, s28, 1
  s_lshl_b32 s32, s32, 16
  s_add_u32 s31, s31, s32
  s_lshl_b32 s32, s35, 14
  s_add_u32 s31, s31, s32
  s_lshl_b32 s59, s30, 8
  s_and_b32 s33, s28, 1
  s_lshl_b32 s33, s33, 7
  s_add_u32 s59, s59, s33
  s_add_u32 s31, s31, s59
  v_lshlrev_b32 v32, 10, v27
  v_lshl_add_u32 v32, v26, 3, v32
  v_add_u32 v32, s31, v32
  v_lshlrev_b32 v33, 3, v26
  s_lshl_b32 s57, s58, 17
  s_lshl_b32 s32, s28, 13
  s_add_u32 s57, s57, s32
  s_add_u32 s57, s57, 67108864
  s_lshl_b32 s32, s35, 15
  s_add_u32 s56, s57, s32
  s_lshl_b32 s32, s35, 11
  s_add_u32 s57, s57, s32
  s_sub_u32 s32, 15, s29
  s_min_u32 s60, s29, s32
  s_lshl_b32 s60, s60, 8
  s_add_u32 s60, s60, 61931520
  v_and_b32 v16, 7, v1
  s_lshl_b32 s32, s35, 3
  v_add_u32 v16, s32, v16
  v_lshlrev_b32 v16, 2, v16
  s_waitcnt lgkmcnt(0)
  s_mov_b32 s8, s88
  s_and_b32 s9, s89, 0xffff
  s_mov_b32 s10, 0x5000000
  s_mov_b32 s11, 0x20000
  s_mov_b32 s12, s42
  s_and_b32 s13, s43, 0xffff
  s_mov_b32 s14, 0x400000
  s_mov_b32 s15, 0x20000
  s_mov_b32 s84, s44
  s_and_b32 s85, s45, 0xffff
  s_mov_b32 s86, 0x158000
  s_mov_b32 s87, 0x20000
  s_mov_b32 s16, s40
  s_and_b32 s17, s41, 0xffff
  s_mov_b32 s18, 0x200000
  s_mov_b32 s19, 0x20000
  s_mov_b32 s20, s48
  s_and_b32 s21, s49, 0xffff
  s_mov_b32 s22, 0x200000
  s_mov_b32 s23, 0x20000
  s_mov_b32 s24, s46
  s_and_b32 s25, s47, 0xffff
  s_mov_b32 s26, 0x400
  s_mov_b32 s27, 0x20000
  buffer_load_dword v15, v16, s[8:11], s60 offen offset:128 sc1
  s_waitcnt vmcnt(0)
  s_barrier
  v_mov_b32 v52, 0
  v_mov_b32 v53, 1
  s_cmp_lg_u32 s28, 0
  s_cbranch_scc1 k3_kernel_skip11
  s_mov_b64 exec, 1
  buffer_store_dword v53, v52, s[8:11], s96 offen sc1
  s_mov_b64 exec, -1
k3_kernel_skip11:
  s_mov_b32 s32, 0
k3_sh_again:
  v_cmp_ne_u32 vcc, 1, v15
  s_cmp_gt_u32 s32, 400000
  s_cbranch_scc1 k3_sh_done
  s_cbranch_vccz k3_sh_done
  s_sleep 8
  buffer_load_dword v15, v16, s[8:11], s60 offen offset:128 sc1
  s_add_u32 s32, s32, 1
  s_waitcnt vmcnt(0)
  s_branch k3_sh_again
k3_sh_done:
  s_add_u32 s53, s52, 0
  s_cmp_ge_u32 s53, 3
  s_cselect_b32 s55, 3, 0
  s_sub_u32 s53, s53, s55
  s_add_u32 s53, s53, 0
  s_mul_i32 s55, s35, 6
  s_add_u32 s53, s53, s55
  s_lshl_b32 s55, s53, 16
  s_lshl_b32 s53, s53, 1
  s_add_u32 m0, s39, 0
  s_nop 0
  buffer_load_dwordx4 v10, s[84:87], s55 offen offset:0 lds
  buffer_load_dwordx4 v11, s[84:87], s55 offen offset:1024 lds
  s_add_u32 m0, s38, 0
  s_add_u32 s54, s53, 0
  s_min_u32 s54, s54, 42
  s_lshl_b32 s54, s54, 10
  s_add_u32 s54, s54, s36
  buffer_load_dwordx4 v6, s[8:11], s54 offen offset:0 sc1 lds
  buffer_load_dwordx4 v7, s[8:11], s54 offen offset:1024 sc1 lds
  s_add_u32 m0, s39, 16384
  s_add_u32 s55, s55, 32768
  buffer_load_dwordx4 v10, s[84:87], s55 offen offset:0 lds
  buffer_load_dwordx4 v11, s[84:87], s55 offen offset:1024 lds
  s_add_u32 m0, s38, 16384
  s_add_u32 s54, s53, 1
  s_min_u32 s54, s54, 42
  s_lshl_b32 s54, s54, 10
  s_add_u32 s54, s54, s36
  buffer_load_dwordx4 v6, s[8:11], s54 offen offset:0 sc1 lds
  buffer_load_dwordx4 v7, s[8:11], s54 offen offset:1024 sc1 lds
  s_add_u32 s53, s52, 1
  s_cmp_ge_u32 s53, 3
  s_cselect_b32 s55, 3, 0
  s_sub_u32 s53, s53, s55
  s_add_u32 s53, s53, 0
  s_mul_i32 s55, s35, 6
  s_add_u32 s53, s53, s55
  s_lshl_b32 s55, s53, 16
  s_lshl_b32 s53, s53, 1
  s_add_u32 m0, s39, 32768
  s_nop 0
  buffer_load_dwordx4 v10, s[84:87], s55 offen offset:0 lds
  buffer_load_dwordx4 v11, s[84:87], s55 offen offset:1024 lds
  s_add_u32 m0, s38, 32768
  s_add_u32 s54, s53, 0
  s_min_u32 s54, s54, 42
  s_lshl_b32 s54, s54, 10
  s_add_u32 s54, s54, s36
  buffer_load_dwordx4 v6, s[8:11], s54 offen offset:0 sc1 lds
  buffer_load_dwordx4 v7, s[8:11], s54 offen offset:1024 sc1 lds
  s_add_u32 m0, s39, 49152
  s_add_u32 s55, s55, 32768
  buffer_load_dwordx4 v10, s[84:87], s55 offen offset:0 lds
  buffer_load_dwordx4 v11, s[84:87], s55 offen offset:1024 lds
  s_add_u32 m0, s38, 49152
  s_add_u32 s54, s53, 1
  s_min_u32 s54, s54, 42
  s_lshl_b32 s54, s54, 10
  s_add_u32 s54, s54, s36
  buffer_load_dwordx4 v6, s[8:11], s54 offen offset:0 sc1 lds
  buffer_load_dwordx4 v7, s[8:11], s54 offen offset:1024 sc1 lds
  s_add_u32 s53, s52, 2
  s_cmp_ge_u32 s53, 3
  s_cselect_b32 s55, 3, 0
  s_sub_u32 s53, s53, s55
  s_add_u32 s53, s53, 0
  s_mul_i32 s55, s35, 6
  s_add_u32 s53, s53, s55
  s_lshl_b32 s55, s53, 16
  s_lshl_b32 s53, s53, 1
  s_add_u32 m0, s39, 65536
  s_nop 0
  buffer_load_dwordx4 v10, s[84:87], s55 offen offset:0 lds
  buffer_load_dwordx4 v11, s[84:87], s55 offen offset:1024 lds
  s_add_u32 m0, s38, 65536
  s_add_u32 s54, s53, 0
  s_min_u32 s54, s54, 42
  s_lshl_b32 s54, s54, 10
  s_add_u32 s54, s54, s36
  buffer_load_dwordx4 v6, s[8:11], s54 offen offset:0 sc1 lds
  buffer_load_dwordx4 v7, s[8:11], s54 offen offset:1024 sc1 lds
  s_add_u32 m0, s39, 81920
  s_add_u32 s55, s55, 32768
  buffer_load_dwordx4 v10, s[84:87], s55 offen offset:0 lds
  buffer_load_dwordx4 v11, s[84:87], s55 offen offset:1024 lds
  s_add_u32 m0, s38, 81920
  s_add_u32 s54, s53, 1
  s_min_u32 s54, s54, 42
  s_lshl_b32 s54, s54, 10
  s_add_u32 s54, s54, s36
  buffer_load_dwordx4 v6, s[8:11], s54 offen offset:0 sc1 lds
  buffer_load_dwordx4 v7, s[8:11], s54 offen offset:1024 sc1 lds
  buffer_load_dwordx2 v[34:35], v32, s[16:19], 0 offen offset:0
  buffer_load_dwordx2 v[42:43], v33, s[24:27], s59 offen offset:0
  buffer_load_dwordx2 v[36:37], v32, s[16:19], 0 offen offset:32
  buffer_load_dwordx2 v[44:45], v33, s[24:27], s59 offen offset:32
  buffer_load_dwordx2 v[38:39], v32, s[16:19], 0 offen offset:64
  buffer_load_dwordx2 v[46:47], v33, s[24:27], s59 offen offset:64
  buffer_load_dwordx2 v[40:41], v32, s[16:19], 0 offen offset:96
  buffer_load_dwordx2 v[48:49], v33, s[24:27], s59 offen offset:96
  s_waitcnt vmcnt(24)
  s_barrier
  ds_read_b128 v[116:119], v12 offset:0
  ds_read_b128 v[120:123], v12 offset:1024
  ds_read_b128 v[124:127], v12 offset:2048
  ds_read_b128 v[128:131], v12 offset:3072
  ds_read_b64_tr_b16 v[148:149], v204 offset:0
  ds_read_b64_tr_b16 v[150:151], v205 offset:0
  ds_read_b64_tr_b16 v[152:153], v206 offset:0
  ds_read_b64_tr_b16 v[154:155], v207 offset:0
  ds_read_b64_tr_b16 v[156:157], v208 offset:0
  ds_read_b64_tr_b16 v[158:159], v209 offset:0
  ds_read_b64_tr_b16 v[160:161], v210 offset:0
  ds_read_b64_tr_b16 v[162:163], v211 offset:0
  s_waitcnt lgkmcnt(4)
  v_mfma_f32_16x16x32_bf16 v[52:55], v[148:151], v[116:119], 0
  ds_read_b128 v[132:135], v12 offset:16384
  v_mfma_f32_16x16x32_bf16 v[68:71], v[148:151], v[120:123], 0
  ds_read_b128 v[136:139], v12 offset:17408
  s_add_u32 s53, s52, 0
  s_cmp_ge_u32 s53, 3
  s_cselect_b32 s55, 3, 0
  s_sub_u32 s53, s53, s55
  s_add_u32 s53, s53, 3
  s_mul_i32 s55, s35, 6
  s_add_u32 s53, s53, s55
  s_lshl_b32 s55, s53, 16
  s_lshl_b32 s53, s53, 1
  v_mfma_f32_16x16x32_bf16 v[84:87], v[148:151], v[124:127], 0
  ds_read_b128 v[140:143], v12 offset:18432
  v_mfma_f32_16x16x32_bf16 v[100:103], v[148:151], v[128:131], 0
  ds_read_b128 v[144:147], v12 offset:19456
  s_add_u32 m0, s39, 98304
  v_mfma_f32_16x16x32_bf16 v[56:59], v[152:155], v[116:119], 0
  ds_read_b64_tr_b16 v[164:165], v204 offset:16384
  v_mfma_f32_16x16x32_bf16 v[72:75], v[152:155], v[120:123], 0
  ds_read_b64_tr_b16 v[166:167], v205 offset:16384
  buffer_load_dwordx4 v10, s[84:87], s55 offen offset:0 lds
  v_mfma_f32_16x16x32_bf16 v[88:91], v[152:155], v[124:127], 0
  ds_read_b64_tr_b16 v[168:169], v206 offset:16384
  v_mfma_f32_16x16x32_bf16 v[104:107], v[152:155], v[128:131], 0
  ds_read_b64_tr_b16 v[170:171], v207 offset:16384
  buffer_load_dwordx4 v11, s[84:87], s55 offen offset:1024 lds
  s_waitcnt lgkmcnt(8)
  v_mfma_f32_16x16x32_bf16 v[60:63], v[156:159], v[116:119], 0
  ds_read_b64_tr_b16 v[172:173], v208 offset:16384
  v_mfma_f32_16x16x32_bf16 v[76:79], v[156:159], v[120:123], 0
  ds_read_b64_tr_b16 v[174:175], v209 offset:16384
  s_add_u32 m0, s38, 98304
  v_mfma_f32_16x16x32_bf16 v[92:95], v[156:159], v[124:127], 0
  ds_read_b64_tr_b16 v[176:177], v210 offset:16384
  v_mfma_f32_16x16x32_bf16 v[108:111], v[156:159], v[128:131], 0
  ds_read_b64_tr_b16 v[178:179], v211 offset:16384
  s_add_u32 s54, s53, 0
  s_min_u32 s54, s54, 42
  s_lshl_b32 s54, s54, 10
  s_add_u32 s54, s54, s36
  v_mfma_f32_16x16x32_bf16 v[64:67], v[160:163], v[116:119], 0
  buffer_load_dwordx4 v6, s[8:11], s54 offen offset:0 sc1 lds
  v_mfma_f32_16x16x32_bf16 v[80:83], v[160:163], v[120:123], 0
  buffer_load_dwordx4 v7, s[8:11], s54 offen offset:1024 sc1 lds
  v_mfma_f32_16x16x32_bf16 v[96:99], v[160:163], v[124:127], 0
  s_add_u32 m0, s39, 114688
  v_mfma_f32_16x16x32_bf16 v[112:115], v[160:163], v[128:131], 0
  s_add_u32 s55, s55, 32768
  s_waitcnt lgkmcnt(4)
  v_mfma_f32_16x16x32_bf16 v[52:55], v[164:167], v[132:135], v[52:55]
  s_waitcnt vmcnt(20)
  s_barrier
  buffer_load_dwordx4 v10, s[84:87], s55 offen offset:0 lds
  buffer_load_dwordx4 v11, s[84:87], s55 offen offset:1024 lds
  s_add_u32 m0, s38, 114688
  s_add_u32 s54, s53, 1
  s_min_u32 s54, s54, 42
  s_lshl_b32 s54, s54, 10
  s_add_u32 s54, s54, s36
  buffer_load_dwordx4 v6, s[8:11], s54 offen offset:0 sc1 lds
  buffer_load_dwordx4 v7, s[8:11], s54 offen offset:1024 sc1 lds
  v_mfma_f32_16x16x32_bf16 v[68:71], v[164:167], v[136:139], v[68:71]
  ds_read_b128 v[116:119], v12 offset:32768
  s_add_u32 s53, s52, 1
  s_cmp_ge_u32 s53, 3
  s_cselect_b32 s55, 3, 0
  s_sub_u32 s53, s53, s55
  s_add_u32 s53, s53, 3
  s_mul_i32 s55, s35, 6
  s_add_u32 s53, s53, s55
  s_lshl_b32 s55, s53, 16
  s_lshl_b32 s53, s53, 1
  v_mfma_f32_16x16x32_bf16 v[84:87], v[164:167], v[140:143], v[84:87]
  ds_read_b128 v[120:123], v12 offset:33792
  v_mfma_f32_16x16x32_bf16 v[100:103], v[164:167], v[144:147], v[100:103]
  ds_read_b128 v[124:127], v12 offset:34816
  s_add_u32 m0, s39, 131072
  v_mfma_f32_16x16x32_bf16 v[56:59], v[168:171], v[132:135], v[56:59]
  ds_read_b128 v[128:131], v12 offset:35840
  v_mfma_f32_16x16x32_bf16 v[72:75], v[168:171], v[136:139], v[72:75]
  ds_read_b64_tr_b16 v[148:149], v204 offset:32768
  buffer_load_dwordx4 v10, s[84:87], s55 offen offset:0 lds
  v_mfma_f32_16x16x32_bf16 v[88:91], v[168:171], v[140:143], v[88:91]
  ds_read_b64_tr_b16 v[150:151], v205 offset:32768
  v_mfma_f32_16x16x32_bf16 v[104:107], v[168:171], v[144:147], v[104:107]
  ds_read_b64_tr_b16 v[152:153], v206 offset:32768
  buffer_load_dwordx4 v11, s[84:87], s55 offen offset:1024 lds
  s_waitcnt lgkmcnt(7)
  v_mfma_f32_16x16x32_bf16 v[60:63], v[172:175], v[132:135], v[60:63]
  ds_read_b64_tr_b16 v[154:155], v207 offset:32768
  v_mfma_f32_16x16x32_bf16 v[76:79], v[172:175], v[136:139], v[76:79]
  ds_read_b64_tr_b16 v[156:157], v208 offset:32768
  s_add_u32 m0, s38, 131072
  v_mfma_f32_16x16x32_bf16 v[92:95], v[172:175], v[140:143], v[92:95]
  ds_read_b64_tr_b16 v[158:159], v209 offset:32768
  v_mfma_f32_16x16x32_bf16 v[108:111], v[172:175], v[144:147], v[108:111]
  ds_read_b64_tr_b16 v[160:161], v210 offset:32768
  s_add_u32 s54, s53, 0
  s_min_u32 s54, s54, 42
  s_lshl_b32 s54, s54, 10
  s_add_u32 s54, s54, s36
  v_mfma_f32_16x16x32_bf16 v[64:67], v[176:179], v[132:135], v[64:67]
  ds_read_b64_tr_b16 v[162:163], v211 offset:32768
  buffer_load_dwordx4 v6, s[8:11], s54 offen offset:0 sc1 lds
  v_mfma_f32_16x16x32_bf16 v[80:83], v[176:179], v[136:139], v[80:83]
  buffer_load_dwordx4 v7, s[8:11], s54 offen offset:1024 sc1 lds
  v_mfma_f32_16x16x32_bf16 v[96:99], v[176:179], v[140:143], v[96:99]
  s_add_u32 m0, s39, 147456
  v_mfma_f32_16x16x32_bf16 v[112:115], v[176:179], v[144:147], v[112:115]
  s_add_u32 s55, s55, 32768
  s_waitcnt lgkmcnt(4)
  v_mfma_f32_16x16x32_bf16 v[52:55], v[148:151], v[116:119], v[52:55]
  ds_read_b128 v[132:135], v12 offset:49152
  v_mfma_f32_16x16x32_bf16 v[68:71], v[148:151], v[120:123], v[68:71]
  ds_read_b128 v[136:139], v12 offset:50176
  buffer_load_dwordx4 v10, s[84:87], s55 offen offset:0 lds
  v_mfma_f32_16x16x32_bf16 v[84:87], v[148:151], v[124:127], v[84:87]
  ds_read_b128 v[140:143], v12 offset:51200
  v_mfma_f32_16x16x32_bf16 v[100:103], v[148:151], v[128:131], v[100:103]
  ds_read_b128 v[144:147], v12 offset:52224
  buffer_load_dwordx4 v11, s[84:87], s55 offen offset:1024 lds
  v_mfma_f32_16x16x32_bf16 v[56:59], v[152:155], v[116:119], v[56:59]
  ds_read_b64_tr_b16 v[164:165], v204 offset:49152
  v_mfma_f32_16x16x32_bf16 v[72:75], v[152:155], v[120:123], v[72:75]
  ds_read_b64_tr_b16 v[166:167], v205 offset:49152
  s_add_u32 m0, s38, 147456
  v_mfma_f32_16x16x32_bf16 v[88:91], v[152:155], v[124:127], v[88:91]
  ds_read_b64_tr_b16 v[168:169], v206 offset:49152
  v_mfma_f32_16x16x32_bf16 v[104:107], v[152:155], v[128:131], v[104:107]
  ds_read_b64_tr_b16 v[170:171], v207 offset:49152
  s_add_u32 s54, s53, 1
  s_min_u32 s54, s54, 42
  s_lshl_b32 s54, s54, 10
  s_add_u32 s54, s54, s36
  s_waitcnt lgkmcnt(8)
  v_mfma_f32_16x16x32_bf16 v[60:63], v[156:159], v[116:119], v[60:63]
  ds_read_b64_tr_b16 v[172:173], v208 offset:49152
  v_mfma_f32_16x16x32_bf16 v[76:79], v[156:159], v[120:123], v[76:79]
  ds_read_b64_tr_b16 v[174:175], v209 offset:49152
  buffer_load_dwordx4 v6, s[8:11], s54 offen offset:0 sc1 lds
  v_mfma_f32_16x16x32_bf16 v[92:95], v[156:159], v[124:127], v[92:95]
  ds_read_b64_tr_b16 v[176:177], v210 offset:49152
  v_mfma_f32_16x16x32_bf16 v[108:111], v[156:159], v[128:131], v[108:111]
  ds_read_b64_tr_b16 v[178:179], v211 offset:49152
  buffer_load_dwordx4 v7, s[8:11], s54 offen offset:1024 sc1 lds
  v_mfma_f32_16x16x32_bf16 v[64:67], v[160:163], v[116:119], v[64:67]
  v_mfma_f32_16x16x32_bf16 v[80:83], v[160:163], v[120:123], v[80:83]
  v_mfma_f32_16x16x32_bf16 v[96:99], v[160:163], v[124:127], v[96:99]
  v_mfma_f32_16x16x32_bf16 v[112:115], v[160:163], v[128:131], v[112:115]
  s_waitcnt lgkmcnt(4)
  v_mfma_f32_16x16x32_bf16 v[52:55], v[164:167], v[132:135], v[52:55]
  s_waitcnt vmcnt(24)
  s_barrier
  buffer_load_dword v15, v16, s[8:11], s60 offen offset:0 sc1
  v_mfma_f32_16x16x32_bf16 v[68:71], v[164:167], v[136:139], v[68:71]
  ds_read_b128 v[116:119], v13 offset:0
  s_add_u32 s53, s52, 2
  s_cmp_ge_u32 s53, 3
  s_cselect_b32 s55, 3, 0
  s_sub_u32 s53, s53, s55
  s_add_u32 s53, s53, 3
  s_mul_i32 s55, s35, 6
  s_add_u32 s53, s53, s55
  s_lshl_b32 s55, s53, 16
  s_lshl_b32 s53, s53, 1
  v_mfma_f32_16x16x32_bf16 v[84:87], v[164:167], v[140:143], v[84:87]
  ds_read_b128 v[120:123], v13 offset:1024
  v_mfma_f32_16x16x32_bf16 v[100:103], v[164:167], v[144:147], v[100:103]
  ds_read_b128 v[124:127], v13 offset:2048
  s_add_u32 m0, s39, 0
  v_mfma_f32_16x16x32_bf16 v[56:59], v[168:171], v[132:135], v[56:59]
  ds_read_b128 v[128:131], v13 offset:3072
  v_mfma_f32_16x16x32_bf16 v[72:75], v[168:171], v[136:139], v[72:75]
  ds_read_b64_tr_b16 v[148:149], v212 offset:0
  buffer_load_dwordx4 v10, s[84:87], s55 offen offset:0 lds
  v_mfma_f32_16x16x32_bf16 v[88:91], v[168:171], v[140:143], v[88:91]
  ds_read_b64_tr_b16 v[150:151], v213 offset:0
  v_mfma_f32_16x16x32_bf16 v[104:107], v[168:171], v[144:147], v[104:107]
  ds_read_b64_tr_b16 v[152:153], v214 offset:0
  buffer_load_dwordx4 v11, s[84:87], s55 offen offset:1024 lds
  s_waitcnt lgkmcnt(7)
  v_mfma_f32_16x16x32_bf16 v[60:63], v[172:175], v[132:135], v[60:63]
  ds_read_b64_tr_b16 v[154:155], v215 offset:0
  v_mfma_f32_16x16x32_bf16 v[76:79], v[172:175], v[136:139], v[76:79]
  ds_read_b64_tr_b16 v[156:157], v216 offset:0
  s_add_u32 m0, s38, 0
  v_mfma_f32_16x16x32_bf16 v[92:95], v[172:175], v[140:143], v[92:95]
  ds_read_b64_tr_b16 v[158:159], v217 offset:0
  v_mfma_f32_16x16x32_bf16 v[108:111], v[172:175], v[144:147], v[108:111]
  ds_read_b64_tr_b16 v[160:161], v218 offset:0
  s_add_u32 s54, s53, 0
  s_min_u32 s54, s54, 42
  s_lshl_b32 s54, s54, 10
  s_add_u32 s54, s54, s36
  v_mfma_f32_16x16x32_bf16 v[64:67], v[176:179], v[132:135], v[64:67]
  ds_read_b64_tr_b16 v[162:163], v219 offset:0
  buffer_load_dwordx4 v6, s[8:11], s54 offen offset:0 sc1 lds
  v_mfma_f32_16x16x32_bf16 v[80:83], v[176:179], v[136:139], v[80:83]
  buffer_load_dwordx4 v7, s[8:11], s54 offen offset:1024 sc1 lds
  v_mfma_f32_16x16x32_bf16 v[96:99], v[176:179], v[140:143], v[96:99]
  s_add_u32 m0, s39, 16384
  v_mfma_f32_16x16x32_bf16 v[112:115], v[176:179], v[144:147], v[112:115]
  s_add_u32 s55, s55, 32768
  s_waitcnt lgkmcnt(4)
  v_mfma_f32_16x16x32_bf16 v[52:55], v[148:151], v[116:119], v[52:55]
  ds_read_b128 v[132:135], v13 offset:16384
  v_mfma_f32_16x16x32_bf16 v[68:71], v[148:151], v[120:123], v[68:71]
  ds_read_b128 v[136:139], v13 offset:17408
  buffer_load_dwordx4 v10, s[84:87], s55 offen offset:0 lds
  v_mfma_f32_16x16x32_bf16 v[84:87], v[148:151], v[124:127], v[84:87]
  ds_read_b128 v[140:143], v13 offset:18432
  v_mfma_f32_16x16x32_bf16 v[100:103], v[148:151], v[128:131], v[100:103]
  ds_read_b128 v[144:147], v13 offset:19456
  buffer_load_dwordx4 v11, s[84:87], s55 offen offset:1024 lds
  v_mfma_f32_16x16x32_bf16 v[56:59], v[152:155], v[116:119], v[56:59]
  ds_read_b64_tr_b16 v[164:165], v212 offset:16384
  v_mfma_f32_16x16x32_bf16 v[72:75], v[152:155], v[120:123], v[72:75]
  ds_read_b64_tr_b16 v[166:167], v213 offset:16384
  s_add_u32 m0, s38, 16384
  v_mfma_f32_16x16x32_bf16 v[88:91], v[152:155], v[124:127], v[88:91]
  ds_read_b64_tr_b16 v[168:169], v214 offset:16384
  v_mfma_f32_16x16x32_bf16 v[104:107], v[152:155], v[128:131], v[104:107]
  ds_read_b64_tr_b16 v[170:171], v215 offset:16384
  s_add_u32 s54, s53, 1
  s_min_u32 s54, s54, 42
  s_lshl_b32 s54, s54, 10
  s_add_u32 s54, s54, s36
  s_waitcnt lgkmcnt(8)
  v_mfma_f32_16x16x32_bf16 v[60:63], v[156:159], v[116:119], v[60:63]
  ds_read_b64_tr_b16 v[172:173], v216 offset:16384
  v_mfma_f32_16x16x32_bf16 v[76:79], v[156:159], v[120:123], v[76:79]
  ds_read_b64_tr_b16 v[174:175], v217 offset:16384
  buffer_load_dwordx4 v6, s[8:11], s54 offen offset:0 sc1 lds
  v_mfma_f32_16x16x32_bf16 v[92:95], v[156:159], v[124:127], v[92:95]
  ds_read_b64_tr_b16 v[176:177], v218 offset:16384
  v_mfma_f32_16x16x32_bf16 v[108:111], v[156:159], v[128:131], v[108:111]
  ds_read_b64_tr_b16 v[178:179], v219 offset:16384
  buffer_load_dwordx4 v7, s[8:11], s54 offen offset:1024 sc1 lds
  v_mfma_f32_16x16x32_bf16 v[64:67], v[160:163], v[116:119], v[64:67]
  v_mfma_f32_16x16x32_bf16 v[80:83], v[160:163], v[120:123], v[80:83]
  v_mfma_f32_16x16x32_bf16 v[96:99], v[160:163], v[124:127], v[96:99]
  v_mfma_f32_16x16x32_bf16 v[112:115], v[160:163], v[128:131], v[112:115]
  s_waitcnt lgkmcnt(4)
  v_mfma_f32_16x16x32_bf16 v[52:55], v[164:167], v[132:135], v[52:55]
  s_waitcnt vmcnt(17)
  s_barrier
  s_waitcnt vmcnt(8)
  s_mov_b32 s32, 0
k3_sc_again:
  v_cmp_ne_u32 vcc, 1, v15
  s_cmp_gt_u32 s32, 400000
  s_cbranch_scc1 k3_sc_done
  s_cbranch_vccz k3_sc_done
  s_sleep 8
  buffer_load_dword v15, v16, s[8:11], s60 offen offset:0 sc1
  s_add_u32 s32, s32, 1
  s_waitcnt vmcnt(0)
  s_branch k3_sc_again
k3_sc_done:
  v_mfma_f32_16x16x32_bf16 v[68:71], v[164:167], v[136:139], v[68:71]
  ds_read_b128 v[116:119], v13 offset:32768
  s_mov_b32 s53, s52
  s_lshl_b32 s54, s53, 11
  s_add_u32 s54, s54, s34
  s_lshl_b32 s55, s35, 4
  s_add_u32 s55, s55, s53
  s_lshl_b32 s55, s55, 16
  v_mfma_f32_16x16x32_bf16 v[84:87], v[164:167], v[140:143], v[84:87]
  ds_read_b128 v[120:123], v13 offset:33792
  v_mfma_f32_16x16x32_bf16 v[100:103], v[164:167], v[144:147], v[100:103]
  ds_read_b128 v[124:127], v13 offset:34816
  s_add_u32 m0, s39, 32768
  v_mfma_f32_16x16x32_bf16 v[56:59], v[168:171], v[132:135], v[56:59]
  ds_read_b128 v[128:131], v13 offset:35840
  v_mfma_f32_16x16x32_bf16 v[72:75], v[168:171], v[136:139], v[72:75]
  ds_read_b64_tr_b16 v[148:149], v212 offset:32768
  buffer_load_dwordx4 v8, s[12:15], s55 offen offset:0 lds
  v_mfma_f32_16x16x32_bf16 v[88:91], v[168:171], v[140:143], v[88:91]
  ds_read_b64_tr_b16 v[150:151], v213 offset:32768
  v_mfma_f32_16x16x32_bf16 v[104:107], v[168:171], v[144:147], v[104:107]
  ds_read_b64_tr_b16 v[152:153], v214 offset:32768
  buffer_load_dwordx4 v9, s[12:15], s55 offen offset:1024 lds
  s_waitcnt lgkmcnt(7)
  v_mfma_f32_16x16x32_bf16 v[60:63], v[172:175], v[132:135], v[60:63]
  ds_read_b64_tr_b16 v[154:155], v215 offset:32768
  v_mfma_f32_16x16x32_bf16 v[76:79], v[172:175], v[136:139], v[76:79]
  ds_read_b64_tr_b16 v[156:157], v216 offset:32768
  s_add_u32 m0, s38, 32768
  v_mfma_f32_16x16x32_bf16 v[92:95], v[172:175], v[140:143], v[92:95]
  ds_read_b64_tr_b16 v[158:159], v217 offset:32768
  v_mfma_f32_16x16x32_bf16 v[108:111], v[172:175], v[144:147], v[108:111]
  ds_read_b64_tr_b16 v[160:161], v218 offset:32768
  buffer_load_dwordx4 v4, s[8:11], s54 offen offset:0 sc1 lds
  v_mfma_f32_16x16x32_bf16 v[64:67], v[176:179], v[132:135], v[64:67]
  ds_read_b64_tr_b16 v[162:163], v219 offset:32768
  buffer_load_dwordx4 v5, s[8:11], s54 offen offset:1024 sc1 lds
  v_mfma_f32_16x16x32_bf16 v[80:83], v[176:179], v[136:139], v[80:83]
  s_add_u32 m0, s39, 49152
  v_mfma_f32_16x16x32_bf16 v[96:99], v[176:179], v[140:143], v[96:99]
  s_add_u32 s55, s55, 32768
  v_mfma_f32_16x16x32_bf16 v[112:115], v[176:179], v[144:147], v[112:115]
  buffer_load_dwordx4 v8, s[12:15], s55 offen offset:0 lds
  s_waitcnt lgkmcnt(4)
  v_mfma_f32_16x16x32_bf16 v[52:55], v[148:151], v[116:119], v[52:55]
  ds_read_b128 v[132:135], v13 offset:49152
  v_mfma_f32_16x16x32_bf16 v[68:71], v[148:151], v[120:123], v[68:71]
  ds_read_b128 v[136:139], v13 offset:50176
  buffer_load_dwordx4 v9, s[12:15], s55 offen offset:1024 lds
  v_mfma_f32_16x16x32_bf16 v[84:87], v[148:151], v[124:127], v[84:87]
  ds_read_b128 v[140:143], v13 offset:51200
  v_mfma_f32_16x16x32_bf16 v[100:103], v[148:151], v[128:131], v[100:103]
  ds_read_b128 v[144:147], v13 offset:52224
  s_add_u32 m0, s38, 49152
  v_mfma_f32_16x16x32_bf16 v[56:59], v[152:155], v[116:119], v[56:59]
  ds_read_b64_tr_b16 v[164:165], v212 offset:49152
  v_mfma_f32_16x16x32_bf16 v[72:75], v[152:155], v[120:123], v[72:75]
  ds_read_b64_tr_b16 v[166:167], v213 offset:49152
  s_add_u32 s54, s54, 1024
  v_mfma_f32_16x16x32_bf16 v[88:91], v[152:155], v[124:127], v[88:91]
  ds_read_b64_tr_b16 v[168:169], v214 offset:49152
  v_mfma_f32_16x16x32_bf16 v[104:107], v[152:155], v[128:131], v[104:107]
  ds_read_b64_tr_b16 v[170:171], v215 offset:49152
  buffer_load_dwordx4 v4, s[8:11], s54 offen offset:0 sc1 lds
  s_waitcnt lgkmcnt(8)
  v_mfma_f32_16x16x32_bf16 v[60:63], v[156:159], v[116:119], v[60:63]
  ds_read_b64_tr_b16 v[172:173], v216 offset:49152
  v_mfma_f32_16x16x32_bf16 v[76:79], v[156:159], v[120:123], v[76:79]
  ds_read_b64_tr_b16 v[174:175], v217 offset:49152
  buffer_load_dwordx4 v5, s[8:11], s54 offen offset:1024 sc1 lds
  v_mfma_f32_16x16x32_bf16 v[92:95], v[156:159], v[124:127], v[92:95]
  ds_read_b64_tr_b16 v[176:177], v218 offset:49152
  v_mfma_f32_16x16x32_bf16 v[108:111], v[156:159], v[128:131], v[108:111]
  ds_read_b64_tr_b16 v[178:179], v219 offset:49152
  v_mfma_f32_16x16x32_bf16 v[64:67], v[160:163], v[116:119], v[64:67]
  v_mfma_f32_16x16x32_bf16 v[80:83], v[160:163], v[120:123], v[80:83]
  v_mfma_f32_16x16x32_bf16 v[96:99], v[160:163], v[124:127], v[96:99]
  v_mfma_f32_16x16x32_bf16 v[112:115], v[160:163], v[128:131], v[112:115]
  s_waitcnt lgkmcnt(4)
  v_mfma_f32_16x16x32_bf16 v[52:55], v[164:167], v[132:135], v[52:55]
  s_barrier
  v_mfma_f32_16x16x32_bf16 v[68:71], v[164:167], v[136:139], v[68:71]
  ds_read_b128 v[116:119], v14 offset:0
  s_cmp_eq_u32 s52, 0
  s_cselect_b32 s53, 4, 0
  s_lshl_b32 s54, s53, 11
  s_add_u32 s54, s54, s34
  s_lshl_b32 s55, s35, 4
  s_add_u32 s55, s55, s53
  s_lshl_b32 s55, s55, 16
  v_mfma_f32_16x16x32_bf16 v[84:87], v[164:167], v[140:143], v[84:87]
  ds_read_b128 v[120:123], v14 offset:1024
  v_mfma_f32_16x16x32_bf16 v[100:103], v[164:167], v[144:147], v[100:103]
  ds_read_b128 v[124:127], v14 offset:2048
  s_add_u32 m0, s39, 65536
  v_mfma_f32_16x16x32_bf16 v[56:59], v[168:171], v[132:135], v[56:59]
  ds_read_b128 v[128:131], v14 offset:3072
  v_mfma_f32_16x16x32_bf16 v[72:75], v[168:171], v[136:139], v[72:75]
  ds_read_b64_tr_b16 v[148:149], v220 offset:0
  buffer_load_dwordx4 v8, s[12:15], s55 offen offset:0 lds
  v_mfma_f32_16x16x32_bf16 v[88:91], v[168:171], v[140:143], v[88:91]
  ds_read_b64_tr_b16 v[150:151], v221 offset:0
  v_mfma_f32_16x16x32_bf16 v[104:107], v[168:171], v[144:147], v[104:107]
  ds_read_b64_tr_b16 v[152:153], v222 offset:0
  buffer_load_dwordx4 v9, s[12:15], s55 offen offset:1024 lds
  s_waitcnt lgkmcnt(7)
  v_mfma_f32_16x16x32_bf16 v[60:63], v[172:175], v[132:135], v[60:63]
  ds_read_b64_tr_b16 v[154:155], v223 offset:0
  v_mfma_f32_16x16x32_bf16 v[76:79], v[172:175], v[136:139], v[76:79]
  ds_read_b64_tr_b16 v[156:157], v224 offset:0
  s_add_u32 m0, s38, 65536
  v_mfma_f32_16x16x32_bf16 v[92:95], v[172:175], v[140:143], v[92:95]
  ds_read_b64_tr_b16 v[158:159], v225 offset:0
  v_mfma_f32_16x16x32_bf16 v[108:111], v[172:175], v[144:147], v[108:111]
  ds_read_b64_tr_b16 v[160:161], v226 offset:0
  buffer_load_dwordx4 v4, s[8:11], s54 offen offset:0 sc1 lds
  v_mfma_f32_16x16x32_bf16 v[64:67], v[176:179], v[132:135], v[64:67]
  ds_read_b64_tr_b16 v[162:163], v227 offset:0
  buffer_load_dwordx4 v5, s[8:11], s54 offen offset:1024 sc1 lds
  v_mfma_f32_16x16x32_bf16 v[80:83], v[176:179], v[136:139], v[80:83]
  s_add_u32 m0, s39, 81920
  v_mfma_f32_16x16x32_bf16 v[96:99], v[176:179], v[140:143], v[96:99]
  s_add_u32 s55, s55, 32768
  v_mfma_f32_16x16x32_bf16 v[112:115], v[176:179], v[144:147], v[112:115]
  buffer_load_dwordx4 v8, s[12:15], s55 offen offset:0 lds
  s_waitcnt lgkmcnt(4)
  v_mfma_f32_16x16x32_bf16 v[52:55], v[148:151], v[116:119], v[52:55]
  ds_read_b128 v[132:135], v14 offset:16384
  v_mfma_f32_16x16x32_bf16 v[68:71], v[148:151], v[120:123], v[68:71]
  ds_read_b128 v[136:139], v14 offset:17408
  buffer_load_dwordx4 v9, s[12:15], s55 offen offset:1024 lds
  v_mfma_f32_16x16x32_bf16 v[84:87], v[148:151], v[124:127], v[84:87]
  ds_read_b128 v[140:143], v14 offset:18432
  v_mfma_f32_16x16x32_bf16 v[100:103], v[148:151], v[128:131], v[100:103]
  ds_read_b128 v[144:147], v14 offset:19456
  s_add_u32 m0, s38, 81920
  v_mfma_f32_16x16x32_bf16 v[56:59], v[152:155], v[116:119], v[56:59]
  ds_read_b64_tr_b16 v[164:165], v220 offset:16384
  v_mfma_f32_16x16x32_bf16 v[72:75], v[152:155], v[120:123], v[72:75]
  ds_read_b64_tr_b16 v[166:167], v221 offset:16384
  s_add_u32 s54, s54, 1024
  v_mfma_f32_16x16x32_bf16 v[88:91], v[152:155], v[124:127], v[88:91]
  ds_read_b64_tr_b16 v[168:169], v222 offset:16384
  v_mfma_f32_16x16x32_bf16 v[104:107], v[152:155], v[128:131], v[104:107]
  ds_read_b64_tr_b16 v[170:171], v223 offset:16384
  buffer_load_dwordx4 v4, s[8:11], s54 offen offset:0 sc1 lds
  s_waitcnt lgkmcnt(8)
  v_mfma_f32_16x16x32_bf16 v[60:63], v[156:159], v[116:119], v[60:63]
  ds_read_b64_tr_b16 v[172:173], v224 offset:16384
  v_mfma_f32_16x16x32_bf16 v[76:79], v[156:159], v[120:123], v[76:79]
  ds_read_b64_tr_b16 v[174:175], v225 offset:16384
  buffer_load_dwordx4 v5, s[8:11], s54 offen offset:1024 sc1 lds
  v_mfma_f32_16x16x32_bf16 v[92:95], v[156:159], v[124:127], v[92:95]
  ds_read_b64_tr_b16 v[176:177], v226 offset:16384
  v_mfma_f32_16x16x32_bf16 v[108:111], v[156:159], v[128:131], v[108:111]
  ds_read_b64_tr_b16 v[178:179], v227 offset:16384
  v_mfma_f32_16x16x32_bf16 v[64:67], v[160:163], v[116:119], v[64:67]
  v_mfma_f32_16x16x32_bf16 v[80:83], v[160:163], v[120:123], v[80:83]
  v_mfma_f32_16x16x32_bf16 v[96:99], v[160:163], v[124:127], v[96:99]
  v_mfma_f32_16x16x32_bf16 v[112:115], v[160:163], v[128:131], v[112:115]
  s_waitcnt lgkmcnt(4)
  v_mfma_f32_16x16x32_bf16 v[52:55], v[164:167], v[132:135], v[52:55]
  s_waitcnt vmcnt(16)
  s_barrier
  v_mfma_f32_16x16x32_bf16 v[68:71], v[164:167], v[136:139], v[68:71]
  ds_read_b128 v[116:119], v12 offset:0
  s_cmp_eq_u32 s52, 1
  s_cselect_b32 s53, 5, 1
  s_lshl_b32 s54, s53, 11
  s_add_u32 s54, s54, s34
  s_lshl_b32 s55, s35, 4
  s_add_u32 s55, s55, s53
  s_lshl_b32 s55, s55, 16
  v_mfma_f32_16x16x32_bf16 v[84:87], v[164:167], v[140:143], v[84:87]
  ds_read_b128 v[120:123], v12 offset:1024
  v_mfma_f32_16x16x32_bf16 v[100:103], v[164:167], v[144:147], v[100:103]
  ds_read_b128 v[124:127], v12 offset:2048
  s_add_u32 m0, s39, 98304
  v_mfma_f32_16x16x32_bf16 v[56:59], v[168:171], v[132:135], v[56:59]
  ds_read_b128 v[128:131], v12 offset:3072
  v_mfma_f32_16x16x32_bf16 v[72:75], v[168:171], v[136:139], v[72:75]
  ds_read_b64_tr_b16 v[148:149], v204 offset:0
  buffer_load_dwordx4 v8, s[12:15], s55 offen offset:0 lds
  v_mfma_f32_16x16x32_bf16 v[88:91], v[168:171], v[140:143], v[88:91]
  ds_read_b64_tr_b16 v[150:151], v205 offset:0
  v_mfma_f32_16x16x32_bf16 v[104:107], v[168:171], v[144:147], v[104:107]
  ds_read_b64_tr_b16 v[152:153], v206 offset:0
  buffer_load_dwordx4 v9, s[12:15], s55 offen offset:1024 lds
  s_waitcnt lgkmcnt(7)
  v_mfma_f32_16x16x32_bf16 v[60:63], v[172:175], v[132:135], v[60:63]
  ds_read_b64_tr_b16 v[154:155], v207 offset:0
  v_mfma_f32_16x16x32_bf16 v[76:79], v[172:175], v[136:139], v[76:79]
  ds_read_b64_tr_b16 v[156:157], v208 offset:0
  s_add_u32 m0, s38, 98304
  v_mfma_f32_16x16x32_bf16 v[92:95], v[172:175], v[140:143], v[92:95]
  ds_read_b64_tr_b16 v[158:159], v209 offset:0
  v_mfma_f32_16x16x32_bf16 v[108:111], v[172:175], v[144:147], v[108:111]
  ds_read_b64_tr_b16 v[160:161], v210 offset:0
  buffer_load_dwordx4 v4, s[8:11], s54 offen offset:0 sc1 lds
  v_mfma_f32_16x16x32_bf16 v[64:67], v[176:179], v[132:135], v[64:67]
  ds_read_b64_tr_b16 v[162:163], v211 offset:0
  buffer_load_dwordx4 v5, s[8:11], s54 offen offset:1024 sc1 lds
  v_mfma_f32_16x16x32_bf16 v[80:83], v[176:179], v[136:139], v[80:83]
  s_add_u32 m0, s39, 114688
  v_mfma_f32_16x16x32_bf16 v[96:99], v[176:179], v[140:143], v[96:99]
  s_add_u32 s55, s55, 32768
  v_mfma_f32_16x16x32_bf16 v[112:115], v[176:179], v[144:147], v[112:115]
  buffer_load_dwordx4 v8, s[12:15], s55 offen offset:0 lds
  s_waitcnt lgkmcnt(4)
  v_mfma_f32_16x16x32_bf16 v[52:55], v[148:151], v[116:119], v[52:55]
  ds_read_b128 v[132:135], v12 offset:16384
  v_mfma_f32_16x16x32_bf16 v[68:71], v[148:151], v[120:123], v[68:71]
  ds_read_b128 v[136:139], v12 offset:17408
  buffer_load_dwordx4 v9, s[12:15], s55 offen offset:1024 lds
  v_mfma_f32_16x16x32_bf16 v[84:87], v[148:151], v[124:127], v[84:87]
  ds_read_b128 v[140:143], v12 offset:18432
  v_mfma_f32_16x16x32_bf16 v[100:103], v[148:151], v[128:131], v[100:103]
  ds_read_b128 v[144:147], v12 offset:19456
  s_add_u32 m0, s38, 114688
  v_mfma_f32_16x16x32_bf16 v[56:59], v[152:155], v[116:119], v[56:59]
  ds_read_b64_tr_b16 v[164:165], v204 offset:16384
  v_mfma_f32_16x16x32_bf16 v[72:75], v[152:155], v[120:123], v[72:75]
  ds_read_b64_tr_b16 v[166:167], v205 offset:16384
  s_add_u32 s54, s54, 1024
  v_mfma_f32_16x16x32_bf16 v[88:91], v[152:155], v[124:127], v[88:91]
  ds_read_b64_tr_b16 v[168:169], v206 offset:16384
  v_mfma_f32_16x16x32_bf16 v[104:107], v[152:155], v[128:131], v[104:107]
  ds_read_b64_tr_b16 v[170:171], v207 offset:16384
  buffer_load_dwordx4 v4, s[8:11], s54 offen offset:0 sc1 lds
  s_waitcnt lgkmcnt(8)
  v_mfma_f32_16x16x32_bf16 v[60:63], v[156:159], v[116:119], v[60:63]
  ds_read_b64_tr_b16 v[172:173], v208 offset:16384
  v_mfma_f32_16x16x32_bf16 v[76:79], v[156:159], v[120:123], v[76:79]
  ds_read_b64_tr_b16 v[174:175], v209 offset:16384
  buffer_load_dwordx4 v5, s[8:11], s54 offen offset:1024 sc1 lds
  v_mfma_f32_16x16x32_bf16 v[92:95], v[156:159], v[124:127], v[92:95]
  ds_read_b64_tr_b16 v[176:177], v210 offset:16384
  v_mfma_f32_16x16x32_bf16 v[108:111], v[156:159], v[128:131], v[108:111]
  ds_read_b64_tr_b16 v[178:179], v211 offset:16384
  v_mfma_f32_16x16x32_bf16 v[64:67], v[160:163], v[116:119], v[64:67]
  v_mfma_f32_16x16x32_bf16 v[80:83], v[160:163], v[120:123], v[80:83]
  v_mfma_f32_16x16x32_bf16 v[96:99], v[160:163], v[124:127], v[96:99]
  v_mfma_f32_16x16x32_bf16 v[112:115], v[160:163], v[128:131], v[112:115]
  s_waitcnt lgkmcnt(4)
  v_mfma_f32_16x16x32_bf16 v[52:55], v[164:167], v[132:135], v[52:55]
  s_waitcnt vmcnt(16)
  s_barrier
  v_mfma_f32_16x16x32_bf16 v[68:71], v[164:167], v[136:139], v[68:71]
  ds_read_b128 v[116:119], v12 offset:32768
  s_cmp_eq_u32 s52, 2
  s_cselect_b32 s53, 6, 2
  s_lshl_b32 s54, s53, 11
  s_add_u32 s54, s54, s34
  s_lshl_b32 s55, s35, 4
  s_add_u32 s55, s55, s53
  s_lshl_b32 s55, s55, 16
  v_mfma_f32_16x16x32_bf16 v[84:87], v[164:167], v[140:143], v[84:87]
  ds_read_b128 v[120:123], v12 offset:33792
  v_mfma_f32_16x16x32_bf16 v[100:103], v[164:167], v[144:147], v[100:103]
  ds_read_b128 v[124:127], v12 offset:34816
  s_add_u32 m0, s39, 131072
  v_mfma_f32_16x16x32_bf16 v[56:59], v[168:171], v[132:135], v[56:59]
  ds_read_b128 v[128:131], v12 offset:35840
  v_mfma_f32_16x16x32_bf16 v[72:75], v[168:171], v[136:139], v[72:75]
  ds_read_b64_tr_b16 v[148:149], v180 offset:32768
  buffer_load_dwordx4 v8, s[12:15], s55 offen offset:0 lds
  v_mfma_f32_16x16x32_bf16 v[88:91], v[168:171], v[140:143], v[88:91]
  ds_read_b64_tr_b16 v[150:151], v181 offset:32768
  v_mfma_f32_16x16x32_bf16 v[104:107], v[168:171], v[144:147], v[104:107]
  ds_read_b64_tr_b16 v[152:153], v182 offset:32768
  buffer_load_dwordx4 v9, s[12:15], s55 offen offset:1024 lds
  s_waitcnt lgkmcnt(7)
  v_mfma_f32_16x16x32_bf16 v[60:63], v[172:175], v[132:135], v[60:63]
  ds_read_b64_tr_b16 v[154:155], v183 offset:32768
  v_mfma_f32_16x16x32_bf16 v[76:79], v[172:175], v[136:139], v[76:79]
  ds_read_b64_tr_b16 v[156:157], v184 offset:32768
  s_add_u32 m0, s38, 131072
  v_mfma_f32_16x16x32_bf16 v[92:95], v[172:175], v[140:143], v[92:95]
  ds_read_b64_tr_b16 v[158:159], v185 offset:32768
  v_mfma_f32_16x16x32_bf16 v[108:111], v[172:175], v[144:147], v[108:111]
  ds_read_b64_tr_b16 v[160:161], v186 offset:32768
  buffer_load_dwordx4 v4, s[8:11], s54 offen offset:0 sc1 lds
  v_mfma_f32_16x16x32_bf16 v[64:67], v[176:179], v[132:135], v[64:67]
  ds_read_b64_tr_b16 v[162:163], v187 offset:32768
  buffer_load_dwordx4 v5, s[8:11], s54 offen offset:1024 sc1 lds
  v_mfma_f32_16x16x32_bf16 v[80:83], v[176:179], v[136:139], v[80:83]
  s_add_u32 m0, s39, 147456
  v_mfma_f32_16x16x32_bf16 v[96:99], v[176:179], v[140:143], v[96:99]
  s_add_u32 s55, s55, 32768
  v_mfma_f32_16x16x32_bf16 v[112:115], v[176:179], v[144:147], v[112:115]
  buffer_load_dwordx4 v8, s[12:15], s55 offen offset:0 lds
  s_waitcnt lgkmcnt(4)
  v_mfma_f32_16x16x32_bf16 v[52:55], v[148:151], v[116:119], v[52:55]
  ds_read_b128 v[132:135], v12 offset:49152
  v_mfma_f32_16x16x32_bf16 v[68:71], v[148:151], v[120:123], v[68:71]
  ds_read_b128 v[136:139], v12 offset:50176
  buffer_load_dwordx4 v9, s[12:15], s55 offen offset:1024 lds
  v_mfma_f32_16x16x32_bf16 v[84:87], v[148:151], v[124:127], v[84:87]
  ds_read_b128 v[140:143], v12 offset:51200
  v_mfma_f32_16x16x32_bf16 v[100:103], v[148:151], v[128:131], v[100:103]
  ds_read_b128 v[144:147], v12 offset:52224
  s_add_u32 m0, s38, 147456
  v_mfma_f32_16x16x32_bf16 v[56:59], v[152:155], v[116:119], v[56:59]
  ds_read_b64_tr_b16 v[164:165], v180 offset:49152
  v_mfma_f32_16x16x32_bf16 v[72:75], v[152:155], v[120:123], v[72:75]
  ds_read_b64_tr_b16 v[166:167], v181 offset:49152
  s_add_u32 s54, s54, 1024
  v_mfma_f32_16x16x32_bf16 v[88:91], v[152:155], v[124:127], v[88:91]
  ds_read_b64_tr_b16 v[168:169], v182 offset:49152
  v_mfma_f32_16x16x32_bf16 v[104:107], v[152:155], v[128:131], v[104:107]
  ds_read_b64_tr_b16 v[170:171], v183 offset:49152
  buffer_load_dwordx4 v4, s[8:11], s54 offen offset:0 sc1 lds
  s_waitcnt lgkmcnt(8)
  v_mfma_f32_16x16x32_bf16 v[60:63], v[156:159], v[116:119], v[60:63]
  ds_read_b64_tr_b16 v[172:173], v184 offset:49152
  v_mfma_f32_16x16x32_bf16 v[76:79], v[156:159], v[120:123], v[76:79]
  ds_read_b64_tr_b16 v[174:175], v185 offset:49152
  buffer_load_dwordx4 v5, s[8:11], s54 offen offset:1024 sc1 lds
  v_mfma_f32_16x16x32_bf16 v[92:95], v[156:159], v[124:127], v[92:95]
  ds_read_b64_tr_b16 v[176:177], v186 offset:49152
  v_mfma_f32_16x16x32_bf16 v[108:111], v[156:159], v[128:131], v[108:111]
  ds_read_b64_tr_b16 v[178:179], v187 offset:49152
  v_mfma_f32_16x16x32_bf16 v[64:67], v[160:163], v[116:119], v[64:67]
  v_mfma_f32_16x16x32_bf16 v[80:83], v[160:163], v[120:123], v[80:83]
  v_mfma_f32_16x16x32_bf16 v[96:99], v[160:163], v[124:127], v[96:99]
  v_mfma_f32_16x16x32_bf16 v[112:115], v[160:163], v[128:131], v[112:115]
  s_waitcnt lgkmcnt(4)
  v_mfma_f32_16x16x32_bf16 v[52:55], v[164:167], v[132:135], v[52:55]
  s_waitcnt vmcnt(16)
  s_barrier
  v_mfma_f32_16x16x32_bf16 v[68:71], v[164:167], v[136:139], v[68:71]
  ds_read_b128 v[116:119], v13 offset:0
  s_cmp_eq_u32 s52, 3
  s_cselect_b32 s53, 7, 3
  s_lshl_b32 s54, s53, 11
  s_add_u32 s54, s54, s34
  s_lshl_b32 s55, s35, 4
  s_add_u32 s55, s55, s53
  s_lshl_b32 s55, s55, 16
  v_mfma_f32_16x16x32_bf16 v[84:87], v[164:167], v[140:143], v[84:87]
  ds_read_b128 v[120:123], v13 offset:1024
  v_mfma_f32_16x16x32_bf16 v[100:103], v[164:167], v[144:147], v[100:103]
  ds_read_b128 v[124:127], v13 offset:2048
  s_add_u32 m0, s39, 0
  v_mfma_f32_16x16x32_bf16 v[56:59], v[168:171], v[132:135], v[56:59]
  ds_read_b128 v[128:131], v13 offset:3072
  v_mfma_f32_16x16x32_bf16 v[72:75], v[168:171], v[136:139], v[72:75]
  ds_read_b64_tr_b16 v[148:149], v188 offset:0
  buffer_load_dwordx4 v8, s[12:15], s55 offen offset:0 lds
  v_mfma_f32_16x16x32_bf16 v[88:91], v[168:171], v[140:143], v[88:91]
  ds_read_b64_tr_b16 v[150:151], v189 offset:0
  v_mfma_f32_16x16x32_bf16 v[104:107], v[168:171], v[144:147], v[104:107]
  ds_read_b64_tr_b16 v[152:153], v190 offset:0
  buffer_load_dwordx4 v9, s[12:15], s55 offen offset:1024 lds
  s_waitcnt lgkmcnt(7)
  v_mfma_f32_16x16x32_bf16 v[60:63], v[172:175], v[132:135], v[60:63]
  ds_read_b64_tr_b16 v[154:155], v191 offset:0
  v_mfma_f32_16x16x32_bf16 v[76:79], v[172:175], v[136:139], v[76:79]
  ds_read_b64_tr_b16 v[156:157], v192 offset:0
  s_add_u32 m0, s38, 0
  v_mfma_f32_16x16x32_bf16 v[92:95], v[172:175], v[140:143], v[92:95]
  ds_read_b64_tr_b16 v[158:159], v193 offset:0
  v_mfma_f32_16x16x32_bf16 v[108:111], v[172:175], v[144:147], v[108:111]
  ds_read_b64_tr_b16 v[160:161], v194 offset:0
  buffer_load_dwordx4 v4, s[8:11], s54 offen offset:0 sc1 lds
  v_mfma_f32_16x16x32_bf16 v[64:67], v[176:179], v[132:135], v[64:67]
  ds_read_b64_tr_b16 v[162:163], v195 offset:0
  buffer_load_dwordx4 v5, s[8:11], s54 offen offset:1024 sc1 lds
  v_mfma_f32_16x16x32_bf16 v[80:83], v[176:179], v[136:139], v[80:83]
  s_add_u32 m0, s39, 16384
  v_mfma_f32_16x16x32_bf16 v[96:99], v[176:179], v[140:143], v[96:99]
  s_add_u32 s55, s55, 32768
  v_mfma_f32_16x16x32_bf16 v[112:115], v[176:179], v[144:147], v[112:115]
  buffer_load_dwordx4 v8, s[12:15], s55 offen offset:0 lds
  s_waitcnt lgkmcnt(4)
  v_mfma_f32_16x16x32_bf16 v[52:55], v[148:151], v[116:119], v[52:55]
  ds_read_b128 v[132:135], v13 offset:16384
  v_mfma_f32_16x16x32_bf16 v[68:71], v[148:151], v[120:123], v[68:71]
  ds_read_b128 v[136:139], v13 offset:17408
  buffer_load_dwordx4 v9, s[12:15], s55 offen offset:1024 lds
  v_mfma_f32_16x16x32_bf16 v[84:87], v[148:151], v[124:127], v[84:87]
  ds_read_b128 v[140:143], v13 offset:18432
  v_mfma_f32_16x16x32_bf16 v[100:103], v[148:151], v[128:131], v[100:103]
  ds_read_b128 v[144:147], v13 offset:19456
  s_add_u32 m0, s38, 16384
  v_mfma_f32_16x16x32_bf16 v[56:59], v[152:155], v[116:119], v[56:59]
  ds_read_b64_tr_b16 v[164:165], v188 offset:16384
  v_mfma_f32_16x16x32_bf16 v[72:75], v[152:155], v[120:123], v[72:75]
  ds_read_b64_tr_b16 v[166:167], v189 offset:16384
  s_add_u32 s54, s54, 1024
  v_mfma_f32_16x16x32_bf16 v[88:91], v[152:155], v[124:127], v[88:91]
  ds_read_b64_tr_b16 v[168:169], v190 offset:16384
  v_mfma_f32_16x16x32_bf16 v[104:107], v[152:155], v[128:131], v[104:107]
  ds_read_b64_tr_b16 v[170:171], v191 offset:16384
  buffer_load_dwordx4 v4, s[8:11], s54 offen offset:0 sc1 lds
  s_waitcnt lgkmcnt(8)
  v_mfma_f32_16x16x32_bf16 v[60:63], v[156:159], v[116:119], v[60:63]
  ds_read_b64_tr_b16 v[172:173], v192 offset:16384
  v_mfma_f32_16x16x32_bf16 v[76:79], v[156:159], v[120:123], v[76:79]
  ds_read_b64_tr_b16 v[174:175], v193 offset:16384
  buffer_load_dwordx4 v5, s[8:11], s54 offen offset:1024 sc1 lds
  v_mfma_f32_16x16x32_bf16 v[92:95], v[156:159], v[124:127], v[92:95]
  ds_read_b64_tr_b16 v[176:177], v194 offset:16384
  v_mfma_f32_16x16x32_bf16 v[108:111], v[156:159], v[128:131], v[108:111]
  ds_read_b64_tr_b16 v[178:179], v195 offset:16384
  v_mfma_f32_16x16x32_bf16 v[64:67], v[160:163], v[116:119], v[64:67]
  v_mfma_f32_16x16x32_bf16 v[80:83], v[160:163], v[120:123], v[80:83]
  v_mfma_f32_16x16x32_bf16 v[96:99], v[160:163], v[124:127], v[96:99]
  v_mfma_f32_16x16x32_bf16 v[112:115], v[160:163], v[128:131], v[112:115]
  s_waitcnt lgkmcnt(4)
  v_mfma_f32_16x16x32_bf16 v[52:55], v[164:167], v[132:135], v[52:55]
  s_waitcnt vmcnt(16)
  s_barrier
  v_mfma_f32_16x16x32_bf16 v[68:71], v[164:167], v[136:139], v[68:71]
  ds_read_b128 v[116:119], v13 offset:32768
  s_cmp_eq_u32 s52, 0
  s_cselect_b32 s53, 8, 4
  s_lshl_b32 s54, s53, 11
  s_add_u32 s54, s54, s34
  s_lshl_b32 s55, s35, 4
  s_add_u32 s55, s55, s53
  s_lshl_b32 s55, s55, 16
  v_mfma_f32_16x16x32_bf16 v[84:87], v[164:167], v[140:143], v[84:87]
  ds_read_b128 v[120:123], v13 offset:33792
  v_mfma_f32_16x16x32_bf16 v[100:103], v[164:167], v[144:147], v[100:103]
  ds_read_b128 v[124:127], v13 offset:34816
  s_add_u32 m0, s39, 32768
  v_mfma_f32_16x16x32_bf16 v[56:59], v[168:171], v[132:135], v[56:59]
  ds_read_b128 v[128:131], v13 offset:35840
  v_mfma_f32_16x16x32_bf16 v[72:75], v[168:171], v[136:139], v[72:75]
  ds_read_b64_tr_b16 v[148:149], v188 offset:32768
  buffer_load_dwordx4 v8, s[12:15], s55 offen offset:0 lds
  v_mfma_f32_16x16x32_bf16 v[88:91], v[168:171], v[140:143], v[88:91]
  ds_read_b64_tr_b16 v[150:151], v189 offset:32768
  v_mfma_f32_16x16x32_bf16 v[104:107], v[168:171], v[144:147], v[104:107]
  ds_read_b64_tr_b16 v[152:153], v190 offset:32768
  buffer_load_dwordx4 v9, s[12:15], s55 offen offset:1024 lds
  s_waitcnt lgkmcnt(7)
  v_mfma_f32_16x16x32_bf16 v[60:63], v[172:175], v[132:135], v[60:63]
  ds_read_b64_tr_b16 v[154:155], v191 offset:32768
  v_mfma_f32_16x16x32_bf16 v[76:79], v[172:175], v[136:139], v[76:79]
  ds_read_b64_tr_b16 v[156:157], v192 offset:32768
  s_add_u32 m0, s38, 32768
  v_mfma_f32_16x16x32_bf16 v[92:95], v[172:175], v[140:143], v[92:95]
  ds_read_b64_tr_b16 v[158:159], v193 offset:32768
  v_mfma_f32_16x16x32_bf16 v[108:111], v[172:175], v[144:147], v[108:111]
  ds_read_b64_tr_b16 v[160:161], v194 offset:32768
  buffer_load_dwordx4 v4, s[8:11], s54 offen offset:0 sc1 lds
  v_mfma_f32_16x16x32_bf16 v[64:67], v[176:179], v[132:135], v[64:67]
  ds_read_b64_tr_b16 v[162:163], v195 offset:32768
  buffer_load_dwordx4 v5, s[8:11], s54 offen offset:1024 sc1 lds
  v_mfma_f32_16x16x32_bf16 v[80:83], v[176:179], v[136:139], v[80:83]
  s_add_u32 m0, s39, 49152
  v_mfma_f32_16x16x32_bf16 v[96:99], v[176:179], v[140:143], v[96:99]
  s_add_u32 s55, s55, 32768
  v_mfma_f32_16x16x32_bf16 v[112:115], v[176:179], v[144:147], v[112:115]
  buffer_load_dwordx4 v8, s[12:15], s55 offen offset:0 lds
  s_waitcnt lgkmcnt(4)
  v_mfma_f32_16x16x32_bf16 v[52:55], v[148:151], v[116:119], v[52:55]
  ds_read_b128 v[132:135], v13 offset:49152
  v_mfma_f32_16x16x32_bf16 v[68:71], v[148:151], v[120:123], v[68:71]
  ds_read_b128 v[136:139], v13 offset:50176
  buffer_load_dwordx4 v9, s[12:15], s55 offen offset:1024 lds
  v_mfma_f32_16x16x32_bf16 v[84:87], v[148:151], v[124:127], v[84:87]
  ds_read_b128 v[140:143], v13 offset:51200
  v_mfma_f32_16x16x32_bf16 v[100:103], v[148:151], v[128:131], v[100:103]
  ds_read_b128 v[144:147], v13 offset:52224
  s_add_u32 m0, s38, 49152
  v_mfma_f32_16x16x32_bf16 v[56:59], v[152:155], v[116:119], v[56:59]
  ds_read_b64_tr_b16 v[164:165], v188 offset:49152
  v_mfma_f32_16x16x32_bf16 v[72:75], v[152:155], v[120:123], v[72:75]
  ds_read_b64_tr_b16 v[166:167], v189 offset:49152
  s_add_u32 s54, s54, 1024
  v_mfma_f32_16x16x32_bf16 v[88:91], v[152:155], v[124:127], v[88:91]
  ds_read_b64_tr_b16 v[168:169], v190 offset:49152
  v_mfma_f32_16x16x32_bf16 v[104:107], v[152:155], v[128:131], v[104:107]
  ds_read_b64_tr_b16 v[170:171], v191 offset:49152
  buffer_load_dwordx4 v4, s[8:11], s54 offen offset:0 sc1 lds
  s_waitcnt lgkmcnt(8)
  v_mfma_f32_16x16x32_bf16 v[60:63], v[156:159], v[116:119], v[60:63]
  ds_read_b64_tr_b16 v[172:173], v192 offset:49152
  v_mfma_f32_16x16x32_bf16 v[76:79], v[156:159], v[120:123], v[76:79]
  ds_read_b64_tr_b16 v[174:175], v193 offset:49152
  buffer_load_dwordx4 v5, s[8:11], s54 offen offset:1024 sc1 lds
  v_mfma_f32_16x16x32_bf16 v[92:95], v[156:159], v[124:127], v[92:95]
  ds_read_b64_tr_b16 v[176:177], v194 offset:49152
  v_mfma_f32_16x16x32_bf16 v[108:111], v[156:159], v[128:131], v[108:111]
  ds_read_b64_tr_b16 v[178:179], v195 offset:49152
  v_mfma_f32_16x16x32_bf16 v[64:67], v[160:163], v[116:119], v[64:67]
  v_mfma_f32_16x16x32_bf16 v[80:83], v[160:163], v[120:123], v[80:83]
  v_mfma_f32_16x16x32_bf16 v[96:99], v[160:163], v[124:127], v[96:99]
  v_mfma_f32_16x16x32_bf16 v[112:115], v[160:163], v[128:131], v[112:115]
  s_waitcnt lgkmcnt(4)
  v_mfma_f32_16x16x32_bf16 v[52:55], v[164:167], v[132:135], v[52:55]
  s_waitcnt vmcnt(16)
  s_barrier
  v_mfma_f32_16x16x32_bf16 v[68:71], v[164:167], v[136:139], v[68:71]
  ds_read_b128 v[116:119], v14 offset:0
  s_cmp_eq_u32 s52, 1
  s_cselect_b32 s53, 9, 5
  s_lshl_b32 s54, s53, 11
  s_add_u32 s54, s54, s34
  s_lshl_b32 s55, s35, 4
  s_add_u32 s55, s55, s53
  s_lshl_b32 s55, s55, 16
  v_mfma_f32_16x16x32_bf16 v[84:87], v[164:167], v[140:143], v[84:87]
  ds_read_b128 v[120:123], v14 offset:1024
  v_mfma_f32_16x16x32_bf16 v[100:103], v[164:167], v[144:147], v[100:103]
  ds_read_b128 v[124:127], v14 offset:2048
  s_add_u32 m0, s39, 65536
  v_mfma_f32_16x16x32_bf16 v[56:59], v[168:171], v[132:135], v[56:59]
  ds_read_b128 v[128:131], v14 offset:3072
  v_mfma_f32_16x16x32_bf16 v[72:75], v[168:171], v[136:139], v[72:75]
  ds_read_b64_tr_b16 v[148:149], v196 offset:0
  buffer_load_dwordx4 v8, s[12:15], s55 offen offset:0 lds
  v_mfma_f32_16x16x32_bf16 v[88:91], v[168:171], v[140:143], v[88:91]
  ds_read_b64_tr_b16 v[150:151], v197 offset:0
  v_mfma_f32_16x16x32_bf16 v[104:107], v[168:171], v[144:147], v[104:107]
  ds_read_b64_tr_b16 v[152:153], v198 offset:0
  buffer_load_dwordx4 v9, s[12:15], s55 offen offset:1024 lds
  s_waitcnt lgkmcnt(7)
  v_mfma_f32_16x16x32_bf16 v[60:63], v[172:175], v[132:135], v[60:63]
  ds_read_b64_tr_b16 v[154:155], v199 offset:0
  v_mfma_f32_16x16x32_bf16 v[76:79], v[172:175], v[136:139], v[76:79]
  ds_read_b64_tr_b16 v[156:157], v200 offset:0
  s_add_u32 m0, s38, 65536
  v_mfma_f32_16x16x32_bf16 v[92:95], v[172:175], v[140:143], v[92:95]
  ds_read_b64_tr_b16 v[158:159], v201 offset:0
  v_mfma_f32_16x16x32_bf16 v[108:111], v[172:175], v[144:147], v[108:111]
  ds_read_b64_tr_b16 v[160:161], v202 offset:0
  buffer_load_dwordx4 v4, s[8:11], s54 offen offset:0 sc1 lds
  v_mfma_f32_16x16x32_bf16 v[64:67], v[176:179], v[132:135], v[64:67]
  ds_read_b64_tr_b16 v[162:163], v203 offset:0
  buffer_load_dwordx4 v5, s[8:11], s54 offen offset:1024 sc1 lds
  v_mfma_f32_16x16x32_bf16 v[80:83], v[176:179], v[136:139], v[80:83]
  s_add_u32 m0, s39, 81920
  v_mfma_f32_16x16x32_bf16 v[96:99], v[176:179], v[140:143], v[96:99]
  s_add_u32 s55, s55, 32768
  v_mfma_f32_16x16x32_bf16 v[112:115], v[176:179], v[144:147], v[112:115]
  buffer_load_dwordx4 v8, s[12:15], s55 offen offset:0 lds
  s_waitcnt lgkmcnt(4)
  v_mfma_f32_16x16x32_bf16 v[52:55], v[148:151], v[116:119], v[52:55]
  ds_read_b128 v[132:135], v14 offset:16384
  v_mfma_f32_16x16x32_bf16 v[68:71], v[148:151], v[120:123], v[68:71]
  ds_read_b128 v[136:139], v14 offset:17408
  buffer_load_dwordx4 v9, s[12:15], s55 offen offset:1024 lds
  v_mfma_f32_16x16x32_bf16 v[84:87], v[148:151], v[124:127], v[84:87]
  ds_read_b128 v[140:143], v14 offset:18432
  v_mfma_f32_16x16x32_bf16 v[100:103], v[148:151], v[128:131], v[100:103]
  ds_read_b128 v[144:147], v14 offset:19456
  s_add_u32 m0, s38, 81920
  v_mfma_f32_16x16x32_bf16 v[56:59], v[152:155], v[116:119], v[56:59]
  ds_read_b64_tr_b16 v[164:165], v196 offset:16384
  v_mfma_f32_16x16x32_bf16 v[72:75], v[152:155], v[120:123], v[72:75]
  ds_read_b64_tr_b16 v[166:167], v197 offset:16384
  s_add_u32 s54, s54, 1024
  v_mfma_f32_16x16x32_bf16 v[88:91], v[152:155], v[124:127], v[88:91]
  ds_read_b64_tr_b16 v[168:169], v198 offset:16384
  v_mfma_f32_16x16x32_bf16 v[104:107], v[152:155], v[128:131], v[104:107]
  ds_read_b64_tr_b16 v[170:171], v199 offset:16384
  buffer_load_dwordx4 v4, s[8:11], s54 offen offset:0 sc1 lds
  s_waitcnt lgkmcnt(8)
  v_mfma_f32_16x16x32_bf16 v[60:63], v[156:159], v[116:119], v[60:63]
  ds_read_b64_tr_b16 v[172:173], v200 offset:16384
  v_mfma_f32_16x16x32_bf16 v[76:79], v[156:159], v[120:123], v[76:79]
  ds_read_b64_tr_b16 v[174:175], v201 offset:16384
  buffer_load_dwordx4 v5, s[8:11], s54 offen offset:1024 sc1 lds
  v_mfma_f32_16x16x32_bf16 v[92:95], v[156:159], v[124:127], v[92:95]
  ds_read_b64_tr_b16 v[176:177], v202 offset:16384
  v_mfma_f32_16x16x32_bf16 v[108:111], v[156:159], v[128:131], v[108:111]
  ds_read_b64_tr_b16 v[178:179], v203 offset:16384
  v_mfma_f32_16x16x32_bf16 v[64:67], v[160:163], v[116:119], v[64:67]
  v_mfma_f32_16x16x32_bf16 v[80:83], v[160:163], v[120:123], v[80:83]
  v_mfma_f32_16x16x32_bf16 v[96:99], v[160:163], v[124:127], v[96:99]
  v_mfma_f32_16x16x32_bf16 v[112:115], v[160:163], v[128:131], v[112:115]
  s_waitcnt lgkmcnt(4)
  v_mfma_f32_16x16x32_bf16 v[52:55], v[164:167], v[132:135], v[52:55]
  s_waitcnt vmcnt(16)
  s_barrier
  v_mfma_f32_16x16x32_bf16 v[68:71], v[164:167], v[136:139], v[68:71]
  ds_read_b128 v[116:119], v12 offset:0
  s_cmp_eq_u32 s52, 2
  s_cselect_b32 s53, 10, 6
  s_lshl_b32 s54, s53, 11
  s_add_u32 s54, s54, s34
  s_lshl_b32 s55, s35, 4
  s_add_u32 s55, s55, s53
  s_lshl_b32 s55, s55, 16
  v_mfma_f32_16x16x32_bf16 v[84:87], v[164:167], v[140:143], v[84:87]
  ds_read_b128 v[120:123], v12 offset:1024
  v_mfma_f32_16x16x32_bf16 v[100:103], v[164:167], v[144:147], v[100:103]
  ds_read_b128 v[124:127], v12 offset:2048
  s_add_u32 m0, s39, 98304
  v_mfma_f32_16x16x32_bf16 v[56:59], v[168:171], v[132:135], v[56:59]
  ds_read_b128 v[128:131], v12 offset:3072
  v_mfma_f32_16x16x32_bf16 v[72:75], v[168:171], v[136:139], v[72:75]
  ds_read_b64_tr_b16 v[148:149], v180 offset:0
  buffer_load_dwordx4 v8, s[12:15], s55 offen offset:0 lds
  v_mfma_f32_16x16x32_bf16 v[88:91], v[168:171], v[140:143], v[88:91]
  ds_read_b64_tr_b16 v[150:151], v181 offset:0
  v_mfma_f32_16x16x32_bf16 v[104:107], v[168:171], v[144:147], v[104:107]
  ds_read_b64_tr_b16 v[152:153], v182 offset:0
  buffer_load_dwordx4 v9, s[12:15], s55 offen offset:1024 lds
  s_waitcnt lgkmcnt(7)
  v_mfma_f32_16x16x32_bf16 v[60:63], v[172:175], v[132:135], v[60:63]
  ds_read_b64_tr_b16 v[154:155], v183 offset:0
  v_mfma_f32_16x16x32_bf16 v[76:79], v[172:175], v[136:139], v[76:79]
  ds_read_b64_tr_b16 v[156:157], v184 offset:0
  s_add_u32 m0, s38, 98304
  v_mfma_f32_16x16x32_bf16 v[92:95], v[172:175], v[140:143], v[92:95]
  ds_read_b64_tr_b16 v[158:159], v185 offset:0
  v_mfma_f32_16x16x32_bf16 v[108:111], v[172:175], v[144:147], v[108:111]
  ds_read_b64_tr_b16 v[160:161], v186 offset:0
  buffer_load_dwordx4 v4, s[8:11], s54 offen offset:0 sc1 lds
  v_mfma_f32_16x16x32_bf16 v[64:67], v[176:179], v[132:135], v[64:67]
  ds_read_b64_tr_b16 v[162:163], v187 offset:0
  buffer_load_dwordx4 v5, s[8:11], s54 offen offset:1024 sc1 lds
  v_mfma_f32_16x16x32_bf16 v[80:83], v[176:179], v[136:139], v[80:83]
  s_add_u32 m0, s39, 114688
  v_mfma_f32_16x16x32_bf16 v[96:99], v[176:179], v[140:143], v[96:99]
  s_add_u32 s55, s55, 32768
  v_mfma_f32_16x16x32_bf16 v[112:115], v[176:179], v[144:147], v[112:115]
  buffer_load_dwordx4 v8, s[12:15], s55 offen offset:0 lds
  s_waitcnt lgkmcnt(4)
  v_mfma_f32_16x16x32_bf16 v[52:55], v[148:151], v[116:119], v[52:55]
  ds_read_b128 v[132:135], v12 offset:16384
  v_mfma_f32_16x16x32_bf16 v[68:71], v[148:151], v[120:123], v[68:71]
  ds_read_b128 v[136:139], v12 offset:17408
  buffer_load_dwordx4 v9, s[12:15], s55 offen offset:1024 lds
  v_mfma_f32_16x16x32_bf16 v[84:87], v[148:151], v[124:127], v[84:87]
  ds_read_b128 v[140:143], v12 offset:18432
  v_mfma_f32_16x16x32_bf16 v[100:103], v[148:151], v[128:131], v[100:103]
  ds_read_b128 v[144:147], v12 offset:19456
  s_add_u32 m0, s38, 114688
  v_mfma_f32_16x16x32_bf16 v[56:59], v[152:155], v[116:119], v[56:59]
  ds_read_b64_tr_b16 v[164:165], v180 offset:16384
  v_mfma_f32_16x16x32_bf16 v[72:75], v[152:155], v[120:123], v[72:75]
  ds_read_b64_tr_b16 v[166:167], v181 offset:16384
  s_add_u32 s54, s54, 1024
  v_mfma_f32_16x16x32_bf16 v[88:91], v[152:155], v[124:127], v[88:91]
  ds_read_b64_tr_b16 v[168:169], v182 offset:16384
  v_mfma_f32_16x16x32_bf16 v[104:107], v[152:155], v[128:131], v[104:107]
  ds_read_b64_tr_b16 v[170:171], v183 offset:16384
  buffer_load_dwordx4 v4, s[8:11], s54 offen offset:0 sc1 lds
  s_waitcnt lgkmcnt(8)
  v_mfma_f32_16x16x32_bf16 v[60:63], v[156:159], v[116:119], v[60:63]
  ds_read_b64_tr_b16 v[172:173], v184 offset:16384
  v_mfma_f32_16x16x32_bf16 v[76:79], v[156:159], v[120:123], v[76:79]
  ds_read_b64_tr_b16 v[174:175], v185 offset:16384
  buffer_load_dwordx4 v5, s[8:11], s54 offen offset:1024 sc1 lds
  v_mfma_f32_16x16x32_bf16 v[92:95], v[156:159], v[124:127], v[92:95]
  ds_read_b64_tr_b16 v[176:177], v186 offset:16384
  v_mfma_f32_16x16x32_bf16 v[108:111], v[156:159], v[128:131], v[108:111]
  ds_read_b64_tr_b16 v[178:179], v187 offset:16384
  v_mfma_f32_16x16x32_bf16 v[64:67], v[160:163], v[116:119], v[64:67]
  v_mfma_f32_16x16x32_bf16 v[80:83], v[160:163], v[120:123], v[80:83]
  v_mfma_f32_16x16x32_bf16 v[96:99], v[160:163], v[124:127], v[96:99]
  v_mfma_f32_16x16x32_bf16 v[112:115], v[160:163], v[128:131], v[112:115]
  s_waitcnt lgkmcnt(4)
  v_mfma_f32_16x16x32_bf16 v[52:55], v[164:167], v[132:135], v[52:55]
  s_waitcnt vmcnt(16)
  s_barrier
  v_mfma_f32_16x16x32_bf16 v[68:71], v[164:167], v[136:139], v[68:71]
  ds_read_b128 v[116:119], v12 offset:32768
  s_cmp_eq_u32 s52, 3
  s_cselect_b32 s53, 11, 7
  s_lshl_b32 s54, s53, 11
  s_add_u32 s54, s54, s34
  s_lshl_b32 s55, s35, 4
  s_add_u32 s55, s55, s53
  s_lshl_b32 s55, s55, 16
  v_mfma_f32_16x16x32_bf16 v[84:87], v[164:167], v[140:143], v[84:87]
  ds_read_b128 v[120:123], v12 offset:33792
  v_mfma_f32_16x16x32_bf16 v[100:103], v[164:167], v[144:147], v[100:103]
  ds_read_b128 v[124:127], v12 offset:34816
  s_add_u32 m0, s39, 131072
  v_mfma_f32_16x16x32_bf16 v[56:59], v[168:171], v[132:135], v[56:59]
  ds_read_b128 v[128:131], v12 offset:35840
  v_mfma_f32_16x16x32_bf16 v[72:75], v[168:171], v[136:139], v[72:75]
  ds_read_b64_tr_b16 v[148:149], v180 offset:32768
  buffer_load_dwordx4 v8, s[12:15], s55 offen offset:0 lds
  v_mfma_f32_16x16x32_bf16 v[88:91], v[168:171], v[140:143], v[88:91]
  ds_read_b64_tr_b16 v[150:151], v181 offset:32768
  v_mfma_f32_16x16x32_bf16 v[104:107], v[168:171], v[144:147], v[104:107]
  ds_read_b64_tr_b16 v[152:153], v182 offset:32768
  buffer_load_dwordx4 v9, s[12:15], s55 offen offset:1024 lds
  s_waitcnt lgkmcnt(7)
  v_mfma_f32_16x16x32_bf16 v[60:63], v[172:175], v[132:135], v[60:63]
  ds_read_b64_tr_b16 v[154:155], v183 offset:32768
  v_mfma_f32_16x16x32_bf16 v[76:79], v[172:175], v[136:139], v[76:79]
  ds_read_b64_tr_b16 v[156:157], v184 offset:32768
  s_add_u32 m0, s38, 131072
  v_mfma_f32_16x16x32_bf16 v[92:95], v[172:175], v[140:143], v[92:95]
  ds_read_b64_tr_b16 v[158:159], v185 offset:32768
  v_mfma_f32_16x16x32_bf16 v[108:111], v[172:175], v[144:147], v[108:111]
  ds_read_b64_tr_b16 v[160:161], v186 offset:32768
  buffer_load_dwordx4 v4, s[8:11], s54 offen offset:0 sc1 lds
  v_mfma_f32_16x16x32_bf16 v[64:67], v[176:179], v[132:135], v[64:67]
  ds_read_b64_tr_b16 v[162:163], v187 offset:32768
  buffer_load_dwordx4 v5, s[8:11], s54 offen offset:1024 sc1 lds
  v_mfma_f32_16x16x32_bf16 v[80:83], v[176:179], v[136:139], v[80:83]
  s_add_u32 m0, s39, 147456
  v_mfma_f32_16x16x32_bf16 v[96:99], v[176:179], v[140:143], v[96:99]
  s_add_u32 s55, s55, 32768
  v_mfma_f32_16x16x32_bf16 v[112:115], v[176:179], v[144:147], v[112:115]
  buffer_load_dwordx4 v8, s[12:15], s55 offen offset:0 lds
  s_waitcnt lgkmcnt(4)
  v_mfma_f32_16x16x32_bf16 v[52:55], v[148:151], v[116:119], v[52:55]
  ds_read_b128 v[132:135], v12 offset:49152
  v_mfma_f32_16x16x32_bf16 v[68:71], v[148:151], v[120:123], v[68:71]
  ds_read_b128 v[136:139], v12 offset:50176
  buffer_load_dwordx4 v9, s[12:15], s55 offen offset:1024 lds
  v_mfma_f32_16x16x32_bf16 v[84:87], v[148:151], v[124:127], v[84:87]
  ds_read_b128 v[140:143], v12 offset:51200
  v_mfma_f32_16x16x32_bf16 v[100:103], v[148:151], v[128:131], v[100:103]
  ds_read_b128 v[144:147], v12 offset:52224
  s_add_u32 m0, s38, 147456
  v_mfma_f32_16x16x32_bf16 v[56:59], v[152:155], v[116:119], v[56:59]
  ds_read_b64_tr_b16 v[164:165], v180 offset:49152
  v_mfma_f32_16x16x32_bf16 v[72:75], v[152:155], v[120:123], v[72:75]
  ds_read_b64_tr_b16 v[166:167], v181 offset:49152
  s_add_u32 s54, s54, 1024
  v_mfma_f32_16x16x32_bf16 v[88:91], v[152:155], v[124:127], v[88:91]
  ds_read_b64_tr_b16 v[168:169], v182 offset:49152
  v_mfma_f32_16x16x32_bf16 v[104:107], v[152:155], v[128:131], v[104:107]
  ds_read_b64_tr_b16 v[170:171], v183 offset:49152
  buffer_load_dwordx4 v4, s[8:11], s54 offen offset:0 sc1 lds
  s_waitcnt lgkmcnt(8)
  v_mfma_f32_16x16x32_bf16 v[60:63], v[156:159], v[116:119], v[60:63]
  ds_read_b64_tr_b16 v[172:173], v184 offset:49152
  v_mfma_f32_16x16x32_bf16 v[76:79], v[156:159], v[120:123], v[76:79]
  ds_read_b64_tr_b16 v[174:175], v185 offset:49152
  buffer_load_dwordx4 v5, s[8:11], s54 offen offset:1024 sc1 lds
  v_mfma_f32_16x16x32_bf16 v[92:95], v[156:159], v[124:127], v[92:95]
  ds_read_b64_tr_b16 v[176:177], v186 offset:49152
  v_mfma_f32_16x16x32_bf16 v[108:111], v[156:159], v[128:131], v[108:111]
  ds_read_b64_tr_b16 v[178:179], v187 offset:49152
  v_mfma_f32_16x16x32_bf16 v[64:67], v[160:163], v[116:119], v[64:67]
  v_mfma_f32_16x16x32_bf16 v[80:83], v[160:163], v[120:123], v[80:83]
  v_mfma_f32_16x16x32_bf16 v[96:99], v[160:163], v[124:127], v[96:99]
  v_mfma_f32_16x16x32_bf16 v[112:115], v[160:163], v[128:131], v[112:115]
  s_waitcnt lgkmcnt(4)
  v_mfma_f32_16x16x32_bf16 v[52:55], v[164:167], v[132:135], v[52:55]
  s_waitcnt vmcnt(16)
  s_barrier
  v_mfma_f32_16x16x32_bf16 v[68:71], v[164:167], v[136:139], v[68:71]
  ds_read_b128 v[116:119], v13 offset:0
  s_cmp_eq_u32 s52, 0
  s_cselect_b32 s53, 12, 8
  s_lshl_b32 s54, s53, 11
  s_add_u32 s54, s54, s34
  s_lshl_b32 s55, s35, 4
  s_add_u32 s55, s55, s53
  s_lshl_b32 s55, s55, 16
  v_mfma_f32_16x16x32_bf16 v[84:87], v[164:167], v[140:143], v[84:87]
  ds_read_b128 v[120:123], v13 offset:1024
  v_mfma_f32_16x16x32_bf16 v[100:103], v[164:167], v[144:147], v[100:103]
  ds_read_b128 v[124:127], v13 offset:2048
  s_add_u32 m0, s39, 0
  v_mfma_f32_16x16x32_bf16 v[56:59], v[168:171], v[132:135], v[56:59]
  ds_read_b128 v[128:131], v13 offset:3072
  v_mfma_f32_16x16x32_bf16 v[72:75], v[168:171], v[136:139], v[72:75]
  ds_read_b64_tr_b16 v[148:149], v188 offset:0
  buffer_load_dwordx4 v8, s[12:15], s55 offen offset:0 lds
  v_mfma_f32_16x16x32_bf16 v[88:91], v[168:171], v[140:143], v[88:91]
  ds_read_b64_tr_b16 v[150:151], v189 offset:0
  v_mfma_f32_16x16x32_bf16 v[104:107], v[168:171], v[144:147], v[104:107]
  ds_read_b64_tr_b16 v[152:153], v190 offset:0
  buffer_load_dwordx4 v9, s[12:15], s55 offen offset:1024 lds
  s_waitcnt lgkmcnt(7)
  v_mfma_f32_16x16x32_bf16 v[60:63], v[172:175], v[132:135], v[60:63]
  ds_read_b64_tr_b16 v[154:155], v191 offset:0
  v_mfma_f32_16x16x32_bf16 v[76:79], v[172:175], v[136:139], v[76:79]
  ds_read_b64_tr_b16 v[156:157], v192 offset:0
  s_add_u32 m0, s38, 0
  v_mfma_f32_16x16x32_bf16 v[92:95], v[172:175], v[140:143], v[92:95]
  ds_read_b64_tr_b16 v[158:159], v193 offset:0
  v_mfma_f32_16x16x32_bf16 v[108:111], v[172:175], v[144:147], v[108:111]
  ds_read_b64_tr_b16 v[160:161], v194 offset:0
  buffer_load_dwordx4 v4, s[8:11], s54 offen offset:0 sc1 lds
  v_mfma_f32_16x16x32_bf16 v[64:67], v[176:179], v[132:135], v[64:67]
  ds_read_b64_tr_b16 v[162:163], v195 offset:0
  buffer_load_dwordx4 v5, s[8:11], s54 offen offset:1024 sc1 lds
  v_mfma_f32_16x16x32_bf16 v[80:83], v[176:179], v[136:139], v[80:83]
  s_add_u32 m0, s39, 16384
  v_mfma_f32_16x16x32_bf16 v[96:99], v[176:179], v[140:143], v[96:99]
  s_add_u32 s55, s55, 32768
  v_mfma_f32_16x16x32_bf16 v[112:115], v[176:179], v[144:147], v[112:115]
  buffer_load_dwordx4 v8, s[12:15], s55 offen offset:0 lds
  s_waitcnt lgkmcnt(4)
  v_mfma_f32_16x16x32_bf16 v[52:55], v[148:151], v[116:119], v[52:55]
  ds_read_b128 v[132:135], v13 offset:16384
  v_mfma_f32_16x16x32_bf16 v[68:71], v[148:151], v[120:123], v[68:71]
  ds_read_b128 v[136:139], v13 offset:17408
  buffer_load_dwordx4 v9, s[12:15], s55 offen offset:1024 lds
  v_mfma_f32_16x16x32_bf16 v[84:87], v[148:151], v[124:127], v[84:87]
  ds_read_b128 v[140:143], v13 offset:18432
  v_mfma_f32_16x16x32_bf16 v[100:103], v[148:151], v[128:131], v[100:103]
  ds_read_b128 v[144:147], v13 offset:19456
  s_add_u32 m0, s38, 16384
  v_mfma_f32_16x16x32_bf16 v[56:59], v[152:155], v[116:119], v[56:59]
  ds_read_b64_tr_b16 v[164:165], v188 offset:16384
  v_mfma_f32_16x16x32_bf16 v[72:75], v[152:155], v[120:123], v[72:75]
  ds_read_b64_tr_b16 v[166:167], v189 offset:16384
  s_add_u32 s54, s54, 1024
  v_mfma_f32_16x16x32_bf16 v[88:91], v[152:155], v[124:127], v[88:91]
  ds_read_b64_tr_b16 v[168:169], v190 offset:16384
  v_mfma_f32_16x16x32_bf16 v[104:107], v[152:155], v[128:131], v[104:107]
  ds_read_b64_tr_b16 v[170:171], v191 offset:16384
  buffer_load_dwordx4 v4, s[8:11], s54 offen offset:0 sc1 lds
  s_waitcnt lgkmcnt(8)
  v_mfma_f32_16x16x32_bf16 v[60:63], v[156:159], v[116:119], v[60:63]
  ds_read_b64_tr_b16 v[172:173], v192 offset:16384
  v_mfma_f32_16x16x32_bf16 v[76:79], v[156:159], v[120:123], v[76:79]
  ds_read_b64_tr_b16 v[174:175], v193 offset:16384
  buffer_load_dwordx4 v5, s[8:11], s54 offen offset:1024 sc1 lds
  v_mfma_f32_16x16x32_bf16 v[92:95], v[156:159], v[124:127], v[92:95]
  ds_read_b64_tr_b16 v[176:177], v194 offset:16384
  v_mfma_f32_16x16x32_bf16 v[108:111], v[156:159], v[128:131], v[108:111]
  ds_read_b64_tr_b16 v[178:179], v195 offset:16384
  v_mfma_f32_16x16x32_bf16 v[64:67], v[160:163], v[116:119], v[64:67]
  v_mfma_f32_16x16x32_bf16 v[80:83], v[160:163], v[120:123], v[80:83]
  v_mfma_f32_16x16x32_bf16 v[96:99], v[160:163], v[124:127], v[96:99]
  v_mfma_f32_16x16x32_bf16 v[112:115], v[160:163], v[128:131], v[112:115]
  s_waitcnt lgkmcnt(4)
  v_mfma_f32_16x16x32_bf16 v[52:55], v[164:167], v[132:135], v[52:55]
  s_waitcnt vmcnt(16)
  s_barrier
  v_mfma_f32_16x16x32_bf16 v[68:71], v[164:167], v[136:139], v[68:71]
  ds_read_b128 v[116:119], v13 offset:32768
  s_cmp_eq_u32 s52, 1
  s_cselect_b32 s53, 13, 9
  s_lshl_b32 s54, s53, 11
  s_add_u32 s54, s54, s34
  s_lshl_b32 s55, s35, 4
  s_add_u32 s55, s55, s53
  s_lshl_b32 s55, s55, 16
  v_mfma_f32_16x16x32_bf16 v[84:87], v[164:167], v[140:143], v[84:87]
  ds_read_b128 v[120:123], v13 offset:33792
  v_mfma_f32_16x16x32_bf16 v[100:103], v[164:167], v[144:147], v[100:103]
  ds_read_b128 v[124:127], v13 offset:34816
  s_add_u32 m0, s39, 32768
  v_mfma_f32_16x16x32_bf16 v[56:59], v[168:171], v[132:135], v[56:59]
  ds_read_b128 v[128:131], v13 offset:35840
  v_mfma_f32_16x16x32_bf16 v[72:75], v[168:171], v[136:139], v[72:75]
  ds_read_b64_tr_b16 v[148:149], v188 offset:32768
  buffer_load_dwordx4 v8, s[12:15], s55 offen offset:0 lds
  v_mfma_f32_16x16x32_bf16 v[88:91], v[168:171], v[140:143], v[88:91]
  ds_read_b64_tr_b16 v[150:151], v189 offset:32768
  v_mfma_f32_16x16x32_bf16 v[104:107], v[168:171], v[144:147], v[104:107]
  ds_read_b64_tr_b16 v[152:153], v190 offset:32768
  buffer_load_dwordx4 v9, s[12:15], s55 offen offset:1024 lds
  s_waitcnt lgkmcnt(7)
  v_mfma_f32_16x16x32_bf16 v[60:63], v[172:175], v[132:135], v[60:63]
  ds_read_b64_tr_b16 v[154:155], v191 offset:32768
  v_mfma_f32_16x16x32_bf16 v[76:79], v[172:175], v[136:139], v[76:79]
  ds_read_b64_tr_b16 v[156:157], v192 offset:32768
  s_add_u32 m0, s38, 32768
  v_mfma_f32_16x16x32_bf16 v[92:95], v[172:175], v[140:143], v[92:95]
  ds_read_b64_tr_b16 v[158:159], v193 offset:32768
  v_mfma_f32_16x16x32_bf16 v[108:111], v[172:175], v[144:147], v[108:111]
  ds_read_b64_tr_b16 v[160:161], v194 offset:32768
  buffer_load_dwordx4 v4, s[8:11], s54 offen offset:0 sc1 lds
  v_mfma_f32_16x16x32_bf16 v[64:67], v[176:179], v[132:135], v[64:67]
  ds_read_b64_tr_b16 v[162:163], v195 offset:32768
  buffer_load_dwordx4 v5, s[8:11], s54 offen offset:1024 sc1 lds
  v_mfma_f32_16x16x32_bf16 v[80:83], v[176:179], v[136:139], v[80:83]
  s_add_u32 m0, s39, 49152
  v_mfma_f32_16x16x32_bf16 v[96:99], v[176:179], v[140:143], v[96:99]
  s_add_u32 s55, s55, 32768
  v_mfma_f32_16x16x32_bf16 v[112:115], v[176:179], v[144:147], v[112:115]
  buffer_load_dwordx4 v8, s[12:15], s55 offen offset:0 lds
  s_waitcnt lgkmcnt(4)
  v_mfma_f32_16x16x32_bf16 v[52:55], v[148:151], v[116:119], v[52:55]
  ds_read_b128 v[132:135], v13 offset:49152
  v_mfma_f32_16x16x32_bf16 v[68:71], v[148:151], v[120:123], v[68:71]
  ds_read_b128 v[136:139], v13 offset:50176
  buffer_load_dwordx4 v9, s[12:15], s55 offen offset:1024 lds
  v_mfma_f32_16x16x32_bf16 v[84:87], v[148:151], v[124:127], v[84:87]
  ds_read_b128 v[140:143], v13 offset:51200
  v_mfma_f32_16x16x32_bf16 v[100:103], v[148:151], v[128:131], v[100:103]
  ds_read_b128 v[144:147], v13 offset:52224
  s_add_u32 m0, s38, 49152
  v_mfma_f32_16x16x32_bf16 v[56:59], v[152:155], v[116:119], v[56:59]
  ds_read_b64_tr_b16 v[164:165], v188 offset:49152
  v_mfma_f32_16x16x32_bf16 v[72:75], v[152:155], v[120:123], v[72:75]
  ds_read_b64_tr_b16 v[166:167], v189 offset:49152
  s_add_u32 s54, s54, 1024
  v_mfma_f32_16x16x32_bf16 v[88:91], v[152:155], v[124:127], v[88:91]
  ds_read_b64_tr_b16 v[168:169], v190 offset:49152
  v_mfma_f32_16x16x32_bf16 v[104:107], v[152:155], v[128:131], v[104:107]
  ds_read_b64_tr_b16 v[170:171], v191 offset:49152
  buffer_load_dwordx4 v4, s[8:11], s54 offen offset:0 sc1 lds
  s_waitcnt lgkmcnt(8)
  v_mfma_f32_16x16x32_bf16 v[60:63], v[156:159], v[116:119], v[60:63]
  ds_read_b64_tr_b16 v[172:173], v192 offset:49152
  v_mfma_f32_16x16x32_bf16 v[76:79], v[156:159], v[120:123], v[76:79]
  ds_read_b64_tr_b16 v[174:175], v193 offset:49152
  buffer_load_dwordx4 v5, s[8:11], s54 offen offset:1024 sc1 lds
  v_mfma_f32_16x16x32_bf16 v[92:95], v[156:159], v[124:127], v[92:95]
  ds_read_b64_tr_b16 v[176:177], v194 offset:49152
  v_mfma_f32_16x16x32_bf16 v[108:111], v[156:159], v[128:131], v[108:111]
  ds_read_b64_tr_b16 v[178:179], v195 offset:49152
  v_mfma_f32_16x16x32_bf16 v[64:67], v[160:163], v[116:119], v[64:67]
  v_mfma_f32_16x16x32_bf16 v[80:83], v[160:163], v[120:123], v[80:83]
  v_mfma_f32_16x16x32_bf16 v[96:99], v[160:163], v[124:127], v[96:99]
  v_mfma_f32_16x16x32_bf16 v[112:115], v[160:163], v[128:131], v[112:115]
  s_waitcnt lgkmcnt(4)
  v_mfma_f32_16x16x32_bf16 v[52:55], v[164:167], v[132:135], v[52:55]
  s_waitcnt vmcnt(16)
  s_barrier
  v_mfma_f32_16x16x32_bf16 v[68:71], v[164:167], v[136:139], v[68:71]
  ds_read_b128 v[116:119], v14 offset:0
  s_cmp_eq_u32 s52, 2
  s_cselect_b32 s53, 14, 10
  s_lshl_b32 s54, s53, 11
  s_add_u32 s54, s54, s34
  s_lshl_b32 s55, s35, 4
  s_add_u32 s55, s55, s53
  s_lshl_b32 s55, s55, 16
  v_mfma_f32_16x16x32_bf16 v[84:87], v[164:167], v[140:143], v[84:87]
  ds_read_b128 v[120:123], v14 offset:1024
  v_mfma_f32_16x16x32_bf16 v[100:103], v[164:167], v[144:147], v[100:103]
  ds_read_b128 v[124:127], v14 offset:2048
  s_add_u32 m0, s39, 65536
  v_mfma_f32_16x16x32_bf16 v[56:59], v[168:171], v[132:135], v[56:59]
  ds_read_b128 v[128:131], v14 offset:3072
  v_mfma_f32_16x16x32_bf16 v[72:75], v[168:171], v[136:139], v[72:75]
  ds_read_b64_tr_b16 v[148:149], v196 offset:0
  buffer_load_dwordx4 v8, s[12:15], s55 offen offset:0 lds
  v_mfma_f32_16x16x32_bf16 v[88:91], v[168:171], v[140:143], v[88:91]
  ds_read_b64_tr_b16 v[150:151], v197 offset:0
  v_mfma_f32_16x16x32_bf16 v[104:107], v[168:171], v[144:147], v[104:107]
  ds_read_b64_tr_b16 v[152:153], v198 offset:0
  buffer_load_dwordx4 v9, s[12:15], s55 offen offset:1024 lds
  s_waitcnt lgkmcnt(7)
  v_mfma_f32_16x16x32_bf16 v[60:63], v[172:175], v[132:135], v[60:63]
  ds_read_b64_tr_b16 v[154:155], v199 offset:0
  v_mfma_f32_16x16x32_bf16 v[76:79], v[172:175], v[136:139], v[76:79]
  ds_read_b64_tr_b16 v[156:157], v200 offset:0
  s_add_u32 m0, s38, 65536
  v_mfma_f32_16x16x32_bf16 v[92:95], v[172:175], v[140:143], v[92:95]
  ds_read_b64_tr_b16 v[158:159], v201 offset:0
  v_mfma_f32_16x16x32_bf16 v[108:111], v[172:175], v[144:147], v[108:111]
  ds_read_b64_tr_b16 v[160:161], v202 offset:0
  buffer_load_dwordx4 v4, s[8:11], s54 offen offset:0 sc1 lds
  v_mfma_f32_16x16x32_bf16 v[64:67], v[176:179], v[132:135], v[64:67]
  ds_read_b64_tr_b16 v[162:163], v203 offset:0
  buffer_load_dwordx4 v5, s[8:11], s54 offen offset:1024 sc1 lds
  v_mfma_f32_16x16x32_bf16 v[80:83], v[176:179], v[136:139], v[80:83]
  s_add_u32 m0, s39, 81920
  v_mfma_f32_16x16x32_bf16 v[96:99], v[176:179], v[140:143], v[96:99]
  s_add_u32 s55, s55, 32768
  v_mfma_f32_16x16x32_bf16 v[112:115], v[176:179], v[144:147], v[112:115]
  buffer_load_dwordx4 v8, s[12:15], s55 offen offset:0 lds
  s_waitcnt lgkmcnt(4)
  v_mfma_f32_16x16x32_bf16 v[52:55], v[148:151], v[116:119], v[52:55]
  ds_read_b128 v[132:135], v14 offset:16384
  v_mfma_f32_16x16x32_bf16 v[68:71], v[148:151], v[120:123], v[68:71]
  ds_read_b128 v[136:139], v14 offset:17408
  buffer_load_dwordx4 v9, s[12:15], s55 offen offset:1024 lds
  v_mfma_f32_16x16x32_bf16 v[84:87], v[148:151], v[124:127], v[84:87]
  ds_read_b128 v[140:143], v14 offset:18432
  v_mfma_f32_16x16x32_bf16 v[100:103], v[148:151], v[128:131], v[100:103]
  ds_read_b128 v[144:147], v14 offset:19456
  s_add_u32 m0, s38, 81920
  v_mfma_f32_16x16x32_bf16 v[56:59], v[152:155], v[116:119], v[56:59]
  ds_read_b64_tr_b16 v[164:165], v196 offset:16384
  v_mfma_f32_16x16x32_bf16 v[72:75], v[152:155], v[120:123], v[72:75]
  ds_read_b64_tr_b16 v[166:167], v197 offset:16384
  s_add_u32 s54, s54, 1024
  v_mfma_f32_16x16x32_bf16 v[88:91], v[152:155], v[124:127], v[88:91]
  ds_read_b64_tr_b16 v[168:169], v198 offset:16384
  v_mfma_f32_16x16x32_bf16 v[104:107], v[152:155], v[128:131], v[104:107]
  ds_read_b64_tr_b16 v[170:171], v199 offset:16384
  buffer_load_dwordx4 v4, s[8:11], s54 offen offset:0 sc1 lds
  s_waitcnt lgkmcnt(8)
  v_mfma_f32_16x16x32_bf16 v[60:63], v[156:159], v[116:119], v[60:63]
  ds_read_b64_tr_b16 v[172:173], v200 offset:16384
  v_mfma_f32_16x16x32_bf16 v[76:79], v[156:159], v[120:123], v[76:79]
  ds_read_b64_tr_b16 v[174:175], v201 offset:16384
  buffer_load_dwordx4 v5, s[8:11], s54 offen offset:1024 sc1 lds
  v_mfma_f32_16x16x32_bf16 v[92:95], v[156:159], v[124:127], v[92:95]
  ds_read_b64_tr_b16 v[176:177], v202 offset:16384
  v_mfma_f32_16x16x32_bf16 v[108:111], v[156:159], v[128:131], v[108:111]
  ds_read_b64_tr_b16 v[178:179], v203 offset:16384
  v_mfma_f32_16x16x32_bf16 v[64:67], v[160:163], v[116:119], v[64:67]
  v_mfma_f32_16x16x32_bf16 v[80:83], v[160:163], v[120:123], v[80:83]
  v_mfma_f32_16x16x32_bf16 v[96:99], v[160:163], v[124:127], v[96:99]
  v_mfma_f32_16x16x32_bf16 v[112:115], v[160:163], v[128:131], v[112:115]
  s_waitcnt lgkmcnt(4)
  v_mfma_f32_16x16x32_bf16 v[52:55], v[164:167], v[132:135], v[52:55]
  s_waitcnt vmcnt(16)
  s_barrier
  v_mfma_f32_16x16x32_bf16 v[68:71], v[164:167], v[136:139], v[68:71]
  ds_read_b128 v[116:119], v12 offset:0
  s_cmp_eq_u32 s52, 3
  s_cselect_b32 s53, 15, 11
  s_lshl_b32 s54, s53, 11
  s_add_u32 s54, s54, s34
  s_lshl_b32 s55, s35, 4
  s_add_u32 s55, s55, s53
  s_lshl_b32 s55, s55, 16
  v_mfma_f32_16x16x32_bf16 v[84:87], v[164:167], v[140:143], v[84:87]
  ds_read_b128 v[120:123], v12 offset:1024
  v_mfma_f32_16x16x32_bf16 v[100:103], v[164:167], v[144:147], v[100:103]
  ds_read_b128 v[124:127], v12 offset:2048
  s_add_u32 m0, s39, 98304
  v_mfma_f32_16x16x32_bf16 v[56:59], v[168:171], v[132:135], v[56:59]
  ds_read_b128 v[128:131], v12 offset:3072
  v_mfma_f32_16x16x32_bf16 v[72:75], v[168:171], v[136:139], v[72:75]
  ds_read_b64_tr_b16 v[148:149], v180 offset:0
  buffer_load_dwordx4 v8, s[12:15], s55 offen offset:0 lds
  v_mfma_f32_16x16x32_bf16 v[88:91], v[168:171], v[140:143], v[88:91]
  ds_read_b64_tr_b16 v[150:151], v181 offset:0
  v_mfma_f32_16x16x32_bf16 v[104:107], v[168:171], v[144:147], v[104:107]
  ds_read_b64_tr_b16 v[152:153], v182 offset:0
  buffer_load_dwordx4 v9, s[12:15], s55 offen offset:1024 lds
  s_waitcnt lgkmcnt(7)
  v_mfma_f32_16x16x32_bf16 v[60:63], v[172:175], v[132:135], v[60:63]
  ds_read_b64_tr_b16 v[154:155], v183 offset:0
  v_mfma_f32_16x16x32_bf16 v[76:79], v[172:175], v[136:139], v[76:79]
  ds_read_b64_tr_b16 v[156:157], v184 offset:0
  s_add_u32 m0, s38, 98304
  v_mfma_f32_16x16x32_bf16 v[92:95], v[172:175], v[140:143], v[92:95]
  ds_read_b64_tr_b16 v[158:159], v185 offset:0
  v_mfma_f32_16x16x32_bf16 v[108:111], v[172:175], v[144:147], v[108:111]
  ds_read_b64_tr_b16 v[160:161], v186 offset:0
  buffer_load_dwordx4 v4, s[8:11], s54 offen offset:0 sc1 lds
  v_mfma_f32_16x16x32_bf16 v[64:67], v[176:179], v[132:135], v[64:67]
  ds_read_b64_tr_b16 v[162:163], v187 offset:0
  buffer_load_dwordx4 v5, s[8:11], s54 offen offset:1024 sc1 lds
  v_mfma_f32_16x16x32_bf16 v[80:83], v[176:179], v[136:139], v[80:83]
  s_add_u32 m0, s39, 114688
  v_mfma_f32_16x16x32_bf16 v[96:99], v[176:179], v[140:143], v[96:99]
  s_add_u32 s55, s55, 32768
  v_mfma_f32_16x16x32_bf16 v[112:115], v[176:179], v[144:147], v[112:115]
  buffer_load_dwordx4 v8, s[12:15], s55 offen offset:0 lds
  s_waitcnt lgkmcnt(4)
  v_mfma_f32_16x16x32_bf16 v[52:55], v[148:151], v[116:119], v[52:55]
  ds_read_b128 v[132:135], v12 offset:16384
  v_mfma_f32_16x16x32_bf16 v[68:71], v[148:151], v[120:123], v[68:71]
  ds_read_b128 v[136:139], v12 offset:17408
  buffer_load_dwordx4 v9, s[12:15], s55 offen offset:1024 lds
  v_mfma_f32_16x16x32_bf16 v[84:87], v[148:151], v[124:127], v[84:87]
  ds_read_b128 v[140:143], v12 offset:18432
  v_mfma_f32_16x16x32_bf16 v[100:103], v[148:151], v[128:131], v[100:103]
  ds_read_b128 v[144:147], v12 offset:19456
  s_add_u32 m0, s38, 114688
  v_mfma_f32_16x16x32_bf16 v[56:59], v[152:155], v[116:119], v[56:59]
  ds_read_b64_tr_b16 v[164:165], v180 offset:16384
  v_mfma_f32_16x16x32_bf16 v[72:75], v[152:155], v[120:123], v[72:75]
  ds_read_b64_tr_b16 v[166:167], v181 offset:16384
  s_add_u32 s54, s54, 1024
  v_mfma_f32_16x16x32_bf16 v[88:91], v[152:155], v[124:127], v[88:91]
  ds_read_b64_tr_b16 v[168:169], v182 offset:16384
  v_mfma_f32_16x16x32_bf16 v[104:107], v[152:155], v[128:131], v[104:107]
  ds_read_b64_tr_b16 v[170:171], v183 offset:16384
  buffer_load_dwordx4 v4, s[8:11], s54 offen offset:0 sc1 lds
  s_waitcnt lgkmcnt(8)
  v_mfma_f32_16x16x32_bf16 v[60:63], v[156:159], v[116:119], v[60:63]
  ds_read_b64_tr_b16 v[172:173], v184 offset:16384
  v_mfma_f32_16x16x32_bf16 v[76:79], v[156:159], v[120:123], v[76:79]
  ds_read_b64_tr_b16 v[174:175], v185 offset:16384
  buffer_load_dwordx4 v5, s[8:11], s54 offen offset:1024 sc1 lds
  v_mfma_f32_16x16x32_bf16 v[92:95], v[156:159], v[124:127], v[92:95]
  ds_read_b64_tr_b16 v[176:177], v186 offset:16384
  v_mfma_f32_16x16x32_bf16 v[108:111], v[156:159], v[128:131], v[108:111]
  ds_read_b64_tr_b16 v[178:179], v187 offset:16384
  v_mfma_f32_16x16x32_bf16 v[64:67], v[160:163], v[116:119], v[64:67]
  v_mfma_f32_16x16x32_bf16 v[80:83], v[160:163], v[120:123], v[80:83]
  v_mfma_f32_16x16x32_bf16 v[96:99], v[160:163], v[124:127], v[96:99]
  v_mfma_f32_16x16x32_bf16 v[112:115], v[160:163], v[128:131], v[112:115]
  s_waitcnt lgkmcnt(4)
  v_mfma_f32_16x16x32_bf16 v[52:55], v[164:167], v[132:135], v[52:55]
  s_waitcnt vmcnt(16)
  s_barrier
  v_mfma_f32_16x16x32_bf16 v[68:71], v[164:167], v[136:139], v[68:71]
  ds_read_b128 v[116:119], v12 offset:32768
  s_add_u32 s55, s52, 0
  s_and_b32 s55, s55, 3
  s_cmp_le_u32 s55, 0
  s_cselect_b32 s53, 13, 12
  s_lshl_b32 s54, s53, 11
  s_add_u32 s54, s54, s34
  s_lshl_b32 s55, s35, 4
  s_add_u32 s55, s55, s53
  s_lshl_b32 s55, s55, 16
  v_mfma_f32_16x16x32_bf16 v[84:87], v[164:167], v[140:143], v[84:87]
  ds_read_b128 v[120:123], v12 offset:33792
  v_mfma_f32_16x16x32_bf16 v[100:103], v[164:167], v[144:147], v[100:103]
  ds_read_b128 v[124:127], v12 offset:34816
  s_add_u32 m0, s39, 131072
  v_mfma_f32_16x16x32_bf16 v[56:59], v[168:171], v[132:135], v[56:59]
  ds_read_b128 v[128:131], v12 offset:35840
  v_mfma_f32_16x16x32_bf16 v[72:75], v[168:171], v[136:139], v[72:75]
  ds_read_b64_tr_b16 v[148:149], v180 offset:32768
  buffer_load_dwordx4 v8, s[12:15], s55 offen offset:0 lds
  v_mfma_f32_16x16x32_bf16 v[88:91], v[168:171], v[140:143], v[88:91]
  ds_read_b64_tr_b16 v[150:151], v181 offset:32768
  v_mfma_f32_16x16x32_bf16 v[104:107], v[168:171], v[144:147], v[104:107]
  ds_read_b64_tr_b16 v[152:153], v182 offset:32768
  buffer_load_dwordx4 v9, s[12:15], s55 offen offset:1024 lds
  s_waitcnt lgkmcnt(7)
  v_mfma_f32_16x16x32_bf16 v[60:63], v[172:175], v[132:135], v[60:63]
  ds_read_b64_tr_b16 v[154:155], v183 offset:32768
  v_mfma_f32_16x16x32_bf16 v[76:79], v[172:175], v[136:139], v[76:79]
  ds_read_b64_tr_b16 v[156:157], v184 offset:32768
  s_add_u32 m0, s38, 131072
  v_mfma_f32_16x16x32_bf16 v[92:95], v[172:175], v[140:143], v[92:95]
  ds_read_b64_tr_b16 v[158:159], v185 offset:32768
  v_mfma_f32_16x16x32_bf16 v[108:111], v[172:175], v[144:147], v[108:111]
  ds_read_b64_tr_b16 v[160:161], v186 offset:32768
  buffer_load_dwordx4 v4, s[8:11], s54 offen offset:0 sc1 lds
  v_mfma_f32_16x16x32_bf16 v[64:67], v[176:179], v[132:135], v[64:67]
  ds_read_b64_tr_b16 v[162:163], v187 offset:32768
  buffer_load_dwordx4 v5, s[8:11], s54 offen offset:1024 sc1 lds
  v_mfma_f32_16x16x32_bf16 v[80:83], v[176:179], v[136:139], v[80:83]
  s_add_u32 m0, s39, 147456
  v_mfma_f32_16x16x32_bf16 v[96:99], v[176:179], v[140:143], v[96:99]
  s_add_u32 s55, s55, 32768
  v_mfma_f32_16x16x32_bf16 v[112:115], v[176:179], v[144:147], v[112:115]
  buffer_load_dwordx4 v8, s[12:15], s55 offen offset:0 lds
  s_waitcnt lgkmcnt(4)
  v_mfma_f32_16x16x32_bf16 v[52:55], v[148:151], v[116:119], v[52:55]
  ds_read_b128 v[132:135], v12 offset:49152
  v_mfma_f32_16x16x32_bf16 v[68:71], v[148:151], v[120:123], v[68:71]
  ds_read_b128 v[136:139], v12 offset:50176
  buffer_load_dwordx4 v9, s[12:15], s55 offen offset:1024 lds
  v_mfma_f32_16x16x32_bf16 v[84:87], v[148:151], v[124:127], v[84:87]
  ds_read_b128 v[140:143], v12 offset:51200
  v_mfma_f32_16x16x32_bf16 v[100:103], v[148:151], v[128:131], v[100:103]
  ds_read_b128 v[144:147], v12 offset:52224
  s_add_u32 m0, s38, 147456
  v_mfma_f32_16x16x32_bf16 v[56:59], v[152:155], v[116:119], v[56:59]
  ds_read_b64_tr_b16 v[164:165], v180 offset:49152
  v_mfma_f32_16x16x32_bf16 v[72:75], v[152:155], v[120:123], v[72:75]
  ds_read_b64_tr_b16 v[166:167], v181 offset:49152
  s_add_u32 s54, s54, 1024
  v_mfma_f32_16x16x32_bf16 v[88:91], v[152:155], v[124:127], v[88:91]
  ds_read_b64_tr_b16 v[168:169], v182 offset:49152
  v_mfma_f32_16x16x32_bf16 v[104:107], v[152:155], v[128:131], v[104:107]
  ds_read_b64_tr_b16 v[170:171], v183 offset:49152
  buffer_load_dwordx4 v4, s[8:11], s54 offen offset:0 sc1 lds
  s_waitcnt lgkmcnt(8)
  v_mfma_f32_16x16x32_bf16 v[60:63], v[156:159], v[116:119], v[60:63]
  ds_read_b64_tr_b16 v[172:173], v184 offset:49152
  v_mfma_f32_16x16x32_bf16 v[76:79], v[156:159], v[120:123], v[76:79]
  ds_read_b64_tr_b16 v[174:175], v185 offset:49152
  buffer_load_dwordx4 v5, s[8:11], s54 offen offset:1024 sc1 lds
  v_mfma_f32_16x16x32_bf16 v[92:95], v[156:159], v[124:127], v[92:95]
  ds_read_b64_tr_b16 v[176:177], v186 offset:49152
  v_mfma_f32_16x16x32_bf16 v[108:111], v[156:159], v[128:131], v[108:111]
  ds_read_b64_tr_b16 v[178:179], v187 offset:49152
  v_mfma_f32_16x16x32_bf16 v[64:67], v[160:163], v[116:119], v[64:67]
  v_mfma_f32_16x16x32_bf16 v[80:83], v[160:163], v[120:123], v[80:83]
  v_mfma_f32_16x16x32_bf16 v[96:99], v[160:163], v[124:127], v[96:99]
  v_mfma_f32_16x16x32_bf16 v[112:115], v[160:163], v[128:131], v[112:115]
  s_waitcnt lgkmcnt(4)
  v_mfma_f32_16x16x32_bf16 v[52:55], v[164:167], v[132:135], v[52:55]
  s_waitcnt vmcnt(16)
  s_barrier
  v_mfma_f32_16x16x32_bf16 v[68:71], v[164:167], v[136:139], v[68:71]
  ds_read_b128 v[116:119], v13 offset:0
  s_add_u32 s55, s52, 0
  s_and_b32 s55, s55, 3
  s_cmp_le_u32 s55, 1
  s_cselect_b32 s53, 14, 13
  s_lshl_b32 s54, s53, 11
  s_add_u32 s54, s54, s34
  s_lshl_b32 s55, s35, 4
  s_add_u32 s55, s55, s53
  s_lshl_b32 s55, s55, 16
  v_mfma_f32_16x16x32_bf16 v[84:87], v[164:167], v[140:143], v[84:87]
  ds_read_b128 v[120:123], v13 offset:1024
  v_mfma_f32_16x16x32_bf16 v[100:103], v[164:167], v[144:147], v[100:103]
  ds_read_b128 v[124:127], v13 offset:2048
  s_add_u32 m0, s39, 0
  v_mfma_f32_16x16x32_bf16 v[56:59], v[168:171], v[132:135], v[56:59]
  ds_read_b128 v[128:131], v13 offset:3072
  v_mfma_f32_16x16x32_bf16 v[72:75], v[168:171], v[136:139], v[72:75]
  ds_read_b64_tr_b16 v[148:149], v188 offset:0
  buffer_load_dwordx4 v8, s[12:15], s55 offen offset:0 lds
  v_mfma_f32_16x16x32_bf16 v[88:91], v[168:171], v[140:143], v[88:91]
  ds_read_b64_tr_b16 v[150:151], v189 offset:0
  v_mfma_f32_16x16x32_bf16 v[104:107], v[168:171], v[144:147], v[104:107]
  ds_read_b64_tr_b16 v[152:153], v190 offset:0
  buffer_load_dwordx4 v9, s[12:15], s55 offen offset:1024 lds
  s_waitcnt lgkmcnt(7)
  v_mfma_f32_16x16x32_bf16 v[60:63], v[172:175], v[132:135], v[60:63]
  ds_read_b64_tr_b16 v[154:155], v191 offset:0
  v_mfma_f32_16x16x32_bf16 v[76:79], v[172:175], v[136:139], v[76:79]
  ds_read_b64_tr_b16 v[156:157], v192 offset:0
  s_add_u32 m0, s38, 0
  v_mfma_f32_16x16x32_bf16 v[92:95], v[172:175], v[140:143], v[92:95]
  ds_read_b64_tr_b16 v[158:159], v193 offset:0
  v_mfma_f32_16x16x32_bf16 v[108:111], v[172:175], v[144:147], v[108:111]
  ds_read_b64_tr_b16 v[160:161], v194 offset:0
  buffer_load_dwordx4 v4, s[8:11], s54 offen offset:0 sc1 lds
  v_mfma_f32_16x16x32_bf16 v[64:67], v[176:179], v[132:135], v[64:67]
  ds_read_b64_tr_b16 v[162:163], v195 offset:0
  buffer_load_dwordx4 v5, s[8:11], s54 offen offset:1024 sc1 lds
  v_mfma_f32_16x16x32_bf16 v[80:83], v[176:179], v[136:139], v[80:83]
  s_add_u32 m0, s39, 16384
  v_mfma_f32_16x16x32_bf16 v[96:99], v[176:179], v[140:143], v[96:99]
  s_add_u32 s55, s55, 32768
  v_mfma_f32_16x16x32_bf16 v[112:115], v[176:179], v[144:147], v[112:115]
  buffer_load_dwordx4 v8, s[12:15], s55 offen offset:0 lds
  s_waitcnt lgkmcnt(4)
  v_mfma_f32_16x16x32_bf16 v[52:55], v[148:151], v[116:119], v[52:55]
  ds_read_b128 v[132:135], v13 offset:16384
  v_mfma_f32_16x16x32_bf16 v[68:71], v[148:151], v[120:123], v[68:71]
  ds_read_b128 v[136:139], v13 offset:17408
  buffer_load_dwordx4 v9, s[12:15], s55 offen offset:1024 lds
  v_mfma_f32_16x16x32_bf16 v[84:87], v[148:151], v[124:127], v[84:87]
  ds_read_b128 v[140:143], v13 offset:18432
  v_mfma_f32_16x16x32_bf16 v[100:103], v[148:151], v[128:131], v[100:103]
  ds_read_b128 v[144:147], v13 offset:19456
  s_add_u32 m0, s38, 16384
  v_mfma_f32_16x16x32_bf16 v[56:59], v[152:155], v[116:119], v[56:59]
  ds_read_b64_tr_b16 v[164:165], v188 offset:16384
  v_mfma_f32_16x16x32_bf16 v[72:75], v[152:155], v[120:123], v[72:75]
  ds_read_b64_tr_b16 v[166:167], v189 offset:16384
  s_add_u32 s54, s54, 1024
  v_mfma_f32_16x16x32_bf16 v[88:91], v[152:155], v[124:127], v[88:91]
  ds_read_b64_tr_b16 v[168:169], v190 offset:16384
  v_mfma_f32_16x16x32_bf16 v[104:107], v[152:155], v[128:131], v[104:107]
  ds_read_b64_tr_b16 v[170:171], v191 offset:16384
  buffer_load_dwordx4 v4, s[8:11], s54 offen offset:0 sc1 lds
  s_waitcnt lgkmcnt(8)
  v_mfma_f32_16x16x32_bf16 v[60:63], v[156:159], v[116:119], v[60:63]
  ds_read_b64_tr_b16 v[172:173], v192 offset:16384
  v_mfma_f32_16x16x32_bf16 v[76:79], v[156:159], v[120:123], v[76:79]
  ds_read_b64_tr_b16 v[174:175], v193 offset:16384
  buffer_load_dwordx4 v5, s[8:11], s54 offen offset:1024 sc1 lds
  v_mfma_f32_16x16x32_bf16 v[92:95], v[156:159], v[124:127], v[92:95]
  ds_read_b64_tr_b16 v[176:177], v194 offset:16384
  v_mfma_f32_16x16x32_bf16 v[108:111], v[156:159], v[128:131], v[108:111]
  ds_read_b64_tr_b16 v[178:179], v195 offset:16384
  v_mfma_f32_16x16x32_bf16 v[64:67], v[160:163], v[116:119], v[64:67]
  v_mfma_f32_16x16x32_bf16 v[80:83], v[160:163], v[120:123], v[80:83]
  v_mfma_f32_16x16x32_bf16 v[96:99], v[160:163], v[124:127], v[96:99]
  v_mfma_f32_16x16x32_bf16 v[112:115], v[160:163], v[128:131], v[112:115]
  s_waitcnt lgkmcnt(4)
  v_mfma_f32_16x16x32_bf16 v[52:55], v[164:167], v[132:135], v[52:55]
  s_waitcnt vmcnt(16)
  s_barrier
  v_mfma_f32_16x16x32_bf16 v[68:71], v[164:167], v[136:139], v[68:71]
  ds_read_b128 v[116:119], v13 offset:32768
  s_add_u32 s55, s52, 0
  s_and_b32 s55, s55, 3
  s_cmp_le_u32 s55, 2
  s_cselect_b32 s53, 15, 14
  s_lshl_b32 s54, s53, 11
  s_add_u32 s54, s54, s34
  s_lshl_b32 s55, s35, 4
  s_add_u32 s55, s55, s53
  s_lshl_b32 s55, s55, 16
  v_mfma_f32_16x16x32_bf16 v[84:87], v[164:167], v[140:143], v[84:87]
  ds_read_b128 v[120:123], v13 offset:33792
  v_mfma_f32_16x16x32_bf16 v[100:103], v[164:167], v[144:147], v[100:103]
  ds_read_b128 v[124:127], v13 offset:34816
  s_add_u32 m0, s39, 32768
  v_mfma_f32_16x16x32_bf16 v[56:59], v[168:171], v[132:135], v[56:59]
  ds_read_b128 v[128:131], v13 offset:35840
  v_mfma_f32_16x16x32_bf16 v[72:75], v[168:171], v[136:139], v[72:75]
  ds_read_b64_tr_b16 v[148:149], v188 offset:32768
  buffer_load_dwordx4 v8, s[12:15], s55 offen offset:0 lds
  v_mfma_f32_16x16x32_bf16 v[88:91], v[168:171], v[140:143], v[88:91]
  ds_read_b64_tr_b16 v[150:151], v189 offset:32768
  v_mfma_f32_16x16x32_bf16 v[104:107], v[168:171], v[144:147], v[104:107]
  ds_read_b64_tr_b16 v[152:153], v190 offset:32768
  buffer_load_dwordx4 v9, s[12:15], s55 offen offset:1024 lds
  s_waitcnt lgkmcnt(7)
  v_mfma_f32_16x16x32_bf16 v[60:63], v[172:175], v[132:135], v[60:63]
  ds_read_b64_tr_b16 v[154:155], v191 offset:32768
  v_mfma_f32_16x16x32_bf16 v[76:79], v[172:175], v[136:139], v[76:79]
  ds_read_b64_tr_b16 v[156:157], v192 offset:32768
  s_add_u32 m0, s38, 32768
  v_mfma_f32_16x16x32_bf16 v[92:95], v[172:175], v[140:143], v[92:95]
  ds_read_b64_tr_b16 v[158:159], v193 offset:32768
  v_mfma_f32_16x16x32_bf16 v[108:111], v[172:175], v[144:147], v[108:111]
  ds_read_b64_tr_b16 v[160:161], v194 offset:32768
  buffer_load_dwordx4 v4, s[8:11], s54 offen offset:0 sc1 lds
  v_mfma_f32_16x16x32_bf16 v[64:67], v[176:179], v[132:135], v[64:67]
  ds_read_b64_tr_b16 v[162:163], v195 offset:32768
  buffer_load_dwordx4 v5, s[8:11], s54 offen offset:1024 sc1 lds
  v_mfma_f32_16x16x32_bf16 v[80:83], v[176:179], v[136:139], v[80:83]
  s_add_u32 m0, s39, 49152
  v_mfma_f32_16x16x32_bf16 v[96:99], v[176:179], v[140:143], v[96:99]
  s_add_u32 s55, s55, 32768
  v_mfma_f32_16x16x32_bf16 v[112:115], v[176:179], v[144:147], v[112:115]
  buffer_load_dwordx4 v8, s[12:15], s55 offen offset:0 lds
  s_waitcnt lgkmcnt(4)
  v_mfma_f32_16x16x32_bf16 v[52:55], v[148:151], v[116:119], v[52:55]
  ds_read_b128 v[132:135], v13 offset:49152
  v_mfma_f32_16x16x32_bf16 v[68:71], v[148:151], v[120:123], v[68:71]
  ds_read_b128 v[136:139], v13 offset:50176
  buffer_load_dwordx4 v9, s[12:15], s55 offen offset:1024 lds
  v_mfma_f32_16x16x32_bf16 v[84:87], v[148:151], v[124:127], v[84:87]
  ds_read_b128 v[140:143], v13 offset:51200
  v_mfma_f32_16x16x32_bf16 v[100:103], v[148:151], v[128:131], v[100:103]
  ds_read_b128 v[144:147], v13 offset:52224
  s_add_u32 m0, s38, 49152
  v_mfma_f32_16x16x32_bf16 v[56:59], v[152:155], v[116:119], v[56:59]
  ds_read_b64_tr_b16 v[164:165], v188 offset:49152
  v_mfma_f32_16x16x32_bf16 v[72:75], v[152:155], v[120:123], v[72:75]
  ds_read_b64_tr_b16 v[166:167], v189 offset:49152
  s_add_u32 s54, s54, 1024
  v_mfma_f32_16x16x32_bf16 v[88:91], v[152:155], v[124:127], v[88:91]
  ds_read_b64_tr_b16 v[168:169], v190 offset:49152
  v_mfma_f32_16x16x32_bf16 v[104:107], v[152:155], v[128:131], v[104:107]
  ds_read_b64_tr_b16 v[170:171], v191 offset:49152
  buffer_load_dwordx4 v4, s[8:11], s54 offen offset:0 sc1 lds
  s_waitcnt lgkmcnt(8)
  v_mfma_f32_16x16x32_bf16 v[60:63], v[156:159], v[116:119], v[60:63]
  ds_read_b64_tr_b16 v[172:173], v192 offset:49152
  v_mfma_f32_16x16x32_bf16 v[76:79], v[156:159], v[120:123], v[76:79]
  ds_read_b64_tr_b16 v[174:175], v193 offset:49152
  buffer_load_dwordx4 v5, s[8:11], s54 offen offset:1024 sc1 lds
  v_mfma_f32_16x16x32_bf16 v[92:95], v[156:159], v[124:127], v[92:95]
  ds_read_b64_tr_b16 v[176:177], v194 offset:49152
  v_mfma_f32_16x16x32_bf16 v[108:111], v[156:159], v[128:131], v[108:111]
  ds_read_b64_tr_b16 v[178:179], v195 offset:49152
  v_mfma_f32_16x16x32_bf16 v[64:67], v[160:163], v[116:119], v[64:67]
  v_mfma_f32_16x16x32_bf16 v[80:83], v[160:163], v[120:123], v[80:83]
  v_mfma_f32_16x16x32_bf16 v[96:99], v[160:163], v[124:127], v[96:99]
  v_mfma_f32_16x16x32_bf16 v[112:115], v[160:163], v[128:131], v[112:115]
  s_waitcnt lgkmcnt(4)
  v_mfma_f32_16x16x32_bf16 v[52:55], v[164:167], v[132:135], v[52:55]
  s_waitcnt vmcnt(16)
  s_barrier
  v_mfma_f32_16x16x32_bf16 v[68:71], v[164:167], v[136:139], v[68:71]
  ds_read_b128 v[116:119], v14 offset:0
  v_mfma_f32_16x16x32_bf16 v[84:87], v[164:167], v[140:143], v[84:87]
  ds_read_b128 v[120:123], v14 offset:1024
  v_mfma_f32_16x16x32_bf16 v[100:103], v[164:167], v[144:147], v[100:103]
  ds_read_b128 v[124:127], v14 offset:2048
  v_mfma_f32_16x16x32_bf16 v[56:59], v[168:171], v[132:135], v[56:59]
  ds_read_b128 v[128:131], v14 offset:3072
  v_mfma_f32_16x16x32_bf16 v[72:75], v[168:171], v[136:139], v[72:75]
  ds_read_b64_tr_b16 v[148:149], v196 offset:0
  v_mfma_f32_16x16x32_bf16 v[88:91], v[168:171], v[140:143], v[88:91]
  ds_read_b64_tr_b16 v[150:151], v197 offset:0
  v_mfma_f32_16x16x32_bf16 v[104:107], v[168:171], v[144:147], v[104:107]
  ds_read_b64_tr_b16 v[152:153], v198 offset:0
  s_waitcnt lgkmcnt(7)
  v_mfma_f32_16x16x32_bf16 v[60:63], v[172:175], v[132:135], v[60:63]
  ds_read_b64_tr_b16 v[154:155], v199 offset:0
  v_mfma_f32_16x16x32_bf16 v[76:79], v[172:175], v[136:139], v[76:79]
  ds_read_b64_tr_b16 v[156:157], v200 offset:0
  v_mfma_f32_16x16x32_bf16 v[92:95], v[172:175], v[140:143], v[92:95]
  ds_read_b64_tr_b16 v[158:159], v201 offset:0
  v_mfma_f32_16x16x32_bf16 v[108:111], v[172:175], v[144:147], v[108:111]
  ds_read_b64_tr_b16 v[160:161], v202 offset:0
  v_mfma_f32_16x16x32_bf16 v[64:67], v[176:179], v[132:135], v[64:67]
  ds_read_b64_tr_b16 v[162:163], v203 offset:0
  v_mfma_f32_16x16x32_bf16 v[80:83], v[176:179], v[136:139], v[80:83]
  v_mfma_f32_16x16x32_bf16 v[96:99], v[176:179], v[140:143], v[96:99]
  v_mfma_f32_16x16x32_bf16 v[112:115], v[176:179], v[144:147], v[112:115]
  s_waitcnt lgkmcnt(4)
  v_mfma_f32_16x16x32_bf16 v[52:55], v[148:151], v[116:119], v[52:55]
  ds_read_b128 v[132:135], v14 offset:16384
  v_mfma_f32_16x16x32_bf16 v[68:71], v[148:151], v[120:123], v[68:71]
  ds_read_b128 v[136:139], v14 offset:17408
  v_mfma_f32_16x16x32_bf16 v[84:87], v[148:151], v[124:127], v[84:87]
  ds_read_b128 v[140:143], v14 offset:18432
  v_mfma_f32_16x16x32_bf16 v[100:103], v[148:151], v[128:131], v[100:103]
  ds_read_b128 v[144:147], v14 offset:19456
  v_mfma_f32_16x16x32_bf16 v[56:59], v[152:155], v[116:119], v[56:59]
  ds_read_b64_tr_b16 v[164:165], v196 offset:16384
  v_mfma_f32_16x16x32_bf16 v[72:75], v[152:155], v[120:123], v[72:75]
  ds_read_b64_tr_b16 v[166:167], v197 offset:16384
  v_mfma_f32_16x16x32_bf16 v[88:91], v[152:155], v[124:127], v[88:91]
  ds_read_b64_tr_b16 v[168:169], v198 offset:16384
  v_mfma_f32_16x16x32_bf16 v[104:107], v[152:155], v[128:131], v[104:107]
  ds_read_b64_tr_b16 v[170:171], v199 offset:16384
  s_waitcnt lgkmcnt(8)
  v_mfma_f32_16x16x32_bf16 v[60:63], v[156:159], v[116:119], v[60:63]
  ds_read_b64_tr_b16 v[172:173], v200 offset:16384
  v_mfma_f32_16x16x32_bf16 v[76:79], v[156:159], v[120:123], v[76:79]
  ds_read_b64_tr_b16 v[174:175], v201 offset:16384
  v_mfma_f32_16x16x32_bf16 v[92:95], v[156:159], v[124:127], v[92:95]
  ds_read_b64_tr_b16 v[176:177], v202 offset:16384
  v_mfma_f32_16x16x32_bf16 v[108:111], v[156:159], v[128:131], v[108:111]
  ds_read_b64_tr_b16 v[178:179], v203 offset:16384
  v_mfma_f32_16x16x32_bf16 v[64:67], v[160:163], v[116:119], v[64:67]
  v_mfma_f32_16x16x32_bf16 v[80:83], v[160:163], v[120:123], v[80:83]
  v_mfma_f32_16x16x32_bf16 v[96:99], v[160:163], v[124:127], v[96:99]
  v_mfma_f32_16x16x32_bf16 v[112:115], v[160:163], v[128:131], v[112:115]
  s_waitcnt lgkmcnt(4)
  v_mfma_f32_16x16x32_bf16 v[52:55], v[164:167], v[132:135], v[52:55]
  s_waitcnt vmcnt(8)
  s_barrier
  v_mfma_f32_16x16x32_bf16 v[68:71], v[164:167], v[136:139], v[68:71]
  ds_read_b128 v[116:119], v12 offset:0
  v_mfma_f32_16x16x32_bf16 v[84:87], v[164:167], v[140:143], v[84:87]
  ds_read_b128 v[120:123], v12 offset:1024
  v_mfma_f32_16x16x32_bf16 v[100:103], v[164:167], v[144:147], v[100:103]
  ds_read_b128 v[124:127], v12 offset:2048
  v_mfma_f32_16x16x32_bf16 v[56:59], v[168:171], v[132:135], v[56:59]
  ds_read_b128 v[128:131], v12 offset:3072
  v_mfma_f32_16x16x32_bf16 v[72:75], v[168:171], v[136:139], v[72:75]
  ds_read_b64_tr_b16 v[148:149], v180 offset:0
  v_mfma_f32_16x16x32_bf16 v[88:91], v[168:171], v[140:143], v[88:91]
  ds_read_b64_tr_b16 v[150:151], v181 offset:0
  v_mfma_f32_16x16x32_bf16 v[104:107], v[168:171], v[144:147], v[104:107]
  ds_read_b64_tr_b16 v[152:153], v182 offset:0
  s_waitcnt lgkmcnt(7)
  v_mfma_f32_16x16x32_bf16 v[60:63], v[172:175], v[132:135], v[60:63]
  ds_read_b64_tr_b16 v[154:155], v183 offset:0
  v_mfma_f32_16x16x32_bf16 v[76:79], v[172:175], v[136:139], v[76:79]
  ds_read_b64_tr_b16 v[156:157], v184 offset:0
  v_mfma_f32_16x16x32_bf16 v[92:95], v[172:175], v[140:143], v[92:95]
  ds_read_b64_tr_b16 v[158:159], v185 offset:0
  v_mfma_f32_16x16x32_bf16 v[108:111], v[172:175], v[144:147], v[108:111]
  ds_read_b64_tr_b16 v[160:161], v186 offset:0
  v_mfma_f32_16x16x32_bf16 v[64:67], v[176:179], v[132:135], v[64:67]
  ds_read_b64_tr_b16 v[162:163], v187 offset:0
  v_mfma_f32_16x16x32_bf16 v[80:83], v[176:179], v[136:139], v[80:83]
  v_mfma_f32_16x16x32_bf16 v[96:99], v[176:179], v[140:143], v[96:99]
  v_mfma_f32_16x16x32_bf16 v[112:115], v[176:179], v[144:147], v[112:115]
  s_waitcnt lgkmcnt(4)
  v_mfma_f32_16x16x32_bf16 v[52:55], v[148:151], v[116:119], v[52:55]
  ds_read_b128 v[132:135], v12 offset:16384
  v_mfma_f32_16x16x32_bf16 v[68:71], v[148:151], v[120:123], v[68:71]
  ds_read_b128 v[136:139], v12 offset:17408
  v_mfma_f32_16x16x32_bf16 v[84:87], v[148:151], v[124:127], v[84:87]
  ds_read_b128 v[140:143], v12 offset:18432
  v_mfma_f32_16x16x32_bf16 v[100:103], v[148:151], v[128:131], v[100:103]
  ds_read_b128 v[144:147], v12 offset:19456
  v_mfma_f32_16x16x32_bf16 v[56:59], v[152:155], v[116:119], v[56:59]
  ds_read_b64_tr_b16 v[164:165], v180 offset:16384
  v_mfma_f32_16x16x32_bf16 v[72:75], v[152:155], v[120:123], v[72:75]
  ds_read_b64_tr_b16 v[166:167], v181 offset:16384
  v_mfma_f32_16x16x32_bf16 v[88:91], v[152:155], v[124:127], v[88:91]
  ds_read_b64_tr_b16 v[168:169], v182 offset:16384
  v_mfma_f32_16x16x32_bf16 v[104:107], v[152:155], v[128:131], v[104:107]
  ds_read_b64_tr_b16 v[170:171], v183 offset:16384
  s_waitcnt lgkmcnt(8)
  v_mfma_f32_16x16x32_bf16 v[60:63], v[156:159], v[116:119], v[60:63]
  ds_read_b64_tr_b16 v[172:173], v184 offset:16384
  v_mfma_f32_16x16x32_bf16 v[76:79], v[156:159], v[120:123], v[76:79]
  ds_read_b64_tr_b16 v[174:175], v185 offset:16384
  v_mfma_f32_16x16x32_bf16 v[92:95], v[156:159], v[124:127], v[92:95]
  ds_read_b64_tr_b16 v[176:177], v186 offset:16384
  v_mfma_f32_16x16x32_bf16 v[108:111], v[156:159], v[128:131], v[108:111]
  ds_read_b64_tr_b16 v[178:179], v187 offset:16384
  v_mfma_f32_16x16x32_bf16 v[64:67], v[160:163], v[116:119], v[64:67]
  v_mfma_f32_16x16x32_bf16 v[80:83], v[160:163], v[120:123], v[80:83]
  v_mfma_f32_16x16x32_bf16 v[96:99], v[160:163], v[124:127], v[96:99]
  v_mfma_f32_16x16x32_bf16 v[112:115], v[160:163], v[128:131], v[112:115]
  s_waitcnt lgkmcnt(4)
  v_mfma_f32_16x16x32_bf16 v[52:55], v[164:167], v[132:135], v[52:55]
  s_waitcnt vmcnt(0)
  s_barrier
  v_mfma_f32_16x16x32_bf16 v[68:71], v[164:167], v[136:139], v[68:71]
  ds_read_b128 v[116:119], v12 offset:32768
  v_mfma_f32_16x16x32_bf16 v[84:87], v[164:167], v[140:143], v[84:87]
  ds_read_b128 v[120:123], v12 offset:33792
  v_mfma_f32_16x16x32_bf16 v[100:103], v[164:167], v[144:147], v[100:103]
  ds_read_b128 v[124:127], v12 offset:34816
  v_mfma_f32_16x16x32_bf16 v[56:59], v[168:171], v[132:135], v[56:59]
  ds_read_b128 v[128:131], v12 offset:35840
  v_mfma_f32_16x16x32_bf16 v[72:75], v[168:171], v[136:139], v[72:75]
  ds_read_b64_tr_b16 v[148:149], v180 offset:32768
  v_mfma_f32_16x16x32_bf16 v[88:91], v[168:171], v[140:143], v[88:91]
  ds_read_b64_tr_b16 v[150:151], v181 offset:32768
  v_mfma_f32_16x16x32_bf16 v[104:107], v[168:171], v[144:147], v[104:107]
  ds_read_b64_tr_b16 v[152:153], v182 offset:32768
  s_waitcnt lgkmcnt(7)
  v_mfma_f32_16x16x32_bf16 v[60:63], v[172:175], v[132:135], v[60:63]
  ds_read_b64_tr_b16 v[154:155], v183 offset:32768
  v_mfma_f32_16x16x32_bf16 v[76:79], v[172:175], v[136:139], v[76:79]
  ds_read_b64_tr_b16 v[156:157], v184 offset:32768
  v_mfma_f32_16x16x32_bf16 v[92:95], v[172:175], v[140:143], v[92:95]
  ds_read_b64_tr_b16 v[158:159], v185 offset:32768
  v_mfma_f32_16x16x32_bf16 v[108:111], v[172:175], v[144:147], v[108:111]
  ds_read_b64_tr_b16 v[160:161], v186 offset:32768
  v_mfma_f32_16x16x32_bf16 v[64:67], v[176:179], v[132:135], v[64:67]
  ds_read_b64_tr_b16 v[162:163], v187 offset:32768
  v_mfma_f32_16x16x32_bf16 v[80:83], v[176:179], v[136:139], v[80:83]
  v_mfma_f32_16x16x32_bf16 v[96:99], v[176:179], v[140:143], v[96:99]
  v_mfma_f32_16x16x32_bf16 v[112:115], v[176:179], v[144:147], v[112:115]
  s_waitcnt lgkmcnt(4)
  v_mfma_f32_16x16x32_bf16 v[52:55], v[148:151], v[116:119], v[52:55]
  ds_read_b128 v[132:135], v12 offset:49152
  v_mfma_f32_16x16x32_bf16 v[68:71], v[148:151], v[120:123], v[68:71]
  ds_read_b128 v[136:139], v12 offset:50176
  v_mfma_f32_16x16x32_bf16 v[84:87], v[148:151], v[124:127], v[84:87]
  ds_read_b128 v[140:143], v12 offset:51200
  v_mfma_f32_16x16x32_bf16 v[100:103], v[148:151], v[128:131], v[100:103]
  ds_read_b128 v[144:147], v12 offset:52224
  v_mfma_f32_16x16x32_bf16 v[56:59], v[152:155], v[116:119], v[56:59]
  ds_read_b64_tr_b16 v[164:165], v180 offset:49152
  v_mfma_f32_16x16x32_bf16 v[72:75], v[152:155], v[120:123], v[72:75]
  ds_read_b64_tr_b16 v[166:167], v181 offset:49152
  v_mfma_f32_16x16x32_bf16 v[88:91], v[152:155], v[124:127], v[88:91]
  ds_read_b64_tr_b16 v[168:169], v182 offset:49152
  v_mfma_f32_16x16x32_bf16 v[104:107], v[152:155], v[128:131], v[104:107]
  ds_read_b64_tr_b16 v[170:171], v183 offset:49152
  s_waitcnt lgkmcnt(8)
  v_mfma_f32_16x16x32_bf16 v[60:63], v[156:159], v[116:119], v[60:63]
  ds_read_b64_tr_b16 v[172:173], v184 offset:49152
  v_mfma_f32_16x16x32_bf16 v[76:79], v[156:159], v[120:123], v[76:79]
  ds_read_b64_tr_b16 v[174:175], v185 offset:49152
  v_mfma_f32_16x16x32_bf16 v[92:95], v[156:159], v[124:127], v[92:95]
  ds_read_b64_tr_b16 v[176:177], v186 offset:49152
  v_mfma_f32_16x16x32_bf16 v[108:111], v[156:159], v[128:131], v[108:111]
  ds_read_b64_tr_b16 v[178:179], v187 offset:49152
  v_mfma_f32_16x16x32_bf16 v[64:67], v[160:163], v[116:119], v[64:67]
  v_mfma_f32_16x16x32_bf16 v[80:83], v[160:163], v[120:123], v[80:83]
  v_mfma_f32_16x16x32_bf16 v[96:99], v[160:163], v[124:127], v[96:99]
  v_mfma_f32_16x16x32_bf16 v[112:115], v[160:163], v[128:131], v[112:115]
  s_waitcnt lgkmcnt(4)
  v_mfma_f32_16x16x32_bf16 v[52:55], v[164:167], v[132:135], v[52:55]
  v_mfma_f32_16x16x32_bf16 v[68:71], v[164:167], v[136:139], v[68:71]
  v_mfma_f32_16x16x32_bf16 v[84:87], v[164:167], v[140:143], v[84:87]
  v_mfma_f32_16x16x32_bf16 v[100:103], v[164:167], v[144:147], v[100:103]
  v_mfma_f32_16x16x32_bf16 v[56:59], v[168:171], v[132:135], v[56:59]
  v_mfma_f32_16x16x32_bf16 v[72:75], v[168:171], v[136:139], v[72:75]
  v_mfma_f32_16x16x32_bf16 v[88:91], v[168:171], v[140:143], v[88:91]
  v_mfma_f32_16x16x32_bf16 v[104:107], v[168:171], v[144:147], v[104:107]
  s_waitcnt lgkmcnt(0)
  v_mfma_f32_16x16x32_bf16 v[60:63], v[172:175], v[132:135], v[60:63]
  v_mfma_f32_16x16x32_bf16 v[76:79], v[172:175], v[136:139], v[76:79]
  v_mfma_f32_16x16x32_bf16 v[92:95], v[172:175], v[140:143], v[92:95]
  v_mfma_f32_16x16x32_bf16 v[108:111], v[172:175], v[144:147], v[108:111]
  v_mfma_f32_16x16x32_bf16 v[64:67], v[176:179], v[132:135], v[64:67]
  v_mfma_f32_16x16x32_bf16 v[80:83], v[176:179], v[136:139], v[80:83]
  v_mfma_f32_16x16x32_bf16 v[96:99], v[176:179], v[140:143], v[96:99]
  v_mfma_f32_16x16x32_bf16 v[112:115], v[176:179], v[144:147], v[112:115]
  s_nop 7
  s_cmp_eq_u32 s35, 0
  s_cbranch_scc1 k3_kernel_own2
  v_cvt_pk_bf16_f32 v52, v52, v53
  v_cvt_pk_bf16_f32 v53, v54, v55
  v_cvt_pk_bf16_f32 v54, v56, v57
  v_cvt_pk_bf16_f32 v55, v58, v59
  v_cvt_pk_bf16_f32 v56, v60, v61
  v_cvt_pk_bf16_f32 v57, v62, v63
  v_cvt_pk_bf16_f32 v58, v64, v65
  v_cvt_pk_bf16_f32 v59, v66, v67
  buffer_store_dwordx4 v[52:55], v2, s[8:11], s56 offen offset:0 sc1
  buffer_store_dwordx4 v[56:59], v2, s[8:11], s56 offen offset:1024 sc1
  s_branch k3_kernel_nxt3
k3_kernel_own2:
  v_mov_b32 v148, v52
  v_mov_b32 v149, v53
  v_mov_b32 v150, v54
  v_mov_b32 v151, v55
  v_mov_b32 v152, v56
  v_mov_b32 v153, v57
  v_mov_b32 v154, v58
  v_mov_b32 v155, v59
  v_mov_b32 v156, v60
  v_mov_b32 v157, v61
  v_mov_b32 v158, v62
  v_mov_b32 v159, v63
  v_mov_b32 v160, v64
  v_mov_b32 v161, v65
  v_mov_b32 v162, v66
  v_mov_b32 v163, v67
k3_kernel_nxt3:
  s_cmp_eq_u32 s35, 1
  s_cbranch_scc1 k3_kernel_own4
  v_cvt_pk_bf16_f32 v68, v68, v69
  v_cvt_pk_bf16_f32 v69, v70, v71
  v_cvt_pk_bf16_f32 v70, v72, v73
  v_cvt_pk_bf16_f32 v71, v74, v75
  v_cvt_pk_bf16_f32 v72, v76, v77
  v_cvt_pk_bf16_f32 v73, v78, v79
  v_cvt_pk_bf16_f32 v74, v80, v81
  v_cvt_pk_bf16_f32 v75, v82, v83
  buffer_store_dwordx4 v[68:71], v2, s[8:11], s56 offen offset:2048 sc1
  buffer_store_dwordx4 v[72:75], v2, s[8:11], s56 offen offset:3072 sc1
  s_branch k3_kernel_nxt5
k3_kernel_own4:
  v_mov_b32 v148, v68
  v_mov_b32 v149, v69
  v_mov_b32 v150, v70
  v_mov_b32 v151, v71
  v_mov_b32 v152, v72
  v_mov_b32 v153, v73
  v_mov_b32 v154, v74
  v_mov_b32 v155, v75
  v_mov_b32 v156, v76
  v_mov_b32 v157, v77
  v_mov_b32 v158, v78
  v_mov_b32 v159, v79
  v_mov_b32 v160, v80
  v_mov_b32 v161, v81
  v_mov_b32 v162, v82
  v_mov_b32 v163, v83
k3_kernel_nxt5:
  s_cmp_eq_u32 s35, 2
  s_cbranch_scc1 k3_kernel_own6
  v_cvt_pk_bf16_f32 v84, v84, v85
  v_cvt_pk_bf16_f32 v85, v86, v87
  v_cvt_pk_bf16_f32 v86, v88, v89
  v_cvt_pk_bf16_f32 v87, v90, v91
  v_cvt_pk_bf16_f32 v88, v92, v93
  v_cvt_pk_bf16_f32 v89, v94, v95
  v_cvt_pk_bf16_f32 v90, v96, v97
  v_cvt_pk_bf16_f32 v91, v98, v99
  s_add_u32 s31, s56, 4096
  buffer_store_dwordx4 v[84:87], v2, s[8:11], s31 offen offset:0 sc1
  buffer_store_dwordx4 v[88:91], v2, s[8:11], s31 offen offset:1024 sc1
  s_branch k3_kernel_nxt7
k3_kernel_own6:
  v_mov_b32 v148, v84
  v_mov_b32 v149, v85
  v_mov_b32 v150, v86
  v_mov_b32 v151, v87
  v_mov_b32 v152, v88
  v_mov_b32 v153, v89
  v_mov_b32 v154, v90
  v_mov_b32 v155, v91
  v_mov_b32 v156, v92
  v_mov_b32 v157, v93
  v_mov_b32 v158, v94
  v_mov_b32 v159, v95
  v_mov_b32 v160, v96
  v_mov_b32 v161, v97
  v_mov_b32 v162, v98
  v_mov_b32 v163, v99
k3_kernel_nxt7:
  s_cmp_eq_u32 s35, 3
  s_cbranch_scc1 k3_kernel_own8
  v_cvt_pk_bf16_f32 v100, v100, v101
  v_cvt_pk_bf16_f32 v101, v102, v103
  v_cvt_pk_bf16_f32 v102, v104, v105
  v_cvt_pk_bf16_f32 v103, v106, v107
  v_cvt_pk_bf16_f32 v104, v108, v109
  v_cvt_pk_bf16_f32 v105, v110, v111
  v_cvt_pk_bf16_f32 v106, v112, v113
  v_cvt_pk_bf16_f32 v107, v114, v115
  s_add_u32 s31, s56, 4096
  buffer_store_dwordx4 v[100:103], v2, s[8:11], s31 offen offset:2048 sc1
  buffer_store_dwordx4 v[104:107], v2, s[8:11], s31 offen offset:3072 sc1
  s_branch k3_kernel_nxt9
k3_kernel_own8:
  v_mov_b32 v148, v100
  v_mov_b32 v149, v101
  v_mov_b32 v150, v102
  v_mov_b32 v151, v103
  v_mov_b32 v152, v104
  v_mov_b32 v153, v105
  v_mov_b32 v154, v106
  v_mov_b32 v155, v107
  v_mov_b32 v156, v108
  v_mov_b32 v157, v109
  v_mov_b32 v158, v110
  v_mov_b32 v159, v111
  v_mov_b32 v160, v112
  v_mov_b32 v161, v113
  v_mov_b32 v162, v114
  v_mov_b32 v163, v115
k3_kernel_nxt9:
  v_lshlrev_b32 v180, 16, v34
  v_and_b32 v181, 0xffff0000, v34
  v_lshlrev_b32 v196, 16, v42
  v_and_b32 v197, 0xffff0000, v42
  v_lshlrev_b32 v182, 16, v35
  v_and_b32 v183, 0xffff0000, v35
  v_lshlrev_b32 v198, 16, v43
  v_and_b32 v199, 0xffff0000, v43
  v_lshlrev_b32 v184, 16, v36
  v_and_b32 v185, 0xffff0000, v36
  v_lshlrev_b32 v200, 16, v44
  v_and_b32 v201, 0xffff0000, v44
  v_lshlrev_b32 v186, 16, v37
  v_and_b32 v187, 0xffff0000, v37
  v_lshlrev_b32 v202, 16, v45
  v_and_b32 v203, 0xffff0000, v45
  v_lshlrev_b32 v188, 16, v38
  v_and_b32 v189, 0xffff0000, v38
  v_lshlrev_b32 v204, 16, v46
  v_and_b32 v205, 0xffff0000, v46
  v_lshlrev_b32 v190, 16, v39
  v_and_b32 v191, 0xffff0000, v39
  v_lshlrev_b32 v206, 16, v47
  v_and_b32 v207, 0xffff0000, v47
  v_lshlrev_b32 v192, 16, v40
  v_and_b32 v193, 0xffff0000, v40
  v_lshlrev_b32 v208, 16, v48
  v_and_b32 v209, 0xffff0000, v48
  v_lshlrev_b32 v194, 16, v41
  v_and_b32 v195, 0xffff0000, v41
  v_lshlrev_b32 v210, 16, v49
  v_and_b32 v211, 0xffff0000, v49
  v_pk_add_f32 v[148:149], v[148:149], v[180:181]
  v_pk_add_f32 v[148:149], v[148:149], v[196:197]
  v_pk_add_f32 v[150:151], v[150:151], v[182:183]
  v_pk_add_f32 v[150:151], v[150:151], v[198:199]
  v_pk_add_f32 v[152:153], v[152:153], v[184:185]
  v_pk_add_f32 v[152:153], v[152:153], v[200:201]
  v_pk_add_f32 v[154:155], v[154:155], v[186:187]
  v_pk_add_f32 v[154:155], v[154:155], v[202:203]
  v_pk_add_f32 v[156:157], v[156:157], v[188:189]
  v_pk_add_f32 v[156:157], v[156:157], v[204:205]
  v_pk_add_f32 v[158:159], v[158:159], v[190:191]
  v_pk_add_f32 v[158:159], v[158:159], v[206:207]
  v_pk_add_f32 v[160:161], v[160:161], v[192:193]
  v_pk_add_f32 v[160:161], v[160:161], v[208:209]
  v_pk_add_f32 v[162:163], v[162:163], v[194:195]
  v_pk_add_f32 v[162:163], v[162:163], v[210:211]
  s_lshl_b32 s31, s58, 8
  s_add_u32 s31, s31, 61865984
  s_lshl_b32 s33, s35, 2
  s_add_u32 s33, s33, s31
  v_and_b32 v16, 3, v1
  v_lshlrev_b32 v16, 2, v16
  v_mov_b32 v116, 0
  v_mov_b32 v117, 0
  v_mov_b32 v118, 0
  v_mov_b32 v119, 0
  v_mov_b32 v120, 0
  v_mov_b32 v121, 0
  v_mov_b32 v122, 0
  v_mov_b32 v123, 0
  v_mov_b32 v124, 0
  v_mov_b32 v125, 0
  v_mov_b32 v126, 0
  v_mov_b32 v127, 0
  v_mov_b32 v128, 0
  v_mov_b32 v129, 0
  v_mov_b32 v130, 0
  v_mov_b32 v131, 0
  v_mov_b32 v132, 0
  v_mov_b32 v133, 0
  v_mov_b32 v134, 0
  v_mov_b32 v135, 0
  v_mov_b32 v136, 0
  v_mov_b32 v137, 0
  v_mov_b32 v138, 0
  v_mov_b32 v139, 0
  v_mov_b32 v140, 0
  v_mov_b32 v141, 0
  v_mov_b32 v142, 0
  v_mov_b32 v143, 0
  v_mov_b32 v144, 0
  v_mov_b32 v145, 0
  v_mov_b32 v146, 0
  v_mov_b32 v147, 0
  s_waitcnt vmcnt(0)
  s_barrier
  v_mov_b32 v52, 0
  v_mov_b32 v53, 1
  s_cmp_lg_u32 s28, 0
  s_cbranch_scc1 k3_kernel_skip110
  s_mov_b64 exec, 1
  buffer_store_dword v53, v52, s[8:11], s33 offen sc1
  s_mov_b64 exec, -1
k3_kernel_skip110:
  buffer_load_dword v15, v16, s[8:11], s31 offen sc1
  s_waitcnt vmcnt(0)
  s_mov_b32 s32, 0
k3_sx_again:
  v_cmp_ne_u32 vcc, 1, v15
  s_cmp_gt_u32 s32, 400000
  s_cbranch_scc1 k3_sx_done
  s_cbranch_vccz k3_sx_done
  s_sleep 1
  buffer_load_dword v15, v16, s[8:11], s31 offen sc1
  s_add_u32 s32, s32, 1
  s_waitcnt vmcnt(0)
  s_branch k3_sx_again
k3_sx_done:
  s_cmp_eq_u32 s35, 0
  s_cbranch_scc1 k3_kernel_skp11
  buffer_load_dwordx4 v[116:119], v2, s[8:11], s57 offen offset:0 sc1
  buffer_load_dwordx4 v[120:123], v2, s[8:11], s57 offen offset:1024 sc1
k3_kernel_skp11:
  s_add_u32 s57, s57, 32768
  s_cmp_eq_u32 s35, 1
  s_cbranch_scc1 k3_kernel_skp12
  buffer_load_dwordx4 v[124:127], v2, s[8:11], s57 offen offset:0 sc1
  buffer_load_dwordx4 v[128:131], v2, s[8:11], s57 offen offset:1024 sc1
k3_kernel_skp12:
  s_add_u32 s57, s57, 32768
  s_cmp_eq_u32 s35, 2
  s_cbranch_scc1 k3_kernel_skp13
  buffer_load_dwordx4 v[132:135], v2, s[8:11], s57 offen offset:0 sc1
  buffer_load_dwordx4 v[136:139], v2, s[8:11], s57 offen offset:1024 sc1
k3_kernel_skp13:
  s_add_u32 s57, s57, 32768
  s_cmp_eq_u32 s35, 3
  s_cbranch_scc1 k3_kernel_skp14
  buffer_load_dwordx4 v[140:143], v2, s[8:11], s57 offen offset:0 sc1
  buffer_load_dwordx4 v[144:147], v2, s[8:11], s57 offen offset:1024 sc1
k3_kernel_skp14:
  s_add_u32 s57, s57, 32768
  s_waitcnt vmcnt(0)
  v_lshlrev_b32 v180, 16, v116
  v_and_b32 v181, 0xffff0000, v116
  v_pk_add_f32 v[148:149], v[148:149], v[180:181]
  v_lshlrev_b32 v182, 16, v117
  v_and_b32 v183, 0xffff0000, v117
  v_pk_add_f32 v[150:151], v[150:151], v[182:183]
  v_lshlrev_b32 v184, 16, v118
  v_and_b32 v185, 0xffff0000, v118
  v_pk_add_f32 v[152:153], v[152:153], v[184:185]
  v_lshlrev_b32 v186, 16, v119
  v_and_b32 v187, 0xffff0000, v119
  v_pk_add_f32 v[154:155], v[154:155], v[186:187]
  v_lshlrev_b32 v180, 16, v120
  v_and_b32 v181, 0xffff0000, v120
  v_pk_add_f32 v[156:157], v[156:157], v[180:181]
  v_lshlrev_b32 v182, 16, v121
  v_and_b32 v183, 0xffff0000, v121
  v_pk_add_f32 v[158:159], v[158:159], v[182:183]
  v_lshlrev_b32 v184, 16, v122
  v_and_b32 v185, 0xffff0000, v122
  v_pk_add_f32 v[160:161], v[160:161], v[184:185]
  v_lshlrev_b32 v186, 16, v123
  v_and_b32 v187, 0xffff0000, v123
  v_pk_add_f32 v[162:163], v[162:163], v[186:187]
  v_lshlrev_b32 v180, 16, v124
  v_and_b32 v181, 0xffff0000, v124
  v_pk_add_f32 v[148:149], v[148:149], v[180:181]
  v_lshlrev_b32 v182, 16, v125
  v_and_b32 v183, 0xffff0000, v125
  v_pk_add_f32 v[150:151], v[150:151], v[182:183]
  v_lshlrev_b32 v184, 16, v126
  v_and_b32 v185, 0xffff0000, v126
  v_pk_add_f32 v[152:153], v[152:153], v[184:185]
  v_lshlrev_b32 v186, 16, v127
  v_and_b32 v187, 0xffff0000, v127
  v_pk_add_f32 v[154:155], v[154:155], v[186:187]
  v_lshlrev_b32 v180, 16, v128
  v_and_b32 v181, 0xffff0000, v128
  v_pk_add_f32 v[156:157], v[156:157], v[180:181]
  v_lshlrev_b32 v182, 16, v129
  v_and_b32 v183, 0xffff0000, v129
  v_pk_add_f32 v[158:159], v[158:159], v[182:183]
  v_lshlrev_b32 v184, 16, v130
  v_and_b32 v185, 0xffff0000, v130
  v_pk_add_f32 v[160:161], v[160:161], v[184:185]
  v_lshlrev_b32 v186, 16, v131
  v_and_b32 v187, 0xffff0000, v131
  v_pk_add_f32 v[162:163], v[162:163], v[186:187]
  v_lshlrev_b32 v180, 16, v132
  v_and_b32 v181, 0xffff0000, v132
  v_pk_add_f32 v[148:149], v[148:149], v[180:181]
  v_lshlrev_b32 v182, 16, v133
  v_and_b32 v183, 0xffff0000, v133
  v_pk_add_f32 v[150:151], v[150:151], v[182:183]
  v_lshlrev_b32 v184, 16, v134
  v_and_b32 v185, 0xffff0000, v134
  v_pk_add_f32 v[152:153], v[152:153], v[184:185]
  v_lshlrev_b32 v186, 16, v135
  v_and_b32 v187, 0xffff0000, v135
  v_pk_add_f32 v[154:155], v[154:155], v[186:187]
  v_lshlrev_b32 v180, 16, v136
  v_and_b32 v181, 0xffff0000, v136
  v_pk_add_f32 v[156:157], v[156:157], v[180:181]
  v_lshlrev_b32 v182, 16, v137
  v_and_b32 v183, 0xffff0000, v137
  v_pk_add_f32 v[158:159], v[158:159], v[182:183]
  v_lshlrev_b32 v184, 16, v138
  v_and_b32 v185, 0xffff0000, v138
  v_pk_add_f32 v[160:161], v[160:161], v[184:185]
  v_lshlrev_b32 v186, 16, v139
  v_and_b32 v187, 0xffff0000, v139
  v_pk_add_f32 v[162:163], v[162:163], v[186:187]
  v_lshlrev_b32 v180, 16, v140
  v_and_b32 v181, 0xffff0000, v140
  v_pk_add_f32 v[148:149], v[148:149], v[180:181]
  v_lshlrev_b32 v182, 16, v141
  v_and_b32 v183, 0xffff0000, v141
  v_pk_add_f32 v[150:151], v[150:151], v[182:183]
  v_lshlrev_b32 v184, 16, v142
  v_and_b32 v185, 0xffff0000, v142
  v_pk_add_f32 v[152:153], v[152:153], v[184:185]
  v_lshlrev_b32 v186, 16, v143
  v_and_b32 v187, 0xffff0000, v143
  v_pk_add_f32 v[154:155], v[154:155], v[186:187]
  v_lshlrev_b32 v180, 16, v144
  v_and_b32 v181, 0xffff0000, v144
  v_pk_add_f32 v[156:157], v[156:157], v[180:181]
  v_lshlrev_b32 v182, 16, v145
  v_and_b32 v183, 0xffff0000, v145
  v_pk_add_f32 v[158:159], v[158:159], v[182:183]
  v_lshlrev_b32 v184, 16, v146
  v_and_b32 v185, 0xffff0000, v146
  v_pk_add_f32 v[160:161], v[160:161], v[184:185]
  v_lshlrev_b32 v186, 16, v147
  v_and_b32 v187, 0xffff0000, v147
  v_pk_add_f32 v[162:163], v[162:163], v[186:187]
  v_cvt_pk_bf16_f32 v148, v148, v149
  v_cvt_pk_bf16_f32 v149, v150, v151
  v_cvt_pk_bf16_f32 v150, v152, v153
  v_cvt_pk_bf16_f32 v151, v154, v155
  v_cvt_pk_bf16_f32 v156, v156, v157
  v_cvt_pk_bf16_f32 v157, v158, v159
  v_cvt_pk_bf16_f32 v158, v160, v161
  v_cvt_pk_bf16_f32 v159, v162, v163
  v_mul_u32_u24 v15, 24, v30
  v_add_u32 v32, v32, v15
  v_permlane16_swap_b32 v148, v150
  v_permlane16_swap_b32 v149, v151
  buffer_store_dwordx4 v[148:151], v32, s[20:23], 0 offen offset:0
  v_permlane16_swap_b32 v156, v158
  v_permlane16_swap_b32 v157, v159
  buffer_store_dwordx4 v[156:159], v32, s[20:23], 0 offen offset:64
k3_end:
  s_endpgm
.section .rodata,"a"
.p2align 6
.amdhsa_kernel parallel_sum__compressed_kv_cla__mixer_channel_mlp__prompt_kernel
  .amdhsa_next_free_vgpr 512
  .amdhsa_next_free_sgpr 102
  .amdhsa_accum_offset 256
  .amdhsa_group_segment_fixed_size 0
  .amdhsa_kernarg_size 112
  .amdhsa_user_sgpr_count 2
  .amdhsa_user_sgpr_kernarg_segment_ptr 1
  .amdhsa_system_sgpr_workgroup_id_x 1
  .amdhsa_float_denorm_mode_32 3
.end_amdhsa_kernel
```
